```python
import torch

def _softmax(x, axis=-1):
    return torch.softmax(x, dim=axis)

def _gelu(x):
    return torch.nn.functional.gelu(x, approximate='tanh')

def _silu(x):
    return torch.nn.functional.silu(x)

def _sigmoid(x):
    return torch.sigmoid(x)

def _layernorm(x, axis=-1, eps=1e-05):
    m = x.mean(dim=axis, keepdim=True)
    v = x.var(dim=axis, keepdim=True, unbiased=False)
    return (x - m) / torch.sqrt(v + eps)

def _scatter_add(tgt, idx, src, axis=0):
    return tgt.clone().index_add_(axis, idx, src)

def _segment_sum(src, seg, n):
    out = torch.zeros((n,) + src.shape[1:], dtype=src.dtype)
    return out.index_add_(0, seg, src)

def _pad(x, pw):
    flat = tuple((v for pair in reversed(pw) for v in pair))
    return torch.nn.functional.pad(x, flat)
kernel_name = 'concat_heads__linear_kernel_hedgehog__memory_aug_recurrent_mem_tr__prompt'

def setup_inputs():

    _w = lambda a: (lambda t: t.to(torch.bfloat16) if t.is_floating_point() else t)(torch.as_tensor(a))

    def _A_setup():
        B, S, D, H = (1, 2048, 512, 32)
        Dh = D // H
        return {'x': _w((lambda *s: torch.randn(*s, dtype=torch.bfloat16) * 0.8)(B, S, D)), 'wqkv': _w((lambda *s: torch.randn(*s, dtype=torch.bfloat16) * 0.8)(D, 3 * D)), 'w_phi': _w((lambda *s: torch.randn(*s, dtype=torch.bfloat16) * 0.8)(H, Dh, Dh) * Dh ** (-0.5)), 'wo': _w((lambda *s: torch.randn(*s, dtype=torch.bfloat16) * 0.05)(D, D))}
    _A_in = _A_setup()

    def _B_setup():
        B, S, Dm = (1, 2048, 512)
        H, Dh = (32, 128)
        M, seg = (8, 32)
        seg = min(seg, S)
        S = S // seg * seg
        return {'x': _w((lambda *s: torch.randn(*s, dtype=torch.bfloat16) * 0.05)(B, S, Dm)), 'mem0': _w((lambda *s: torch.randn(*s, dtype=torch.bfloat16) * 1.6)(B, M, Dm)), 'Wq': _w((lambda *s: torch.randn(*s, dtype=torch.bfloat16) * 0.8)(Dm, H, Dh) * Dm ** (-0.5)), 'Wk': _w((lambda *s: torch.randn(*s, dtype=torch.bfloat16) * 0.8)(Dm, H, Dh) * Dm ** (-0.5)), 'Wv': _w((lambda *s: torch.randn(*s, dtype=torch.bfloat16) * 1.6)(Dm, H, Dh) * Dm ** (-0.5)), 'Wo': _w((lambda *s: torch.randn(*s, dtype=torch.bfloat16) * 1.6)(H, Dh, Dm) * (H * Dh) ** (-0.5)), 'seg_len': seg}
    _B_in = _B_setup()
    return {'A_x': _A_in['x'], 'A_wqkv': _A_in['wqkv'], 'A_w_phi': _A_in['w_phi'], 'A_wo': _A_in['wo'], 'B_x': _B_in['x'], 'B_mem0': _B_in['mem0'], 'B_Wq': _B_in['Wq'], 'B_Wk': _B_in['Wk'], 'B_Wv': _B_in['Wv'], 'B_Wo': _B_in['Wo'], 'B_seg_len': _B_in['seg_len']}

def reference(A_x, A_wqkv, A_w_phi, A_wo, B_x, B_mem0, B_Wq, B_Wk, B_Wv, B_Wo, B_seg_len):

    def _A_ref(x, wqkv, w_phi, wo):
        B, S, D = x.shape
        H = 32
        Dh = D // H
        qkv = (lambda x, *d: x.permute(*d))((x @ wqkv).reshape(B, S, 3, H, Dh), 2, 0, 3, 1, 4)
        q, k, v = (qkv[0], qkv[1], qkv[2])
        pq = torch.einsum('bhsd,hdf->bhsf', q, w_phi)
        pk = torch.einsum('bhsd,hdf->bhsf', k, w_phi)
        phi_q = torch.concatenate([_softmax(pq, axis=-1), _softmax(-pq, axis=-1)], axis=-1)
        phi_k = torch.concatenate([_softmax(pk, axis=-1), _softmax(-pk, axis=-1)], axis=-1)
        kv = torch.einsum('bhsf,bhsd->bhfd', phi_k, v)
        z = torch.einsum('bhsf->bhf', phi_k)
        num = torch.einsum('bhqf,bhfd->bhqd', phi_q, kv)
        den = torch.einsum('bhqf,bhf->bhq', phi_q, z)[..., None] + 1e-06
        o = num / den
        return (lambda x, *d: x.permute(*d))(o, 0, 2, 1, 3).reshape(B, S, D) @ wo

    def _B_ref(x, mem0, Wq, Wk, Wv, Wo, seg_len):
        B, S, Dm = x.shape
        H, Dh = (Wq.shape[1], Wq.shape[2])
        M = mem0.shape[1]
        scale = Dh ** (-0.5)
        n_seg = S // seg_len
        L = M + seg_len
        idx = torch.arange(L)
        mask = (idx[:, None] < M) | (idx[:, None] >= idx[None, :])
        mem = mem0
        outs = []
        for s in range(n_seg):
            xs = x[:, s * seg_len:(s + 1) * seg_len, :].clone()
            h = torch.concatenate([mem, xs], axis=1)
            q = torch.einsum('btd,dhe->bhte', h, Wq)
            k = torch.einsum('btd,dhe->bhte', h, Wk)
            v = torch.einsum('btd,dhe->bhte', h, Wv)
            scores = torch.einsum('bhqe,bhke->bhqk', q, k) * scale
            scores = torch.where(mask[None, None], scores, -1000000000.0)
            p = _softmax(scores, axis=-1)
            o = torch.einsum('bhqk,bhke->bhqe', p, v)
            o = torch.einsum('bhte,hed->btd', o, Wo)
            mem = o[:, :M, :].clone()
            outs.append(o[:, M:, :])
        return torch.concatenate(outs, axis=1)
    a = _A_ref(A_x, A_wqkv, A_w_phi, A_wo)
    b = _B_ref(B_x, B_mem0, B_Wq, B_Wk, B_Wv, B_Wo, B_seg_len)
    return torch.concatenate([a, b], axis=-1)
```

```asm
; @launch grid=(256,1,1) block=(256,1,1) lds=163840
.amdgcn_target "amdgcn-amd-amdhsa--gfx950"
.text
.globl concat_heads__linear_kernel_hedgehog__memory_aug_recurrent_mem_tr__prompt_kernel
.p2align 8
.type concat_heads__linear_kernel_hedgehog__memory_aug_recurrent_mem_tr__prompt_kernel,@function
concat_heads__linear_kernel_hedgehog__memory_aug_recurrent_mem_tr__prompt_kernel:
    s_cmp_lt_u32 s2, 256
    s_cbranch_scc1 L_go
    s_endpgm
L_go:
    s_load_dwordx4 s[80:83], s[0:1], 96
    s_getreg_b32 s3, hwreg(HW_REG_XCC_ID, 0, 4)
    s_lshl_b32 s70, s3, 2
    s_lshr_b32 s70, 0x76540321, s70
    s_and_b32 s70, s70, 15
    s_cmp_lt_u32 s3, 8
    s_cselect_b32 s3, s70, s3
    v_lshrrev_b32 v1, 6, v0
    v_and_b32 v0, 63, v0
    v_readfirstlane_b32 s33, v1
    v_lshlrev_b32 v4, 2, v0
    v_lshlrev_b32 v0, 4, v0
    v_mov_b32 v3, 0
    v_mov_b32 v6, 163836
    s_mov_b64 s[48:49], -1
    s_mov_b32 s50, 1500000
    s_waitcnt lgkmcnt(0)
    s_load_dwordx8 s[84:91], s[0:1], 48
    s_load_dwordx2 s[92:93], s[0:1], 40
    s_mov_b32 s28, s80
    s_and_b32 s29, s81, 0xffff
    s_mov_b32 s30, 0x100
    s_mov_b32 s31, 0x20000
    s_mov_b32 s4, s82
    s_and_b32 s5, s83, 0xffff
    s_mov_b32 s6, 0x10000000
    s_mov_b32 s7, 0x20000
    s_cmp_eq_u32 s33, 0
    s_cbranch_scc0 L_tk
    s_lshl_b32 s70, s3, 2
    s_cmp_lt_u32 s3, 4
    s_cselect_b32 s71, 60, 112
    s_add_u32 s70, s70, s71
    s_cmp_eq_u32 s3, 0
    s_cselect_b32 s70, 0, s70
    s_cmp_lt_u32 s3, 8
    s_cselect_b32 s70, s70, 252
    v_mov_b32 v2, 1
    v_mov_b32 v5, s70
    s_lshl_b32 s71, s2, 9
    v_mov_b64 v[10:11], 0
    v_lshrrev_b32 v12, 1, v0
    s_mov_b64 exec, 1
    global_atomic_add v2, v5, v2, s[28:29] sc0
    s_mov_b64 exec, -1
    buffer_store_dwordx2 v[10:11], v12, s[4:7], s71 offen sc1
    s_waitcnt vmcnt(1)
    v_readfirstlane_b32 s72, v2
    s_cmp_lt_u32 s3, 8
    s_cselect_b32 s72, s72, 32
    s_lshl_b32 s73, s3, 5
    s_add_u32 s73, s73, s72
    s_cmp_lt_u32 s72, 32
    s_cbranch_scc1 L_have
    s_waitcnt vmcnt(0)
    v_mov_b32 v2, 1
    s_mov_b64 exec, 1
    global_atomic_add v3, v2, s[28:29] offset:192
    s_mov_b64 exec, -1
    v_mov_b32 v2, 1
    s_mov_b64 exec, 1
    global_atomic_add v2, v3, v2, s[28:29] offset:144 sc0
    s_mov_b64 exec, -1
    s_waitcnt vmcnt(0)
    v_readfirstlane_b32 s72, v2
    s_movk_i32 s62, 256
L_spin_1:
    global_load_ushort v2, v3, s[28:29] offset:192 sc1
    s_sub_u32 s50, s50, 1
    s_cselect_b64 s[48:49], 0, s[48:49]
    s_waitcnt vmcnt(0)
    v_cmp_gt_u32 vcc, s62, v2
    s_and_b64 vcc, vcc, s[48:49]
    s_cbranch_scc0 L_spino_2
    s_sleep 1
    s_branch L_spin_1
L_spino_2:
    global_load_dword v2, v4, s[28:29] sc1
    s_mov_b32 s73, 255
    s_waitcnt vmcnt(0)
    v_readlane_b32 s74, v2, 0
    s_min_u32 s74, s74, 32
    s_add_u32 s72, s72, s74
    s_cmp_lt_u32 s72, 32
    s_cbranch_scc0 L_ov_3
    s_add_u32 s73, s72, 0
    s_branch L_have2
L_ov_3:
    s_sub_u32 s72, s72, 32
    v_readlane_b32 s74, v2, 16
    s_min_u32 s74, s74, 32
    s_add_u32 s72, s72, s74
    s_cmp_lt_u32 s72, 32
    s_cbranch_scc0 L_ov_4
    s_add_u32 s73, s72, 32
    s_branch L_have2
L_ov_4:
    s_sub_u32 s72, s72, 32
    v_readlane_b32 s74, v2, 17
    s_min_u32 s74, s74, 32
    s_add_u32 s72, s72, s74
    s_cmp_lt_u32 s72, 32
    s_cbranch_scc0 L_ov_5
    s_add_u32 s73, s72, 64
    s_branch L_have2
L_ov_5:
    s_sub_u32 s72, s72, 32
    v_readlane_b32 s74, v2, 18
    s_min_u32 s74, s74, 32
    s_add_u32 s72, s72, s74
    s_cmp_lt_u32 s72, 32
    s_cbranch_scc0 L_ov_6
    s_add_u32 s73, s72, 96
    s_branch L_have2
L_ov_6:
    s_sub_u32 s72, s72, 32
    v_readlane_b32 s74, v2, 32
    s_min_u32 s74, s74, 32
    s_add_u32 s72, s72, s74
    s_cmp_lt_u32 s72, 32
    s_cbranch_scc0 L_ov_7
    s_add_u32 s73, s72, 128
    s_branch L_have2
L_ov_7:
    s_sub_u32 s72, s72, 32
    v_readlane_b32 s74, v2, 33
    s_min_u32 s74, s74, 32
    s_add_u32 s72, s72, s74
    s_cmp_lt_u32 s72, 32
    s_cbranch_scc0 L_ov_8
    s_add_u32 s73, s72, 160
    s_branch L_have2
L_ov_8:
    s_sub_u32 s72, s72, 32
    v_readlane_b32 s74, v2, 34
    s_min_u32 s74, s74, 32
    s_add_u32 s72, s72, s74
    s_cmp_lt_u32 s72, 32
    s_cbranch_scc0 L_ov_9
    s_add_u32 s73, s72, 192
    s_branch L_have2
L_ov_9:
    s_sub_u32 s72, s72, 32
    v_readlane_b32 s74, v2, 35
    s_min_u32 s74, s74, 32
    s_add_u32 s72, s72, s74
    s_cmp_lt_u32 s72, 32
    s_cbranch_scc0 L_ov_10
    s_add_u32 s73, s72, 224
    s_branch L_have2
L_ov_10:
    s_sub_u32 s72, s72, 32
    s_branch L_have2
L_have:
    v_mov_b32 v2, s73
    ds_write_b32 v6, v2
    s_waitcnt lgkmcnt(0)
    s_barrier
    s_waitcnt vmcnt(0)
    v_mov_b32 v2, 1
    s_mov_b64 exec, 1
    global_atomic_add v3, v2, s[28:29] offset:192
    s_mov_b64 exec, -1
    s_branch L_tk2
L_have2:
    v_mov_b32 v2, s73
    ds_write_b32 v6, v2
    s_waitcnt lgkmcnt(0)
    s_branch L_tk1
L_tk:
    s_cmp_eq_u32 s33, 1
    s_cbranch_scc0 L_tk1
    s_lshr_b32 s70, s2, 3
    s_lshl_b32 s70, s70, 12
    s_getpc_b64 s[72:73]
L_pc0:
    s_sub_u32 s72, s72, L_pc0-concat_heads__linear_kernel_hedgehog__memory_aug_recurrent_mem_tr__prompt_kernel
    s_subb_u32 s73, s73, 0
    v_lshl_add_u32 v7, v0, 2, s70
    v_min_u32 v7, L_code_end-concat_heads__linear_kernel_hedgehog__memory_aug_recurrent_mem_tr__prompt_kernel-4, v7
    s_nop 7
    global_load_dword v255, v7, s[72:73]
L_tk1:
    s_barrier
L_tk2:
    ds_read_b32 v2, v6
    s_waitcnt lgkmcnt(0)
    v_readfirstlane_b32 s32, v2
    s_cmp_lt_u32 s32, 32
    s_cbranch_scc0 L_rl_11
    s_branch L_role_chain
L_rl_11:
    s_sub_u32 s32, s32, 32
    s_cmp_lt_u32 s32, 64
    s_cbranch_scc0 L_rl_12
    s_branch L_role_qkv
L_rl_12:
    s_sub_u32 s32, s32, 64
    s_cmp_lt_u32 s32, 32
    s_cbranch_scc0 L_rl_13
    s_branch L_role_idle
L_rl_13:
    s_sub_u32 s32, s32, 32
    s_cmp_lt_u32 s32, 32
    s_cbranch_scc0 L_rl_14
    s_branch L_role_att
L_rl_14:
    s_sub_u32 s32, s32, 32
    s_cmp_lt_u32 s32, 64
    s_cbranch_scc0 L_rl_15
    s_branch L_role_b4
L_rl_15:
    s_sub_u32 s32, s32, 64
    s_and_b32 s32, s32, 31
L_role_a:
    s_load_dwordx8 s[80:87], s[0:1], 0
    s_load_dwordx2 s[88:89], s[0:1], 88
    s_lshr_b32 s70, s32, 2
    s_and_b32 s71, s32, 3
    s_lshl_b32 s74, s71, 2
    s_add_u32 s74, s74, s33
    s_waitcnt lgkmcnt(0)
    s_mov_b32 s8, s80
    s_and_b32 s9, s81, 0xffff
    s_mov_b32 s10, 0x200000
    s_mov_b32 s11, 0x20000
    s_mov_b32 s16, s82
    s_and_b32 s17, s83, 0xffff
    s_mov_b32 s18, 0x180000
    s_mov_b32 s19, 0x20000
    s_mov_b32 s20, s84
    s_and_b32 s21, s85, 0xffff
    s_mov_b32 s22, 0x4000
    s_mov_b32 s23, 0x20000
    s_mov_b32 s12, s86
    s_and_b32 s13, s87, 0xffff
    s_mov_b32 s14, 0x80000
    s_mov_b32 s15, 0x20000
    v_lshrrev_b32 v32, 4, v0
    v_and_b32 v33, 15, v32
    v_lshrrev_b32 v34, 4, v32
    v_lshrrev_b32 v35, 2, v32
    v_and_b32 v36, 3, v32
    v_and_b32 v37, 3, v35
    v_bfe_u32 v38, v34, 0, 2
    v_mul_u32_u24 v80, 128, v38
    v_bfe_u32 v38, v33, 0, 4
    v_mul_u32_u24 v38, 2, v38
    v_add_u32 v80, v80, v38
    s_lshl_b32 s72, s74, 10
    buffer_load_ushort v82, v80, s[20:23], s72 offen offset:0
    buffer_load_ushort v83, v80, s[20:23], s72 offen offset:32
    buffer_load_ushort v84, v80, s[20:23], s72 offen offset:64
    buffer_load_ushort v85, v80, s[20:23], s72 offen offset:96
    buffer_load_ushort v86, v80, s[20:23], s72 offen offset:512
    buffer_load_ushort v87, v80, s[20:23], s72 offen offset:544
    buffer_load_ushort v88, v80, s[20:23], s72 offen offset:576
    buffer_load_ushort v89, v80, s[20:23], s72 offen offset:608
    v_lshlrev_b32 v38, 2, v34
    v_sub_u32 v38, v33, v38
    v_mov_b32 v39, 0x3f80
    v_mov_b32 v40, 0x3f800000
    v_cmp_eq_u32 vcc, 0, v38
    s_nop 1
    v_cndmask_b32 v10, 0, v39, vcc
    v_cmp_eq_u32 vcc, 1, v38
    s_nop 1
    v_cndmask_b32 v10, v10, v40, vcc
    v_cmp_eq_u32 vcc, 2, v38
    s_nop 1
    v_cndmask_b32 v11, 0, v39, vcc
    v_cmp_eq_u32 vcc, 3, v38
    s_nop 1
    v_cndmask_b32 v11, v11, v40, vcc
    v_mov_b32 v12, 0x3f803f80
    v_mov_b32 v13, 0x3f803f80
    v_mov_b32 v14, 0x3f803f80
    v_mov_b32 v15, 0x3f803f80
    v_mov_b64 v[96:97], 0
    v_mov_b64 v[98:99], 0
    v_mov_b64 v[100:101], 0
    v_mov_b64 v[102:103], 0
    v_mov_b64 v[104:105], 0
    v_mov_b64 v[106:107], 0
    v_mov_b64 v[108:109], 0
    v_mov_b64 v[110:111], 0
    v_mov_b64 v[112:113], 0
    v_mov_b64 v[114:115], 0
    v_mov_b64 v[116:117], 0
    v_mov_b64 v[118:119], 0
    v_mov_b64 v[120:121], 0
    v_mov_b64 v[122:123], 0
    v_mov_b64 v[124:125], 0
    v_mov_b64 v[126:127], 0
    s_waitcnt vmcnt(0)
    v_lshl_or_b32 v6, v83, 16, v82
    v_lshl_or_b32 v7, v85, 16, v84
    v_lshl_or_b32 v8, v87, 16, v86
    v_lshl_or_b32 v9, v89, 16, v88
    s_lshl_b32 s72, s71, 8
    s_lshl_b32 s34, s70, 18
    s_lshl_b32 s73, s33, 13
    s_add_u32 s34, s34, s73
    v_lshrrev_b32 v32, 4, v0
    v_and_b32 v33, 15, v32
    v_lshrrev_b32 v34, 4, v32
    v_lshrrev_b32 v35, 2, v32
    v_and_b32 v36, 3, v32
    v_and_b32 v37, 3, v35
    s_lshl_b32 s62, s33, 4
    v_add_u32 v38, s62, v34
    s_mov_b32 s62, 3072
    v_mul_lo_u32 v4, s62, v38
    v_xor_b32 v38, v37, v34
    v_lshl_add_u32 v4, v38, 6, v4
    v_lshl_add_u32 v4, v36, 4, v4
    v_add_u32 v4, s72, v4
    s_mul_i32 s60, s33, 28672
    v_xor_b32 v39, s33, v37
    v_bfe_u32 v38, v34, 1, 1
    v_mul_u32_u24 v16, 28672, v38
    v_bfe_u32 v38, v34, 0, 1
    v_mul_u32_u24 v38, 2048, v38
    v_add_u32 v16, v16, v38
    v_bfe_u32 v38, v37, 0, 2
    v_mul_u32_u24 v38, 256, v38
    v_add_u32 v16, v16, v38
    v_bfe_u32 v38, v39, 0, 2
    v_mul_u32_u24 v38, 64, v38
    v_add_u32 v16, v16, v38
    v_bfe_u32 v38, v36, 0, 2
    v_mul_u32_u24 v38, 8, v38
    v_add_u32 v16, v16, v38
    v_add_u32 v17, 57344, v16
    v_bfe_u32 v38, v33, 0, 4
    v_mul_u32_u24 v1, 1056, v38
    v_bfe_u32 v38, v34, 0, 2
    v_mul_u32_u24 v38, 16, v38
    v_add_u32 v1, v1, v38
    v_add_u32 v1, 114688, v1
    v_bfe_u32 v38, v33, 2, 1
    v_mul_u32_u24 v2, 4096, v38
    v_bfe_u32 v38, v34, 0, 2
    v_mul_u32_u24 v38, 256, v38
    v_add_u32 v2, v2, v38
    v_bfe_u32 v38, v33, 3, 1
    v_mul_u32_u24 v38, 64, v38
    v_add_u32 v2, v2, v38
    v_bfe_u32 v38, v33, 0, 2
    v_mul_u32_u24 v38, 16, v38
    v_add_u32 v2, v2, v38
    v_mov_b32 v3, 0
    s_mul_i32 s35, s33, 8448
    s_add_u32 s35, s35, 114688
    s_add_u32 m0, s60, 0
    s_mov_b32 s62, 1024
    buffer_load_dwordx4 v4, s[16:19], s62 offen  lds
    s_add_u32 m0, s60, 1024
    s_mov_b32 s62, 13312
    buffer_load_dwordx4 v4, s[16:19], s62 offen  lds
    s_add_u32 m0, s60, 2048
    s_mov_b32 s62, 25600
    buffer_load_dwordx4 v4, s[16:19], s62 offen  lds
    s_add_u32 m0, s60, 3072
    s_mov_b32 s62, 37888
    buffer_load_dwordx4 v4, s[16:19], s62 offen  lds
    s_add_u32 m0, s60, 4096
    s_mov_b32 s62, 197632
    buffer_load_dwordx4 v4, s[16:19], s62 offen  lds
    s_add_u32 m0, s60, 5120
    s_mov_b32 s62, 209920
    buffer_load_dwordx4 v4, s[16:19], s62 offen  lds
    s_add_u32 m0, s60, 6144
    s_mov_b32 s62, 222208
    buffer_load_dwordx4 v4, s[16:19], s62 offen  lds
    s_add_u32 m0, s60, 7168
    s_mov_b32 s62, 234496
    buffer_load_dwordx4 v4, s[16:19], s62 offen  lds
    s_waitcnt vmcnt(4) lgkmcnt(0)
    s_barrier
    s_add_u32 m0, s60, 8192
    s_mov_b32 s62, 394240
    buffer_load_dwordx4 v4, s[16:19], s62 offen  lds
    s_add_u32 m0, s60, 9216
    s_mov_b32 s62, 406528
    buffer_load_dwordx4 v4, s[16:19], s62 offen  lds
    s_add_u32 m0, s60, 10240
    s_mov_b32 s62, 418816
    buffer_load_dwordx4 v4, s[16:19], s62 offen  lds
    s_add_u32 m0, s60, 11264
    s_mov_b32 s62, 431104
    buffer_load_dwordx4 v4, s[16:19], s62 offen  lds
    ds_read_b64_tr_b16 a[0:1], v16 offset:0
    ds_read_b64_tr_b16 a[2:3], v16 offset:1024
    ds_read_b64_tr_b16 a[4:5], v17 offset:0
    ds_read_b64_tr_b16 a[6:7], v17 offset:1024
    ds_read_b64_tr_b16 a[8:9], v16 offset:32
    ds_read_b64_tr_b16 a[10:11], v16 offset:1056
    ds_read_b64_tr_b16 a[12:13], v17 offset:32
    ds_read_b64_tr_b16 a[14:15], v17 offset:1056
    s_waitcnt vmcnt(4) lgkmcnt(0)
    s_barrier
    s_add_u32 m0, s60, 12288
    s_mov_b32 s62, 590848
    buffer_load_dwordx4 v4, s[16:19], s62 offen  lds
    s_add_u32 m0, s60, 13312
    s_mov_b32 s62, 603136
    buffer_load_dwordx4 v4, s[16:19], s62 offen  lds
    s_add_u32 m0, s60, 14336
    s_mov_b32 s62, 615424
    buffer_load_dwordx4 v4, s[16:19], s62 offen  lds
    s_add_u32 m0, s60, 15360
    s_mov_b32 s62, 627712
    buffer_load_dwordx4 v4, s[16:19], s62 offen  lds
    ds_read_b64_tr_b16 a[16:17], v16 offset:4096
    ds_read_b64_tr_b16 a[18:19], v16 offset:5120
    ds_read_b64_tr_b16 a[20:21], v17 offset:4096
    ds_read_b64_tr_b16 a[22:23], v17 offset:5120
    ds_read_b64_tr_b16 a[24:25], v16 offset:4128
    ds_read_b64_tr_b16 a[26:27], v16 offset:5152
    ds_read_b64_tr_b16 a[28:29], v17 offset:4128
    ds_read_b64_tr_b16 a[30:31], v17 offset:5152
    s_waitcnt vmcnt(4) lgkmcnt(0)
    s_barrier
    s_add_u32 m0, s60, 16384
    s_mov_b32 s62, 787456
    buffer_load_dwordx4 v4, s[16:19], s62 offen  lds
    s_add_u32 m0, s60, 17408
    s_mov_b32 s62, 799744
    buffer_load_dwordx4 v4, s[16:19], s62 offen  lds
    s_add_u32 m0, s60, 18432
    s_mov_b32 s62, 812032
    buffer_load_dwordx4 v4, s[16:19], s62 offen  lds
    s_add_u32 m0, s60, 19456
    s_mov_b32 s62, 824320
    buffer_load_dwordx4 v4, s[16:19], s62 offen  lds
    ds_read_b64_tr_b16 a[32:33], v16 offset:8192
    ds_read_b64_tr_b16 a[34:35], v16 offset:9216
    ds_read_b64_tr_b16 a[36:37], v17 offset:8192
    ds_read_b64_tr_b16 a[38:39], v17 offset:9216
    ds_read_b64_tr_b16 a[40:41], v16 offset:8224
    ds_read_b64_tr_b16 a[42:43], v16 offset:9248
    ds_read_b64_tr_b16 a[44:45], v17 offset:8224
    ds_read_b64_tr_b16 a[46:47], v17 offset:9248
    s_waitcnt vmcnt(4) lgkmcnt(0)
    s_barrier
    s_add_u32 m0, s60, 20480
    s_mov_b32 s62, 984064
    buffer_load_dwordx4 v4, s[16:19], s62 offen  lds
    s_add_u32 m0, s60, 21504
    s_mov_b32 s62, 996352
    buffer_load_dwordx4 v4, s[16:19], s62 offen  lds
    s_add_u32 m0, s60, 22528
    s_mov_b32 s62, 1008640
    buffer_load_dwordx4 v4, s[16:19], s62 offen  lds
    s_add_u32 m0, s60, 23552
    s_mov_b32 s62, 1020928
    buffer_load_dwordx4 v4, s[16:19], s62 offen  lds
    ds_read_b64_tr_b16 a[48:49], v16 offset:12288
    ds_read_b64_tr_b16 a[50:51], v16 offset:13312
    ds_read_b64_tr_b16 a[52:53], v17 offset:12288
    ds_read_b64_tr_b16 a[54:55], v17 offset:13312
    ds_read_b64_tr_b16 a[56:57], v16 offset:12320
    ds_read_b64_tr_b16 a[58:59], v16 offset:13344
    ds_read_b64_tr_b16 a[60:61], v17 offset:12320
    ds_read_b64_tr_b16 a[62:63], v17 offset:13344
    s_waitcnt vmcnt(4) lgkmcnt(0)
    s_barrier
    s_add_u32 m0, s60, 24576
    s_mov_b32 s62, 1180672
    buffer_load_dwordx4 v4, s[16:19], s62 offen  lds
    s_add_u32 m0, s60, 25600
    s_mov_b32 s62, 1192960
    buffer_load_dwordx4 v4, s[16:19], s62 offen  lds
    s_add_u32 m0, s60, 26624
    s_mov_b32 s62, 1205248
    buffer_load_dwordx4 v4, s[16:19], s62 offen  lds
    s_add_u32 m0, s60, 27648
    s_mov_b32 s62, 1217536
    buffer_load_dwordx4 v4, s[16:19], s62 offen  lds
    ds_read_b64_tr_b16 a[64:65], v16 offset:16384
    ds_read_b64_tr_b16 a[66:67], v16 offset:17408
    ds_read_b64_tr_b16 a[68:69], v17 offset:16384
    ds_read_b64_tr_b16 a[70:71], v17 offset:17408
    ds_read_b64_tr_b16 a[72:73], v16 offset:16416
    ds_read_b64_tr_b16 a[74:75], v16 offset:17440
    ds_read_b64_tr_b16 a[76:77], v17 offset:16416
    ds_read_b64_tr_b16 a[78:79], v17 offset:17440
    s_waitcnt vmcnt(4) lgkmcnt(0)
    s_barrier
    s_add_u32 m0, s60, 0
    s_mov_b32 s62, 1377280
    buffer_load_dwordx4 v4, s[16:19], s62 offen  lds
    s_add_u32 m0, s60, 1024
    s_mov_b32 s62, 1389568
    buffer_load_dwordx4 v4, s[16:19], s62 offen  lds
    s_add_u32 m0, s60, 2048
    s_mov_b32 s62, 1401856
    buffer_load_dwordx4 v4, s[16:19], s62 offen  lds
    s_add_u32 m0, s60, 3072
    s_mov_b32 s62, 1414144
    buffer_load_dwordx4 v4, s[16:19], s62 offen  lds
    ds_read_b64_tr_b16 a[80:81], v16 offset:20480
    ds_read_b64_tr_b16 a[82:83], v16 offset:21504
    ds_read_b64_tr_b16 a[84:85], v17 offset:20480
    ds_read_b64_tr_b16 a[86:87], v17 offset:21504
    ds_read_b64_tr_b16 a[88:89], v16 offset:20512
    ds_read_b64_tr_b16 a[90:91], v16 offset:21536
    ds_read_b64_tr_b16 a[92:93], v17 offset:20512
    ds_read_b64_tr_b16 a[94:95], v17 offset:21536
    s_waitcnt vmcnt(4) lgkmcnt(0)
    s_barrier
    s_add_u32 m0, s60, 4096
    s_mov_b32 s62, 2048
    buffer_load_dwordx4 v4, s[16:19], s62 offen  lds
    s_add_u32 m0, s60, 5120
    s_mov_b32 s62, 14336
    buffer_load_dwordx4 v4, s[16:19], s62 offen  lds
    s_add_u32 m0, s60, 6144
    s_mov_b32 s62, 26624
    buffer_load_dwordx4 v4, s[16:19], s62 offen  lds
    s_add_u32 m0, s60, 7168
    s_mov_b32 s62, 38912
    buffer_load_dwordx4 v4, s[16:19], s62 offen  lds
    ds_read_b64_tr_b16 a[96:97], v16 offset:24576
    ds_read_b64_tr_b16 a[98:99], v16 offset:25600
    ds_read_b64_tr_b16 a[100:101], v17 offset:24576
    ds_read_b64_tr_b16 a[102:103], v17 offset:25600
    ds_read_b64_tr_b16 a[104:105], v16 offset:24608
    ds_read_b64_tr_b16 a[106:107], v16 offset:25632
    ds_read_b64_tr_b16 a[108:109], v17 offset:24608
    ds_read_b64_tr_b16 a[110:111], v17 offset:25632
    s_waitcnt vmcnt(4) lgkmcnt(0)
    s_barrier
    s_add_u32 m0, s60, 8192
    s_mov_b32 s62, 198656
    buffer_load_dwordx4 v4, s[16:19], s62 offen  lds
    s_add_u32 m0, s60, 9216
    s_mov_b32 s62, 210944
    buffer_load_dwordx4 v4, s[16:19], s62 offen  lds
    s_add_u32 m0, s60, 10240
    s_mov_b32 s62, 223232
    buffer_load_dwordx4 v4, s[16:19], s62 offen  lds
    s_add_u32 m0, s60, 11264
    s_mov_b32 s62, 235520
    buffer_load_dwordx4 v4, s[16:19], s62 offen  lds
    ds_read_b64_tr_b16 a[112:113], v16 offset:0
    ds_read_b64_tr_b16 a[114:115], v16 offset:1024
    ds_read_b64_tr_b16 a[116:117], v17 offset:0
    ds_read_b64_tr_b16 a[118:119], v17 offset:1024
    ds_read_b64_tr_b16 a[120:121], v16 offset:32
    ds_read_b64_tr_b16 a[122:123], v16 offset:1056
    ds_read_b64_tr_b16 a[124:125], v17 offset:32
    ds_read_b64_tr_b16 a[126:127], v17 offset:1056
    s_waitcnt vmcnt(4) lgkmcnt(0)
    s_barrier
    s_add_u32 m0, s60, 12288
    s_mov_b32 s62, 395264
    buffer_load_dwordx4 v4, s[16:19], s62 offen  lds
    s_add_u32 m0, s60, 13312
    s_mov_b32 s62, 407552
    buffer_load_dwordx4 v4, s[16:19], s62 offen  lds
    s_add_u32 m0, s60, 14336
    s_mov_b32 s62, 419840
    buffer_load_dwordx4 v4, s[16:19], s62 offen  lds
    s_add_u32 m0, s60, 15360
    s_mov_b32 s62, 432128
    buffer_load_dwordx4 v4, s[16:19], s62 offen  lds
    ds_read_b64_tr_b16 a[128:129], v16 offset:4096
    ds_read_b64_tr_b16 a[130:131], v16 offset:5120
    ds_read_b64_tr_b16 a[132:133], v17 offset:4096
    ds_read_b64_tr_b16 a[134:135], v17 offset:5120
    ds_read_b64_tr_b16 a[136:137], v16 offset:4128
    ds_read_b64_tr_b16 a[138:139], v16 offset:5152
    ds_read_b64_tr_b16 a[140:141], v17 offset:4128
    ds_read_b64_tr_b16 a[142:143], v17 offset:5152
    s_waitcnt vmcnt(4) lgkmcnt(0)
    s_barrier
    s_add_u32 m0, s60, 16384
    s_mov_b32 s62, 591872
    buffer_load_dwordx4 v4, s[16:19], s62 offen  lds
    s_add_u32 m0, s60, 17408
    s_mov_b32 s62, 604160
    buffer_load_dwordx4 v4, s[16:19], s62 offen  lds
    s_add_u32 m0, s60, 18432
    s_mov_b32 s62, 616448
    buffer_load_dwordx4 v4, s[16:19], s62 offen  lds
    s_add_u32 m0, s60, 19456
    s_mov_b32 s62, 628736
    buffer_load_dwordx4 v4, s[16:19], s62 offen  lds
    ds_read_b64_tr_b16 a[144:145], v16 offset:8192
    ds_read_b64_tr_b16 a[146:147], v16 offset:9216
    ds_read_b64_tr_b16 a[148:149], v17 offset:8192
    ds_read_b64_tr_b16 a[150:151], v17 offset:9216
    ds_read_b64_tr_b16 a[152:153], v16 offset:8224
    ds_read_b64_tr_b16 a[154:155], v16 offset:9248
    ds_read_b64_tr_b16 a[156:157], v17 offset:8224
    ds_read_b64_tr_b16 a[158:159], v17 offset:9248
    s_waitcnt vmcnt(4) lgkmcnt(0)
    s_barrier
    s_add_u32 m0, s60, 20480
    s_mov_b32 s62, 788480
    buffer_load_dwordx4 v4, s[16:19], s62 offen  lds
    s_add_u32 m0, s60, 21504
    s_mov_b32 s62, 800768
    buffer_load_dwordx4 v4, s[16:19], s62 offen  lds
    s_add_u32 m0, s60, 22528
    s_mov_b32 s62, 813056
    buffer_load_dwordx4 v4, s[16:19], s62 offen  lds
    s_add_u32 m0, s60, 23552
    s_mov_b32 s62, 825344
    buffer_load_dwordx4 v4, s[16:19], s62 offen  lds
    ds_read_b64_tr_b16 a[160:161], v16 offset:12288
    ds_read_b64_tr_b16 a[162:163], v16 offset:13312
    ds_read_b64_tr_b16 a[164:165], v17 offset:12288
    ds_read_b64_tr_b16 a[166:167], v17 offset:13312
    ds_read_b64_tr_b16 a[168:169], v16 offset:12320
    ds_read_b64_tr_b16 a[170:171], v16 offset:13344
    ds_read_b64_tr_b16 a[172:173], v17 offset:12320
    ds_read_b64_tr_b16 a[174:175], v17 offset:13344
    s_waitcnt vmcnt(4) lgkmcnt(0)
    s_barrier
    s_add_u32 m0, s60, 24576
    s_mov_b32 s62, 985088
    buffer_load_dwordx4 v4, s[16:19], s62 offen  lds
    s_add_u32 m0, s60, 25600
    s_mov_b32 s62, 997376
    buffer_load_dwordx4 v4, s[16:19], s62 offen  lds
    s_add_u32 m0, s60, 26624
    s_mov_b32 s62, 1009664
    buffer_load_dwordx4 v4, s[16:19], s62 offen  lds
    s_add_u32 m0, s60, 27648
    s_mov_b32 s62, 1021952
    buffer_load_dwordx4 v4, s[16:19], s62 offen  lds
    ds_read_b64_tr_b16 a[176:177], v16 offset:16384
    ds_read_b64_tr_b16 a[178:179], v16 offset:17408
    ds_read_b64_tr_b16 a[180:181], v17 offset:16384
    ds_read_b64_tr_b16 a[182:183], v17 offset:17408
    ds_read_b64_tr_b16 a[184:185], v16 offset:16416
    ds_read_b64_tr_b16 a[186:187], v16 offset:17440
    ds_read_b64_tr_b16 a[188:189], v17 offset:16416
    ds_read_b64_tr_b16 a[190:191], v17 offset:17440
    s_waitcnt vmcnt(4) lgkmcnt(0)
    s_barrier
    s_add_u32 m0, s60, 0
    s_mov_b32 s62, 1181696
    buffer_load_dwordx4 v4, s[16:19], s62 offen  lds
    s_add_u32 m0, s60, 1024
    s_mov_b32 s62, 1193984
    buffer_load_dwordx4 v4, s[16:19], s62 offen  lds
    s_add_u32 m0, s60, 2048
    s_mov_b32 s62, 1206272
    buffer_load_dwordx4 v4, s[16:19], s62 offen  lds
    s_add_u32 m0, s60, 3072
    s_mov_b32 s62, 1218560
    buffer_load_dwordx4 v4, s[16:19], s62 offen  lds
    ds_read_b64_tr_b16 a[192:193], v16 offset:20480
    ds_read_b64_tr_b16 a[194:195], v16 offset:21504
    ds_read_b64_tr_b16 a[196:197], v17 offset:20480
    ds_read_b64_tr_b16 a[198:199], v17 offset:21504
    ds_read_b64_tr_b16 a[200:201], v16 offset:20512
    ds_read_b64_tr_b16 a[202:203], v16 offset:21536
    ds_read_b64_tr_b16 a[204:205], v17 offset:20512
    ds_read_b64_tr_b16 a[206:207], v17 offset:21536
    s_waitcnt vmcnt(4) lgkmcnt(0)
    s_barrier
    s_add_u32 m0, s60, 4096
    s_mov_b32 s62, 1378304
    buffer_load_dwordx4 v4, s[16:19], s62 offen  lds
    s_add_u32 m0, s60, 5120
    s_mov_b32 s62, 1390592
    buffer_load_dwordx4 v4, s[16:19], s62 offen  lds
    s_add_u32 m0, s60, 6144
    s_mov_b32 s62, 1402880
    buffer_load_dwordx4 v4, s[16:19], s62 offen  lds
    s_add_u32 m0, s60, 7168
    s_mov_b32 s62, 1415168
    buffer_load_dwordx4 v4, s[16:19], s62 offen  lds
    ds_read_b64_tr_b16 a[208:209], v16 offset:24576
    ds_read_b64_tr_b16 a[210:211], v16 offset:25600
    ds_read_b64_tr_b16 a[212:213], v17 offset:24576
    ds_read_b64_tr_b16 a[214:215], v17 offset:25600
    ds_read_b64_tr_b16 a[216:217], v16 offset:24608
    ds_read_b64_tr_b16 a[218:219], v16 offset:25632
    ds_read_b64_tr_b16 a[220:221], v17 offset:24608
    ds_read_b64_tr_b16 a[222:223], v17 offset:25632
    s_waitcnt vmcnt(4) lgkmcnt(0)
    s_barrier
    s_add_u32 m0, s60, 8192
    s_mov_b32 s62, 0
    buffer_load_dwordx4 v4, s[16:19], s62 offen  lds
    s_add_u32 m0, s60, 9216
    s_mov_b32 s62, 12288
    buffer_load_dwordx4 v4, s[16:19], s62 offen  lds
    s_add_u32 m0, s60, 10240
    s_mov_b32 s62, 24576
    buffer_load_dwordx4 v4, s[16:19], s62 offen  lds
    s_add_u32 m0, s60, 11264
    s_mov_b32 s62, 36864
    buffer_load_dwordx4 v4, s[16:19], s62 offen  lds
    ds_read_b64_tr_b16 a[224:225], v16 offset:0
    ds_read_b64_tr_b16 a[226:227], v16 offset:1024
    ds_read_b64_tr_b16 a[228:229], v17 offset:0
    ds_read_b64_tr_b16 a[230:231], v17 offset:1024
    ds_read_b64_tr_b16 a[232:233], v16 offset:32
    ds_read_b64_tr_b16 a[234:235], v16 offset:1056
    ds_read_b64_tr_b16 a[236:237], v17 offset:32
    ds_read_b64_tr_b16 a[238:239], v17 offset:1056
    s_waitcnt vmcnt(4) lgkmcnt(0)
    s_barrier
    s_add_u32 m0, s60, 12288
    s_mov_b32 s62, 196608
    buffer_load_dwordx4 v4, s[16:19], s62 offen  lds
    s_add_u32 m0, s60, 13312
    s_mov_b32 s62, 208896
    buffer_load_dwordx4 v4, s[16:19], s62 offen  lds
    s_add_u32 m0, s60, 14336
    s_mov_b32 s62, 221184
    buffer_load_dwordx4 v4, s[16:19], s62 offen  lds
    s_add_u32 m0, s60, 15360
    s_mov_b32 s62, 233472
    buffer_load_dwordx4 v4, s[16:19], s62 offen  lds
    s_add_u32 m0, s35, 0
    s_add_u32 s62, s34, 0
    buffer_load_dwordx4 v0, s[8:11], s62 offen lds
    s_add_u32 m0, s35, 1056
    s_add_u32 s62, s34, 1024
    buffer_load_dwordx4 v0, s[8:11], s62 offen lds
    s_add_u32 m0, s35, 2112
    s_add_u32 s62, s34, 2048
    buffer_load_dwordx4 v0, s[8:11], s62 offen lds
    s_add_u32 m0, s35, 3168
    s_add_u32 s62, s34, 3072
    buffer_load_dwordx4 v0, s[8:11], s62 offen lds
    s_add_u32 m0, s35, 4224
    s_add_u32 s62, s34, 4096
    buffer_load_dwordx4 v0, s[8:11], s62 offen lds
    s_add_u32 m0, s35, 5280
    s_add_u32 s62, s34, 5120
    buffer_load_dwordx4 v0, s[8:11], s62 offen lds
    s_add_u32 m0, s35, 6336
    s_add_u32 s62, s34, 6144
    buffer_load_dwordx4 v0, s[8:11], s62 offen lds
    s_add_u32 m0, s35, 7392
    s_add_u32 s62, s34, 7168
    buffer_load_dwordx4 v0, s[8:11], s62 offen lds
    global_load_ushort v5, v3, s[28:29] offset:192 sc1
    ds_read_b64_tr_b16 a[240:241], v16 offset:4096
    ds_read_b64_tr_b16 a[242:243], v16 offset:5120
    ds_read_b64_tr_b16 a[244:245], v17 offset:4096
    ds_read_b64_tr_b16 a[246:247], v17 offset:5120
    ds_read_b64_tr_b16 a[248:249], v16 offset:4128
    ds_read_b64_tr_b16 a[250:251], v16 offset:5152
    ds_read_b64_tr_b16 a[252:253], v17 offset:4128
    ds_read_b64_tr_b16 a[254:255], v17 offset:5152
    s_waitcnt vmcnt(13) lgkmcnt(0)
    s_barrier
    s_add_u32 m0, s60, 16384
    s_mov_b32 s62, 393216
    buffer_load_dwordx4 v4, s[16:19], s62 offen  lds
    s_add_u32 m0, s60, 17408
    s_mov_b32 s62, 405504
    buffer_load_dwordx4 v4, s[16:19], s62 offen  lds
    s_add_u32 m0, s60, 18432
    s_mov_b32 s62, 417792
    buffer_load_dwordx4 v4, s[16:19], s62 offen  lds
    s_add_u32 m0, s60, 19456
    s_mov_b32 s62, 430080
    buffer_load_dwordx4 v4, s[16:19], s62 offen  lds
    ds_read_b64_tr_b16 v[128:129], v16 offset:8192
    ds_read_b64_tr_b16 v[130:131], v16 offset:9216
    ds_read_b64_tr_b16 v[132:133], v17 offset:8192
    ds_read_b64_tr_b16 v[134:135], v17 offset:9216
    ds_read_b64_tr_b16 v[136:137], v16 offset:8224
    ds_read_b64_tr_b16 v[138:139], v16 offset:9248
    ds_read_b64_tr_b16 v[140:141], v17 offset:8224
    ds_read_b64_tr_b16 v[142:143], v17 offset:9248
    s_waitcnt vmcnt(13) lgkmcnt(0)
    s_barrier
    s_add_u32 m0, s60, 20480
    s_mov_b32 s62, 589824
    buffer_load_dwordx4 v4, s[16:19], s62 offen  lds
    s_add_u32 m0, s60, 21504
    s_mov_b32 s62, 602112
    buffer_load_dwordx4 v4, s[16:19], s62 offen  lds
    s_add_u32 m0, s60, 22528
    s_mov_b32 s62, 614400
    buffer_load_dwordx4 v4, s[16:19], s62 offen  lds
    s_add_u32 m0, s60, 23552
    s_mov_b32 s62, 626688
    buffer_load_dwordx4 v4, s[16:19], s62 offen  lds
    ds_read_b64_tr_b16 v[144:145], v16 offset:12288
    ds_read_b64_tr_b16 v[146:147], v16 offset:13312
    ds_read_b64_tr_b16 v[148:149], v17 offset:12288
    ds_read_b64_tr_b16 v[150:151], v17 offset:13312
    ds_read_b64_tr_b16 v[152:153], v16 offset:12320
    ds_read_b64_tr_b16 v[154:155], v16 offset:13344
    ds_read_b64_tr_b16 v[156:157], v17 offset:12320
    ds_read_b64_tr_b16 v[158:159], v17 offset:13344
    s_waitcnt vmcnt(4) lgkmcnt(0)
    s_barrier
    s_add_u32 m0, s60, 24576
    s_mov_b32 s62, 786432
    buffer_load_dwordx4 v4, s[16:19], s62 offen  lds
    s_add_u32 m0, s60, 25600
    s_mov_b32 s62, 798720
    buffer_load_dwordx4 v4, s[16:19], s62 offen  lds
    s_add_u32 m0, s60, 26624
    s_mov_b32 s62, 811008
    buffer_load_dwordx4 v4, s[16:19], s62 offen  lds
    s_add_u32 m0, s60, 27648
    s_mov_b32 s62, 823296
    buffer_load_dwordx4 v4, s[16:19], s62 offen  lds
    ds_read_b64_tr_b16 v[160:161], v16 offset:16384
    ds_read_b64_tr_b16 v[162:163], v16 offset:17408
    ds_read_b64_tr_b16 v[164:165], v17 offset:16384
    ds_read_b64_tr_b16 v[166:167], v17 offset:17408
    ds_read_b64_tr_b16 v[168:169], v16 offset:16416
    ds_read_b64_tr_b16 v[170:171], v16 offset:17440
    ds_read_b64_tr_b16 v[172:173], v17 offset:16416
    ds_read_b64_tr_b16 v[174:175], v17 offset:17440
    s_waitcnt vmcnt(4) lgkmcnt(0)
    s_barrier
    s_add_u32 m0, s60, 0
    s_mov_b32 s62, 983040
    buffer_load_dwordx4 v4, s[16:19], s62 offen  lds
    s_add_u32 m0, s60, 1024
    s_mov_b32 s62, 995328
    buffer_load_dwordx4 v4, s[16:19], s62 offen  lds
    s_add_u32 m0, s60, 2048
    s_mov_b32 s62, 1007616
    buffer_load_dwordx4 v4, s[16:19], s62 offen  lds
    s_add_u32 m0, s60, 3072
    s_mov_b32 s62, 1019904
    buffer_load_dwordx4 v4, s[16:19], s62 offen  lds
    ds_read_b64_tr_b16 v[176:177], v16 offset:20480
    ds_read_b64_tr_b16 v[178:179], v16 offset:21504
    ds_read_b64_tr_b16 v[180:181], v17 offset:20480
    ds_read_b64_tr_b16 v[182:183], v17 offset:21504
    ds_read_b64_tr_b16 v[184:185], v16 offset:20512
    ds_read_b64_tr_b16 v[186:187], v16 offset:21536
    ds_read_b64_tr_b16 v[188:189], v17 offset:20512
    ds_read_b64_tr_b16 v[190:191], v17 offset:21536
    s_waitcnt vmcnt(4) lgkmcnt(0)
    s_barrier
    s_add_u32 m0, s60, 4096
    s_mov_b32 s62, 1179648
    buffer_load_dwordx4 v4, s[16:19], s62 offen  lds
    s_add_u32 m0, s60, 5120
    s_mov_b32 s62, 1191936
    buffer_load_dwordx4 v4, s[16:19], s62 offen  lds
    s_add_u32 m0, s60, 6144
    s_mov_b32 s62, 1204224
    buffer_load_dwordx4 v4, s[16:19], s62 offen  lds
    s_add_u32 m0, s60, 7168
    s_mov_b32 s62, 1216512
    buffer_load_dwordx4 v4, s[16:19], s62 offen  lds
    ds_read_b64_tr_b16 v[192:193], v16 offset:24576
    ds_read_b64_tr_b16 v[194:195], v16 offset:25600
    ds_read_b64_tr_b16 v[196:197], v17 offset:24576
    ds_read_b64_tr_b16 v[198:199], v17 offset:25600
    ds_read_b64_tr_b16 v[200:201], v16 offset:24608
    ds_read_b64_tr_b16 v[202:203], v16 offset:25632
    ds_read_b64_tr_b16 v[204:205], v17 offset:24608
    ds_read_b64_tr_b16 v[206:207], v17 offset:25632
    s_waitcnt vmcnt(4) lgkmcnt(0)
    s_barrier
    s_add_u32 m0, s60, 8192
    s_mov_b32 s62, 1376256
    buffer_load_dwordx4 v4, s[16:19], s62 offen  lds
    s_add_u32 m0, s60, 9216
    s_mov_b32 s62, 1388544
    buffer_load_dwordx4 v4, s[16:19], s62 offen  lds
    s_add_u32 m0, s60, 10240
    s_mov_b32 s62, 1400832
    buffer_load_dwordx4 v4, s[16:19], s62 offen  lds
    s_add_u32 m0, s60, 11264
    s_mov_b32 s62, 1413120
    buffer_load_dwordx4 v4, s[16:19], s62 offen  lds
    ds_read_b64_tr_b16 v[208:209], v16 offset:0
    ds_read_b64_tr_b16 v[210:211], v16 offset:1024
    ds_read_b64_tr_b16 v[212:213], v17 offset:0
    ds_read_b64_tr_b16 v[214:215], v17 offset:1024
    ds_read_b64_tr_b16 v[216:217], v16 offset:32
    ds_read_b64_tr_b16 v[218:219], v16 offset:1056
    ds_read_b64_tr_b16 v[220:221], v17 offset:32
    ds_read_b64_tr_b16 v[222:223], v17 offset:1056
    s_waitcnt vmcnt(4) lgkmcnt(0)
    s_barrier
    ds_read_b64_tr_b16 v[224:225], v16 offset:4096
    ds_read_b64_tr_b16 v[226:227], v16 offset:5120
    ds_read_b64_tr_b16 v[228:229], v17 offset:4096
    ds_read_b64_tr_b16 v[230:231], v17 offset:5120
    ds_read_b64_tr_b16 v[232:233], v16 offset:4128
    ds_read_b64_tr_b16 v[234:235], v16 offset:5152
    ds_read_b64_tr_b16 v[236:237], v17 offset:4128
    ds_read_b64_tr_b16 v[238:239], v17 offset:5152
    s_waitcnt vmcnt(0) lgkmcnt(0)
    s_barrier
    ds_read_b64_tr_b16 v[240:241], v16 offset:8192
    ds_read_b64_tr_b16 v[242:243], v16 offset:9216
    ds_read_b64_tr_b16 v[244:245], v17 offset:8192
    ds_read_b64_tr_b16 v[246:247], v17 offset:9216
    ds_read_b64_tr_b16 v[248:249], v16 offset:8224
    ds_read_b64_tr_b16 v[250:251], v16 offset:9248
    ds_read_b64_tr_b16 v[252:253], v17 offset:8224
    ds_read_b64_tr_b16 v[254:255], v17 offset:9248
    s_waitcnt lgkmcnt(0)
    s_barrier
    s_movk_i32 s62, 256
    v_cmp_gt_u32 vcc, s62, v5
    s_cbranch_vccz L_arrok_16
    s_movk_i32 s62, 256
L_spin_17:
    global_load_ushort v4, v3, s[28:29] offset:192 sc1
    s_sub_u32 s50, s50, 1
    s_cselect_b64 s[48:49], 0, s[48:49]
    s_waitcnt vmcnt(0)
    v_cmp_gt_u32 vcc, s62, v4
    s_and_b64 vcc, vcc, s[48:49]
    s_cbranch_scc0 L_spino_18
    s_sleep 8
    s_branch L_spin_17
L_spino_18:
L_arrok_16:
    s_mov_b32 s37, 8
    s_lshl_b32 s73, s32, 17
    s_lshl_b32 s72, s33, 15
    s_add_u32 s73, s73, s72
    s_add_u32 s73, s73, 100663296
    s_add_u32 s40, s4, s73
    s_addc_u32 s41, s5, 0
    s_mov_b32 s52, 0x3fb8aa3b
    s_mov_b32 s53, 0xbfb8aa3b
    s_mov_b32 s36, -33792
    s_mov_b32 s38, 0
L_proj_19:
    s_waitcnt vmcnt(4)
    s_barrier
    ds_read_b128 v[16:19], v1 offset:0
    ds_read_b128 v[20:23], v1 offset:16896
    s_add_u32 s34, s34, 32768
    s_add_u32 s35, s35, s36
    s_add_u32 m0, s35, 0
    s_add_u32 s62, s34, 0
    buffer_load_dwordx4 v0, s[8:11], s62 offen lds
    s_add_u32 m0, s35, 1056
    s_add_u32 s62, s34, 1024
    buffer_load_dwordx4 v0, s[8:11], s62 offen lds
    s_add_u32 m0, s35, 2112
    s_add_u32 s62, s34, 2048
    buffer_load_dwordx4 v0, s[8:11], s62 offen lds
    s_add_u32 m0, s35, 3168
    s_add_u32 s62, s34, 3072
    buffer_load_dwordx4 v0, s[8:11], s62 offen lds
    s_add_u32 m0, s35, 4224
    s_add_u32 s62, s34, 4096
    buffer_load_dwordx4 v0, s[8:11], s62 offen lds
    s_add_u32 m0, s35, 5280
    s_add_u32 s62, s34, 5120
    buffer_load_dwordx4 v0, s[8:11], s62 offen lds
    s_add_u32 m0, s35, 6336
    s_add_u32 s62, s34, 6144
    buffer_load_dwordx4 v0, s[8:11], s62 offen lds
    s_add_u32 m0, s35, 7392
    s_add_u32 s62, s34, 7168
    buffer_load_dwordx4 v0, s[8:11], s62 offen lds
    ds_read_b128 v[24:27], v1 offset:64
    ds_read_b128 v[28:31], v1 offset:16960
    s_waitcnt lgkmcnt(2)
    v_mfma_f32_16x16x32_bf16 v[48:51], a[0:3], v[16:19], 0
    v_mfma_f32_16x16x32_bf16 v[52:55], a[8:11], v[16:19], 0
    v_mfma_f32_16x16x32_bf16 v[56:59], a[0:3], v[20:23], 0
    v_mfma_f32_16x16x32_bf16 v[60:63], a[8:11], v[20:23], 0
    v_mfma_f32_16x16x32_bf16 v[64:67], v[16:19], a[128:131], 0
    v_mfma_f32_16x16x32_bf16 v[68:71], v[16:19], a[136:139], 0
    v_mfma_f32_16x16x32_bf16 v[72:75], v[20:23], a[128:131], 0
    v_mfma_f32_16x16x32_bf16 v[76:79], v[20:23], a[136:139], 0
    v_mfma_f32_16x16x32_bf16 v[32:35], v[128:131], v[16:19], 0
    v_mfma_f32_16x16x32_bf16 v[36:39], v[136:139], v[16:19], 0
    v_mfma_f32_16x16x32_bf16 v[40:43], v[128:131], v[20:23], 0
    v_mfma_f32_16x16x32_bf16 v[44:47], v[136:139], v[20:23], 0
    ds_read_b128 v[16:19], v1 offset:128
    ds_read_b128 v[20:23], v1 offset:17024
    s_waitcnt lgkmcnt(2)
    v_mfma_f32_16x16x32_bf16 v[48:51], a[4:7], v[24:27], v[48:51]
    v_mfma_f32_16x16x32_bf16 v[52:55], a[12:15], v[24:27], v[52:55]
    v_mfma_f32_16x16x32_bf16 v[56:59], a[4:7], v[28:31], v[56:59]
    v_mfma_f32_16x16x32_bf16 v[60:63], a[12:15], v[28:31], v[60:63]
    v_mfma_f32_16x16x32_bf16 v[64:67], v[24:27], a[132:135], v[64:67]
    v_mfma_f32_16x16x32_bf16 v[68:71], v[24:27], a[140:143], v[68:71]
    v_mfma_f32_16x16x32_bf16 v[72:75], v[28:31], a[132:135], v[72:75]
    v_mfma_f32_16x16x32_bf16 v[76:79], v[28:31], a[140:143], v[76:79]
    v_mfma_f32_16x16x32_bf16 v[32:35], v[132:135], v[24:27], v[32:35]
    v_mfma_f32_16x16x32_bf16 v[36:39], v[140:143], v[24:27], v[36:39]
    v_mfma_f32_16x16x32_bf16 v[40:43], v[132:135], v[28:31], v[40:43]
    v_mfma_f32_16x16x32_bf16 v[44:47], v[140:143], v[28:31], v[44:47]
    ds_read_b128 v[24:27], v1 offset:192
    ds_read_b128 v[28:31], v1 offset:17088
    s_waitcnt lgkmcnt(2)
    v_mfma_f32_16x16x32_bf16 v[48:51], a[16:19], v[16:19], v[48:51]
    v_mfma_f32_16x16x32_bf16 v[52:55], a[24:27], v[16:19], v[52:55]
    v_mfma_f32_16x16x32_bf16 v[56:59], a[16:19], v[20:23], v[56:59]
    v_mfma_f32_16x16x32_bf16 v[60:63], a[24:27], v[20:23], v[60:63]
    v_mfma_f32_16x16x32_bf16 v[64:67], v[16:19], a[144:147], v[64:67]
    v_mfma_f32_16x16x32_bf16 v[68:71], v[16:19], a[152:155], v[68:71]
    v_mfma_f32_16x16x32_bf16 v[72:75], v[20:23], a[144:147], v[72:75]
    v_mfma_f32_16x16x32_bf16 v[76:79], v[20:23], a[152:155], v[76:79]
    v_mfma_f32_16x16x32_bf16 v[32:35], v[144:147], v[16:19], v[32:35]
    v_mfma_f32_16x16x32_bf16 v[36:39], v[152:155], v[16:19], v[36:39]
    v_mfma_f32_16x16x32_bf16 v[40:43], v[144:147], v[20:23], v[40:43]
    v_mfma_f32_16x16x32_bf16 v[44:47], v[152:155], v[20:23], v[44:47]
    ds_read_b128 v[16:19], v1 offset:256
    ds_read_b128 v[20:23], v1 offset:17152
    s_waitcnt lgkmcnt(2)
    v_mfma_f32_16x16x32_bf16 v[48:51], a[20:23], v[24:27], v[48:51]
    v_mfma_f32_16x16x32_bf16 v[52:55], a[28:31], v[24:27], v[52:55]
    v_mfma_f32_16x16x32_bf16 v[56:59], a[20:23], v[28:31], v[56:59]
    v_mfma_f32_16x16x32_bf16 v[60:63], a[28:31], v[28:31], v[60:63]
    v_mfma_f32_16x16x32_bf16 v[64:67], v[24:27], a[148:151], v[64:67]
    v_mfma_f32_16x16x32_bf16 v[68:71], v[24:27], a[156:159], v[68:71]
    v_mfma_f32_16x16x32_bf16 v[72:75], v[28:31], a[148:151], v[72:75]
    v_mfma_f32_16x16x32_bf16 v[76:79], v[28:31], a[156:159], v[76:79]
    v_mfma_f32_16x16x32_bf16 v[32:35], v[148:151], v[24:27], v[32:35]
    v_mfma_f32_16x16x32_bf16 v[36:39], v[156:159], v[24:27], v[36:39]
    v_mfma_f32_16x16x32_bf16 v[40:43], v[148:151], v[28:31], v[40:43]
    v_mfma_f32_16x16x32_bf16 v[44:47], v[156:159], v[28:31], v[44:47]
    ds_read_b128 v[24:27], v1 offset:320
    ds_read_b128 v[28:31], v1 offset:17216
    s_waitcnt lgkmcnt(2)
    v_mfma_f32_16x16x32_bf16 v[48:51], a[32:35], v[16:19], v[48:51]
    v_mfma_f32_16x16x32_bf16 v[52:55], a[40:43], v[16:19], v[52:55]
    v_mfma_f32_16x16x32_bf16 v[56:59], a[32:35], v[20:23], v[56:59]
    v_mfma_f32_16x16x32_bf16 v[60:63], a[40:43], v[20:23], v[60:63]
    v_mfma_f32_16x16x32_bf16 v[64:67], v[16:19], a[160:163], v[64:67]
    v_mfma_f32_16x16x32_bf16 v[68:71], v[16:19], a[168:171], v[68:71]
    v_mfma_f32_16x16x32_bf16 v[72:75], v[20:23], a[160:163], v[72:75]
    v_mfma_f32_16x16x32_bf16 v[76:79], v[20:23], a[168:171], v[76:79]
    v_mfma_f32_16x16x32_bf16 v[32:35], v[160:163], v[16:19], v[32:35]
    v_mfma_f32_16x16x32_bf16 v[36:39], v[168:171], v[16:19], v[36:39]
    v_mfma_f32_16x16x32_bf16 v[40:43], v[160:163], v[20:23], v[40:43]
    v_mfma_f32_16x16x32_bf16 v[44:47], v[168:171], v[20:23], v[44:47]
    ds_read_b128 v[16:19], v1 offset:384
    ds_read_b128 v[20:23], v1 offset:17280
    s_waitcnt lgkmcnt(2)
    v_mfma_f32_16x16x32_bf16 v[48:51], a[36:39], v[24:27], v[48:51]
    v_mfma_f32_16x16x32_bf16 v[52:55], a[44:47], v[24:27], v[52:55]
    v_mfma_f32_16x16x32_bf16 v[56:59], a[36:39], v[28:31], v[56:59]
    v_mfma_f32_16x16x32_bf16 v[60:63], a[44:47], v[28:31], v[60:63]
    v_mfma_f32_16x16x32_bf16 v[64:67], v[24:27], a[164:167], v[64:67]
    v_mfma_f32_16x16x32_bf16 v[68:71], v[24:27], a[172:175], v[68:71]
    v_mfma_f32_16x16x32_bf16 v[72:75], v[28:31], a[164:167], v[72:75]
    v_mfma_f32_16x16x32_bf16 v[76:79], v[28:31], a[172:175], v[76:79]
    v_mfma_f32_16x16x32_bf16 v[32:35], v[164:167], v[24:27], v[32:35]
    v_mfma_f32_16x16x32_bf16 v[36:39], v[172:175], v[24:27], v[36:39]
    v_mfma_f32_16x16x32_bf16 v[40:43], v[164:167], v[28:31], v[40:43]
    v_mfma_f32_16x16x32_bf16 v[44:47], v[172:175], v[28:31], v[44:47]
    ds_read_b128 v[24:27], v1 offset:448
    ds_read_b128 v[28:31], v1 offset:17344
    s_waitcnt lgkmcnt(2)
    v_mfma_f32_16x16x32_bf16 v[48:51], a[48:51], v[16:19], v[48:51]
    v_mfma_f32_16x16x32_bf16 v[52:55], a[56:59], v[16:19], v[52:55]
    v_mfma_f32_16x16x32_bf16 v[56:59], a[48:51], v[20:23], v[56:59]
    v_mfma_f32_16x16x32_bf16 v[60:63], a[56:59], v[20:23], v[60:63]
    v_mfma_f32_16x16x32_bf16 v[64:67], v[16:19], a[176:179], v[64:67]
    v_mfma_f32_16x16x32_bf16 v[68:71], v[16:19], a[184:187], v[68:71]
    v_mfma_f32_16x16x32_bf16 v[72:75], v[20:23], a[176:179], v[72:75]
    v_mfma_f32_16x16x32_bf16 v[76:79], v[20:23], a[184:187], v[76:79]
    v_mfma_f32_16x16x32_bf16 v[32:35], v[176:179], v[16:19], v[32:35]
    v_mfma_f32_16x16x32_bf16 v[36:39], v[184:187], v[16:19], v[36:39]
    v_mfma_f32_16x16x32_bf16 v[40:43], v[176:179], v[20:23], v[40:43]
    v_mfma_f32_16x16x32_bf16 v[44:47], v[184:187], v[20:23], v[44:47]
    ds_read_b128 v[16:19], v1 offset:512
    ds_read_b128 v[20:23], v1 offset:17408
    s_waitcnt lgkmcnt(2)
    v_mfma_f32_16x16x32_bf16 v[48:51], a[52:55], v[24:27], v[48:51]
    v_mfma_f32_16x16x32_bf16 v[52:55], a[60:63], v[24:27], v[52:55]
    v_mfma_f32_16x16x32_bf16 v[56:59], a[52:55], v[28:31], v[56:59]
    v_mfma_f32_16x16x32_bf16 v[60:63], a[60:63], v[28:31], v[60:63]
    v_mfma_f32_16x16x32_bf16 v[64:67], v[24:27], a[180:183], v[64:67]
    v_mfma_f32_16x16x32_bf16 v[68:71], v[24:27], a[188:191], v[68:71]
    v_mfma_f32_16x16x32_bf16 v[72:75], v[28:31], a[180:183], v[72:75]
    v_mfma_f32_16x16x32_bf16 v[76:79], v[28:31], a[188:191], v[76:79]
    v_mfma_f32_16x16x32_bf16 v[32:35], v[180:183], v[24:27], v[32:35]
    v_mfma_f32_16x16x32_bf16 v[36:39], v[188:191], v[24:27], v[36:39]
    v_mfma_f32_16x16x32_bf16 v[40:43], v[180:183], v[28:31], v[40:43]
    v_mfma_f32_16x16x32_bf16 v[44:47], v[188:191], v[28:31], v[44:47]
    ds_read_b128 v[24:27], v1 offset:576
    ds_read_b128 v[28:31], v1 offset:17472
    s_waitcnt lgkmcnt(2)
    v_mfma_f32_16x16x32_bf16 v[48:51], a[64:67], v[16:19], v[48:51]
    v_mfma_f32_16x16x32_bf16 v[52:55], a[72:75], v[16:19], v[52:55]
    v_mfma_f32_16x16x32_bf16 v[56:59], a[64:67], v[20:23], v[56:59]
    v_mfma_f32_16x16x32_bf16 v[60:63], a[72:75], v[20:23], v[60:63]
    v_mfma_f32_16x16x32_bf16 v[64:67], v[16:19], a[192:195], v[64:67]
    v_mfma_f32_16x16x32_bf16 v[68:71], v[16:19], a[200:203], v[68:71]
    v_mfma_f32_16x16x32_bf16 v[72:75], v[20:23], a[192:195], v[72:75]
    v_mfma_f32_16x16x32_bf16 v[76:79], v[20:23], a[200:203], v[76:79]
    v_mfma_f32_16x16x32_bf16 v[32:35], v[192:195], v[16:19], v[32:35]
    v_mfma_f32_16x16x32_bf16 v[36:39], v[200:203], v[16:19], v[36:39]
    v_mfma_f32_16x16x32_bf16 v[40:43], v[192:195], v[20:23], v[40:43]
    v_mfma_f32_16x16x32_bf16 v[44:47], v[200:203], v[20:23], v[44:47]
    ds_read_b128 v[16:19], v1 offset:640
    ds_read_b128 v[20:23], v1 offset:17536
    s_waitcnt lgkmcnt(2)
    v_mfma_f32_16x16x32_bf16 v[48:51], a[68:71], v[24:27], v[48:51]
    v_mfma_f32_16x16x32_bf16 v[52:55], a[76:79], v[24:27], v[52:55]
    v_mfma_f32_16x16x32_bf16 v[56:59], a[68:71], v[28:31], v[56:59]
    v_mfma_f32_16x16x32_bf16 v[60:63], a[76:79], v[28:31], v[60:63]
    v_mfma_f32_16x16x32_bf16 v[64:67], v[24:27], a[196:199], v[64:67]
    v_mfma_f32_16x16x32_bf16 v[68:71], v[24:27], a[204:207], v[68:71]
    v_mfma_f32_16x16x32_bf16 v[72:75], v[28:31], a[196:199], v[72:75]
    v_mfma_f32_16x16x32_bf16 v[76:79], v[28:31], a[204:207], v[76:79]
    v_mfma_f32_16x16x32_bf16 v[32:35], v[196:199], v[24:27], v[32:35]
    v_mfma_f32_16x16x32_bf16 v[36:39], v[204:207], v[24:27], v[36:39]
    v_mfma_f32_16x16x32_bf16 v[40:43], v[196:199], v[28:31], v[40:43]
    v_mfma_f32_16x16x32_bf16 v[44:47], v[204:207], v[28:31], v[44:47]
    ds_read_b128 v[24:27], v1 offset:704
    ds_read_b128 v[28:31], v1 offset:17600
    s_waitcnt lgkmcnt(2)
    v_mfma_f32_16x16x32_bf16 v[48:51], a[80:83], v[16:19], v[48:51]
    v_mfma_f32_16x16x32_bf16 v[52:55], a[88:91], v[16:19], v[52:55]
    v_mfma_f32_16x16x32_bf16 v[56:59], a[80:83], v[20:23], v[56:59]
    v_mfma_f32_16x16x32_bf16 v[60:63], a[88:91], v[20:23], v[60:63]
    v_mfma_f32_16x16x32_bf16 v[64:67], v[16:19], a[208:211], v[64:67]
    v_mfma_f32_16x16x32_bf16 v[68:71], v[16:19], a[216:219], v[68:71]
    v_mfma_f32_16x16x32_bf16 v[72:75], v[20:23], a[208:211], v[72:75]
    v_mfma_f32_16x16x32_bf16 v[76:79], v[20:23], a[216:219], v[76:79]
    v_mfma_f32_16x16x32_bf16 v[32:35], v[208:211], v[16:19], v[32:35]
    v_mfma_f32_16x16x32_bf16 v[36:39], v[216:219], v[16:19], v[36:39]
    v_mfma_f32_16x16x32_bf16 v[40:43], v[208:211], v[20:23], v[40:43]
    v_mfma_f32_16x16x32_bf16 v[44:47], v[216:219], v[20:23], v[44:47]
    ds_read_b128 v[16:19], v1 offset:768
    ds_read_b128 v[20:23], v1 offset:17664
    s_waitcnt lgkmcnt(2)
    v_mfma_f32_16x16x32_bf16 v[48:51], a[84:87], v[24:27], v[48:51]
    v_mfma_f32_16x16x32_bf16 v[52:55], a[92:95], v[24:27], v[52:55]
    v_mfma_f32_16x16x32_bf16 v[56:59], a[84:87], v[28:31], v[56:59]
    v_mfma_f32_16x16x32_bf16 v[60:63], a[92:95], v[28:31], v[60:63]
    v_mfma_f32_16x16x32_bf16 v[64:67], v[24:27], a[212:215], v[64:67]
    v_mfma_f32_16x16x32_bf16 v[68:71], v[24:27], a[220:223], v[68:71]
    v_mfma_f32_16x16x32_bf16 v[72:75], v[28:31], a[212:215], v[72:75]
    v_mfma_f32_16x16x32_bf16 v[76:79], v[28:31], a[220:223], v[76:79]
    v_mfma_f32_16x16x32_bf16 v[32:35], v[212:215], v[24:27], v[32:35]
    v_mfma_f32_16x16x32_bf16 v[36:39], v[220:223], v[24:27], v[36:39]
    v_mfma_f32_16x16x32_bf16 v[40:43], v[212:215], v[28:31], v[40:43]
    v_mfma_f32_16x16x32_bf16 v[44:47], v[220:223], v[28:31], v[44:47]
    ds_read_b128 v[24:27], v1 offset:832
    ds_read_b128 v[28:31], v1 offset:17728
    s_waitcnt lgkmcnt(2)
    v_mfma_f32_16x16x32_bf16 v[48:51], a[96:99], v[16:19], v[48:51]
    v_mfma_f32_16x16x32_bf16 v[52:55], a[104:107], v[16:19], v[52:55]
    v_mfma_f32_16x16x32_bf16 v[56:59], a[96:99], v[20:23], v[56:59]
    v_mfma_f32_16x16x32_bf16 v[60:63], a[104:107], v[20:23], v[60:63]
    v_mfma_f32_16x16x32_bf16 v[64:67], v[16:19], a[224:227], v[64:67]
    v_mfma_f32_16x16x32_bf16 v[68:71], v[16:19], a[232:235], v[68:71]
    v_mfma_f32_16x16x32_bf16 v[72:75], v[20:23], a[224:227], v[72:75]
    v_mfma_f32_16x16x32_bf16 v[76:79], v[20:23], a[232:235], v[76:79]
    v_mfma_f32_16x16x32_bf16 v[32:35], v[224:227], v[16:19], v[32:35]
    v_mfma_f32_16x16x32_bf16 v[36:39], v[232:235], v[16:19], v[36:39]
    v_mfma_f32_16x16x32_bf16 v[40:43], v[224:227], v[20:23], v[40:43]
    v_mfma_f32_16x16x32_bf16 v[44:47], v[232:235], v[20:23], v[44:47]
    ds_read_b128 v[16:19], v1 offset:896
    ds_read_b128 v[20:23], v1 offset:17792
    s_waitcnt lgkmcnt(2)
    v_mfma_f32_16x16x32_bf16 v[48:51], a[100:103], v[24:27], v[48:51]
    v_mfma_f32_16x16x32_bf16 v[52:55], a[108:111], v[24:27], v[52:55]
    v_mfma_f32_16x16x32_bf16 v[56:59], a[100:103], v[28:31], v[56:59]
    v_mfma_f32_16x16x32_bf16 v[60:63], a[108:111], v[28:31], v[60:63]
    v_mfma_f32_16x16x32_bf16 v[64:67], v[24:27], a[228:231], v[64:67]
    v_mfma_f32_16x16x32_bf16 v[68:71], v[24:27], a[236:239], v[68:71]
    v_mfma_f32_16x16x32_bf16 v[72:75], v[28:31], a[228:231], v[72:75]
    v_mfma_f32_16x16x32_bf16 v[76:79], v[28:31], a[236:239], v[76:79]
    v_mfma_f32_16x16x32_bf16 v[32:35], v[228:231], v[24:27], v[32:35]
    v_mfma_f32_16x16x32_bf16 v[36:39], v[236:239], v[24:27], v[36:39]
    v_mfma_f32_16x16x32_bf16 v[40:43], v[228:231], v[28:31], v[40:43]
    v_mfma_f32_16x16x32_bf16 v[44:47], v[236:239], v[28:31], v[44:47]
    ds_read_b128 v[24:27], v1 offset:960
    ds_read_b128 v[28:31], v1 offset:17856
    s_waitcnt lgkmcnt(2)
    v_mfma_f32_16x16x32_bf16 v[48:51], a[112:115], v[16:19], v[48:51]
    v_mfma_f32_16x16x32_bf16 v[52:55], a[120:123], v[16:19], v[52:55]
    v_mfma_f32_16x16x32_bf16 v[56:59], a[112:115], v[20:23], v[56:59]
    v_mfma_f32_16x16x32_bf16 v[60:63], a[120:123], v[20:23], v[60:63]
    v_mfma_f32_16x16x32_bf16 v[64:67], v[16:19], a[240:243], v[64:67]
    v_mfma_f32_16x16x32_bf16 v[68:71], v[16:19], a[248:251], v[68:71]
    v_mfma_f32_16x16x32_bf16 v[72:75], v[20:23], a[240:243], v[72:75]
    v_mfma_f32_16x16x32_bf16 v[76:79], v[20:23], a[248:251], v[76:79]
    v_mfma_f32_16x16x32_bf16 v[32:35], v[240:243], v[16:19], v[32:35]
    v_mfma_f32_16x16x32_bf16 v[36:39], v[248:251], v[16:19], v[36:39]
    v_mfma_f32_16x16x32_bf16 v[40:43], v[240:243], v[20:23], v[40:43]
    v_mfma_f32_16x16x32_bf16 v[44:47], v[248:251], v[20:23], v[44:47]
    s_waitcnt lgkmcnt(0)
    v_mfma_f32_16x16x32_bf16 v[48:51], a[116:119], v[24:27], v[48:51]
    v_mfma_f32_16x16x32_bf16 v[52:55], a[124:127], v[24:27], v[52:55]
    v_mfma_f32_16x16x32_bf16 v[56:59], a[116:119], v[28:31], v[56:59]
    v_mfma_f32_16x16x32_bf16 v[60:63], a[124:127], v[28:31], v[60:63]
    v_mfma_f32_16x16x32_bf16 v[64:67], v[24:27], a[244:247], v[64:67]
    v_mfma_f32_16x16x32_bf16 v[68:71], v[24:27], a[252:255], v[68:71]
    v_mfma_f32_16x16x32_bf16 v[72:75], v[28:31], a[244:247], v[72:75]
    v_mfma_f32_16x16x32_bf16 v[76:79], v[28:31], a[252:255], v[76:79]
    v_mfma_f32_16x16x32_bf16 v[32:35], v[244:247], v[24:27], v[32:35]
    v_mfma_f32_16x16x32_bf16 v[36:39], v[252:255], v[24:27], v[36:39]
    v_mfma_f32_16x16x32_bf16 v[40:43], v[244:247], v[28:31], v[40:43]
    v_mfma_f32_16x16x32_bf16 v[44:47], v[252:255], v[28:31], v[44:47]
    v_add_u32 v1, s36, v1
    s_sub_u32 s36, 0, s36
    v_cvt_pk_bf16_f32 v16, v48, v49
    v_cvt_pk_bf16_f32 v17, v50, v51
    v_cvt_pk_bf16_f32 v18, v52, v53
    v_cvt_pk_bf16_f32 v19, v54, v55
    v_cvt_pk_bf16_f32 v20, v56, v57
    v_cvt_pk_bf16_f32 v21, v58, v59
    v_cvt_pk_bf16_f32 v22, v60, v61
    v_cvt_pk_bf16_f32 v23, v62, v63
    v_cvt_pk_bf16_f32 v24, v32, v33
    v_cvt_pk_bf16_f32 v25, v34, v35
    v_cvt_pk_bf16_f32 v26, v36, v37
    v_cvt_pk_bf16_f32 v27, v38, v39
    v_cvt_pk_bf16_f32 v28, v40, v41
    v_cvt_pk_bf16_f32 v29, v42, v43
    v_cvt_pk_bf16_f32 v30, v44, v45
    v_cvt_pk_bf16_f32 v31, v46, v47
    s_nop 0
    v_mfma_f32_16x16x16_bf16 v[48:51], v[6:7], v[16:17], 0
    v_mfma_f32_16x16x16_bf16 v[52:55], v[8:9], v[18:19], 0
    v_mfma_f32_16x16x16_bf16 v[56:59], v[6:7], v[20:21], 0
    v_mfma_f32_16x16x16_bf16 v[60:63], v[8:9], v[22:23], 0
    v_mfma_f32_16x16x16_bf16 v[32:35], v[6:7], v[24:25], 0
    v_mfma_f32_16x16x16_bf16 v[36:39], v[8:9], v[26:27], 0
    v_mfma_f32_16x16x16_bf16 v[40:43], v[6:7], v[28:29], 0
    v_mfma_f32_16x16x16_bf16 v[44:47], v[8:9], v[30:31], 0
    v_max3_f32 v88, v48, v49, v50
    v_min3_f32 v89, v48, v49, v50
    v_max_f32 v88, v88, v51
    v_min_f32 v89, v89, v51
    v_mov_b64 v[90:91], v[88:89]
    s_nop 1
    v_permlane32_swap_b32 v88, v90
    v_permlane32_swap_b32 v89, v91
    v_max_f32 v88, v88, v90
    v_min_f32 v89, v89, v91
    v_mov_b64 v[90:91], v[88:89]
    s_nop 1
    v_permlane16_swap_b32 v88, v90
    v_permlane16_swap_b32 v89, v91
    v_max_f32 v88, v88, v90
    v_min_f32 v89, v89, v91
    v_mul_f32 v88, s53, v88
    v_mul_f32 v89, s52, v89
    v_fma_f32 v80, v48, s52, v88
    v_fma_f32 v84, v48, s53, v89
    v_fma_f32 v81, v49, s52, v88
    v_fma_f32 v85, v49, s53, v89
    v_fma_f32 v82, v50, s52, v88
    v_fma_f32 v86, v50, s53, v89
    v_fma_f32 v83, v51, s52, v88
    v_fma_f32 v87, v51, s53, v89
    v_exp_f32 v80, v80
    v_exp_f32 v81, v81
    v_exp_f32 v82, v82
    v_exp_f32 v83, v83
    v_exp_f32 v84, v84
    v_exp_f32 v85, v85
    v_exp_f32 v86, v86
    v_exp_f32 v87, v87
    v_add_f32 v88, v80, v81
    v_add_f32 v89, v84, v85
    v_add_f32 v88, v88, v82
    v_add_f32 v89, v89, v86
    v_add_f32 v88, v88, v83
    v_add_f32 v89, v89, v87
    v_mov_b64 v[90:91], v[88:89]
    s_nop 1
    v_permlane32_swap_b32 v88, v90
    v_permlane32_swap_b32 v89, v91
    v_add_f32 v88, v88, v90
    v_add_f32 v89, v89, v91
    v_mov_b64 v[90:91], v[88:89]
    s_nop 1
    v_permlane16_swap_b32 v88, v90
    v_permlane16_swap_b32 v89, v91
    v_add_f32 v88, v88, v90
    v_add_f32 v89, v89, v91
    v_rcp_f32 v88, v88
    v_rcp_f32 v89, v89
    v_mul_f32 v80, v80, v88
    v_mul_f32 v81, v81, v88
    v_mul_f32 v82, v82, v88
    v_mul_f32 v83, v83, v88
    v_mul_f32 v84, v84, v89
    v_mul_f32 v85, v85, v89
    v_mul_f32 v86, v86, v89
    v_mul_f32 v87, v87, v89
    v_cvt_pk_bf16_f32 v48, v80, v81
    v_cvt_pk_bf16_f32 v49, v82, v83
    v_cvt_pk_bf16_f32 v50, v84, v85
    v_cvt_pk_bf16_f32 v51, v86, v87
    v_max3_f32 v88, v52, v53, v54
    v_min3_f32 v89, v52, v53, v54
    v_max_f32 v88, v88, v55
    v_min_f32 v89, v89, v55
    v_mov_b64 v[90:91], v[88:89]
    s_nop 1
    v_permlane32_swap_b32 v88, v90
    v_permlane32_swap_b32 v89, v91
    v_max_f32 v88, v88, v90
    v_min_f32 v89, v89, v91
    v_mov_b64 v[90:91], v[88:89]
    s_nop 1
    v_permlane16_swap_b32 v88, v90
    v_permlane16_swap_b32 v89, v91
    v_max_f32 v88, v88, v90
    v_min_f32 v89, v89, v91
    v_mul_f32 v88, s53, v88
    v_mul_f32 v89, s52, v89
    v_fma_f32 v80, v52, s52, v88
    v_fma_f32 v84, v52, s53, v89
    v_fma_f32 v81, v53, s52, v88
    v_fma_f32 v85, v53, s53, v89
    v_fma_f32 v82, v54, s52, v88
    v_fma_f32 v86, v54, s53, v89
    v_fma_f32 v83, v55, s52, v88
    v_fma_f32 v87, v55, s53, v89
    v_exp_f32 v80, v80
    v_exp_f32 v81, v81
    v_exp_f32 v82, v82
    v_exp_f32 v83, v83
    v_exp_f32 v84, v84
    v_exp_f32 v85, v85
    v_exp_f32 v86, v86
    v_exp_f32 v87, v87
    v_add_f32 v88, v80, v81
    v_add_f32 v89, v84, v85
    v_add_f32 v88, v88, v82
    v_add_f32 v89, v89, v86
    v_add_f32 v88, v88, v83
    v_add_f32 v89, v89, v87
    v_mov_b64 v[90:91], v[88:89]
    s_nop 1
    v_permlane32_swap_b32 v88, v90
    v_permlane32_swap_b32 v89, v91
    v_add_f32 v88, v88, v90
    v_add_f32 v89, v89, v91
    v_mov_b64 v[90:91], v[88:89]
    s_nop 1
    v_permlane16_swap_b32 v88, v90
    v_permlane16_swap_b32 v89, v91
    v_add_f32 v88, v88, v90
    v_add_f32 v89, v89, v91
    v_rcp_f32 v88, v88
    v_rcp_f32 v89, v89
    v_mul_f32 v80, v80, v88
    v_mul_f32 v81, v81, v88
    v_mul_f32 v82, v82, v88
    v_mul_f32 v83, v83, v88
    v_mul_f32 v84, v84, v89
    v_mul_f32 v85, v85, v89
    v_mul_f32 v86, v86, v89
    v_mul_f32 v87, v87, v89
    v_cvt_pk_bf16_f32 v52, v80, v81
    v_cvt_pk_bf16_f32 v53, v82, v83
    v_cvt_pk_bf16_f32 v54, v84, v85
    v_cvt_pk_bf16_f32 v55, v86, v87
    v_max3_f32 v88, v56, v57, v58
    v_min3_f32 v89, v56, v57, v58
    v_max_f32 v88, v88, v59
    v_min_f32 v89, v89, v59
    v_mov_b64 v[90:91], v[88:89]
    s_nop 1
    v_permlane32_swap_b32 v88, v90
    v_permlane32_swap_b32 v89, v91
    v_max_f32 v88, v88, v90
    v_min_f32 v89, v89, v91
    v_mov_b64 v[90:91], v[88:89]
    s_nop 1
    v_permlane16_swap_b32 v88, v90
    v_permlane16_swap_b32 v89, v91
    v_max_f32 v88, v88, v90
    v_min_f32 v89, v89, v91
    v_mul_f32 v88, s53, v88
    v_mul_f32 v89, s52, v89
    v_fma_f32 v80, v56, s52, v88
    v_fma_f32 v84, v56, s53, v89
    v_fma_f32 v81, v57, s52, v88
    v_fma_f32 v85, v57, s53, v89
    v_fma_f32 v82, v58, s52, v88
    v_fma_f32 v86, v58, s53, v89
    v_fma_f32 v83, v59, s52, v88
    v_fma_f32 v87, v59, s53, v89
    v_exp_f32 v80, v80
    v_exp_f32 v81, v81
    v_exp_f32 v82, v82
    v_exp_f32 v83, v83
    v_exp_f32 v84, v84
    v_exp_f32 v85, v85
    v_exp_f32 v86, v86
    v_exp_f32 v87, v87
    v_add_f32 v88, v80, v81
    v_add_f32 v89, v84, v85
    v_add_f32 v88, v88, v82
    v_add_f32 v89, v89, v86
    v_add_f32 v88, v88, v83
    v_add_f32 v89, v89, v87
    v_mov_b64 v[90:91], v[88:89]
    s_nop 1
    v_permlane32_swap_b32 v88, v90
    v_permlane32_swap_b32 v89, v91
    v_add_f32 v88, v88, v90
    v_add_f32 v89, v89, v91
    v_mov_b64 v[90:91], v[88:89]
    s_nop 1
    v_permlane16_swap_b32 v88, v90
    v_permlane16_swap_b32 v89, v91
    v_add_f32 v88, v88, v90
    v_add_f32 v89, v89, v91
    v_rcp_f32 v88, v88
    v_rcp_f32 v89, v89
    v_mul_f32 v80, v80, v88
    v_mul_f32 v81, v81, v88
    v_mul_f32 v82, v82, v88
    v_mul_f32 v83, v83, v88
    v_mul_f32 v84, v84, v89
    v_mul_f32 v85, v85, v89
    v_mul_f32 v86, v86, v89
    v_mul_f32 v87, v87, v89
    v_cvt_pk_bf16_f32 v56, v80, v81
    v_cvt_pk_bf16_f32 v57, v82, v83
    v_cvt_pk_bf16_f32 v58, v84, v85
    v_cvt_pk_bf16_f32 v59, v86, v87
    v_max3_f32 v88, v60, v61, v62
    v_min3_f32 v89, v60, v61, v62
    v_max_f32 v88, v88, v63
    v_min_f32 v89, v89, v63
    v_mov_b64 v[90:91], v[88:89]
    s_nop 1
    v_permlane32_swap_b32 v88, v90
    v_permlane32_swap_b32 v89, v91
    v_max_f32 v88, v88, v90
    v_min_f32 v89, v89, v91
    v_mov_b64 v[90:91], v[88:89]
    s_nop 1
    v_permlane16_swap_b32 v88, v90
    v_permlane16_swap_b32 v89, v91
    v_max_f32 v88, v88, v90
    v_min_f32 v89, v89, v91
    v_mul_f32 v88, s53, v88
    v_mul_f32 v89, s52, v89
    v_fma_f32 v80, v60, s52, v88
    v_fma_f32 v84, v60, s53, v89
    v_fma_f32 v81, v61, s52, v88
    v_fma_f32 v85, v61, s53, v89
    v_fma_f32 v82, v62, s52, v88
    v_fma_f32 v86, v62, s53, v89
    v_fma_f32 v83, v63, s52, v88
    v_fma_f32 v87, v63, s53, v89
    v_exp_f32 v80, v80
    v_exp_f32 v81, v81
    v_exp_f32 v82, v82
    v_exp_f32 v83, v83
    v_exp_f32 v84, v84
    v_exp_f32 v85, v85
    v_exp_f32 v86, v86
    v_exp_f32 v87, v87
    v_add_f32 v88, v80, v81
    v_add_f32 v89, v84, v85
    v_add_f32 v88, v88, v82
    v_add_f32 v89, v89, v86
    v_add_f32 v88, v88, v83
    v_add_f32 v89, v89, v87
    v_mov_b64 v[90:91], v[88:89]
    s_nop 1
    v_permlane32_swap_b32 v88, v90
    v_permlane32_swap_b32 v89, v91
    v_add_f32 v88, v88, v90
    v_add_f32 v89, v89, v91
    v_mov_b64 v[90:91], v[88:89]
    s_nop 1
    v_permlane16_swap_b32 v88, v90
    v_permlane16_swap_b32 v89, v91
    v_add_f32 v88, v88, v90
    v_add_f32 v89, v89, v91
    v_rcp_f32 v88, v88
    v_rcp_f32 v89, v89
    v_mul_f32 v80, v80, v88
    v_mul_f32 v81, v81, v88
    v_mul_f32 v82, v82, v88
    v_mul_f32 v83, v83, v88
    v_mul_f32 v84, v84, v89
    v_mul_f32 v85, v85, v89
    v_mul_f32 v86, v86, v89
    v_mul_f32 v87, v87, v89
    v_cvt_pk_bf16_f32 v60, v80, v81
    v_cvt_pk_bf16_f32 v61, v82, v83
    v_cvt_pk_bf16_f32 v62, v84, v85
    v_cvt_pk_bf16_f32 v63, v86, v87
    v_cvt_pk_bf16_f32 v16, v64, v65
    v_cvt_pk_bf16_f32 v17, v66, v67
    v_cvt_pk_bf16_f32 v18, v72, v73
    v_cvt_pk_bf16_f32 v19, v74, v75
    v_cvt_pk_bf16_f32 v20, v68, v69
    v_cvt_pk_bf16_f32 v21, v70, v71
    v_cvt_pk_bf16_f32 v22, v76, v77
    v_cvt_pk_bf16_f32 v23, v78, v79
    s_nop 0
    v_mfma_f32_16x16x16_bf16 v[64:67], v[48:49], v[10:11], 0
    v_mfma_f32_16x16x16_bf16 v[68:71], v[56:57], v[10:11], 0
    v_mfma_f32_16x16x16_bf16 v[72:75], v[50:51], v[10:11], 0
    v_mfma_f32_16x16x16_bf16 v[76:79], v[58:59], v[10:11], 0
    v_max3_f32 v88, v32, v33, v34
    v_min3_f32 v89, v32, v33, v34
    v_max_f32 v88, v88, v35
    v_min_f32 v89, v89, v35
    v_mov_b64 v[90:91], v[88:89]
    s_nop 1
    v_permlane32_swap_b32 v88, v90
    v_permlane32_swap_b32 v89, v91
    v_max_f32 v88, v88, v90
    v_min_f32 v89, v89, v91
    v_mov_b64 v[90:91], v[88:89]
    s_nop 1
    v_permlane16_swap_b32 v88, v90
    v_permlane16_swap_b32 v89, v91
    v_max_f32 v88, v88, v90
    v_min_f32 v89, v89, v91
    v_mul_f32 v88, s53, v88
    v_mul_f32 v89, s52, v89
    v_fma_f32 v80, v32, s52, v88
    v_fma_f32 v84, v32, s53, v89
    v_fma_f32 v81, v33, s52, v88
    v_fma_f32 v85, v33, s53, v89
    v_fma_f32 v82, v34, s52, v88
    v_fma_f32 v86, v34, s53, v89
    v_fma_f32 v83, v35, s52, v88
    v_fma_f32 v87, v35, s53, v89
    v_exp_f32 v80, v80
    v_exp_f32 v81, v81
    v_exp_f32 v82, v82
    v_exp_f32 v83, v83
    v_exp_f32 v84, v84
    v_exp_f32 v85, v85
    v_exp_f32 v86, v86
    v_exp_f32 v87, v87
    v_add_f32 v88, v80, v81
    v_add_f32 v89, v84, v85
    v_add_f32 v88, v88, v82
    v_add_f32 v89, v89, v86
    v_add_f32 v88, v88, v83
    v_add_f32 v89, v89, v87
    v_mov_b64 v[90:91], v[88:89]
    s_nop 1
    v_permlane32_swap_b32 v88, v90
    v_permlane32_swap_b32 v89, v91
    v_add_f32 v88, v88, v90
    v_add_f32 v89, v89, v91
    v_mov_b64 v[90:91], v[88:89]
    s_nop 1
    v_permlane16_swap_b32 v88, v90
    v_permlane16_swap_b32 v89, v91
    v_add_f32 v88, v88, v90
    v_add_f32 v89, v89, v91
    v_rcp_f32 v88, v88
    v_rcp_f32 v89, v89
    v_mul_f32 v80, v80, v88
    v_mul_f32 v81, v81, v88
    v_mul_f32 v82, v82, v88
    v_mul_f32 v83, v83, v88
    v_mul_f32 v84, v84, v89
    v_mul_f32 v85, v85, v89
    v_mul_f32 v86, v86, v89
    v_mul_f32 v87, v87, v89
    v_cvt_pk_bf16_f32 v32, v80, v81
    v_cvt_pk_bf16_f32 v33, v82, v83
    v_cvt_pk_bf16_f32 v34, v84, v85
    v_cvt_pk_bf16_f32 v35, v86, v87
    v_cvt_pk_bf16_f32 v24, v64, v65
    v_cvt_pk_bf16_f32 v25, v66, v67
    v_cvt_pk_bf16_f32 v26, v68, v69
    v_cvt_pk_bf16_f32 v27, v70, v71
    v_cvt_pk_bf16_f32 v28, v72, v73
    v_cvt_pk_bf16_f32 v29, v74, v75
    v_cvt_pk_bf16_f32 v30, v76, v77
    v_cvt_pk_bf16_f32 v31, v78, v79
    s_nop 1
    v_mfma_f32_16x16x32_bf16 v[96:99], v[24:27], v[16:19], v[96:99]
    v_mfma_f32_16x16x32_bf16 v[104:107], v[24:27], v[12:15], v[104:107]
    v_mfma_f32_16x16x32_bf16 v[100:103], v[28:31], v[16:19], v[100:103]
    v_mfma_f32_16x16x32_bf16 v[108:111], v[28:31], v[12:15], v[108:111]
    v_max3_f32 v88, v40, v41, v42
    v_min3_f32 v89, v40, v41, v42
    v_max_f32 v88, v88, v43
    v_min_f32 v89, v89, v43
    v_mov_b64 v[90:91], v[88:89]
    s_nop 1
    v_permlane32_swap_b32 v88, v90
    v_permlane32_swap_b32 v89, v91
    v_max_f32 v88, v88, v90
    v_min_f32 v89, v89, v91
    v_mov_b64 v[90:91], v[88:89]
    s_nop 1
    v_permlane16_swap_b32 v88, v90
    v_permlane16_swap_b32 v89, v91
    v_max_f32 v88, v88, v90
    v_min_f32 v89, v89, v91
    v_mul_f32 v88, s53, v88
    v_mul_f32 v89, s52, v89
    v_fma_f32 v80, v40, s52, v88
    v_fma_f32 v84, v40, s53, v89
    v_fma_f32 v81, v41, s52, v88
    v_fma_f32 v85, v41, s53, v89
    v_fma_f32 v82, v42, s52, v88
    v_fma_f32 v86, v42, s53, v89
    v_fma_f32 v83, v43, s52, v88
    v_fma_f32 v87, v43, s53, v89
    v_exp_f32 v80, v80
    v_exp_f32 v81, v81
    v_exp_f32 v82, v82
    v_exp_f32 v83, v83
    v_exp_f32 v84, v84
    v_exp_f32 v85, v85
    v_exp_f32 v86, v86
    v_exp_f32 v87, v87
    v_add_f32 v88, v80, v81
    v_add_f32 v89, v84, v85
    v_add_f32 v88, v88, v82
    v_add_f32 v89, v89, v86
    v_add_f32 v88, v88, v83
    v_add_f32 v89, v89, v87
    v_mov_b64 v[90:91], v[88:89]
    s_nop 1
    v_permlane32_swap_b32 v88, v90
    v_permlane32_swap_b32 v89, v91
    v_add_f32 v88, v88, v90
    v_add_f32 v89, v89, v91
    v_mov_b64 v[90:91], v[88:89]
    s_nop 1
    v_permlane16_swap_b32 v88, v90
    v_permlane16_swap_b32 v89, v91
    v_add_f32 v88, v88, v90
    v_add_f32 v89, v89, v91
    v_rcp_f32 v88, v88
    v_rcp_f32 v89, v89
    v_mul_f32 v80, v80, v88
    v_mul_f32 v81, v81, v88
    v_mul_f32 v82, v82, v88
    v_mul_f32 v83, v83, v88
    v_mul_f32 v84, v84, v89
    v_mul_f32 v85, v85, v89
    v_mul_f32 v86, v86, v89
    v_mul_f32 v87, v87, v89
    v_cvt_pk_bf16_f32 v40, v80, v81
    v_cvt_pk_bf16_f32 v41, v82, v83
    v_cvt_pk_bf16_f32 v42, v84, v85
    v_cvt_pk_bf16_f32 v43, v86, v87
    s_nop 0
    v_mfma_f32_16x16x16_bf16 v[64:67], v[52:53], v[10:11], 0
    v_mfma_f32_16x16x16_bf16 v[68:71], v[60:61], v[10:11], 0
    v_mfma_f32_16x16x16_bf16 v[72:75], v[54:55], v[10:11], 0
    v_mfma_f32_16x16x16_bf16 v[76:79], v[62:63], v[10:11], 0
    v_max3_f32 v88, v36, v37, v38
    v_min3_f32 v89, v36, v37, v38
    v_max_f32 v88, v88, v39
    v_min_f32 v89, v89, v39
    v_mov_b64 v[90:91], v[88:89]
    s_nop 1
    v_permlane32_swap_b32 v88, v90
    v_permlane32_swap_b32 v89, v91
    v_max_f32 v88, v88, v90
    v_min_f32 v89, v89, v91
    v_mov_b64 v[90:91], v[88:89]
    s_nop 1
    v_permlane16_swap_b32 v88, v90
    v_permlane16_swap_b32 v89, v91
    v_max_f32 v88, v88, v90
    v_min_f32 v89, v89, v91
    v_mul_f32 v88, s53, v88
    v_mul_f32 v89, s52, v89
    v_fma_f32 v80, v36, s52, v88
    v_fma_f32 v84, v36, s53, v89
    v_fma_f32 v81, v37, s52, v88
    v_fma_f32 v85, v37, s53, v89
    v_fma_f32 v82, v38, s52, v88
    v_fma_f32 v86, v38, s53, v89
    v_fma_f32 v83, v39, s52, v88
    v_fma_f32 v87, v39, s53, v89
    v_exp_f32 v80, v80
    v_exp_f32 v81, v81
    v_exp_f32 v82, v82
    v_exp_f32 v83, v83
    v_exp_f32 v84, v84
    v_exp_f32 v85, v85
    v_exp_f32 v86, v86
    v_exp_f32 v87, v87
    v_add_f32 v88, v80, v81
    v_add_f32 v89, v84, v85
    v_add_f32 v88, v88, v82
    v_add_f32 v89, v89, v86
    v_add_f32 v88, v88, v83
    v_add_f32 v89, v89, v87
    v_mov_b64 v[90:91], v[88:89]
    s_nop 1
    v_permlane32_swap_b32 v88, v90
    v_permlane32_swap_b32 v89, v91
    v_add_f32 v88, v88, v90
    v_add_f32 v89, v89, v91
    v_mov_b64 v[90:91], v[88:89]
    s_nop 1
    v_permlane16_swap_b32 v88, v90
    v_permlane16_swap_b32 v89, v91
    v_add_f32 v88, v88, v90
    v_add_f32 v89, v89, v91
    v_rcp_f32 v88, v88
    v_rcp_f32 v89, v89
    v_mul_f32 v80, v80, v88
    v_mul_f32 v81, v81, v88
    v_mul_f32 v82, v82, v88
    v_mul_f32 v83, v83, v88
    v_mul_f32 v84, v84, v89
    v_mul_f32 v85, v85, v89
    v_mul_f32 v86, v86, v89
    v_mul_f32 v87, v87, v89
    v_cvt_pk_bf16_f32 v36, v80, v81
    v_cvt_pk_bf16_f32 v37, v82, v83
    v_cvt_pk_bf16_f32 v38, v84, v85
    v_cvt_pk_bf16_f32 v39, v86, v87
    v_cvt_pk_bf16_f32 v24, v64, v65
    v_cvt_pk_bf16_f32 v25, v66, v67
    v_cvt_pk_bf16_f32 v26, v68, v69
    v_cvt_pk_bf16_f32 v27, v70, v71
    v_cvt_pk_bf16_f32 v28, v72, v73
    v_cvt_pk_bf16_f32 v29, v74, v75
    v_cvt_pk_bf16_f32 v30, v76, v77
    v_cvt_pk_bf16_f32 v31, v78, v79
    s_nop 1
    v_mfma_f32_16x16x32_bf16 v[112:115], v[24:27], v[20:23], v[112:115]
    v_mfma_f32_16x16x32_bf16 v[120:123], v[24:27], v[12:15], v[120:123]
    v_mfma_f32_16x16x32_bf16 v[116:119], v[28:31], v[20:23], v[116:119]
    v_mfma_f32_16x16x32_bf16 v[124:127], v[28:31], v[12:15], v[124:127]
    v_max3_f32 v88, v44, v45, v46
    v_min3_f32 v89, v44, v45, v46
    v_max_f32 v88, v88, v47
    v_min_f32 v89, v89, v47
    v_mov_b64 v[90:91], v[88:89]
    s_nop 1
    v_permlane32_swap_b32 v88, v90
    v_permlane32_swap_b32 v89, v91
    v_max_f32 v88, v88, v90
    v_min_f32 v89, v89, v91
    v_mov_b64 v[90:91], v[88:89]
    s_nop 1
    v_permlane16_swap_b32 v88, v90
    v_permlane16_swap_b32 v89, v91
    v_max_f32 v88, v88, v90
    v_min_f32 v89, v89, v91
    v_mul_f32 v88, s53, v88
    v_mul_f32 v89, s52, v89
    v_fma_f32 v80, v44, s52, v88
    v_fma_f32 v84, v44, s53, v89
    v_fma_f32 v81, v45, s52, v88
    v_fma_f32 v85, v45, s53, v89
    v_fma_f32 v82, v46, s52, v88
    v_fma_f32 v86, v46, s53, v89
    v_fma_f32 v83, v47, s52, v88
    v_fma_f32 v87, v47, s53, v89
    v_exp_f32 v80, v80
    v_exp_f32 v81, v81
    v_exp_f32 v82, v82
    v_exp_f32 v83, v83
    v_exp_f32 v84, v84
    v_exp_f32 v85, v85
    v_exp_f32 v86, v86
    v_exp_f32 v87, v87
    v_add_f32 v88, v80, v81
    v_add_f32 v89, v84, v85
    v_add_f32 v88, v88, v82
    v_add_f32 v89, v89, v86
    v_add_f32 v88, v88, v83
    v_add_f32 v89, v89, v87
    v_mov_b64 v[90:91], v[88:89]
    s_nop 1
    v_permlane32_swap_b32 v88, v90
    v_permlane32_swap_b32 v89, v91
    v_add_f32 v88, v88, v90
    v_add_f32 v89, v89, v91
    v_mov_b64 v[90:91], v[88:89]
    s_nop 1
    v_permlane16_swap_b32 v88, v90
    v_permlane16_swap_b32 v89, v91
    v_add_f32 v88, v88, v90
    v_add_f32 v89, v89, v91
    v_rcp_f32 v88, v88
    v_rcp_f32 v89, v89
    v_mul_f32 v80, v80, v88
    v_mul_f32 v81, v81, v88
    v_mul_f32 v82, v82, v88
    v_mul_f32 v83, v83, v88
    v_mul_f32 v84, v84, v89
    v_mul_f32 v85, v85, v89
    v_mul_f32 v86, v86, v89
    v_mul_f32 v87, v87, v89
    v_cvt_pk_bf16_f32 v44, v80, v81
    v_cvt_pk_bf16_f32 v45, v82, v83
    v_cvt_pk_bf16_f32 v46, v84, v85
    v_cvt_pk_bf16_f32 v47, v86, v87
    global_store_dwordx4 v0, v[32:35], s[40:41] offset:0 sc1
    global_store_dwordx4 v0, v[36:39], s[40:41] offset:1024 sc1
    global_store_dwordx4 v0, v[40:43], s[40:41] offset:2048 sc1
    global_store_dwordx4 v0, v[44:47], s[40:41] offset:3072 sc1
    s_add_u32 s40, s40, 4096
    s_addc_u32 s41, s41, 0
    s_add_u32 s38, s38, 1
    s_cmp_lt_u32 s38, s37
    s_cbranch_scc1 L_proj_19
    s_lshl_b32 s73, s74, 16
    s_lshl_b32 s72, s70, 13
    s_add_u32 s73, s73, s72
    s_add_u32 s73, s73, 104861696
    s_add_u32 s42, s4, s73
    s_addc_u32 s43, s5, 0
    global_store_dwordx4 v0, v[96:99], s[42:43] offset:-4096 sc1
    global_store_dwordx4 v0, v[100:103], s[42:43] offset:-3072 sc1
    global_store_dwordx4 v0, v[104:107], s[42:43] offset:-2048 sc1
    global_store_dwordx4 v0, v[108:111], s[42:43] offset:-1024 sc1
    global_store_dwordx4 v0, v[112:115], s[42:43] offset:0 sc1
    global_store_dwordx4 v0, v[116:119], s[42:43] offset:1024 sc1
    global_store_dwordx4 v0, v[120:123], s[42:43] offset:2048 sc1
    global_store_dwordx4 v0, v[124:127], s[42:43] offset:3072 sc1
    s_lshl_b32 s73, s71, 7
    s_lshl_b32 s72, s70, 2
    s_add_u32 s73, s73, s72
    s_add_u32 s73, s73, 8192
    s_add_u32 s46, s4, s73
    s_addc_u32 s47, s5, 0
    s_waitcnt vmcnt(0)
    s_barrier
    s_cmp_eq_u32 s33, 0
    s_cbranch_scc0 L_nofl_20
    v_mov_b32 v4, 1
    s_mov_b64 exec, 1
    global_store_dword v3, v4, s[46:47] sc1
    s_mov_b64 exec, -1
L_nofl_20:
    v_lshrrev_b32 v32, 4, v0
    v_and_b32 v33, 15, v32
    v_lshrrev_b32 v34, 4, v32
    v_lshrrev_b32 v35, 2, v32
    v_and_b32 v36, 3, v32
    v_and_b32 v37, 3, v35
    s_lshl_b32 s60, s33, 15
    v_bfe_u32 v38, v35, 0, 4
    v_mul_u32_u24 v80, 1024, v38
    v_bfe_u32 v38, v36, 0, 2
    v_mul_u32_u24 v38, 16, v38
    v_add_u32 v80, v80, v38
    s_lshl_b32 s72, s74, 6
    v_add_u32 v80, s72, v80
    v_bfe_u32 v38, v34, 0, 2
    v_mul_u32_u24 v81, 256, v38
    v_bfe_u32 v38, v37, 0, 2
    v_mul_u32_u24 v38, 64, v38
    v_add_u32 v81, v81, v38
    v_bfe_u32 v38, v36, 0, 2
    v_mul_u32_u24 v38, 16, v38
    v_add_u32 v81, v81, v38
    v_add_u32 v81, s60, v81
    v_bfe_u32 v38, v32, 0, 3
    v_mul_u32_u24 v82, 4, v38
    v_bfe_u32 v38, v33, 0, 4
    v_mul_u32_u24 v83, 2048, v38
    v_bfe_u32 v38, v34, 0, 2
    v_mul_u32_u24 v38, 16, v38
    v_add_u32 v83, v83, v38
    s_add_u32 m0, s60, 0
    s_mov_b32 s62, 0
    buffer_load_dwordx4 v80, s[12:15], s62 offen lds
    s_add_u32 m0, s60, 1024
    s_mov_b32 s62, 16384
    buffer_load_dwordx4 v80, s[12:15], s62 offen lds
    s_add_u32 m0, s60, 2048
    s_mov_b32 s62, 32768
    buffer_load_dwordx4 v80, s[12:15], s62 offen lds
    s_add_u32 m0, s60, 3072
    s_mov_b32 s62, 49152
    buffer_load_dwordx4 v80, s[12:15], s62 offen lds
    s_add_u32 m0, s60, 4096
    s_mov_b32 s62, 65536
    buffer_load_dwordx4 v80, s[12:15], s62 offen lds
    s_add_u32 m0, s60, 5120
    s_mov_b32 s62, 81920
    buffer_load_dwordx4 v80, s[12:15], s62 offen lds
    s_add_u32 m0, s60, 6144
    s_mov_b32 s62, 98304
    buffer_load_dwordx4 v80, s[12:15], s62 offen lds
    s_add_u32 m0, s60, 7168
    s_mov_b32 s62, 114688
    buffer_load_dwordx4 v80, s[12:15], s62 offen lds
    s_add_u32 m0, s60, 8192
    s_mov_b32 s62, 131072
    buffer_load_dwordx4 v80, s[12:15], s62 offen lds
    s_add_u32 m0, s60, 9216
    s_mov_b32 s62, 147456
    buffer_load_dwordx4 v80, s[12:15], s62 offen lds
    s_add_u32 m0, s60, 10240
    s_mov_b32 s62, 163840
    buffer_load_dwordx4 v80, s[12:15], s62 offen lds
    s_add_u32 m0, s60, 11264
    s_mov_b32 s62, 180224
    buffer_load_dwordx4 v80, s[12:15], s62 offen lds
    s_add_u32 m0, s60, 12288
    s_mov_b32 s62, 196608
    buffer_load_dwordx4 v80, s[12:15], s62 offen lds
    s_add_u32 m0, s60, 13312
    s_mov_b32 s62, 212992
    buffer_load_dwordx4 v80, s[12:15], s62 offen lds
    s_add_u32 m0, s60, 14336
    s_mov_b32 s62, 229376
    buffer_load_dwordx4 v80, s[12:15], s62 offen lds
    s_add_u32 m0, s60, 15360
    s_mov_b32 s62, 245760
    buffer_load_dwordx4 v80, s[12:15], s62 offen lds
    s_add_u32 m0, s60, 16384
    s_mov_b32 s62, 262144
    buffer_load_dwordx4 v80, s[12:15], s62 offen lds
    s_add_u32 m0, s60, 17408
    s_mov_b32 s62, 278528
    buffer_load_dwordx4 v80, s[12:15], s62 offen lds
    s_add_u32 m0, s60, 18432
    s_mov_b32 s62, 294912
    buffer_load_dwordx4 v80, s[12:15], s62 offen lds
    s_add_u32 m0, s60, 19456
    s_mov_b32 s62, 311296
    buffer_load_dwordx4 v80, s[12:15], s62 offen lds
    s_add_u32 m0, s60, 20480
    s_mov_b32 s62, 327680
    buffer_load_dwordx4 v80, s[12:15], s62 offen lds
    s_add_u32 m0, s60, 21504
    s_mov_b32 s62, 344064
    buffer_load_dwordx4 v80, s[12:15], s62 offen lds
    s_add_u32 m0, s60, 22528
    s_mov_b32 s62, 360448
    buffer_load_dwordx4 v80, s[12:15], s62 offen lds
    s_add_u32 m0, s60, 23552
    s_mov_b32 s62, 376832
    buffer_load_dwordx4 v80, s[12:15], s62 offen lds
    s_add_u32 m0, s60, 24576
    s_mov_b32 s62, 393216
    buffer_load_dwordx4 v80, s[12:15], s62 offen lds
    s_add_u32 m0, s60, 25600
    s_mov_b32 s62, 409600
    buffer_load_dwordx4 v80, s[12:15], s62 offen lds
    s_add_u32 m0, s60, 26624
    s_mov_b32 s62, 425984
    buffer_load_dwordx4 v80, s[12:15], s62 offen lds
    s_add_u32 m0, s60, 27648
    s_mov_b32 s62, 442368
    buffer_load_dwordx4 v80, s[12:15], s62 offen lds
    s_add_u32 m0, s60, 28672
    s_mov_b32 s62, 458752
    buffer_load_dwordx4 v80, s[12:15], s62 offen lds
    s_add_u32 m0, s60, 29696
    s_mov_b32 s62, 475136
    buffer_load_dwordx4 v80, s[12:15], s62 offen lds
    s_add_u32 m0, s60, 30720
    s_mov_b32 s62, 491520
    buffer_load_dwordx4 v80, s[12:15], s62 offen lds
    s_add_u32 m0, s60, 31744
    s_mov_b32 s62, 507904
    buffer_load_dwordx4 v80, s[12:15], s62 offen lds
    s_waitcnt vmcnt(28)
    ds_read_b64_tr_b16 a[0:1], v81 offset:0
    ds_read_b64_tr_b16 a[2:3], v81 offset:1024
    ds_read_b64_tr_b16 a[4:5], v81 offset:2048
    ds_read_b64_tr_b16 a[6:7], v81 offset:3072
    ds_read_b64_tr_b16 a[8:9], v81 offset:8
    ds_read_b64_tr_b16 a[10:11], v81 offset:1032
    ds_read_b64_tr_b16 a[12:13], v81 offset:2056
    ds_read_b64_tr_b16 a[14:15], v81 offset:3080
    s_waitcnt vmcnt(24)
    ds_read_b64_tr_b16 a[16:17], v81 offset:4096
    ds_read_b64_tr_b16 a[18:19], v81 offset:5120
    ds_read_b64_tr_b16 a[20:21], v81 offset:6144
    ds_read_b64_tr_b16 a[22:23], v81 offset:7168
    ds_read_b64_tr_b16 a[24:25], v81 offset:4104
    ds_read_b64_tr_b16 a[26:27], v81 offset:5128
    ds_read_b64_tr_b16 a[28:29], v81 offset:6152
    ds_read_b64_tr_b16 a[30:31], v81 offset:7176
    s_waitcnt vmcnt(20)
    ds_read_b64_tr_b16 a[32:33], v81 offset:8192
    ds_read_b64_tr_b16 a[34:35], v81 offset:9216
    ds_read_b64_tr_b16 a[36:37], v81 offset:10240
    ds_read_b64_tr_b16 a[38:39], v81 offset:11264
    ds_read_b64_tr_b16 a[40:41], v81 offset:8200
    ds_read_b64_tr_b16 a[42:43], v81 offset:9224
    ds_read_b64_tr_b16 a[44:45], v81 offset:10248
    ds_read_b64_tr_b16 a[46:47], v81 offset:11272
    s_waitcnt vmcnt(16)
    ds_read_b64_tr_b16 a[48:49], v81 offset:12288
    ds_read_b64_tr_b16 a[50:51], v81 offset:13312
    ds_read_b64_tr_b16 a[52:53], v81 offset:14336
    ds_read_b64_tr_b16 a[54:55], v81 offset:15360
    ds_read_b64_tr_b16 a[56:57], v81 offset:12296
    ds_read_b64_tr_b16 a[58:59], v81 offset:13320
    ds_read_b64_tr_b16 a[60:61], v81 offset:14344
    ds_read_b64_tr_b16 a[62:63], v81 offset:15368
    s_waitcnt vmcnt(12)
    ds_read_b64_tr_b16 a[64:65], v81 offset:16384
    ds_read_b64_tr_b16 a[66:67], v81 offset:17408
    ds_read_b64_tr_b16 a[68:69], v81 offset:18432
    ds_read_b64_tr_b16 a[70:71], v81 offset:19456
    ds_read_b64_tr_b16 a[72:73], v81 offset:16392
    ds_read_b64_tr_b16 a[74:75], v81 offset:17416
    ds_read_b64_tr_b16 a[76:77], v81 offset:18440
    ds_read_b64_tr_b16 a[78:79], v81 offset:19464
    s_waitcnt vmcnt(8)
    ds_read_b64_tr_b16 a[80:81], v81 offset:20480
    ds_read_b64_tr_b16 a[82:83], v81 offset:21504
    ds_read_b64_tr_b16 a[84:85], v81 offset:22528
    ds_read_b64_tr_b16 a[86:87], v81 offset:23552
    ds_read_b64_tr_b16 a[88:89], v81 offset:20488
    ds_read_b64_tr_b16 a[90:91], v81 offset:21512
    ds_read_b64_tr_b16 a[92:93], v81 offset:22536
    ds_read_b64_tr_b16 a[94:95], v81 offset:23560
    s_waitcnt vmcnt(4)
    ds_read_b64_tr_b16 a[96:97], v81 offset:24576
    ds_read_b64_tr_b16 a[98:99], v81 offset:25600
    ds_read_b64_tr_b16 a[100:101], v81 offset:26624
    ds_read_b64_tr_b16 a[102:103], v81 offset:27648
    ds_read_b64_tr_b16 a[104:105], v81 offset:24584
    ds_read_b64_tr_b16 a[106:107], v81 offset:25608
    ds_read_b64_tr_b16 a[108:109], v81 offset:26632
    ds_read_b64_tr_b16 a[110:111], v81 offset:27656
    s_waitcnt vmcnt(0)
    ds_read_b64_tr_b16 a[112:113], v81 offset:28672
    ds_read_b64_tr_b16 a[114:115], v81 offset:29696
    ds_read_b64_tr_b16 a[116:117], v81 offset:30720
    ds_read_b64_tr_b16 a[118:119], v81 offset:31744
    ds_read_b64_tr_b16 a[120:121], v81 offset:28680
    ds_read_b64_tr_b16 a[122:123], v81 offset:29704
    ds_read_b64_tr_b16 a[124:125], v81 offset:30728
    ds_read_b64_tr_b16 a[126:127], v81 offset:31752
    s_waitcnt lgkmcnt(0)
    s_lshl_b32 s73, s71, 7
    s_add_u32 s73, s73, 8192
    s_add_u32 s46, s4, s73
    s_addc_u32 s47, s5, 0
L_spin_21:
    global_load_dword v4, v82, s[46:47] sc1
    s_sub_u32 s50, s50, 1
    s_cselect_b64 s[48:49], 0, s[48:49]
    s_waitcnt vmcnt(0)
    v_cmp_eq_u32 vcc, 0, v4
    s_and_b64 vcc, vcc, s[48:49]
    s_cbranch_scc0 L_spino_22
    s_sleep 4
    s_branch L_spin_21
L_spino_22:
    s_lshl_b32 s73, s74, 16
    s_add_u32 s73, s73, 104861696
    s_add_u32 s42, s4, s73
    s_addc_u32 s43, s5, 0
    global_load_dwordx4 v[96:99], v0, s[42:43] offset:-4096 sc1
    global_load_dwordx4 v[100:103], v0, s[42:43] offset:-3072 sc1
    global_load_dwordx4 v[104:107], v0, s[42:43] offset:-2048 sc1
    global_load_dwordx4 v[108:111], v0, s[42:43] offset:-1024 sc1
    global_load_dwordx4 v[112:115], v0, s[42:43] offset:0 sc1
    global_load_dwordx4 v[116:119], v0, s[42:43] offset:1024 sc1
    global_load_dwordx4 v[120:123], v0, s[42:43] offset:2048 sc1
    global_load_dwordx4 v[124:127], v0, s[42:43] offset:3072 sc1
    s_add_u32 s42, s42, 8192
    s_addc_u32 s43, s43, 0
    global_load_dwordx4 v[160:163], v0, s[42:43] offset:-4096 sc1
    global_load_dwordx4 v[164:167], v0, s[42:43] offset:-3072 sc1
    global_load_dwordx4 v[168:171], v0, s[42:43] offset:-2048 sc1
    global_load_dwordx4 v[172:175], v0, s[42:43] offset:-1024 sc1
    global_load_dwordx4 v[176:179], v0, s[42:43] offset:0 sc1
    global_load_dwordx4 v[180:183], v0, s[42:43] offset:1024 sc1
    global_load_dwordx4 v[184:187], v0, s[42:43] offset:2048 sc1
    global_load_dwordx4 v[188:191], v0, s[42:43] offset:3072 sc1
    s_add_u32 s42, s42, 8192
    s_addc_u32 s43, s43, 0
    global_load_dwordx4 v[192:195], v0, s[42:43] offset:-4096 sc1
    global_load_dwordx4 v[196:199], v0, s[42:43] offset:-3072 sc1
    global_load_dwordx4 v[200:203], v0, s[42:43] offset:-2048 sc1
    global_load_dwordx4 v[204:207], v0, s[42:43] offset:-1024 sc1
    global_load_dwordx4 v[208:211], v0, s[42:43] offset:0 sc1
    global_load_dwordx4 v[212:215], v0, s[42:43] offset:1024 sc1
    global_load_dwordx4 v[216:219], v0, s[42:43] offset:2048 sc1
    global_load_dwordx4 v[220:223], v0, s[42:43] offset:3072 sc1
    s_add_u32 s42, s42, 8192
    s_addc_u32 s43, s43, 0
    global_load_dwordx4 v[224:227], v0, s[42:43] offset:-4096 sc1
    global_load_dwordx4 v[228:231], v0, s[42:43] offset:-3072 sc1
    global_load_dwordx4 v[232:235], v0, s[42:43] offset:-2048 sc1
    global_load_dwordx4 v[236:239], v0, s[42:43] offset:-1024 sc1
    global_load_dwordx4 v[240:243], v0, s[42:43] offset:0 sc1
    global_load_dwordx4 v[244:247], v0, s[42:43] offset:1024 sc1
    global_load_dwordx4 v[248:251], v0, s[42:43] offset:2048 sc1
    global_load_dwordx4 v[252:255], v0, s[42:43] offset:3072 sc1
    s_add_u32 s42, s42, 8192
    s_addc_u32 s43, s43, 0
    s_waitcnt vmcnt(0)
    v_pk_add_f32 v[96:97], v[96:97], v[160:161]
    v_pk_add_f32 v[98:99], v[98:99], v[162:163]
    v_pk_add_f32 v[100:101], v[100:101], v[164:165]
    v_pk_add_f32 v[102:103], v[102:103], v[166:167]
    v_pk_add_f32 v[104:105], v[104:105], v[168:169]
    v_pk_add_f32 v[106:107], v[106:107], v[170:171]
    v_pk_add_f32 v[108:109], v[108:109], v[172:173]
    v_pk_add_f32 v[110:111], v[110:111], v[174:175]
    v_pk_add_f32 v[112:113], v[112:113], v[176:177]
    v_pk_add_f32 v[114:115], v[114:115], v[178:179]
    v_pk_add_f32 v[116:117], v[116:117], v[180:181]
    v_pk_add_f32 v[118:119], v[118:119], v[182:183]
    v_pk_add_f32 v[120:121], v[120:121], v[184:185]
    v_pk_add_f32 v[122:123], v[122:123], v[186:187]
    v_pk_add_f32 v[124:125], v[124:125], v[188:189]
    v_pk_add_f32 v[126:127], v[126:127], v[190:191]
    v_pk_add_f32 v[96:97], v[96:97], v[192:193]
    v_pk_add_f32 v[98:99], v[98:99], v[194:195]
    v_pk_add_f32 v[100:101], v[100:101], v[196:197]
    v_pk_add_f32 v[102:103], v[102:103], v[198:199]
    v_pk_add_f32 v[104:105], v[104:105], v[200:201]
    v_pk_add_f32 v[106:107], v[106:107], v[202:203]
    v_pk_add_f32 v[108:109], v[108:109], v[204:205]
    v_pk_add_f32 v[110:111], v[110:111], v[206:207]
    v_pk_add_f32 v[112:113], v[112:113], v[208:209]
    v_pk_add_f32 v[114:115], v[114:115], v[210:211]
    v_pk_add_f32 v[116:117], v[116:117], v[212:213]
    v_pk_add_f32 v[118:119], v[118:119], v[214:215]
    v_pk_add_f32 v[120:121], v[120:121], v[216:217]
    v_pk_add_f32 v[122:123], v[122:123], v[218:219]
    v_pk_add_f32 v[124:125], v[124:125], v[220:221]
    v_pk_add_f32 v[126:127], v[126:127], v[222:223]
    v_pk_add_f32 v[96:97], v[96:97], v[224:225]
    v_pk_add_f32 v[98:99], v[98:99], v[226:227]
    v_pk_add_f32 v[100:101], v[100:101], v[228:229]
    v_pk_add_f32 v[102:103], v[102:103], v[230:231]
    v_pk_add_f32 v[104:105], v[104:105], v[232:233]
    v_pk_add_f32 v[106:107], v[106:107], v[234:235]
    v_pk_add_f32 v[108:109], v[108:109], v[236:237]
    v_pk_add_f32 v[110:111], v[110:111], v[238:239]
    v_pk_add_f32 v[112:113], v[112:113], v[240:241]
    v_pk_add_f32 v[114:115], v[114:115], v[242:243]
    v_pk_add_f32 v[116:117], v[116:117], v[244:245]
    v_pk_add_f32 v[118:119], v[118:119], v[246:247]
    v_pk_add_f32 v[120:121], v[120:121], v[248:249]
    v_pk_add_f32 v[122:123], v[122:123], v[250:251]
    v_pk_add_f32 v[124:125], v[124:125], v[252:253]
    v_pk_add_f32 v[126:127], v[126:127], v[254:255]
    global_load_dwordx4 v[128:131], v0, s[42:43] offset:-4096 sc1
    global_load_dwordx4 v[132:135], v0, s[42:43] offset:-3072 sc1
    global_load_dwordx4 v[136:139], v0, s[42:43] offset:-2048 sc1
    global_load_dwordx4 v[140:143], v0, s[42:43] offset:-1024 sc1
    global_load_dwordx4 v[144:147], v0, s[42:43] offset:0 sc1
    global_load_dwordx4 v[148:151], v0, s[42:43] offset:1024 sc1
    global_load_dwordx4 v[152:155], v0, s[42:43] offset:2048 sc1
    global_load_dwordx4 v[156:159], v0, s[42:43] offset:3072 sc1
    s_add_u32 s42, s42, 8192
    s_addc_u32 s43, s43, 0
    global_load_dwordx4 v[160:163], v0, s[42:43] offset:-4096 sc1
    global_load_dwordx4 v[164:167], v0, s[42:43] offset:-3072 sc1
    global_load_dwordx4 v[168:171], v0, s[42:43] offset:-2048 sc1
    global_load_dwordx4 v[172:175], v0, s[42:43] offset:-1024 sc1
    global_load_dwordx4 v[176:179], v0, s[42:43] offset:0 sc1
    global_load_dwordx4 v[180:183], v0, s[42:43] offset:1024 sc1
    global_load_dwordx4 v[184:187], v0, s[42:43] offset:2048 sc1
    global_load_dwordx4 v[188:191], v0, s[42:43] offset:3072 sc1
    s_add_u32 s42, s42, 8192
    s_addc_u32 s43, s43, 0
    global_load_dwordx4 v[192:195], v0, s[42:43] offset:-4096 sc1
    global_load_dwordx4 v[196:199], v0, s[42:43] offset:-3072 sc1
    global_load_dwordx4 v[200:203], v0, s[42:43] offset:-2048 sc1
    global_load_dwordx4 v[204:207], v0, s[42:43] offset:-1024 sc1
    global_load_dwordx4 v[208:211], v0, s[42:43] offset:0 sc1
    global_load_dwordx4 v[212:215], v0, s[42:43] offset:1024 sc1
    global_load_dwordx4 v[216:219], v0, s[42:43] offset:2048 sc1
    global_load_dwordx4 v[220:223], v0, s[42:43] offset:3072 sc1
    s_add_u32 s42, s42, 8192
    s_addc_u32 s43, s43, 0
    global_load_dwordx4 v[224:227], v0, s[42:43] offset:-4096 sc1
    global_load_dwordx4 v[228:231], v0, s[42:43] offset:-3072 sc1
    global_load_dwordx4 v[232:235], v0, s[42:43] offset:-2048 sc1
    global_load_dwordx4 v[236:239], v0, s[42:43] offset:-1024 sc1
    global_load_dwordx4 v[240:243], v0, s[42:43] offset:0 sc1
    global_load_dwordx4 v[244:247], v0, s[42:43] offset:1024 sc1
    global_load_dwordx4 v[248:251], v0, s[42:43] offset:2048 sc1
    global_load_dwordx4 v[252:255], v0, s[42:43] offset:3072 sc1
    s_add_u32 s42, s42, 8192
    s_addc_u32 s43, s43, 0
    s_waitcnt vmcnt(0)
    v_pk_add_f32 v[96:97], v[96:97], v[128:129]
    v_pk_add_f32 v[98:99], v[98:99], v[130:131]
    v_pk_add_f32 v[100:101], v[100:101], v[132:133]
    v_pk_add_f32 v[102:103], v[102:103], v[134:135]
    v_pk_add_f32 v[104:105], v[104:105], v[136:137]
    v_pk_add_f32 v[106:107], v[106:107], v[138:139]
    v_pk_add_f32 v[108:109], v[108:109], v[140:141]
    v_pk_add_f32 v[110:111], v[110:111], v[142:143]
    v_pk_add_f32 v[112:113], v[112:113], v[144:145]
    v_pk_add_f32 v[114:115], v[114:115], v[146:147]
    v_pk_add_f32 v[116:117], v[116:117], v[148:149]
    v_pk_add_f32 v[118:119], v[118:119], v[150:151]
    v_pk_add_f32 v[120:121], v[120:121], v[152:153]
    v_pk_add_f32 v[122:123], v[122:123], v[154:155]
    v_pk_add_f32 v[124:125], v[124:125], v[156:157]
    v_pk_add_f32 v[126:127], v[126:127], v[158:159]
    v_pk_add_f32 v[96:97], v[96:97], v[160:161]
    v_pk_add_f32 v[98:99], v[98:99], v[162:163]
    v_pk_add_f32 v[100:101], v[100:101], v[164:165]
    v_pk_add_f32 v[102:103], v[102:103], v[166:167]
    v_pk_add_f32 v[104:105], v[104:105], v[168:169]
    v_pk_add_f32 v[106:107], v[106:107], v[170:171]
    v_pk_add_f32 v[108:109], v[108:109], v[172:173]
    v_pk_add_f32 v[110:111], v[110:111], v[174:175]
    v_pk_add_f32 v[112:113], v[112:113], v[176:177]
    v_pk_add_f32 v[114:115], v[114:115], v[178:179]
    v_pk_add_f32 v[116:117], v[116:117], v[180:181]
    v_pk_add_f32 v[118:119], v[118:119], v[182:183]
    v_pk_add_f32 v[120:121], v[120:121], v[184:185]
    v_pk_add_f32 v[122:123], v[122:123], v[186:187]
    v_pk_add_f32 v[124:125], v[124:125], v[188:189]
    v_pk_add_f32 v[126:127], v[126:127], v[190:191]
    v_pk_add_f32 v[96:97], v[96:97], v[192:193]
    v_pk_add_f32 v[98:99], v[98:99], v[194:195]
    v_pk_add_f32 v[100:101], v[100:101], v[196:197]
    v_pk_add_f32 v[102:103], v[102:103], v[198:199]
    v_pk_add_f32 v[104:105], v[104:105], v[200:201]
    v_pk_add_f32 v[106:107], v[106:107], v[202:203]
    v_pk_add_f32 v[108:109], v[108:109], v[204:205]
    v_pk_add_f32 v[110:111], v[110:111], v[206:207]
    v_pk_add_f32 v[112:113], v[112:113], v[208:209]
    v_pk_add_f32 v[114:115], v[114:115], v[210:211]
    v_pk_add_f32 v[116:117], v[116:117], v[212:213]
    v_pk_add_f32 v[118:119], v[118:119], v[214:215]
    v_pk_add_f32 v[120:121], v[120:121], v[216:217]
    v_pk_add_f32 v[122:123], v[122:123], v[218:219]
    v_pk_add_f32 v[124:125], v[124:125], v[220:221]
    v_pk_add_f32 v[126:127], v[126:127], v[222:223]
    v_pk_add_f32 v[96:97], v[96:97], v[224:225]
    v_pk_add_f32 v[98:99], v[98:99], v[226:227]
    v_pk_add_f32 v[100:101], v[100:101], v[228:229]
    v_pk_add_f32 v[102:103], v[102:103], v[230:231]
    v_pk_add_f32 v[104:105], v[104:105], v[232:233]
    v_pk_add_f32 v[106:107], v[106:107], v[234:235]
    v_pk_add_f32 v[108:109], v[108:109], v[236:237]
    v_pk_add_f32 v[110:111], v[110:111], v[238:239]
    v_pk_add_f32 v[112:113], v[112:113], v[240:241]
    v_pk_add_f32 v[114:115], v[114:115], v[242:243]
    v_pk_add_f32 v[116:117], v[116:117], v[244:245]
    v_pk_add_f32 v[118:119], v[118:119], v[246:247]
    v_pk_add_f32 v[120:121], v[120:121], v[248:249]
    v_pk_add_f32 v[122:123], v[122:123], v[250:251]
    v_pk_add_f32 v[124:125], v[124:125], v[252:253]
    v_pk_add_f32 v[126:127], v[126:127], v[254:255]
    v_cvt_pk_bf16_f32 v16, v96, v97
    v_cvt_pk_bf16_f32 v17, v98, v99
    v_cvt_pk_bf16_f32 v18, v100, v101
    v_cvt_pk_bf16_f32 v19, v102, v103
    v_cvt_pk_bf16_f32 v20, v104, v105
    v_cvt_pk_bf16_f32 v21, v106, v107
    v_cvt_pk_bf16_f32 v22, v108, v109
    v_cvt_pk_bf16_f32 v23, v110, v111
    v_cvt_pk_bf16_f32 v24, v112, v113
    v_cvt_pk_bf16_f32 v25, v114, v115
    v_cvt_pk_bf16_f32 v26, v116, v117
    v_cvt_pk_bf16_f32 v27, v118, v119
    v_cvt_pk_bf16_f32 v28, v120, v121
    v_cvt_pk_bf16_f32 v29, v122, v123
    v_cvt_pk_bf16_f32 v30, v124, v125
    v_cvt_pk_bf16_f32 v31, v126, v127
    s_lshl_b32 s73, s32, 17
    s_lshl_b32 s72, s33, 15
    s_add_u32 s73, s73, s72
    s_add_u32 s73, s73, 100667392
    s_add_u32 s40, s4, s73
    s_addc_u32 s41, s5, 0
    global_load_dwordx4 v[128:131], v0, s[40:41] offset:-4096 sc1
    global_load_dwordx4 v[132:135], v0, s[40:41] offset:-3072 sc1
    global_load_dwordx4 v[136:139], v0, s[40:41] offset:-2048 sc1
    global_load_dwordx4 v[140:143], v0, s[40:41] offset:-1024 sc1
    global_load_dwordx4 v[144:147], v0, s[40:41] offset:0 sc1
    global_load_dwordx4 v[148:151], v0, s[40:41] offset:1024 sc1
    global_load_dwordx4 v[152:155], v0, s[40:41] offset:2048 sc1
    global_load_dwordx4 v[156:159], v0, s[40:41] offset:3072 sc1
    s_add_u32 s40, s40, 8192
    s_addc_u32 s41, s41, 0
    global_load_dwordx4 v[160:163], v0, s[40:41] offset:-4096 sc1
    global_load_dwordx4 v[164:167], v0, s[40:41] offset:-3072 sc1
    global_load_dwordx4 v[168:171], v0, s[40:41] offset:-2048 sc1
    global_load_dwordx4 v[172:175], v0, s[40:41] offset:-1024 sc1
    global_load_dwordx4 v[176:179], v0, s[40:41] offset:0 sc1
    global_load_dwordx4 v[180:183], v0, s[40:41] offset:1024 sc1
    global_load_dwordx4 v[184:187], v0, s[40:41] offset:2048 sc1
    global_load_dwordx4 v[188:191], v0, s[40:41] offset:3072 sc1
    s_add_u32 s40, s40, 8192
    s_addc_u32 s41, s41, 0
    global_load_dwordx4 v[192:195], v0, s[40:41] offset:-4096 sc1
    global_load_dwordx4 v[196:199], v0, s[40:41] offset:-3072 sc1
    global_load_dwordx4 v[200:203], v0, s[40:41] offset:-2048 sc1
    global_load_dwordx4 v[204:207], v0, s[40:41] offset:-1024 sc1
    global_load_dwordx4 v[208:211], v0, s[40:41] offset:0 sc1
    global_load_dwordx4 v[212:215], v0, s[40:41] offset:1024 sc1
    global_load_dwordx4 v[216:219], v0, s[40:41] offset:2048 sc1
    global_load_dwordx4 v[220:223], v0, s[40:41] offset:3072 sc1
    s_add_u32 s40, s40, 8192
    s_addc_u32 s41, s41, 0
    global_load_dwordx4 v[224:227], v0, s[40:41] offset:-4096 sc1
    global_load_dwordx4 v[228:231], v0, s[40:41] offset:-3072 sc1
    global_load_dwordx4 v[232:235], v0, s[40:41] offset:-2048 sc1
    global_load_dwordx4 v[236:239], v0, s[40:41] offset:-1024 sc1
    global_load_dwordx4 v[240:243], v0, s[40:41] offset:0 sc1
    global_load_dwordx4 v[244:247], v0, s[40:41] offset:1024 sc1
    global_load_dwordx4 v[248:251], v0, s[40:41] offset:2048 sc1
    global_load_dwordx4 v[252:255], v0, s[40:41] offset:3072 sc1
    s_add_u32 s40, s40, 8192
    s_addc_u32 s41, s41, 0
    s_lshl_b32 s73, s70, 18
    s_lshl_b32 s72, s74, 10
    s_add_u32 s73, s73, s72
    s_add_u32 s73, s73, 106954752
    s_add_u32 s42, s4, s73
    s_addc_u32 s43, s5, 0
    s_mov_b32 s52, 0x358637bd
    s_waitcnt vmcnt(0)
    v_mfma_f32_16x16x32_bf16 v[40:43], v[20:23], v[128:131], 0
    v_mfma_f32_16x16x32_bf16 v[44:47], v[28:31], v[132:135], 0
    v_mfma_f32_16x16x32_bf16 v[32:35], v[16:19], v[128:131], 0
    v_mfma_f32_16x16x32_bf16 v[36:39], v[24:27], v[132:135], 0
    v_add_f32 v40, s52, v40
    v_add_f32 v44, s52, v44
    v_rcp_f32 v40, v40
    v_rcp_f32 v44, v44
    v_mul_f32 v32, v32, v40
    v_mul_f32 v33, v33, v40
    v_mul_f32 v34, v34, v40
    v_mul_f32 v35, v35, v40
    v_mul_f32 v36, v36, v44
    v_mul_f32 v37, v37, v44
    v_mul_f32 v38, v38, v44
    v_mul_f32 v39, v39, v44
    v_cvt_pk_bf16_f32 v48, v32, v33
    v_cvt_pk_bf16_f32 v49, v34, v35
    v_cvt_pk_bf16_f32 v50, v36, v37
    v_cvt_pk_bf16_f32 v51, v38, v39
    global_store_dwordx4 v0, v[48:51], s[42:43] sc1
    s_add_u32 s42, s42, 16384
    s_addc_u32 s43, s43, 0
    v_mfma_f32_16x16x32_bf16 v[60:63], v[20:23], v[136:139], 0
    v_mfma_f32_16x16x32_bf16 v[64:67], v[28:31], v[140:143], 0
    v_mfma_f32_16x16x32_bf16 v[52:55], v[16:19], v[136:139], 0
    v_mfma_f32_16x16x32_bf16 v[56:59], v[24:27], v[140:143], 0
    v_add_f32 v60, s52, v60
    v_add_f32 v64, s52, v64
    v_rcp_f32 v60, v60
    v_rcp_f32 v64, v64
    v_mul_f32 v52, v52, v60
    v_mul_f32 v53, v53, v60
    v_mul_f32 v54, v54, v60
    v_mul_f32 v55, v55, v60
    v_mul_f32 v56, v56, v64
    v_mul_f32 v57, v57, v64
    v_mul_f32 v58, v58, v64
    v_mul_f32 v59, v59, v64
    v_cvt_pk_bf16_f32 v68, v52, v53
    v_cvt_pk_bf16_f32 v69, v54, v55
    v_cvt_pk_bf16_f32 v70, v56, v57
    v_cvt_pk_bf16_f32 v71, v58, v59
    global_store_dwordx4 v0, v[68:71], s[42:43] sc1
    s_add_u32 s42, s42, 16384
    s_addc_u32 s43, s43, 0
    v_mfma_f32_16x16x32_bf16 v[40:43], v[20:23], v[144:147], 0
    v_mfma_f32_16x16x32_bf16 v[44:47], v[28:31], v[148:151], 0
    v_mfma_f32_16x16x32_bf16 v[32:35], v[16:19], v[144:147], 0
    v_mfma_f32_16x16x32_bf16 v[36:39], v[24:27], v[148:151], 0
    v_add_f32 v40, s52, v40
    v_add_f32 v44, s52, v44
    v_rcp_f32 v40, v40
    v_rcp_f32 v44, v44
    v_mul_f32 v32, v32, v40
    v_mul_f32 v33, v33, v40
    v_mul_f32 v34, v34, v40
    v_mul_f32 v35, v35, v40
    v_mul_f32 v36, v36, v44
    v_mul_f32 v37, v37, v44
    v_mul_f32 v38, v38, v44
    v_mul_f32 v39, v39, v44
    v_cvt_pk_bf16_f32 v48, v32, v33
    v_cvt_pk_bf16_f32 v49, v34, v35
    v_cvt_pk_bf16_f32 v50, v36, v37
    v_cvt_pk_bf16_f32 v51, v38, v39
    global_store_dwordx4 v0, v[48:51], s[42:43] sc1
    s_add_u32 s42, s42, 16384
    s_addc_u32 s43, s43, 0
    v_mfma_f32_16x16x32_bf16 v[60:63], v[20:23], v[152:155], 0
    v_mfma_f32_16x16x32_bf16 v[64:67], v[28:31], v[156:159], 0
    v_mfma_f32_16x16x32_bf16 v[52:55], v[16:19], v[152:155], 0
    v_mfma_f32_16x16x32_bf16 v[56:59], v[24:27], v[156:159], 0
    v_add_f32 v60, s52, v60
    v_add_f32 v64, s52, v64
    v_rcp_f32 v60, v60
    v_rcp_f32 v64, v64
    v_mul_f32 v52, v52, v60
    v_mul_f32 v53, v53, v60
    v_mul_f32 v54, v54, v60
    v_mul_f32 v55, v55, v60
    v_mul_f32 v56, v56, v64
    v_mul_f32 v57, v57, v64
    v_mul_f32 v58, v58, v64
    v_mul_f32 v59, v59, v64
    v_cvt_pk_bf16_f32 v68, v52, v53
    v_cvt_pk_bf16_f32 v69, v54, v55
    v_cvt_pk_bf16_f32 v70, v56, v57
    v_cvt_pk_bf16_f32 v71, v58, v59
    global_store_dwordx4 v0, v[68:71], s[42:43] sc1
    s_add_u32 s42, s42, 16384
    s_addc_u32 s43, s43, 0
    v_mfma_f32_16x16x32_bf16 v[40:43], v[20:23], v[160:163], 0
    v_mfma_f32_16x16x32_bf16 v[44:47], v[28:31], v[164:167], 0
    v_mfma_f32_16x16x32_bf16 v[32:35], v[16:19], v[160:163], 0
    v_mfma_f32_16x16x32_bf16 v[36:39], v[24:27], v[164:167], 0
    v_add_f32 v40, s52, v40
    v_add_f32 v44, s52, v44
    v_rcp_f32 v40, v40
    v_rcp_f32 v44, v44
    v_mul_f32 v32, v32, v40
    v_mul_f32 v33, v33, v40
    v_mul_f32 v34, v34, v40
    v_mul_f32 v35, v35, v40
    v_mul_f32 v36, v36, v44
    v_mul_f32 v37, v37, v44
    v_mul_f32 v38, v38, v44
    v_mul_f32 v39, v39, v44
    v_cvt_pk_bf16_f32 v48, v32, v33
    v_cvt_pk_bf16_f32 v49, v34, v35
    v_cvt_pk_bf16_f32 v50, v36, v37
    v_cvt_pk_bf16_f32 v51, v38, v39
    global_store_dwordx4 v0, v[48:51], s[42:43] sc1
    s_add_u32 s42, s42, 16384
    s_addc_u32 s43, s43, 0
    v_mfma_f32_16x16x32_bf16 v[60:63], v[20:23], v[168:171], 0
    v_mfma_f32_16x16x32_bf16 v[64:67], v[28:31], v[172:175], 0
    v_mfma_f32_16x16x32_bf16 v[52:55], v[16:19], v[168:171], 0
    v_mfma_f32_16x16x32_bf16 v[56:59], v[24:27], v[172:175], 0
    v_add_f32 v60, s52, v60
    v_add_f32 v64, s52, v64
    v_rcp_f32 v60, v60
    v_rcp_f32 v64, v64
    v_mul_f32 v52, v52, v60
    v_mul_f32 v53, v53, v60
    v_mul_f32 v54, v54, v60
    v_mul_f32 v55, v55, v60
    v_mul_f32 v56, v56, v64
    v_mul_f32 v57, v57, v64
    v_mul_f32 v58, v58, v64
    v_mul_f32 v59, v59, v64
    v_cvt_pk_bf16_f32 v68, v52, v53
    v_cvt_pk_bf16_f32 v69, v54, v55
    v_cvt_pk_bf16_f32 v70, v56, v57
    v_cvt_pk_bf16_f32 v71, v58, v59
    global_store_dwordx4 v0, v[68:71], s[42:43] sc1
    s_add_u32 s42, s42, 16384
    s_addc_u32 s43, s43, 0
    v_mfma_f32_16x16x32_bf16 v[40:43], v[20:23], v[176:179], 0
    v_mfma_f32_16x16x32_bf16 v[44:47], v[28:31], v[180:183], 0
    v_mfma_f32_16x16x32_bf16 v[32:35], v[16:19], v[176:179], 0
    v_mfma_f32_16x16x32_bf16 v[36:39], v[24:27], v[180:183], 0
    v_add_f32 v40, s52, v40
    v_add_f32 v44, s52, v44
    v_rcp_f32 v40, v40
    v_rcp_f32 v44, v44
    v_mul_f32 v32, v32, v40
    v_mul_f32 v33, v33, v40
    v_mul_f32 v34, v34, v40
    v_mul_f32 v35, v35, v40
    v_mul_f32 v36, v36, v44
    v_mul_f32 v37, v37, v44
    v_mul_f32 v38, v38, v44
    v_mul_f32 v39, v39, v44
    v_cvt_pk_bf16_f32 v48, v32, v33
    v_cvt_pk_bf16_f32 v49, v34, v35
    v_cvt_pk_bf16_f32 v50, v36, v37
    v_cvt_pk_bf16_f32 v51, v38, v39
    global_store_dwordx4 v0, v[48:51], s[42:43] sc1
    s_add_u32 s42, s42, 16384
    s_addc_u32 s43, s43, 0
    v_mfma_f32_16x16x32_bf16 v[60:63], v[20:23], v[184:187], 0
    v_mfma_f32_16x16x32_bf16 v[64:67], v[28:31], v[188:191], 0
    v_mfma_f32_16x16x32_bf16 v[52:55], v[16:19], v[184:187], 0
    v_mfma_f32_16x16x32_bf16 v[56:59], v[24:27], v[188:191], 0
    v_add_f32 v60, s52, v60
    v_add_f32 v64, s52, v64
    v_rcp_f32 v60, v60
    v_rcp_f32 v64, v64
    v_mul_f32 v52, v52, v60
    v_mul_f32 v53, v53, v60
    v_mul_f32 v54, v54, v60
    v_mul_f32 v55, v55, v60
    v_mul_f32 v56, v56, v64
    v_mul_f32 v57, v57, v64
    v_mul_f32 v58, v58, v64
    v_mul_f32 v59, v59, v64
    v_cvt_pk_bf16_f32 v68, v52, v53
    v_cvt_pk_bf16_f32 v69, v54, v55
    v_cvt_pk_bf16_f32 v70, v56, v57
    v_cvt_pk_bf16_f32 v71, v58, v59
    global_store_dwordx4 v0, v[68:71], s[42:43] sc1
    s_add_u32 s42, s42, 16384
    s_addc_u32 s43, s43, 0
    v_mfma_f32_16x16x32_bf16 v[40:43], v[20:23], v[192:195], 0
    v_mfma_f32_16x16x32_bf16 v[44:47], v[28:31], v[196:199], 0
    v_mfma_f32_16x16x32_bf16 v[32:35], v[16:19], v[192:195], 0
    v_mfma_f32_16x16x32_bf16 v[36:39], v[24:27], v[196:199], 0
    v_add_f32 v40, s52, v40
    v_add_f32 v44, s52, v44
    v_rcp_f32 v40, v40
    v_rcp_f32 v44, v44
    v_mul_f32 v32, v32, v40
    v_mul_f32 v33, v33, v40
    v_mul_f32 v34, v34, v40
    v_mul_f32 v35, v35, v40
    v_mul_f32 v36, v36, v44
    v_mul_f32 v37, v37, v44
    v_mul_f32 v38, v38, v44
    v_mul_f32 v39, v39, v44
    v_cvt_pk_bf16_f32 v48, v32, v33
    v_cvt_pk_bf16_f32 v49, v34, v35
    v_cvt_pk_bf16_f32 v50, v36, v37
    v_cvt_pk_bf16_f32 v51, v38, v39
    global_store_dwordx4 v0, v[48:51], s[42:43] sc1
    s_add_u32 s42, s42, 16384
    s_addc_u32 s43, s43, 0
    v_mfma_f32_16x16x32_bf16 v[60:63], v[20:23], v[200:203], 0
    v_mfma_f32_16x16x32_bf16 v[64:67], v[28:31], v[204:207], 0
    v_mfma_f32_16x16x32_bf16 v[52:55], v[16:19], v[200:203], 0
    v_mfma_f32_16x16x32_bf16 v[56:59], v[24:27], v[204:207], 0
    v_add_f32 v60, s52, v60
    v_add_f32 v64, s52, v64
    v_rcp_f32 v60, v60
    v_rcp_f32 v64, v64
    v_mul_f32 v52, v52, v60
    v_mul_f32 v53, v53, v60
    v_mul_f32 v54, v54, v60
    v_mul_f32 v55, v55, v60
    v_mul_f32 v56, v56, v64
    v_mul_f32 v57, v57, v64
    v_mul_f32 v58, v58, v64
    v_mul_f32 v59, v59, v64
    v_cvt_pk_bf16_f32 v68, v52, v53
    v_cvt_pk_bf16_f32 v69, v54, v55
    v_cvt_pk_bf16_f32 v70, v56, v57
    v_cvt_pk_bf16_f32 v71, v58, v59
    global_store_dwordx4 v0, v[68:71], s[42:43] sc1
    s_add_u32 s42, s42, 16384
    s_addc_u32 s43, s43, 0
    v_mfma_f32_16x16x32_bf16 v[40:43], v[20:23], v[208:211], 0
    v_mfma_f32_16x16x32_bf16 v[44:47], v[28:31], v[212:215], 0
    v_mfma_f32_16x16x32_bf16 v[32:35], v[16:19], v[208:211], 0
    v_mfma_f32_16x16x32_bf16 v[36:39], v[24:27], v[212:215], 0
    v_add_f32 v40, s52, v40
    v_add_f32 v44, s52, v44
    v_rcp_f32 v40, v40
    v_rcp_f32 v44, v44
    v_mul_f32 v32, v32, v40
    v_mul_f32 v33, v33, v40
    v_mul_f32 v34, v34, v40
    v_mul_f32 v35, v35, v40
    v_mul_f32 v36, v36, v44
    v_mul_f32 v37, v37, v44
    v_mul_f32 v38, v38, v44
    v_mul_f32 v39, v39, v44
    v_cvt_pk_bf16_f32 v48, v32, v33
    v_cvt_pk_bf16_f32 v49, v34, v35
    v_cvt_pk_bf16_f32 v50, v36, v37
    v_cvt_pk_bf16_f32 v51, v38, v39
    global_store_dwordx4 v0, v[48:51], s[42:43] sc1
    s_add_u32 s42, s42, 16384
    s_addc_u32 s43, s43, 0
    v_mfma_f32_16x16x32_bf16 v[60:63], v[20:23], v[216:219], 0
    v_mfma_f32_16x16x32_bf16 v[64:67], v[28:31], v[220:223], 0
    v_mfma_f32_16x16x32_bf16 v[52:55], v[16:19], v[216:219], 0
    v_mfma_f32_16x16x32_bf16 v[56:59], v[24:27], v[220:223], 0
    v_add_f32 v60, s52, v60
    v_add_f32 v64, s52, v64
    v_rcp_f32 v60, v60
    v_rcp_f32 v64, v64
    v_mul_f32 v52, v52, v60
    v_mul_f32 v53, v53, v60
    v_mul_f32 v54, v54, v60
    v_mul_f32 v55, v55, v60
    v_mul_f32 v56, v56, v64
    v_mul_f32 v57, v57, v64
    v_mul_f32 v58, v58, v64
    v_mul_f32 v59, v59, v64
    v_cvt_pk_bf16_f32 v68, v52, v53
    v_cvt_pk_bf16_f32 v69, v54, v55
    v_cvt_pk_bf16_f32 v70, v56, v57
    v_cvt_pk_bf16_f32 v71, v58, v59
    global_store_dwordx4 v0, v[68:71], s[42:43] sc1
    s_add_u32 s42, s42, 16384
    s_addc_u32 s43, s43, 0
    v_mfma_f32_16x16x32_bf16 v[40:43], v[20:23], v[224:227], 0
    v_mfma_f32_16x16x32_bf16 v[44:47], v[28:31], v[228:231], 0
    v_mfma_f32_16x16x32_bf16 v[32:35], v[16:19], v[224:227], 0
    v_mfma_f32_16x16x32_bf16 v[36:39], v[24:27], v[228:231], 0
    v_add_f32 v40, s52, v40
    v_add_f32 v44, s52, v44
    v_rcp_f32 v40, v40
    v_rcp_f32 v44, v44
    v_mul_f32 v32, v32, v40
    v_mul_f32 v33, v33, v40
    v_mul_f32 v34, v34, v40
    v_mul_f32 v35, v35, v40
    v_mul_f32 v36, v36, v44
    v_mul_f32 v37, v37, v44
    v_mul_f32 v38, v38, v44
    v_mul_f32 v39, v39, v44
    v_cvt_pk_bf16_f32 v48, v32, v33
    v_cvt_pk_bf16_f32 v49, v34, v35
    v_cvt_pk_bf16_f32 v50, v36, v37
    v_cvt_pk_bf16_f32 v51, v38, v39
    global_store_dwordx4 v0, v[48:51], s[42:43] sc1
    s_add_u32 s42, s42, 16384
    s_addc_u32 s43, s43, 0
    v_mfma_f32_16x16x32_bf16 v[60:63], v[20:23], v[232:235], 0
    v_mfma_f32_16x16x32_bf16 v[64:67], v[28:31], v[236:239], 0
    v_mfma_f32_16x16x32_bf16 v[52:55], v[16:19], v[232:235], 0
    v_mfma_f32_16x16x32_bf16 v[56:59], v[24:27], v[236:239], 0
    v_add_f32 v60, s52, v60
    v_add_f32 v64, s52, v64
    v_rcp_f32 v60, v60
    v_rcp_f32 v64, v64
    v_mul_f32 v52, v52, v60
    v_mul_f32 v53, v53, v60
    v_mul_f32 v54, v54, v60
    v_mul_f32 v55, v55, v60
    v_mul_f32 v56, v56, v64
    v_mul_f32 v57, v57, v64
    v_mul_f32 v58, v58, v64
    v_mul_f32 v59, v59, v64
    v_cvt_pk_bf16_f32 v68, v52, v53
    v_cvt_pk_bf16_f32 v69, v54, v55
    v_cvt_pk_bf16_f32 v70, v56, v57
    v_cvt_pk_bf16_f32 v71, v58, v59
    global_store_dwordx4 v0, v[68:71], s[42:43] sc1
    s_add_u32 s42, s42, 16384
    s_addc_u32 s43, s43, 0
    v_mfma_f32_16x16x32_bf16 v[40:43], v[20:23], v[240:243], 0
    v_mfma_f32_16x16x32_bf16 v[44:47], v[28:31], v[244:247], 0
    v_mfma_f32_16x16x32_bf16 v[32:35], v[16:19], v[240:243], 0
    v_mfma_f32_16x16x32_bf16 v[36:39], v[24:27], v[244:247], 0
    v_add_f32 v40, s52, v40
    v_add_f32 v44, s52, v44
    v_rcp_f32 v40, v40
    v_rcp_f32 v44, v44
    v_mul_f32 v32, v32, v40
    v_mul_f32 v33, v33, v40
    v_mul_f32 v34, v34, v40
    v_mul_f32 v35, v35, v40
    v_mul_f32 v36, v36, v44
    v_mul_f32 v37, v37, v44
    v_mul_f32 v38, v38, v44
    v_mul_f32 v39, v39, v44
    v_cvt_pk_bf16_f32 v48, v32, v33
    v_cvt_pk_bf16_f32 v49, v34, v35
    v_cvt_pk_bf16_f32 v50, v36, v37
    v_cvt_pk_bf16_f32 v51, v38, v39
    global_store_dwordx4 v0, v[48:51], s[42:43] sc1
    s_add_u32 s42, s42, 16384
    s_addc_u32 s43, s43, 0
    v_mfma_f32_16x16x32_bf16 v[60:63], v[20:23], v[248:251], 0
    v_mfma_f32_16x16x32_bf16 v[64:67], v[28:31], v[252:255], 0
    v_mfma_f32_16x16x32_bf16 v[52:55], v[16:19], v[248:251], 0
    v_mfma_f32_16x16x32_bf16 v[56:59], v[24:27], v[252:255], 0
    v_add_f32 v60, s52, v60
    v_add_f32 v64, s52, v64
    v_rcp_f32 v60, v60
    v_rcp_f32 v64, v64
    v_mul_f32 v52, v52, v60
    v_mul_f32 v53, v53, v60
    v_mul_f32 v54, v54, v60
    v_mul_f32 v55, v55, v60
    v_mul_f32 v56, v56, v64
    v_mul_f32 v57, v57, v64
    v_mul_f32 v58, v58, v64
    v_mul_f32 v59, v59, v64
    v_cvt_pk_bf16_f32 v68, v52, v53
    v_cvt_pk_bf16_f32 v69, v54, v55
    v_cvt_pk_bf16_f32 v70, v56, v57
    v_cvt_pk_bf16_f32 v71, v58, v59
    global_store_dwordx4 v0, v[68:71], s[42:43] sc1
    s_add_u32 s42, s42, 16384
    s_addc_u32 s43, s43, 0
    s_lshl_b32 s73, s70, 7
    s_lshl_b32 s72, s71, 2
    s_add_u32 s73, s73, s72
    s_add_u32 s73, s73, 9216
    s_add_u32 s46, s4, s73
    s_addc_u32 s47, s5, 0
    s_waitcnt vmcnt(0)
    s_barrier
    s_cmp_eq_u32 s33, 0
    s_cbranch_scc0 L_nofl_23
    v_mov_b32 v4, 1
    s_mov_b64 exec, 1
    global_store_dword v3, v4, s[46:47] sc1
    s_mov_b64 exec, -1
L_nofl_23:
    s_lshl_b32 s73, s70, 7
    s_add_u32 s73, s73, 9216
    s_add_u32 s46, s4, s73
    s_addc_u32 s47, s5, 0
    v_and_b32 v82, 12, v82
L_spin_24:
    global_load_dword v4, v82, s[46:47] sc1
    s_sub_u32 s50, s50, 1
    s_cselect_b64 s[48:49], 0, s[48:49]
    s_waitcnt vmcnt(0)
    v_cmp_eq_u32 vcc, 0, v4
    s_and_b64 vcc, vcc, s[48:49]
    s_cbranch_scc0 L_spino_25
    s_sleep 4
    s_branch L_spin_24
L_spino_25:
    s_lshl_b32 s73, s70, 18
    s_add_u32 s73, s73, 106958848
    s_add_u32 s40, s4, s73
    s_addc_u32 s41, s5, 0
    s_lshl_b32 s73, s70, 19
    s_lshl_b32 s72, s74, 6
    s_add_u32 s73, s73, s72
    s_add_u32 s24, s88, s73
    s_addc_u32 s25, s89, 0
    global_load_dwordx4 v[128:131], v0, s[40:41] offset:-4096 sc1
    global_load_dwordx4 v[132:135], v0, s[40:41] offset:-3072 sc1
    global_load_dwordx4 v[136:139], v0, s[40:41] offset:-2048 sc1
    global_load_dwordx4 v[140:143], v0, s[40:41] offset:-1024 sc1
    global_load_dwordx4 v[144:147], v0, s[40:41] offset:0 sc1
    global_load_dwordx4 v[148:151], v0, s[40:41] offset:1024 sc1
    global_load_dwordx4 v[152:155], v0, s[40:41] offset:2048 sc1
    global_load_dwordx4 v[156:159], v0, s[40:41] offset:3072 sc1
    s_add_u32 s40, s40, 8192
    s_addc_u32 s41, s41, 0
    global_load_dwordx4 v[160:163], v0, s[40:41] offset:-4096 sc1
    global_load_dwordx4 v[164:167], v0, s[40:41] offset:-3072 sc1
    global_load_dwordx4 v[168:171], v0, s[40:41] offset:-2048 sc1
    global_load_dwordx4 v[172:175], v0, s[40:41] offset:-1024 sc1
    global_load_dwordx4 v[176:179], v0, s[40:41] offset:0 sc1
    global_load_dwordx4 v[180:183], v0, s[40:41] offset:1024 sc1
    global_load_dwordx4 v[184:187], v0, s[40:41] offset:2048 sc1
    global_load_dwordx4 v[188:191], v0, s[40:41] offset:3072 sc1
    s_add_u32 s40, s40, 8192
    s_addc_u32 s41, s41, 0
    s_mov_b32 s38, 0
L_awo_26:
    global_load_dwordx4 v[192:195], v0, s[40:41] offset:-4096 sc1
    global_load_dwordx4 v[196:199], v0, s[40:41] offset:-3072 sc1
    global_load_dwordx4 v[200:203], v0, s[40:41] offset:-2048 sc1
    global_load_dwordx4 v[204:207], v0, s[40:41] offset:-1024 sc1
    global_load_dwordx4 v[208:211], v0, s[40:41] offset:0 sc1
    global_load_dwordx4 v[212:215], v0, s[40:41] offset:1024 sc1
    global_load_dwordx4 v[216:219], v0, s[40:41] offset:2048 sc1
    global_load_dwordx4 v[220:223], v0, s[40:41] offset:3072 sc1
    s_add_u32 s40, s40, 8192
    s_addc_u32 s41, s41, 0
    global_load_dwordx4 v[224:227], v0, s[40:41] offset:-4096 sc1
    global_load_dwordx4 v[228:231], v0, s[40:41] offset:-3072 sc1
    global_load_dwordx4 v[232:235], v0, s[40:41] offset:-2048 sc1
    global_load_dwordx4 v[236:239], v0, s[40:41] offset:-1024 sc1
    global_load_dwordx4 v[240:243], v0, s[40:41] offset:0 sc1
    global_load_dwordx4 v[244:247], v0, s[40:41] offset:1024 sc1
    global_load_dwordx4 v[248:251], v0, s[40:41] offset:2048 sc1
    global_load_dwordx4 v[252:255], v0, s[40:41] offset:3072 sc1
    s_add_u32 s40, s40, 8192
    s_addc_u32 s41, s41, 0
    s_waitcnt vmcnt(16)
    v_mfma_f32_16x16x32_bf16 v[32:35], a[0:3], v[128:131], 0
    v_mfma_f32_16x16x32_bf16 v[36:39], a[8:11], v[128:131], 0
    v_mfma_f32_16x16x32_bf16 v[32:35], a[4:7], v[132:135], v[32:35]
    v_mfma_f32_16x16x32_bf16 v[36:39], a[12:15], v[132:135], v[36:39]
    v_mfma_f32_16x16x32_bf16 v[32:35], a[16:19], v[136:139], v[32:35]
    v_mfma_f32_16x16x32_bf16 v[36:39], a[24:27], v[136:139], v[36:39]
    v_mfma_f32_16x16x32_bf16 v[32:35], a[20:23], v[140:143], v[32:35]
    v_mfma_f32_16x16x32_bf16 v[36:39], a[28:31], v[140:143], v[36:39]
    v_mfma_f32_16x16x32_bf16 v[32:35], a[32:35], v[144:147], v[32:35]
    v_mfma_f32_16x16x32_bf16 v[36:39], a[40:43], v[144:147], v[36:39]
    v_mfma_f32_16x16x32_bf16 v[32:35], a[36:39], v[148:151], v[32:35]
    v_mfma_f32_16x16x32_bf16 v[36:39], a[44:47], v[148:151], v[36:39]
    v_mfma_f32_16x16x32_bf16 v[32:35], a[48:51], v[152:155], v[32:35]
    v_mfma_f32_16x16x32_bf16 v[36:39], a[56:59], v[152:155], v[36:39]
    v_mfma_f32_16x16x32_bf16 v[32:35], a[52:55], v[156:159], v[32:35]
    v_mfma_f32_16x16x32_bf16 v[36:39], a[60:63], v[156:159], v[36:39]
    v_mfma_f32_16x16x32_bf16 v[32:35], a[64:67], v[160:163], v[32:35]
    v_mfma_f32_16x16x32_bf16 v[36:39], a[72:75], v[160:163], v[36:39]
    v_mfma_f32_16x16x32_bf16 v[32:35], a[68:71], v[164:167], v[32:35]
    v_mfma_f32_16x16x32_bf16 v[36:39], a[76:79], v[164:167], v[36:39]
    v_mfma_f32_16x16x32_bf16 v[32:35], a[80:83], v[168:171], v[32:35]
    v_mfma_f32_16x16x32_bf16 v[36:39], a[88:91], v[168:171], v[36:39]
    v_mfma_f32_16x16x32_bf16 v[32:35], a[84:87], v[172:175], v[32:35]
    v_mfma_f32_16x16x32_bf16 v[36:39], a[92:95], v[172:175], v[36:39]
    v_mfma_f32_16x16x32_bf16 v[32:35], a[96:99], v[176:179], v[32:35]
    v_mfma_f32_16x16x32_bf16 v[36:39], a[104:107], v[176:179], v[36:39]
    v_mfma_f32_16x16x32_bf16 v[32:35], a[100:103], v[180:183], v[32:35]
    v_mfma_f32_16x16x32_bf16 v[36:39], a[108:111], v[180:183], v[36:39]
    v_mfma_f32_16x16x32_bf16 v[32:35], a[112:115], v[184:187], v[32:35]
    v_mfma_f32_16x16x32_bf16 v[36:39], a[120:123], v[184:187], v[36:39]
    v_mfma_f32_16x16x32_bf16 v[32:35], a[116:119], v[188:191], v[32:35]
    v_mfma_f32_16x16x32_bf16 v[36:39], a[124:127], v[188:191], v[36:39]
    s_nop 7
    v_cvt_pk_bf16_f32 v40, v32, v33
    v_cvt_pk_bf16_f32 v41, v34, v35
    v_cvt_pk_bf16_f32 v42, v36, v37
    v_cvt_pk_bf16_f32 v43, v38, v39
    global_store_dwordx4 v83, v[40:43], s[24:25]
    s_add_u32 s24, s24, 32768
    s_addc_u32 s25, s25, 0
    global_load_dwordx4 v[128:131], v0, s[40:41] offset:-4096 sc1
    global_load_dwordx4 v[132:135], v0, s[40:41] offset:-3072 sc1
    global_load_dwordx4 v[136:139], v0, s[40:41] offset:-2048 sc1
    global_load_dwordx4 v[140:143], v0, s[40:41] offset:-1024 sc1
    global_load_dwordx4 v[144:147], v0, s[40:41] offset:0 sc1
    global_load_dwordx4 v[148:151], v0, s[40:41] offset:1024 sc1
    global_load_dwordx4 v[152:155], v0, s[40:41] offset:2048 sc1
    global_load_dwordx4 v[156:159], v0, s[40:41] offset:3072 sc1
    s_add_u32 s40, s40, 8192
    s_addc_u32 s41, s41, 0
    global_load_dwordx4 v[160:163], v0, s[40:41] offset:-4096 sc1
    global_load_dwordx4 v[164:167], v0, s[40:41] offset:-3072 sc1
    global_load_dwordx4 v[168:171], v0, s[40:41] offset:-2048 sc1
    global_load_dwordx4 v[172:175], v0, s[40:41] offset:-1024 sc1
    global_load_dwordx4 v[176:179], v0, s[40:41] offset:0 sc1
    global_load_dwordx4 v[180:183], v0, s[40:41] offset:1024 sc1
    global_load_dwordx4 v[184:187], v0, s[40:41] offset:2048 sc1
    global_load_dwordx4 v[188:191], v0, s[40:41] offset:3072 sc1
    s_add_u32 s40, s40, 8192
    s_addc_u32 s41, s41, 0
    s_waitcnt vmcnt(16)
    v_mfma_f32_16x16x32_bf16 v[32:35], a[0:3], v[192:195], 0
    v_mfma_f32_16x16x32_bf16 v[36:39], a[8:11], v[192:195], 0
    v_mfma_f32_16x16x32_bf16 v[32:35], a[4:7], v[196:199], v[32:35]
    v_mfma_f32_16x16x32_bf16 v[36:39], a[12:15], v[196:199], v[36:39]
    v_mfma_f32_16x16x32_bf16 v[32:35], a[16:19], v[200:203], v[32:35]
    v_mfma_f32_16x16x32_bf16 v[36:39], a[24:27], v[200:203], v[36:39]
    v_mfma_f32_16x16x32_bf16 v[32:35], a[20:23], v[204:207], v[32:35]
    v_mfma_f32_16x16x32_bf16 v[36:39], a[28:31], v[204:207], v[36:39]
    v_mfma_f32_16x16x32_bf16 v[32:35], a[32:35], v[208:211], v[32:35]
    v_mfma_f32_16x16x32_bf16 v[36:39], a[40:43], v[208:211], v[36:39]
    v_mfma_f32_16x16x32_bf16 v[32:35], a[36:39], v[212:215], v[32:35]
    v_mfma_f32_16x16x32_bf16 v[36:39], a[44:47], v[212:215], v[36:39]
    v_mfma_f32_16x16x32_bf16 v[32:35], a[48:51], v[216:219], v[32:35]
    v_mfma_f32_16x16x32_bf16 v[36:39], a[56:59], v[216:219], v[36:39]
    v_mfma_f32_16x16x32_bf16 v[32:35], a[52:55], v[220:223], v[32:35]
    v_mfma_f32_16x16x32_bf16 v[36:39], a[60:63], v[220:223], v[36:39]
    v_mfma_f32_16x16x32_bf16 v[32:35], a[64:67], v[224:227], v[32:35]
    v_mfma_f32_16x16x32_bf16 v[36:39], a[72:75], v[224:227], v[36:39]
    v_mfma_f32_16x16x32_bf16 v[32:35], a[68:71], v[228:231], v[32:35]
    v_mfma_f32_16x16x32_bf16 v[36:39], a[76:79], v[228:231], v[36:39]
    v_mfma_f32_16x16x32_bf16 v[32:35], a[80:83], v[232:235], v[32:35]
    v_mfma_f32_16x16x32_bf16 v[36:39], a[88:91], v[232:235], v[36:39]
    v_mfma_f32_16x16x32_bf16 v[32:35], a[84:87], v[236:239], v[32:35]
    v_mfma_f32_16x16x32_bf16 v[36:39], a[92:95], v[236:239], v[36:39]
    v_mfma_f32_16x16x32_bf16 v[32:35], a[96:99], v[240:243], v[32:35]
    v_mfma_f32_16x16x32_bf16 v[36:39], a[104:107], v[240:243], v[36:39]
    v_mfma_f32_16x16x32_bf16 v[32:35], a[100:103], v[244:247], v[32:35]
    v_mfma_f32_16x16x32_bf16 v[36:39], a[108:111], v[244:247], v[36:39]
    v_mfma_f32_16x16x32_bf16 v[32:35], a[112:115], v[248:251], v[32:35]
    v_mfma_f32_16x16x32_bf16 v[36:39], a[120:123], v[248:251], v[36:39]
    v_mfma_f32_16x16x32_bf16 v[32:35], a[116:119], v[252:255], v[32:35]
    v_mfma_f32_16x16x32_bf16 v[36:39], a[124:127], v[252:255], v[36:39]
    s_nop 7
    v_cvt_pk_bf16_f32 v40, v32, v33
    v_cvt_pk_bf16_f32 v41, v34, v35
    v_cvt_pk_bf16_f32 v42, v36, v37
    v_cvt_pk_bf16_f32 v43, v38, v39
    global_store_dwordx4 v83, v[40:43], s[24:25]
    s_add_u32 s24, s24, 32768
    s_addc_u32 s25, s25, 0
    s_add_u32 s38, s38, 1
    s_cmp_lt_u32 s38, 8
    s_cbranch_scc1 L_awo_26
    s_endpgm
L_role_idle:
    s_endpgm
L_role_b4:
    s_load_dwordx2 s[80:81], s[0:1], 72
    s_load_dwordx2 s[82:83], s[0:1], 88
    v_lshrrev_b32 v32, 4, v0
    v_and_b32 v33, 15, v32
    v_lshrrev_b32 v34, 4, v32
    v_lshrrev_b32 v35, 2, v32
    v_and_b32 v36, 3, v32
    v_and_b32 v37, 3, v35
    s_lshr_b32 s90, s32, 4
    s_and_b32 s91, s32, 15
    v_bfe_u32 v38, v35, 0, 4
    v_mul_u32_u24 v8, 1024, v38
    v_bfe_u32 v38, v36, 0, 2
    v_mul_u32_u24 v38, 16, v38
    v_add_u32 v8, v8, v38
    s_lshl_b32 s92, s33, 20
    s_lshl_b32 s93, s91, 6
    s_add_u32 s92, s92, s93
    v_add_u32 v8, s92, v8
    s_lshl_b32 s60, s33, 15
    v_bfe_u32 v38, v37, 1, 1
    v_mul_u32_u24 v9, 2048, v38
    v_bfe_u32 v38, v34, 0, 1
    v_mul_u32_u24 v38, 1024, v38
    v_add_u32 v9, v9, v38
    v_bfe_u32 v38, v34, 1, 1
    v_mul_u32_u24 v38, 256, v38
    v_add_u32 v9, v9, v38
    v_bfe_u32 v38, v37, 0, 1
    v_mul_u32_u24 v38, 64, v38
    v_add_u32 v9, v9, v38
    v_bfe_u32 v38, v36, 0, 2
    v_mul_u32_u24 v38, 8, v38
    v_add_u32 v9, v9, v38
    v_add_u32 v9, s60, v9
    v_mov_b32 v38, 0x4444
    v_mov_b32 v39, 0xeeee
    v_cmp_lt_u32 vcc, 7, v33
    s_nop 1
    v_cndmask_b32 v1, v38, v39, vcc
    v_mov_b32 v2, 0
    v_bfe_u32 v38, v32, 0, 3
    v_mul_u32_u24 v3, 4, v38
    v_bfe_u32 v38, v34, 1, 1
    v_mul_u32_u24 v4, 1152, v38
    v_bfe_u32 v38, v34, 0, 1
    v_mul_u32_u24 v38, 576, v38
    v_add_u32 v4, v4, v38
    v_bfe_u32 v38, v33, 0, 4
    v_mul_u32_u24 v38, 4, v38
    v_add_u32 v4, v4, v38
    s_mul_i32 s92, s33, 2304
    v_add_u32 v4, s92, v4
    v_bfe_u32 v38, v34, 0, 2
    v_mul_u32_u24 v5, 144, v38
    v_bfe_u32 v38, v33, 0, 4
    v_mul_u32_u24 v38, 8, v38
    v_add_u32 v5, v5, v38
    s_and_b32 s92, s33, 1
    s_mul_i32 s93, s92, 576
    v_add_u32 v5, s93, v5
    v_bfe_u32 v38, v34, 0, 2
    v_mul_u32_u24 v6, 2048, v38
    v_bfe_u32 v38, v33, 0, 4
    v_mul_u32_u24 v38, 4, v38
    v_add_u32 v6, v6, v38
    s_waitcnt lgkmcnt(0)
    s_mov_b32 s8, s80
    s_and_b32 s9, s81, 0xffff
    s_mov_b32 s10, 0x400000
    s_mov_b32 s11, 0x20000
    s_lshl_b32 s93, s90, 14
    s_lshl_b32 s92, s92, 13
    s_add_u32 s93, s93, s92
    s_lshl_b32 s92, s91, 6
    s_add_u32 s93, s93, s92
    s_add_u32 s93, s93, 1024
    s_add_u32 s18, s82, s93
    s_addc_u32 s19, s83, 0
    s_lshl_b32 s93, s90, 16
    s_lshl_b32 s92, s33, 14
    s_add_u32 s93, s93, s92
    s_add_u32 s93, s93, 83890176
    s_add_u32 s12, s4, s93
    s_addc_u32 s13, s5, 0
    s_add_u32 s14, s12, 8192
    s_addc_u32 s15, s13, 0
    s_lshr_b32 s93, s90, 1
    s_lshl_b32 s93, s93, 9
    s_lshl_b32 s92, s33, 7
    s_add_u32 s93, s93, s92
    s_add_u32 s93, s93, 65536
    s_add_u32 s16, s4, s93
    s_addc_u32 s17, s5, 0
    s_add_u32 m0, s60, 0
    s_mov_b32 s62, 0
    buffer_load_dwordx4 v8, s[8:11], s62 offen lds
    s_add_u32 m0, s60, 1024
    s_mov_b32 s62, 16384
    buffer_load_dwordx4 v8, s[8:11], s62 offen lds
    s_add_u32 m0, s60, 2048
    s_mov_b32 s62, 32768
    buffer_load_dwordx4 v8, s[8:11], s62 offen lds
    s_add_u32 m0, s60, 3072
    s_mov_b32 s62, 49152
    buffer_load_dwordx4 v8, s[8:11], s62 offen lds
    s_add_u32 m0, s60, 4096
    s_mov_b32 s62, 65536
    buffer_load_dwordx4 v8, s[8:11], s62 offen lds
    s_add_u32 m0, s60, 5120
    s_mov_b32 s62, 81920
    buffer_load_dwordx4 v8, s[8:11], s62 offen lds
    s_add_u32 m0, s60, 6144
    s_mov_b32 s62, 98304
    buffer_load_dwordx4 v8, s[8:11], s62 offen lds
    s_add_u32 m0, s60, 7168
    s_mov_b32 s62, 114688
    buffer_load_dwordx4 v8, s[8:11], s62 offen lds
    s_waitcnt vmcnt(4)
    ds_read_b64_tr_b16 a[0:1], v9 offset:0
    ds_read_b64_tr_b16 a[2:3], v9 offset:128
    ds_read_b64_tr_b16 a[4:5], v9 offset:512
    ds_read_b64_tr_b16 a[6:7], v9 offset:640
    ds_read_b64_tr_b16 a[8:9], v9 offset:32
    ds_read_b64_tr_b16 a[10:11], v9 offset:160
    ds_read_b64_tr_b16 a[12:13], v9 offset:544
    ds_read_b64_tr_b16 a[14:15], v9 offset:672
    s_waitcnt lgkmcnt(0)
    s_add_u32 m0, s60, 0
    s_mov_b32 s62, 131072
    buffer_load_dwordx4 v8, s[8:11], s62 offen lds
    s_add_u32 m0, s60, 1024
    s_mov_b32 s62, 147456
    buffer_load_dwordx4 v8, s[8:11], s62 offen lds
    s_add_u32 m0, s60, 2048
    s_mov_b32 s62, 163840
    buffer_load_dwordx4 v8, s[8:11], s62 offen lds
    s_add_u32 m0, s60, 3072
    s_mov_b32 s62, 180224
    buffer_load_dwordx4 v8, s[8:11], s62 offen lds
    s_waitcnt vmcnt(4)
    ds_read_b64_tr_b16 a[16:17], v9 offset:4096
    ds_read_b64_tr_b16 a[18:19], v9 offset:4224
    ds_read_b64_tr_b16 a[20:21], v9 offset:4608
    ds_read_b64_tr_b16 a[22:23], v9 offset:4736
    ds_read_b64_tr_b16 a[24:25], v9 offset:4128
    ds_read_b64_tr_b16 a[26:27], v9 offset:4256
    ds_read_b64_tr_b16 a[28:29], v9 offset:4640
    ds_read_b64_tr_b16 a[30:31], v9 offset:4768
    s_waitcnt lgkmcnt(0)
    s_add_u32 m0, s60, 4096
    s_mov_b32 s62, 196608
    buffer_load_dwordx4 v8, s[8:11], s62 offen lds
    s_add_u32 m0, s60, 5120
    s_mov_b32 s62, 212992
    buffer_load_dwordx4 v8, s[8:11], s62 offen lds
    s_add_u32 m0, s60, 6144
    s_mov_b32 s62, 229376
    buffer_load_dwordx4 v8, s[8:11], s62 offen lds
    s_add_u32 m0, s60, 7168
    s_mov_b32 s62, 245760
    buffer_load_dwordx4 v8, s[8:11], s62 offen lds
    s_waitcnt vmcnt(4)
    ds_read_b64_tr_b16 a[32:33], v9 offset:0
    ds_read_b64_tr_b16 a[34:35], v9 offset:128
    ds_read_b64_tr_b16 a[36:37], v9 offset:512
    ds_read_b64_tr_b16 a[38:39], v9 offset:640
    ds_read_b64_tr_b16 a[40:41], v9 offset:32
    ds_read_b64_tr_b16 a[42:43], v9 offset:160
    ds_read_b64_tr_b16 a[44:45], v9 offset:544
    ds_read_b64_tr_b16 a[46:47], v9 offset:672
    s_waitcnt lgkmcnt(0)
    s_add_u32 m0, s60, 0
    s_mov_b32 s62, 262144
    buffer_load_dwordx4 v8, s[8:11], s62 offen lds
    s_add_u32 m0, s60, 1024
    s_mov_b32 s62, 278528
    buffer_load_dwordx4 v8, s[8:11], s62 offen lds
    s_add_u32 m0, s60, 2048
    s_mov_b32 s62, 294912
    buffer_load_dwordx4 v8, s[8:11], s62 offen lds
    s_add_u32 m0, s60, 3072
    s_mov_b32 s62, 311296
    buffer_load_dwordx4 v8, s[8:11], s62 offen lds
    s_waitcnt vmcnt(4)
    ds_read_b64_tr_b16 a[48:49], v9 offset:4096
    ds_read_b64_tr_b16 a[50:51], v9 offset:4224
    ds_read_b64_tr_b16 a[52:53], v9 offset:4608
    ds_read_b64_tr_b16 a[54:55], v9 offset:4736
    ds_read_b64_tr_b16 a[56:57], v9 offset:4128
    ds_read_b64_tr_b16 a[58:59], v9 offset:4256
    ds_read_b64_tr_b16 a[60:61], v9 offset:4640
    ds_read_b64_tr_b16 a[62:63], v9 offset:4768
    s_waitcnt lgkmcnt(0)
    s_add_u32 m0, s60, 4096
    s_mov_b32 s62, 327680
    buffer_load_dwordx4 v8, s[8:11], s62 offen lds
    s_add_u32 m0, s60, 5120
    s_mov_b32 s62, 344064
    buffer_load_dwordx4 v8, s[8:11], s62 offen lds
    s_add_u32 m0, s60, 6144
    s_mov_b32 s62, 360448
    buffer_load_dwordx4 v8, s[8:11], s62 offen lds
    s_add_u32 m0, s60, 7168
    s_mov_b32 s62, 376832
    buffer_load_dwordx4 v8, s[8:11], s62 offen lds
    s_waitcnt vmcnt(4)
    ds_read_b64_tr_b16 a[64:65], v9 offset:0
    ds_read_b64_tr_b16 a[66:67], v9 offset:128
    ds_read_b64_tr_b16 a[68:69], v9 offset:512
    ds_read_b64_tr_b16 a[70:71], v9 offset:640
    ds_read_b64_tr_b16 a[72:73], v9 offset:32
    ds_read_b64_tr_b16 a[74:75], v9 offset:160
    ds_read_b64_tr_b16 a[76:77], v9 offset:544
    ds_read_b64_tr_b16 a[78:79], v9 offset:672
    s_waitcnt lgkmcnt(0)
    s_add_u32 m0, s60, 0
    s_mov_b32 s62, 393216
    buffer_load_dwordx4 v8, s[8:11], s62 offen lds
    s_add_u32 m0, s60, 1024
    s_mov_b32 s62, 409600
    buffer_load_dwordx4 v8, s[8:11], s62 offen lds
    s_add_u32 m0, s60, 2048
    s_mov_b32 s62, 425984
    buffer_load_dwordx4 v8, s[8:11], s62 offen lds
    s_add_u32 m0, s60, 3072
    s_mov_b32 s62, 442368
    buffer_load_dwordx4 v8, s[8:11], s62 offen lds
    s_waitcnt vmcnt(4)
    ds_read_b64_tr_b16 a[80:81], v9 offset:4096
    ds_read_b64_tr_b16 a[82:83], v9 offset:4224
    ds_read_b64_tr_b16 a[84:85], v9 offset:4608
    ds_read_b64_tr_b16 a[86:87], v9 offset:4736
    ds_read_b64_tr_b16 a[88:89], v9 offset:4128
    ds_read_b64_tr_b16 a[90:91], v9 offset:4256
    ds_read_b64_tr_b16 a[92:93], v9 offset:4640
    ds_read_b64_tr_b16 a[94:95], v9 offset:4768
    s_waitcnt lgkmcnt(0)
    s_add_u32 m0, s60, 4096
    s_mov_b32 s62, 458752
    buffer_load_dwordx4 v8, s[8:11], s62 offen lds
    s_add_u32 m0, s60, 5120
    s_mov_b32 s62, 475136
    buffer_load_dwordx4 v8, s[8:11], s62 offen lds
    s_add_u32 m0, s60, 6144
    s_mov_b32 s62, 491520
    buffer_load_dwordx4 v8, s[8:11], s62 offen lds
    s_add_u32 m0, s60, 7168
    s_mov_b32 s62, 507904
    buffer_load_dwordx4 v8, s[8:11], s62 offen lds
    s_waitcnt vmcnt(4)
    ds_read_b64_tr_b16 a[96:97], v9 offset:0
    ds_read_b64_tr_b16 a[98:99], v9 offset:128
    ds_read_b64_tr_b16 a[100:101], v9 offset:512
    ds_read_b64_tr_b16 a[102:103], v9 offset:640
    ds_read_b64_tr_b16 a[104:105], v9 offset:32
    ds_read_b64_tr_b16 a[106:107], v9 offset:160
    ds_read_b64_tr_b16 a[108:109], v9 offset:544
    ds_read_b64_tr_b16 a[110:111], v9 offset:672
    s_waitcnt lgkmcnt(0)
    s_add_u32 m0, s60, 0
    s_mov_b32 s62, 524288
    buffer_load_dwordx4 v8, s[8:11], s62 offen lds
    s_add_u32 m0, s60, 1024
    s_mov_b32 s62, 540672
    buffer_load_dwordx4 v8, s[8:11], s62 offen lds
    s_add_u32 m0, s60, 2048
    s_mov_b32 s62, 557056
    buffer_load_dwordx4 v8, s[8:11], s62 offen lds
    s_add_u32 m0, s60, 3072
    s_mov_b32 s62, 573440
    buffer_load_dwordx4 v8, s[8:11], s62 offen lds
    s_waitcnt vmcnt(4)
    ds_read_b64_tr_b16 a[112:113], v9 offset:4096
    ds_read_b64_tr_b16 a[114:115], v9 offset:4224
    ds_read_b64_tr_b16 a[116:117], v9 offset:4608
    ds_read_b64_tr_b16 a[118:119], v9 offset:4736
    ds_read_b64_tr_b16 a[120:121], v9 offset:4128
    ds_read_b64_tr_b16 a[122:123], v9 offset:4256
    ds_read_b64_tr_b16 a[124:125], v9 offset:4640
    ds_read_b64_tr_b16 a[126:127], v9 offset:4768
    s_waitcnt lgkmcnt(0)
    s_add_u32 m0, s60, 4096
    s_mov_b32 s62, 589824
    buffer_load_dwordx4 v8, s[8:11], s62 offen lds
    s_add_u32 m0, s60, 5120
    s_mov_b32 s62, 606208
    buffer_load_dwordx4 v8, s[8:11], s62 offen lds
    s_add_u32 m0, s60, 6144
    s_mov_b32 s62, 622592
    buffer_load_dwordx4 v8, s[8:11], s62 offen lds
    s_add_u32 m0, s60, 7168
    s_mov_b32 s62, 638976
    buffer_load_dwordx4 v8, s[8:11], s62 offen lds
    s_waitcnt vmcnt(4)
    ds_read_b64_tr_b16 a[128:129], v9 offset:0
    ds_read_b64_tr_b16 a[130:131], v9 offset:128
    ds_read_b64_tr_b16 a[132:133], v9 offset:512
    ds_read_b64_tr_b16 a[134:135], v9 offset:640
    ds_read_b64_tr_b16 a[136:137], v9 offset:32
    ds_read_b64_tr_b16 a[138:139], v9 offset:160
    ds_read_b64_tr_b16 a[140:141], v9 offset:544
    ds_read_b64_tr_b16 a[142:143], v9 offset:672
    s_waitcnt lgkmcnt(0)
    s_add_u32 m0, s60, 0
    s_mov_b32 s62, 655360
    buffer_load_dwordx4 v8, s[8:11], s62 offen lds
    s_add_u32 m0, s60, 1024
    s_mov_b32 s62, 671744
    buffer_load_dwordx4 v8, s[8:11], s62 offen lds
    s_add_u32 m0, s60, 2048
    s_mov_b32 s62, 688128
    buffer_load_dwordx4 v8, s[8:11], s62 offen lds
    s_add_u32 m0, s60, 3072
    s_mov_b32 s62, 704512
    buffer_load_dwordx4 v8, s[8:11], s62 offen lds
    s_waitcnt vmcnt(4)
    ds_read_b64_tr_b16 a[144:145], v9 offset:4096
    ds_read_b64_tr_b16 a[146:147], v9 offset:4224
    ds_read_b64_tr_b16 a[148:149], v9 offset:4608
    ds_read_b64_tr_b16 a[150:151], v9 offset:4736
    ds_read_b64_tr_b16 a[152:153], v9 offset:4128
    ds_read_b64_tr_b16 a[154:155], v9 offset:4256
    ds_read_b64_tr_b16 a[156:157], v9 offset:4640
    ds_read_b64_tr_b16 a[158:159], v9 offset:4768
    s_waitcnt lgkmcnt(0)
    s_add_u32 m0, s60, 4096
    s_mov_b32 s62, 720896
    buffer_load_dwordx4 v8, s[8:11], s62 offen lds
    s_add_u32 m0, s60, 5120
    s_mov_b32 s62, 737280
    buffer_load_dwordx4 v8, s[8:11], s62 offen lds
    s_add_u32 m0, s60, 6144
    s_mov_b32 s62, 753664
    buffer_load_dwordx4 v8, s[8:11], s62 offen lds
    s_add_u32 m0, s60, 7168
    s_mov_b32 s62, 770048
    buffer_load_dwordx4 v8, s[8:11], s62 offen lds
    s_waitcnt vmcnt(4)
    ds_read_b64_tr_b16 a[160:161], v9 offset:0
    ds_read_b64_tr_b16 a[162:163], v9 offset:128
    ds_read_b64_tr_b16 a[164:165], v9 offset:512
    ds_read_b64_tr_b16 a[166:167], v9 offset:640
    ds_read_b64_tr_b16 a[168:169], v9 offset:32
    ds_read_b64_tr_b16 a[170:171], v9 offset:160
    ds_read_b64_tr_b16 a[172:173], v9 offset:544
    ds_read_b64_tr_b16 a[174:175], v9 offset:672
    s_waitcnt lgkmcnt(0)
    s_add_u32 m0, s60, 0
    s_mov_b32 s62, 786432
    buffer_load_dwordx4 v8, s[8:11], s62 offen lds
    s_add_u32 m0, s60, 1024
    s_mov_b32 s62, 802816
    buffer_load_dwordx4 v8, s[8:11], s62 offen lds
    s_add_u32 m0, s60, 2048
    s_mov_b32 s62, 819200
    buffer_load_dwordx4 v8, s[8:11], s62 offen lds
    s_add_u32 m0, s60, 3072
    s_mov_b32 s62, 835584
    buffer_load_dwordx4 v8, s[8:11], s62 offen lds
    s_waitcnt vmcnt(4)
    ds_read_b64_tr_b16 a[176:177], v9 offset:4096
    ds_read_b64_tr_b16 a[178:179], v9 offset:4224
    ds_read_b64_tr_b16 a[180:181], v9 offset:4608
    ds_read_b64_tr_b16 a[182:183], v9 offset:4736
    ds_read_b64_tr_b16 a[184:185], v9 offset:4128
    ds_read_b64_tr_b16 a[186:187], v9 offset:4256
    ds_read_b64_tr_b16 a[188:189], v9 offset:4640
    ds_read_b64_tr_b16 a[190:191], v9 offset:4768
    s_waitcnt lgkmcnt(0)
    s_add_u32 m0, s60, 4096
    s_mov_b32 s62, 851968
    buffer_load_dwordx4 v8, s[8:11], s62 offen lds
    s_add_u32 m0, s60, 5120
    s_mov_b32 s62, 868352
    buffer_load_dwordx4 v8, s[8:11], s62 offen lds
    s_add_u32 m0, s60, 6144
    s_mov_b32 s62, 884736
    buffer_load_dwordx4 v8, s[8:11], s62 offen lds
    s_add_u32 m0, s60, 7168
    s_mov_b32 s62, 901120
    buffer_load_dwordx4 v8, s[8:11], s62 offen lds
    s_waitcnt vmcnt(4)
    ds_read_b64_tr_b16 a[192:193], v9 offset:0
    ds_read_b64_tr_b16 a[194:195], v9 offset:128
    ds_read_b64_tr_b16 a[196:197], v9 offset:512
    ds_read_b64_tr_b16 a[198:199], v9 offset:640
    ds_read_b64_tr_b16 a[200:201], v9 offset:32
    ds_read_b64_tr_b16 a[202:203], v9 offset:160
    ds_read_b64_tr_b16 a[204:205], v9 offset:544
    ds_read_b64_tr_b16 a[206:207], v9 offset:672
    s_waitcnt lgkmcnt(0)
    s_add_u32 m0, s60, 0
    s_mov_b32 s62, 917504
    buffer_load_dwordx4 v8, s[8:11], s62 offen lds
    s_add_u32 m0, s60, 1024
    s_mov_b32 s62, 933888
    buffer_load_dwordx4 v8, s[8:11], s62 offen lds
    s_add_u32 m0, s60, 2048
    s_mov_b32 s62, 950272
    buffer_load_dwordx4 v8, s[8:11], s62 offen lds
    s_add_u32 m0, s60, 3072
    s_mov_b32 s62, 966656
    buffer_load_dwordx4 v8, s[8:11], s62 offen lds
    s_waitcnt vmcnt(4)
    ds_read_b64_tr_b16 a[208:209], v9 offset:4096
    ds_read_b64_tr_b16 a[210:211], v9 offset:4224
    ds_read_b64_tr_b16 a[212:213], v9 offset:4608
    ds_read_b64_tr_b16 a[214:215], v9 offset:4736
    ds_read_b64_tr_b16 a[216:217], v9 offset:4128
    ds_read_b64_tr_b16 a[218:219], v9 offset:4256
    ds_read_b64_tr_b16 a[220:221], v9 offset:4640
    ds_read_b64_tr_b16 a[222:223], v9 offset:4768
    s_waitcnt lgkmcnt(0)
    s_add_u32 m0, s60, 4096
    s_mov_b32 s62, 983040
    buffer_load_dwordx4 v8, s[8:11], s62 offen lds
    s_add_u32 m0, s60, 5120
    s_mov_b32 s62, 999424
    buffer_load_dwordx4 v8, s[8:11], s62 offen lds
    s_add_u32 m0, s60, 6144
    s_mov_b32 s62, 1015808
    buffer_load_dwordx4 v8, s[8:11], s62 offen lds
    s_add_u32 m0, s60, 7168
    s_mov_b32 s62, 1032192
    buffer_load_dwordx4 v8, s[8:11], s62 offen lds
    s_waitcnt vmcnt(4)
    ds_read_b64_tr_b16 a[224:225], v9 offset:0
    ds_read_b64_tr_b16 a[226:227], v9 offset:128
    ds_read_b64_tr_b16 a[228:229], v9 offset:512
    ds_read_b64_tr_b16 a[230:231], v9 offset:640
    ds_read_b64_tr_b16 a[232:233], v9 offset:32
    ds_read_b64_tr_b16 a[234:235], v9 offset:160
    ds_read_b64_tr_b16 a[236:237], v9 offset:544
    ds_read_b64_tr_b16 a[238:239], v9 offset:672
    s_waitcnt vmcnt(0)
    ds_read_b64_tr_b16 a[240:241], v9 offset:4096
    ds_read_b64_tr_b16 a[242:243], v9 offset:4224
    ds_read_b64_tr_b16 a[244:245], v9 offset:4608
    ds_read_b64_tr_b16 a[246:247], v9 offset:4736
    ds_read_b64_tr_b16 a[248:249], v9 offset:4128
    ds_read_b64_tr_b16 a[250:251], v9 offset:4256
    ds_read_b64_tr_b16 a[252:253], v9 offset:4640
    ds_read_b64_tr_b16 a[254:255], v9 offset:4768
    s_waitcnt lgkmcnt(0)
    s_movk_i32 s62, 256
L_spin_27:
    global_load_ushort v8, v2, s[28:29] offset:192 sc1
    s_sub_u32 s50, s50, 1
    s_cselect_b64 s[48:49], 0, s[48:49]
    s_waitcnt vmcnt(0)
    v_cmp_gt_u32 vcc, s62, v8
    s_and_b64 vcc, vcc, s[48:49]
    s_cbranch_scc0 L_spino_28
    s_sleep 8
    s_branch L_spin_27
L_spino_28:
    s_barrier
    s_mov_b32 s34, 0
    s_mov_b32 s35, 9216
    s_mov_b32 s36, 0
L_b4_29:
    v_mov_b64 v[16:17], 0
    v_mov_b64 v[18:19], 0
    v_mov_b64 v[20:21], 0
    v_mov_b64 v[22:23], 0
    s_cmp_eq_u32 s36, 1
    s_cbranch_scc1 L_b4go_30
L_spin_32:
    global_load_dword v8, v3, s[16:17] sc1
    s_sub_u32 s50, s50, 1
    s_cselect_b64 s[48:49], 0, s[48:49]
    s_waitcnt vmcnt(0)
    v_cmp_eq_u32 vcc, 0, v8
    s_and_b64 vcc, vcc, s[48:49]
    s_cbranch_scc0 L_spino_33
    s_sleep 1
    s_branch L_spin_32
L_spino_33:
    global_load_dwordx4 v[32:35], v0, s[12:13] offset:-4096 sc1
    global_load_dwordx4 v[36:39], v0, s[12:13] offset:-3072 sc1
    global_load_dwordx4 v[40:43], v0, s[12:13] offset:-2048 sc1
    global_load_dwordx4 v[44:47], v0, s[12:13] offset:-1024 sc1
    global_load_dwordx4 v[48:51], v0, s[12:13] offset:0 sc1
    global_load_dwordx4 v[52:55], v0, s[12:13] offset:1024 sc1
    global_load_dwordx4 v[56:59], v0, s[12:13] offset:2048 sc1
    global_load_dwordx4 v[60:63], v0, s[12:13] offset:3072 sc1
    global_load_dwordx4 v[64:67], v0, s[14:15] offset:-4096 sc1
    global_load_dwordx4 v[68:71], v0, s[14:15] offset:-3072 sc1
    global_load_dwordx4 v[72:75], v0, s[14:15] offset:-2048 sc1
    global_load_dwordx4 v[76:79], v0, s[14:15] offset:-1024 sc1
    global_load_dwordx4 v[80:83], v0, s[14:15] offset:0 sc1
    global_load_dwordx4 v[84:87], v0, s[14:15] offset:1024 sc1
    global_load_dwordx4 v[88:91], v0, s[14:15] offset:2048 sc1
    global_load_dwordx4 v[92:95], v0, s[14:15] offset:3072 sc1
    global_load_dword v8, v3, s[16:17] offset:1024 sc1
    s_add_u32 s12, s12, 262144
    s_addc_u32 s13, s13, 0
    s_add_u32 s14, s14, 262144
    s_addc_u32 s15, s15, 0
    s_add_u32 s16, s16, 1024
    s_addc_u32 s17, s17, 0
L_b4go_30:
    s_waitcnt vmcnt(16)
    v_smfmac_f32_16x16x64_bf16 v[16:19], v[32:35], a[0:7], v1
    v_smfmac_f32_16x16x64_bf16 v[20:23], v[32:35], a[8:15], v1
    s_waitcnt vmcnt(15)
    v_smfmac_f32_16x16x64_bf16 v[16:19], v[36:39], a[16:23], v1
    v_smfmac_f32_16x16x64_bf16 v[20:23], v[36:39], a[24:31], v1
    s_waitcnt vmcnt(14)
    v_smfmac_f32_16x16x64_bf16 v[16:19], v[40:43], a[32:39], v1
    v_smfmac_f32_16x16x64_bf16 v[20:23], v[40:43], a[40:47], v1
    s_waitcnt vmcnt(13)
    v_smfmac_f32_16x16x64_bf16 v[16:19], v[44:47], a[48:55], v1
    v_smfmac_f32_16x16x64_bf16 v[20:23], v[44:47], a[56:63], v1
    s_waitcnt vmcnt(12)
    v_smfmac_f32_16x16x64_bf16 v[16:19], v[48:51], a[64:71], v1
    v_smfmac_f32_16x16x64_bf16 v[20:23], v[48:51], a[72:79], v1
    s_waitcnt vmcnt(11)
    v_smfmac_f32_16x16x64_bf16 v[16:19], v[52:55], a[80:87], v1
    v_smfmac_f32_16x16x64_bf16 v[20:23], v[52:55], a[88:95], v1
    s_waitcnt vmcnt(10)
    v_smfmac_f32_16x16x64_bf16 v[16:19], v[56:59], a[96:103], v1
    v_smfmac_f32_16x16x64_bf16 v[20:23], v[56:59], a[104:111], v1
    s_waitcnt vmcnt(9)
    v_smfmac_f32_16x16x64_bf16 v[16:19], v[60:63], a[112:119], v1
    v_smfmac_f32_16x16x64_bf16 v[20:23], v[60:63], a[120:127], v1
    s_waitcnt vmcnt(8)
    v_smfmac_f32_16x16x64_bf16 v[16:19], v[64:67], a[128:135], v1
    v_smfmac_f32_16x16x64_bf16 v[20:23], v[64:67], a[136:143], v1
    s_waitcnt vmcnt(7)
    v_smfmac_f32_16x16x64_bf16 v[16:19], v[68:71], a[144:151], v1
    v_smfmac_f32_16x16x64_bf16 v[20:23], v[68:71], a[152:159], v1
    s_waitcnt vmcnt(6)
    v_smfmac_f32_16x16x64_bf16 v[16:19], v[72:75], a[160:167], v1
    v_smfmac_f32_16x16x64_bf16 v[20:23], v[72:75], a[168:175], v1
    s_waitcnt vmcnt(5)
    v_smfmac_f32_16x16x64_bf16 v[16:19], v[76:79], a[176:183], v1
    v_smfmac_f32_16x16x64_bf16 v[20:23], v[76:79], a[184:191], v1
    s_waitcnt vmcnt(4)
    v_smfmac_f32_16x16x64_bf16 v[16:19], v[80:83], a[192:199], v1
    v_smfmac_f32_16x16x64_bf16 v[20:23], v[80:83], a[200:207], v1
    s_waitcnt vmcnt(3)
    v_smfmac_f32_16x16x64_bf16 v[16:19], v[84:87], a[208:215], v1
    v_smfmac_f32_16x16x64_bf16 v[20:23], v[84:87], a[216:223], v1
    s_waitcnt vmcnt(2)
    v_smfmac_f32_16x16x64_bf16 v[16:19], v[88:91], a[224:231], v1
    v_smfmac_f32_16x16x64_bf16 v[20:23], v[88:91], a[232:239], v1
    s_waitcnt vmcnt(1)
    v_smfmac_f32_16x16x64_bf16 v[16:19], v[92:95], a[240:247], v1
    v_smfmac_f32_16x16x64_bf16 v[20:23], v[92:95], a[248:255], v1
    s_waitcnt vmcnt(0)
    v_cmp_eq_u32 vcc, 0, v8
    s_mov_b32 s36, 0
    s_cbranch_vccnz L_b4na_31
    s_cmp_eq_u32 s34, 63
    s_cbranch_scc1 L_b4na_31
    s_mov_b32 s36, 1
    global_load_dwordx4 v[32:35], v0, s[12:13] offset:-4096 sc1
    global_load_dwordx4 v[36:39], v0, s[12:13] offset:-3072 sc1
    global_load_dwordx4 v[40:43], v0, s[12:13] offset:-2048 sc1
    global_load_dwordx4 v[44:47], v0, s[12:13] offset:-1024 sc1
    global_load_dwordx4 v[48:51], v0, s[12:13] offset:0 sc1
    global_load_dwordx4 v[52:55], v0, s[12:13] offset:1024 sc1
    global_load_dwordx4 v[56:59], v0, s[12:13] offset:2048 sc1
    global_load_dwordx4 v[60:63], v0, s[12:13] offset:3072 sc1
    global_load_dwordx4 v[64:67], v0, s[14:15] offset:-4096 sc1
    global_load_dwordx4 v[68:71], v0, s[14:15] offset:-3072 sc1
    global_load_dwordx4 v[72:75], v0, s[14:15] offset:-2048 sc1
    global_load_dwordx4 v[76:79], v0, s[14:15] offset:-1024 sc1
    global_load_dwordx4 v[80:83], v0, s[14:15] offset:0 sc1
    global_load_dwordx4 v[84:87], v0, s[14:15] offset:1024 sc1
    global_load_dwordx4 v[88:91], v0, s[14:15] offset:2048 sc1
    global_load_dwordx4 v[92:95], v0, s[14:15] offset:3072 sc1
    global_load_dword v8, v3, s[16:17] offset:1024 sc1
    s_add_u32 s12, s12, 262144
    s_addc_u32 s13, s13, 0
    s_add_u32 s14, s14, 262144
    s_addc_u32 s15, s15, 0
    s_add_u32 s16, s16, 1024
    s_addc_u32 s17, s17, 0
L_b4na_31:
    s_nop 2
    s_nop 1
    ds_write2_b32 v4, v16, v20 offset0:0 offset1:16
    ds_write2_b32 v4, v17, v21 offset0:36 offset1:52
    ds_write2_b32 v4, v18, v22 offset0:72 offset1:88
    ds_write2_b32 v4, v19, v23 offset0:108 offset1:124
    s_waitcnt lgkmcnt(0)
    s_barrier
    s_cmp_ge_u32 s33, 2
    s_cbranch_scc1 L_b4s_34
    ds_read_b64 v[96:97], v5 offset:0
    ds_read_b64 v[98:99], v5 offset:1152
    ds_read_b64 v[100:101], v5 offset:2304
    ds_read_b64 v[102:103], v5 offset:3456
    ds_read_b64 v[104:105], v5 offset:4608
    ds_read_b64 v[106:107], v5 offset:5760
    ds_read_b64 v[108:109], v5 offset:6912
    ds_read_b64 v[110:111], v5 offset:8064
    s_waitcnt lgkmcnt(6)
    v_pk_add_f32 v[96:97], v[96:97], v[98:99]
    s_waitcnt lgkmcnt(5)
    v_pk_add_f32 v[96:97], v[96:97], v[100:101]
    s_waitcnt lgkmcnt(4)
    v_pk_add_f32 v[96:97], v[96:97], v[102:103]
    s_waitcnt lgkmcnt(3)
    v_pk_add_f32 v[96:97], v[96:97], v[104:105]
    s_waitcnt lgkmcnt(2)
    v_pk_add_f32 v[96:97], v[96:97], v[106:107]
    s_waitcnt lgkmcnt(1)
    v_pk_add_f32 v[96:97], v[96:97], v[108:109]
    s_waitcnt lgkmcnt(0)
    v_pk_add_f32 v[96:97], v[96:97], v[110:111]
    v_cvt_pk_bf16_f32 v96, v96, v97
    global_store_dword v6, v96, s[18:19]
L_b4s_34:
    s_add_u32 s18, s18, 65536
    s_addc_u32 s19, s19, 0
    v_add_u32 v4, s35, v4
    v_add_u32 v5, s35, v5
    s_sub_u32 s35, 0, s35
    s_add_u32 s34, s34, 1
    s_cmp_lt_u32 s34, 64
    s_cbranch_scc1 L_b4_29
    s_endpgm
L_role_att:
    v_lshrrev_b32 v200, 4, v0
    v_and_b32 v201, 15, v200
    v_lshrrev_b32 v202, 4, v200
    v_lshrrev_b32 v203, 2, v200
    v_and_b32 v204, 3, v200
    v_and_b32 v205, 3, v203
    v_bfe_u32 v206, v201, 2, 1
    v_mul_u32_u24 v1, 4096, v206
    v_bfe_u32 v206, v202, 0, 2
    v_mul_u32_u24 v206, 256, v206
    v_add_u32 v1, v1, v206
    v_bfe_u32 v206, v201, 3, 1
    v_mul_u32_u24 v206, 64, v206
    v_add_u32 v1, v1, v206
    v_bfe_u32 v206, v201, 0, 2
    v_mul_u32_u24 v206, 16, v206
    v_add_u32 v1, v1, v206
    v_bfe_u32 v206, v202, 0, 2
    v_mul_u32_u24 v3, 256, v206
    v_bfe_u32 v206, v201, 2, 1
    v_mul_u32_u24 v206, 128, v206
    v_add_u32 v3, v3, v206
    v_bfe_u32 v206, v201, 3, 1
    v_mul_u32_u24 v206, 64, v206
    v_add_u32 v3, v3, v206
    v_bfe_u32 v206, v201, 0, 2
    v_mul_u32_u24 v206, 16, v206
    v_add_u32 v3, v3, v206
    v_mov_b32 v191, 0
    v_min_u32 v7, 1, v200
    v_lshlrev_b32 v7, 2, v7
    v_bfe_u32 v206, v202, 0, 2
    v_mul_u32_u24 v190, 512, v206
    v_bfe_u32 v206, v201, 0, 4
    v_mul_u32_u24 v206, 4, v206
    v_add_u32 v190, v190, v206
    v_mov_b32 v206, 0x4444
    v_mov_b32 v207, 0xeeee
    s_mov_b32 vcc_lo, 0xcccccccc
    s_mov_b32 vcc_hi, 0xcccccccc
    v_cndmask_b32 v11, v206, v207, vcc
    v_bfe_u32 v206, v201, 3, 1
    v_mul_u32_u24 v5, 65536, v206
    v_bfe_u32 v206, v202, 0, 2
    v_mul_u32_u24 v206, 256, v206
    v_add_u32 v5, v5, v206
    v_bfe_u32 v206, v201, 0, 3
    v_mul_u32_u24 v206, 16, v206
    v_add_u32 v5, v5, v206
    v_lshlrev_b32 v4, 2, v200
    v_mov_b32 v2, 0
    v_mov_b32 v12, 0x3f803f80
    v_mov_b32 v13, 0x3f803f80
    v_mov_b32 v14, 0x3f803f80
    v_mov_b32 v15, 0x3f803f80
    v_mov_b32 v113, 0
    v_mov_b32 v115, 0
    v_mov_b32 v117, 0
    v_mov_b32 v119, 0
    v_mov_b32 v121, 0
    v_mov_b32 v123, 0
    v_mov_b32 v125, 0
    v_mov_b32 v127, 0
    v_mov_b32 v145, 0
    s_and_b32 s90, s32, 15
    s_lshl_b32 s90, s90, 1
    s_lshr_b32 s91, s33, 1
    s_add_u32 s90, s90, s91
    s_and_b32 s91, s33, 1
    s_lshr_b32 s34, s32, 4
    s_mov_b32 s35, s34
    s_mov_b32 s36, 0
    s_lshl_b32 s92, s91, 4
    v_add_u32 v206, s92, v201
    v_lshlrev_b32 v207, 2, v202
    v_sub_u32 v206, v206, v207
    v_cmp_le_i32 s[70:71], 0, v206
    v_cmp_le_i32 s[72:73], 1, v206
    v_cmp_le_i32 s[74:75], 2, v206
    v_cmp_le_i32 s[76:77], 3, v206
    v_cmp_le_i32 s[78:79], 16, v206
    v_cmp_le_i32 s[80:81], 17, v206
    v_cmp_le_i32 s[82:83], 18, v206
    v_cmp_le_i32 s[84:85], 19, v206
    s_mov_b32 s38, 0x3e0293ee
    s_mov_b32 s39, 0xbe0293ee
    v_mov_b32 v10, 0xd028965f
    s_mul_i32 s92, s90, 65
    s_add_u32 s92, s92, s34
    s_lshl_b32 s93, s92, 13
    s_lshl_b32 s94, s91, 12
    s_add_u32 s93, s93, s94
    s_add_u32 s93, s93, 51380224
    s_add_u32 s8, s4, s93
    s_addc_u32 s9, s5, 0
    s_lshl_b32 s93, s92, 14
    s_add_u32 s93, s93, 16777216
    s_add_u32 s10, s4, s93
    s_addc_u32 s11, s5, 0
    s_lshl_b32 s93, s92, 14
    s_add_u32 s93, s93, 16789504
    s_add_u32 s12, s4, s93
    s_addc_u32 s13, s5, 0
    s_mul_i32 s93, s90, 65
    s_add_u32 s93, s93, s34
    s_lshl_b32 s93, s93, 12
    s_add_u32 s93, s93, 69210112
    s_add_u32 s16, s4, s93
    s_addc_u32 s17, s5, 0
    s_lshl_b32 s93, s34, 18
    s_lshl_b32 s94, s91, 17
    s_add_u32 s93, s93, s94
    s_lshl_b32 s94, s90, 11
    s_add_u32 s93, s93, s94
    s_add_u32 s93, s93, 83886080
    s_add_u32 s18, s4, s93
    s_addc_u32 s19, s5, 0
    s_lshl_b32 s93, s90, 8
    s_add_u32 s93, s93, 0
    s_add_u32 s20, s4, s93
    s_addc_u32 s21, s5, 0
    s_lshl_b32 s93, s34, 10
    s_lshl_b32 s94, s91, 9
    s_add_u32 s93, s93, s94
    s_lshr_b32 s94, s90, 3
    s_mul_i32 s94, s94, 96
    s_add_u32 s93, s93, s94
    s_lshl_b32 s94, s90, 2
    s_add_u32 s93, s93, s94
    s_add_u32 s93, s93, 65536
    s_add_u32 s24, s4, s93
    s_addc_u32 s25, s5, 0
    s_mov_b64 s[52:53], -1
    s_mov_b32 s54, 180000
    s_movk_i32 s62, 256
L_spin_35:
    global_load_ushort v6, v2, s[28:29] offset:192 sc1
    s_sub_u32 s50, s50, 1
    s_cselect_b64 s[48:49], 0, s[48:49]
    s_waitcnt vmcnt(0)
    v_cmp_gt_u32 vcc, s62, v6
    s_and_b64 vcc, vcc, s[48:49]
    s_cbranch_scc0 L_spino_36
    s_sleep 48
    s_branch L_spin_35
L_spino_36:
L_att_37:
    s_lshl_b32 s62, s34, 2
    v_cmp_ge_u32 vcc, s62, v191
    s_cbranch_vccz L_known_38
L_spin_39:
    global_load_dword v6, v7, s[20:21] sc1
    s_sub_u32 s50, s50, 1
    s_cselect_b64 s[48:49], 0, s[48:49]
    s_waitcnt vmcnt(0)
    v_mad_u32_u24 v191, v6, 8, v7
    v_cmp_ge_u32 vcc, s62, v191
    s_and_b64 vcc, vcc, s[48:49]
    s_cbranch_scc0 L_spino_40
    s_sleep 4
    s_branch L_spin_39
L_spino_40:
L_known_38:
    global_load_dwordx4 v[16:19], v0, s[8:9] offset:0 sc1
    global_load_dwordx4 v[20:23], v0, s[8:9] offset:1024 sc1
    global_load_dwordx4 v[24:27], v0, s[8:9] offset:2048 sc1
    global_load_dwordx4 v[28:31], v0, s[8:9] offset:3072 sc1
    global_load_dwordx4 v[32:35], v1, s[10:11] offset:0 sc1
    global_load_dwordx4 v[36:39], v1, s[10:11] offset:1024 sc1
    global_load_dwordx4 v[40:43], v1, s[10:11] offset:2048 sc1
    global_load_dwordx4 v[44:47], v1, s[10:11] offset:3072 sc1
    global_load_dwordx4 v[48:51], v1, s[10:11] offset:128 sc1
    global_load_dwordx4 v[52:55], v1, s[10:11] offset:1152 sc1
    global_load_dwordx4 v[56:59], v1, s[10:11] offset:2176 sc1
    global_load_dwordx4 v[60:63], v1, s[10:11] offset:3200 sc1
    global_load_dwordx4 v[64:67], v0, s[12:13] offset:-4096 sc1
    global_load_dwordx4 v[68:71], v0, s[12:13] offset:-3072 sc1
    global_load_dwordx4 v[72:75], v0, s[12:13] offset:-2048 sc1
    global_load_dwordx4 v[76:79], v0, s[12:13] offset:-1024 sc1
    global_load_dwordx4 v[80:83], v0, s[12:13] offset:0 sc1
    global_load_dwordx4 v[84:87], v0, s[12:13] offset:1024 sc1
    global_load_dwordx4 v[88:91], v0, s[12:13] offset:2048 sc1
    global_load_dwordx4 v[92:95], v0, s[12:13] offset:3072 sc1
    s_waitcnt vmcnt(8)
    v_mfma_f32_16x16x32_bf16 v[128:131], v[32:35], v[16:19], 0
    v_mfma_f32_16x16x32_bf16 v[128:131], v[36:39], v[20:23], v[128:131]
    v_mfma_f32_16x16x32_bf16 v[128:131], v[40:43], v[24:27], v[128:131]
    v_mfma_f32_16x16x32_bf16 v[128:131], v[44:47], v[28:31], v[128:131]
    v_mfma_f32_16x16x32_bf16 v[132:135], v[48:51], v[16:19], 0
    v_mfma_f32_16x16x32_bf16 v[132:135], v[52:55], v[20:23], v[132:135]
    v_mfma_f32_16x16x32_bf16 v[132:135], v[56:59], v[24:27], v[132:135]
    v_mfma_f32_16x16x32_bf16 v[132:135], v[60:63], v[28:31], v[132:135]
    v_mov_b64 v[136:137], 0
    v_mov_b64 v[138:139], 0
    s_nop 3
    v_cndmask_b32 v128, v10, v128, s[70:71]
    v_cndmask_b32 v129, v10, v129, s[72:73]
    v_cndmask_b32 v130, v10, v130, s[74:75]
    v_cndmask_b32 v131, v10, v131, s[76:77]
    v_cndmask_b32 v132, v10, v132, s[78:79]
    v_cndmask_b32 v133, v10, v133, s[80:81]
    v_cndmask_b32 v134, v10, v134, s[82:83]
    v_cndmask_b32 v135, v10, v135, s[84:85]
    v_max3_f32 v8, v128, v129, v130
    v_max3_f32 v8, v8, v131, v132
    v_max3_f32 v8, v8, v133, v134
    v_max_f32 v8, v8, v135
L_spin_41:
    global_load_dwordx4 v[96:99], v3, s[16:17] offset:0 sc1
    global_load_dwordx4 v[100:103], v3, s[16:17] offset:1024 sc1
    global_load_dword v112, v4, s[16:17] offset:2048 sc1
    global_load_dword v114, v4, s[16:17] offset:2304 sc1
    global_load_dword v116, v4, s[16:17] offset:2560 sc1
    global_load_dword v118, v4, s[16:17] offset:2816 sc1
    global_load_dword v120, v4, s[16:17] offset:3072 sc1
    global_load_dword v122, v4, s[16:17] offset:3328 sc1
    global_load_dword v124, v4, s[16:17] offset:3584 sc1
    global_load_dword v126, v4, s[16:17] offset:3840 sc1
    s_sub_u32 s54, s54, 1
    s_cselect_b64 s[52:53], 0, s[52:53]
    s_waitcnt vmcnt(0)
    v_maximum3_f32 v6, v96, v97, v98
    v_maximum3_f32 v6, v6, v99, v100
    v_maximum3_f32 v6, v6, v101, v102
    v_maximum3_f32 v6, v6, v103, v112
    v_maximum3_f32 v6, v6, v114, v116
    v_maximum3_f32 v6, v6, v118, v120
    v_maximum3_f32 v6, v6, v122, v124
    v_cmp_u_f32 vcc, v6, v126
    s_and_b64 vcc, vcc, s[52:53]
    s_cbranch_scc0 L_spino_42
    s_sleep 1
    s_branch L_spin_41
L_spino_42:
    v_smfmac_f32_16x16x64_bf16 v[136:139], v[96:99], v[16:23], v11
    v_smfmac_f32_16x16x64_bf16 v[136:139], v[100:103], v[24:31], v11
    s_nop 7
    v_pk_add_f32 v[136:137], v[136:137], v[138:139]
    v_max3_f32 v8, v8, v136, v137
    v_mov_b32 v9, v8
    s_nop 1
    v_permlane32_swap_b32 v8, v9
    v_max_f32 v8, v8, v9
    v_mov_b32 v9, v8
    s_nop 1
    v_permlane16_swap_b32 v8, v9
    v_max_f32 v8, v8, v9
    v_mul_f32 v8, s39, v8
    v_fma_f32 v128, v128, s38, v8
    v_fma_f32 v129, v129, s38, v8
    v_fma_f32 v130, v130, s38, v8
    v_fma_f32 v131, v131, s38, v8
    v_fma_f32 v132, v132, s38, v8
    v_fma_f32 v133, v133, s38, v8
    v_fma_f32 v134, v134, s38, v8
    v_fma_f32 v135, v135, s38, v8
    v_fma_f32 v136, v136, s38, v8
    v_fma_f32 v137, v137, s38, v8
    v_exp_f32 v128, v128
    v_exp_f32 v129, v129
    v_exp_f32 v130, v130
    v_exp_f32 v131, v131
    v_exp_f32 v132, v132
    v_exp_f32 v133, v133
    v_exp_f32 v134, v134
    v_exp_f32 v135, v135
    v_exp_f32 v136, v136
    v_exp_f32 v137, v137
    v_cvt_pk_bf16_f32 v140, v128, v129
    v_cvt_pk_bf16_f32 v141, v130, v131
    v_cvt_pk_bf16_f32 v142, v132, v133
    v_cvt_pk_bf16_f32 v143, v134, v135
    v_cvt_pk_bf16_f32 v144, v136, v137
    s_waitcnt vmcnt(0)
    s_nop 0
    v_mfma_f32_16x16x32_bf16 v[180:183], v[12:15], v[140:143], 0
    v_mfma_f32_16x16x32_bf16 v[148:151], v[64:67], v[140:143], 0
    v_mfma_f32_16x16x32_bf16 v[152:155], v[68:71], v[140:143], 0
    v_mfma_f32_16x16x32_bf16 v[156:159], v[72:75], v[140:143], 0
    v_mfma_f32_16x16x32_bf16 v[160:163], v[76:79], v[140:143], 0
    v_mfma_f32_16x16x32_bf16 v[164:167], v[80:83], v[140:143], 0
    v_mfma_f32_16x16x32_bf16 v[168:171], v[84:87], v[140:143], 0
    v_mfma_f32_16x16x32_bf16 v[172:175], v[88:91], v[140:143], 0
    v_mfma_f32_16x16x32_bf16 v[176:179], v[92:95], v[140:143], 0
    v_mfma_f32_16x16x16_bf16 v[180:183], v[12:13], v[144:145], v[180:183]
    v_mfma_f32_16x16x16_bf16 v[148:151], v[112:113], v[144:145], v[148:151]
    v_mfma_f32_16x16x16_bf16 v[152:155], v[114:115], v[144:145], v[152:155]
    v_mfma_f32_16x16x16_bf16 v[156:159], v[116:117], v[144:145], v[156:159]
    v_mfma_f32_16x16x16_bf16 v[160:163], v[118:119], v[144:145], v[160:163]
    v_mfma_f32_16x16x16_bf16 v[164:167], v[120:121], v[144:145], v[164:167]
    v_mfma_f32_16x16x16_bf16 v[168:171], v[122:123], v[144:145], v[168:171]
    v_mfma_f32_16x16x16_bf16 v[172:175], v[124:125], v[144:145], v[172:175]
    v_mfma_f32_16x16x16_bf16 v[176:179], v[126:127], v[144:145], v[176:179]
    v_rcp_f32 v180, v180
    s_nop 0
    v_mul_f32 v148, v148, v180
    v_mul_f32 v149, v149, v180
    v_cvt_pk_bf16_f32 v32, v148, v149
    v_mul_f32 v150, v150, v180
    v_mul_f32 v151, v151, v180
    v_cvt_pk_bf16_f32 v33, v150, v151
    v_mul_f32 v152, v152, v180
    v_mul_f32 v153, v153, v180
    v_cvt_pk_bf16_f32 v34, v152, v153
    v_mul_f32 v154, v154, v180
    v_mul_f32 v155, v155, v180
    v_cvt_pk_bf16_f32 v35, v154, v155
    global_store_dwordx4 v5, v[32:35], s[18:19] offset:0 sc1
    v_mul_f32 v156, v156, v180
    v_mul_f32 v157, v157, v180
    v_cvt_pk_bf16_f32 v36, v156, v157
    v_mul_f32 v158, v158, v180
    v_mul_f32 v159, v159, v180
    v_cvt_pk_bf16_f32 v37, v158, v159
    v_mul_f32 v160, v160, v180
    v_mul_f32 v161, v161, v180
    v_cvt_pk_bf16_f32 v38, v160, v161
    v_mul_f32 v162, v162, v180
    v_mul_f32 v163, v163, v180
    v_cvt_pk_bf16_f32 v39, v162, v163
    global_store_dwordx4 v5, v[36:39], s[18:19] offset:128 sc1
    v_mul_f32 v164, v164, v180
    v_mul_f32 v165, v165, v180
    v_cvt_pk_bf16_f32 v40, v164, v165
    v_mul_f32 v166, v166, v180
    v_mul_f32 v167, v167, v180
    v_cvt_pk_bf16_f32 v41, v166, v167
    v_mul_f32 v168, v168, v180
    v_mul_f32 v169, v169, v180
    v_cvt_pk_bf16_f32 v42, v168, v169
    v_mul_f32 v170, v170, v180
    v_mul_f32 v171, v171, v180
    v_cvt_pk_bf16_f32 v43, v170, v171
    global_store_dwordx4 v5, v[40:43], s[18:19] offset:1024 sc1
    s_nop 1
    v_mul_f32 v172, v172, v180
    v_mul_f32 v173, v173, v180
    v_cvt_pk_bf16_f32 v44, v172, v173
    v_mul_f32 v174, v174, v180
    v_mul_f32 v175, v175, v180
    v_cvt_pk_bf16_f32 v45, v174, v175
    v_mul_f32 v176, v176, v180
    v_mul_f32 v177, v177, v180
    v_cvt_pk_bf16_f32 v46, v176, v177
    v_mul_f32 v178, v178, v180
    v_mul_f32 v179, v179, v180
    v_cvt_pk_bf16_f32 v47, v178, v179
    global_store_dwordx4 v5, v[44:47], s[18:19] offset:1152 sc1
    v_mov_b32 v6, 1
    s_waitcnt vmcnt(0)
    s_mov_b64 exec, 1
    global_store_dword v2, v6, s[24:25] sc1
    s_mov_b64 exec, -1
    s_add_u32 s8, s8, 16384
    s_addc_u32 s9, s9, 0
    s_add_u32 s10, s10, 32768
    s_addc_u32 s11, s11, 0
    s_add_u32 s12, s12, 32768
    s_addc_u32 s13, s13, 0
    s_add_u32 s16, s16, 8192
    s_addc_u32 s17, s17, 0
    s_add_u32 s18, s18, 524288
    s_addc_u32 s19, s19, 0
    s_add_u32 s24, s24, 2048
    s_addc_u32 s25, s25, 0
    s_add_u32 s34, s34, 2
    s_cmp_lt_u32 s34, 62
    s_cbranch_scc1 L_att_37
    s_endpgm
L_role_qkv:
    s_load_dwordx4 s[80:83], s[0:1], 48
    s_load_dwordx2 s[84:85], s[0:1], 64
    s_load_dwordx2 s[86:87], s[0:1], 32
    s_mul_i32 s70, s32, 65536
    s_lshr_b32 s70, s70, 17
    s_mul_i32 s71, s70, 2
    s_sub_u32 s71, s32, s71
    s_waitcnt lgkmcnt(0)
    s_mov_b32 s12, s80
    s_and_b32 s13, s81, 0xffff
    s_mov_b32 s14, 0x400000
    s_mov_b32 s15, 0x20000
    s_mov_b32 s16, s82
    s_and_b32 s17, s83, 0xffff
    s_mov_b32 s18, 0x400000
    s_mov_b32 s19, 0x20000
    s_mov_b32 s20, s84
    s_and_b32 s21, s85, 0xffff
    s_mov_b32 s22, 0x400000
    s_mov_b32 s23, 0x20000
    s_mov_b32 s8, s86
    s_and_b32 s9, s87, 0xffff
    s_mov_b32 s10, 0x200000
    s_mov_b32 s11, 0x20000
    s_lshl_b32 s72, s70, 8
    s_lshl_b32 s34, s71, 15
    s_lshl_b32 s73, s33, 13
    s_add_u32 s34, s34, s73
    v_lshrrev_b32 v32, 4, v0
    v_and_b32 v33, 15, v32
    v_lshrrev_b32 v34, 4, v32
    v_lshrrev_b32 v35, 2, v32
    v_and_b32 v36, 3, v32
    v_and_b32 v37, 3, v35
    s_lshl_b32 s62, s33, 4
    v_add_u32 v38, s62, v34
    s_mov_b32 s62, 8192
    v_mul_lo_u32 v4, s62, v38
    v_xor_b32 v38, v37, v34
    v_lshl_add_u32 v4, v38, 6, v4
    v_lshl_add_u32 v4, v36, 4, v4
    v_add_u32 v4, s72, v4
    s_mul_i32 s60, s33, 28672
    v_xor_b32 v39, s33, v37
    v_bfe_u32 v38, v34, 1, 1
    v_mul_u32_u24 v16, 28672, v38
    v_bfe_u32 v38, v34, 0, 1
    v_mul_u32_u24 v38, 2048, v38
    v_add_u32 v16, v16, v38
    v_bfe_u32 v38, v37, 0, 2
    v_mul_u32_u24 v38, 256, v38
    v_add_u32 v16, v16, v38
    v_bfe_u32 v38, v39, 0, 2
    v_mul_u32_u24 v38, 64, v38
    v_add_u32 v16, v16, v38
    v_bfe_u32 v38, v36, 0, 2
    v_mul_u32_u24 v38, 8, v38
    v_add_u32 v16, v16, v38
    v_add_u32 v17, 57344, v16
    v_bfe_u32 v38, v33, 0, 4
    v_mul_u32_u24 v1, 1056, v38
    v_bfe_u32 v38, v34, 0, 2
    v_mul_u32_u24 v38, 16, v38
    v_add_u32 v1, v1, v38
    v_add_u32 v1, 114688, v1
    v_bfe_u32 v38, v33, 2, 1
    v_mul_u32_u24 v2, 4096, v38
    v_bfe_u32 v38, v34, 0, 2
    v_mul_u32_u24 v38, 256, v38
    v_add_u32 v2, v2, v38
    v_bfe_u32 v38, v33, 3, 1
    v_mul_u32_u24 v38, 64, v38
    v_add_u32 v2, v2, v38
    v_bfe_u32 v38, v33, 0, 2
    v_mul_u32_u24 v38, 16, v38
    v_add_u32 v2, v2, v38
    v_mov_b32 v3, 0
    s_mul_i32 s35, s33, 8448
    s_add_u32 s35, s35, 114688
    s_add_u32 m0, s60, 0
    s_mov_b32 s62, 0
    buffer_load_dwordx4 v4, s[16:19], s62 offen  lds
    s_add_u32 m0, s60, 1024
    s_mov_b32 s62, 32768
    buffer_load_dwordx4 v4, s[16:19], s62 offen  lds
    s_add_u32 m0, s60, 2048
    s_mov_b32 s62, 65536
    buffer_load_dwordx4 v4, s[16:19], s62 offen  lds
    s_add_u32 m0, s60, 3072
    s_mov_b32 s62, 98304
    buffer_load_dwordx4 v4, s[16:19], s62 offen  lds
    s_add_u32 m0, s60, 4096
    s_mov_b32 s62, 524288
    buffer_load_dwordx4 v4, s[16:19], s62 offen  lds
    s_add_u32 m0, s60, 5120
    s_mov_b32 s62, 557056
    buffer_load_dwordx4 v4, s[16:19], s62 offen  lds
    s_add_u32 m0, s60, 6144
    s_mov_b32 s62, 589824
    buffer_load_dwordx4 v4, s[16:19], s62 offen  lds
    s_add_u32 m0, s60, 7168
    s_mov_b32 s62, 622592
    buffer_load_dwordx4 v4, s[16:19], s62 offen  lds
    s_add_u32 m0, s60, 8192
    s_mov_b32 s62, 1048576
    buffer_load_dwordx4 v4, s[16:19], s62 offen  lds
    s_add_u32 m0, s60, 9216
    s_mov_b32 s62, 1081344
    buffer_load_dwordx4 v4, s[16:19], s62 offen  lds
    s_add_u32 m0, s60, 10240
    s_mov_b32 s62, 1114112
    buffer_load_dwordx4 v4, s[16:19], s62 offen  lds
    s_add_u32 m0, s60, 11264
    s_mov_b32 s62, 1146880
    buffer_load_dwordx4 v4, s[16:19], s62 offen  lds
    s_add_u32 m0, s60, 12288
    s_mov_b32 s62, 1572864
    buffer_load_dwordx4 v4, s[16:19], s62 offen  lds
    s_add_u32 m0, s60, 13312
    s_mov_b32 s62, 1605632
    buffer_load_dwordx4 v4, s[16:19], s62 offen  lds
    s_add_u32 m0, s60, 14336
    s_mov_b32 s62, 1638400
    buffer_load_dwordx4 v4, s[16:19], s62 offen  lds
    s_add_u32 m0, s60, 15360
    s_mov_b32 s62, 1671168
    buffer_load_dwordx4 v4, s[16:19], s62 offen  lds
    s_add_u32 m0, s60, 16384
    s_mov_b32 s62, 2097152
    buffer_load_dwordx4 v4, s[16:19], s62 offen  lds
    s_add_u32 m0, s60, 17408
    s_mov_b32 s62, 2129920
    buffer_load_dwordx4 v4, s[16:19], s62 offen  lds
    s_add_u32 m0, s60, 18432
    s_mov_b32 s62, 2162688
    buffer_load_dwordx4 v4, s[16:19], s62 offen  lds
    s_add_u32 m0, s60, 19456
    s_mov_b32 s62, 2195456
    buffer_load_dwordx4 v4, s[16:19], s62 offen  lds
    s_add_u32 m0, s60, 20480
    s_mov_b32 s62, 2621440
    buffer_load_dwordx4 v4, s[16:19], s62 offen  lds
    s_add_u32 m0, s60, 21504
    s_mov_b32 s62, 2654208
    buffer_load_dwordx4 v4, s[16:19], s62 offen  lds
    s_add_u32 m0, s60, 22528
    s_mov_b32 s62, 2686976
    buffer_load_dwordx4 v4, s[16:19], s62 offen  lds
    s_add_u32 m0, s60, 23552
    s_mov_b32 s62, 2719744
    buffer_load_dwordx4 v4, s[16:19], s62 offen  lds
    s_waitcnt vmcnt(20) lgkmcnt(0)
    s_barrier
    s_add_u32 m0, s60, 24576
    s_mov_b32 s62, 3145728
    buffer_load_dwordx4 v4, s[16:19], s62 offen  lds
    s_add_u32 m0, s60, 25600
    s_mov_b32 s62, 3178496
    buffer_load_dwordx4 v4, s[16:19], s62 offen  lds
    s_add_u32 m0, s60, 26624
    s_mov_b32 s62, 3211264
    buffer_load_dwordx4 v4, s[16:19], s62 offen  lds
    s_add_u32 m0, s60, 27648
    s_mov_b32 s62, 3244032
    buffer_load_dwordx4 v4, s[16:19], s62 offen  lds
    ds_read_b64_tr_b16 a[0:1], v16 offset:0
    ds_read_b64_tr_b16 a[2:3], v16 offset:1024
    ds_read_b64_tr_b16 a[4:5], v17 offset:0
    ds_read_b64_tr_b16 a[6:7], v17 offset:1024
    ds_read_b64_tr_b16 a[8:9], v16 offset:32
    ds_read_b64_tr_b16 a[10:11], v16 offset:1056
    ds_read_b64_tr_b16 a[12:13], v17 offset:32
    ds_read_b64_tr_b16 a[14:15], v17 offset:1056
    s_waitcnt vmcnt(20) lgkmcnt(0)
    s_barrier
    s_add_u32 m0, s60, 0
    s_mov_b32 s62, 3670016
    buffer_load_dwordx4 v4, s[16:19], s62 offen  lds
    s_add_u32 m0, s60, 1024
    s_mov_b32 s62, 3702784
    buffer_load_dwordx4 v4, s[16:19], s62 offen  lds
    s_add_u32 m0, s60, 2048
    s_mov_b32 s62, 3735552
    buffer_load_dwordx4 v4, s[16:19], s62 offen  lds
    s_add_u32 m0, s60, 3072
    s_mov_b32 s62, 3768320
    buffer_load_dwordx4 v4, s[16:19], s62 offen  lds
    ds_read_b64_tr_b16 a[16:17], v16 offset:4096
    ds_read_b64_tr_b16 a[18:19], v16 offset:5120
    ds_read_b64_tr_b16 a[20:21], v17 offset:4096
    ds_read_b64_tr_b16 a[22:23], v17 offset:5120
    ds_read_b64_tr_b16 a[24:25], v16 offset:4128
    ds_read_b64_tr_b16 a[26:27], v16 offset:5152
    ds_read_b64_tr_b16 a[28:29], v17 offset:4128
    ds_read_b64_tr_b16 a[30:31], v17 offset:5152
    s_waitcnt vmcnt(20) lgkmcnt(0)
    s_barrier
    s_add_u32 m0, s60, 4096
    s_mov_b32 s62, 0
    buffer_load_dwordx4 v4, s[20:23], s62 offen  lds
    s_add_u32 m0, s60, 5120
    s_mov_b32 s62, 32768
    buffer_load_dwordx4 v4, s[20:23], s62 offen  lds
    s_add_u32 m0, s60, 6144
    s_mov_b32 s62, 65536
    buffer_load_dwordx4 v4, s[20:23], s62 offen  lds
    s_add_u32 m0, s60, 7168
    s_mov_b32 s62, 98304
    buffer_load_dwordx4 v4, s[20:23], s62 offen  lds
    ds_read_b64_tr_b16 a[32:33], v16 offset:8192
    ds_read_b64_tr_b16 a[34:35], v16 offset:9216
    ds_read_b64_tr_b16 a[36:37], v17 offset:8192
    ds_read_b64_tr_b16 a[38:39], v17 offset:9216
    ds_read_b64_tr_b16 a[40:41], v16 offset:8224
    ds_read_b64_tr_b16 a[42:43], v16 offset:9248
    ds_read_b64_tr_b16 a[44:45], v17 offset:8224
    ds_read_b64_tr_b16 a[46:47], v17 offset:9248
    s_waitcnt vmcnt(20) lgkmcnt(0)
    s_barrier
    s_add_u32 m0, s60, 8192
    s_mov_b32 s62, 524288
    buffer_load_dwordx4 v4, s[20:23], s62 offen  lds
    s_add_u32 m0, s60, 9216
    s_mov_b32 s62, 557056
    buffer_load_dwordx4 v4, s[20:23], s62 offen  lds
    s_add_u32 m0, s60, 10240
    s_mov_b32 s62, 589824
    buffer_load_dwordx4 v4, s[20:23], s62 offen  lds
    s_add_u32 m0, s60, 11264
    s_mov_b32 s62, 622592
    buffer_load_dwordx4 v4, s[20:23], s62 offen  lds
    ds_read_b64_tr_b16 a[48:49], v16 offset:12288
    ds_read_b64_tr_b16 a[50:51], v16 offset:13312
    ds_read_b64_tr_b16 a[52:53], v17 offset:12288
    ds_read_b64_tr_b16 a[54:55], v17 offset:13312
    ds_read_b64_tr_b16 a[56:57], v16 offset:12320
    ds_read_b64_tr_b16 a[58:59], v16 offset:13344
    ds_read_b64_tr_b16 a[60:61], v17 offset:12320
    ds_read_b64_tr_b16 a[62:63], v17 offset:13344
    s_waitcnt vmcnt(20) lgkmcnt(0)
    s_barrier
    s_add_u32 m0, s60, 12288
    s_mov_b32 s62, 1048576
    buffer_load_dwordx4 v4, s[20:23], s62 offen  lds
    s_add_u32 m0, s60, 13312
    s_mov_b32 s62, 1081344
    buffer_load_dwordx4 v4, s[20:23], s62 offen  lds
    s_add_u32 m0, s60, 14336
    s_mov_b32 s62, 1114112
    buffer_load_dwordx4 v4, s[20:23], s62 offen  lds
    s_add_u32 m0, s60, 15360
    s_mov_b32 s62, 1146880
    buffer_load_dwordx4 v4, s[20:23], s62 offen  lds
    ds_read_b64_tr_b16 a[64:65], v16 offset:16384
    ds_read_b64_tr_b16 a[66:67], v16 offset:17408
    ds_read_b64_tr_b16 a[68:69], v17 offset:16384
    ds_read_b64_tr_b16 a[70:71], v17 offset:17408
    ds_read_b64_tr_b16 a[72:73], v16 offset:16416
    ds_read_b64_tr_b16 a[74:75], v16 offset:17440
    ds_read_b64_tr_b16 a[76:77], v17 offset:16416
    ds_read_b64_tr_b16 a[78:79], v17 offset:17440
    s_waitcnt vmcnt(20) lgkmcnt(0)
    s_barrier
    s_add_u32 m0, s60, 16384
    s_mov_b32 s62, 1572864
    buffer_load_dwordx4 v4, s[20:23], s62 offen  lds
    s_add_u32 m0, s60, 17408
    s_mov_b32 s62, 1605632
    buffer_load_dwordx4 v4, s[20:23], s62 offen  lds
    s_add_u32 m0, s60, 18432
    s_mov_b32 s62, 1638400
    buffer_load_dwordx4 v4, s[20:23], s62 offen  lds
    s_add_u32 m0, s60, 19456
    s_mov_b32 s62, 1671168
    buffer_load_dwordx4 v4, s[20:23], s62 offen  lds
    ds_read_b64_tr_b16 a[80:81], v16 offset:20480
    ds_read_b64_tr_b16 a[82:83], v16 offset:21504
    ds_read_b64_tr_b16 a[84:85], v17 offset:20480
    ds_read_b64_tr_b16 a[86:87], v17 offset:21504
    ds_read_b64_tr_b16 a[88:89], v16 offset:20512
    ds_read_b64_tr_b16 a[90:91], v16 offset:21536
    ds_read_b64_tr_b16 a[92:93], v17 offset:20512
    ds_read_b64_tr_b16 a[94:95], v17 offset:21536
    s_waitcnt vmcnt(20) lgkmcnt(0)
    s_barrier
    s_add_u32 m0, s60, 20480
    s_mov_b32 s62, 2097152
    buffer_load_dwordx4 v4, s[20:23], s62 offen  lds
    s_add_u32 m0, s60, 21504
    s_mov_b32 s62, 2129920
    buffer_load_dwordx4 v4, s[20:23], s62 offen  lds
    s_add_u32 m0, s60, 22528
    s_mov_b32 s62, 2162688
    buffer_load_dwordx4 v4, s[20:23], s62 offen  lds
    s_add_u32 m0, s60, 23552
    s_mov_b32 s62, 2195456
    buffer_load_dwordx4 v4, s[20:23], s62 offen  lds
    ds_read_b64_tr_b16 a[96:97], v16 offset:24576
    ds_read_b64_tr_b16 a[98:99], v16 offset:25600
    ds_read_b64_tr_b16 a[100:101], v17 offset:24576
    ds_read_b64_tr_b16 a[102:103], v17 offset:25600
    ds_read_b64_tr_b16 a[104:105], v16 offset:24608
    ds_read_b64_tr_b16 a[106:107], v16 offset:25632
    ds_read_b64_tr_b16 a[108:109], v17 offset:24608
    ds_read_b64_tr_b16 a[110:111], v17 offset:25632
    s_waitcnt vmcnt(20) lgkmcnt(0)
    s_barrier
    s_add_u32 m0, s60, 24576
    s_mov_b32 s62, 2621440
    buffer_load_dwordx4 v4, s[20:23], s62 offen  lds
    s_add_u32 m0, s60, 25600
    s_mov_b32 s62, 2654208
    buffer_load_dwordx4 v4, s[20:23], s62 offen  lds
    s_add_u32 m0, s60, 26624
    s_mov_b32 s62, 2686976
    buffer_load_dwordx4 v4, s[20:23], s62 offen  lds
    s_add_u32 m0, s60, 27648
    s_mov_b32 s62, 2719744
    buffer_load_dwordx4 v4, s[20:23], s62 offen  lds
    ds_read_b64_tr_b16 a[112:113], v16 offset:0
    ds_read_b64_tr_b16 a[114:115], v16 offset:1024
    ds_read_b64_tr_b16 a[116:117], v17 offset:0
    ds_read_b64_tr_b16 a[118:119], v17 offset:1024
    ds_read_b64_tr_b16 a[120:121], v16 offset:32
    ds_read_b64_tr_b16 a[122:123], v16 offset:1056
    ds_read_b64_tr_b16 a[124:125], v17 offset:32
    ds_read_b64_tr_b16 a[126:127], v17 offset:1056
    s_waitcnt vmcnt(20) lgkmcnt(0)
    s_barrier
    s_add_u32 m0, s60, 0
    s_mov_b32 s62, 3145728
    buffer_load_dwordx4 v4, s[20:23], s62 offen  lds
    s_add_u32 m0, s60, 1024
    s_mov_b32 s62, 3178496
    buffer_load_dwordx4 v4, s[20:23], s62 offen  lds
    s_add_u32 m0, s60, 2048
    s_mov_b32 s62, 3211264
    buffer_load_dwordx4 v4, s[20:23], s62 offen  lds
    s_add_u32 m0, s60, 3072
    s_mov_b32 s62, 3244032
    buffer_load_dwordx4 v4, s[20:23], s62 offen  lds
    ds_read_b64_tr_b16 a[128:129], v16 offset:4096
    ds_read_b64_tr_b16 a[130:131], v16 offset:5120
    ds_read_b64_tr_b16 a[132:133], v17 offset:4096
    ds_read_b64_tr_b16 a[134:135], v17 offset:5120
    ds_read_b64_tr_b16 a[136:137], v16 offset:4128
    ds_read_b64_tr_b16 a[138:139], v16 offset:5152
    ds_read_b64_tr_b16 a[140:141], v17 offset:4128
    ds_read_b64_tr_b16 a[142:143], v17 offset:5152
    s_waitcnt vmcnt(20) lgkmcnt(0)
    s_barrier
    s_add_u32 m0, s60, 4096
    s_mov_b32 s62, 3670016
    buffer_load_dwordx4 v4, s[20:23], s62 offen  lds
    s_add_u32 m0, s60, 5120
    s_mov_b32 s62, 3702784
    buffer_load_dwordx4 v4, s[20:23], s62 offen  lds
    s_add_u32 m0, s60, 6144
    s_mov_b32 s62, 3735552
    buffer_load_dwordx4 v4, s[20:23], s62 offen  lds
    s_add_u32 m0, s60, 7168
    s_mov_b32 s62, 3768320
    buffer_load_dwordx4 v4, s[20:23], s62 offen  lds
    ds_read_b64_tr_b16 a[144:145], v16 offset:8192
    ds_read_b64_tr_b16 a[146:147], v16 offset:9216
    ds_read_b64_tr_b16 a[148:149], v17 offset:8192
    ds_read_b64_tr_b16 a[150:151], v17 offset:9216
    ds_read_b64_tr_b16 a[152:153], v16 offset:8224
    ds_read_b64_tr_b16 a[154:155], v16 offset:9248
    ds_read_b64_tr_b16 a[156:157], v17 offset:8224
    ds_read_b64_tr_b16 a[158:159], v17 offset:9248
    s_waitcnt vmcnt(20) lgkmcnt(0)
    s_barrier
    s_add_u32 m0, s60, 8192
    s_mov_b32 s62, 0
    buffer_load_dwordx4 v4, s[12:15], s62 offen  lds
    s_add_u32 m0, s60, 9216
    s_mov_b32 s62, 32768
    buffer_load_dwordx4 v4, s[12:15], s62 offen  lds
    s_add_u32 m0, s60, 10240
    s_mov_b32 s62, 65536
    buffer_load_dwordx4 v4, s[12:15], s62 offen  lds
    s_add_u32 m0, s60, 11264
    s_mov_b32 s62, 98304
    buffer_load_dwordx4 v4, s[12:15], s62 offen  lds
    ds_read_b64_tr_b16 a[160:161], v16 offset:12288
    ds_read_b64_tr_b16 a[162:163], v16 offset:13312
    ds_read_b64_tr_b16 a[164:165], v17 offset:12288
    ds_read_b64_tr_b16 a[166:167], v17 offset:13312
    ds_read_b64_tr_b16 a[168:169], v16 offset:12320
    ds_read_b64_tr_b16 a[170:171], v16 offset:13344
    ds_read_b64_tr_b16 a[172:173], v17 offset:12320
    ds_read_b64_tr_b16 a[174:175], v17 offset:13344
    s_waitcnt vmcnt(20) lgkmcnt(0)
    s_barrier
    s_add_u32 m0, s60, 12288
    s_mov_b32 s62, 524288
    buffer_load_dwordx4 v4, s[12:15], s62 offen  lds
    s_add_u32 m0, s60, 13312
    s_mov_b32 s62, 557056
    buffer_load_dwordx4 v4, s[12:15], s62 offen  lds
    s_add_u32 m0, s60, 14336
    s_mov_b32 s62, 589824
    buffer_load_dwordx4 v4, s[12:15], s62 offen  lds
    s_add_u32 m0, s60, 15360
    s_mov_b32 s62, 622592
    buffer_load_dwordx4 v4, s[12:15], s62 offen  lds
    ds_read_b64_tr_b16 a[176:177], v16 offset:16384
    ds_read_b64_tr_b16 a[178:179], v16 offset:17408
    ds_read_b64_tr_b16 a[180:181], v17 offset:16384
    ds_read_b64_tr_b16 a[182:183], v17 offset:17408
    ds_read_b64_tr_b16 a[184:185], v16 offset:16416
    ds_read_b64_tr_b16 a[186:187], v16 offset:17440
    ds_read_b64_tr_b16 a[188:189], v17 offset:16416
    ds_read_b64_tr_b16 a[190:191], v17 offset:17440
    s_waitcnt vmcnt(20) lgkmcnt(0)
    s_barrier
    s_add_u32 m0, s60, 16384
    s_mov_b32 s62, 1048576
    buffer_load_dwordx4 v4, s[12:15], s62 offen  lds
    s_add_u32 m0, s60, 17408
    s_mov_b32 s62, 1081344
    buffer_load_dwordx4 v4, s[12:15], s62 offen  lds
    s_add_u32 m0, s60, 18432
    s_mov_b32 s62, 1114112
    buffer_load_dwordx4 v4, s[12:15], s62 offen  lds
    s_add_u32 m0, s60, 19456
    s_mov_b32 s62, 1146880
    buffer_load_dwordx4 v4, s[12:15], s62 offen  lds
    ds_read_b64_tr_b16 a[192:193], v16 offset:20480
    ds_read_b64_tr_b16 a[194:195], v16 offset:21504
    ds_read_b64_tr_b16 a[196:197], v17 offset:20480
    ds_read_b64_tr_b16 a[198:199], v17 offset:21504
    ds_read_b64_tr_b16 a[200:201], v16 offset:20512
    ds_read_b64_tr_b16 a[202:203], v16 offset:21536
    ds_read_b64_tr_b16 a[204:205], v17 offset:20512
    ds_read_b64_tr_b16 a[206:207], v17 offset:21536
    s_waitcnt vmcnt(20) lgkmcnt(0)
    s_barrier
    s_add_u32 m0, s60, 20480
    s_mov_b32 s62, 1572864
    buffer_load_dwordx4 v4, s[12:15], s62 offen  lds
    s_add_u32 m0, s60, 21504
    s_mov_b32 s62, 1605632
    buffer_load_dwordx4 v4, s[12:15], s62 offen  lds
    s_add_u32 m0, s60, 22528
    s_mov_b32 s62, 1638400
    buffer_load_dwordx4 v4, s[12:15], s62 offen  lds
    s_add_u32 m0, s60, 23552
    s_mov_b32 s62, 1671168
    buffer_load_dwordx4 v4, s[12:15], s62 offen  lds
    ds_read_b64_tr_b16 a[208:209], v16 offset:24576
    ds_read_b64_tr_b16 a[210:211], v16 offset:25600
    ds_read_b64_tr_b16 a[212:213], v17 offset:24576
    ds_read_b64_tr_b16 a[214:215], v17 offset:25600
    ds_read_b64_tr_b16 a[216:217], v16 offset:24608
    ds_read_b64_tr_b16 a[218:219], v16 offset:25632
    ds_read_b64_tr_b16 a[220:221], v17 offset:24608
    ds_read_b64_tr_b16 a[222:223], v17 offset:25632
    s_waitcnt vmcnt(20) lgkmcnt(0)
    s_barrier
    s_add_u32 m0, s60, 24576
    s_mov_b32 s62, 2097152
    buffer_load_dwordx4 v4, s[12:15], s62 offen  lds
    s_add_u32 m0, s60, 25600
    s_mov_b32 s62, 2129920
    buffer_load_dwordx4 v4, s[12:15], s62 offen  lds
    s_add_u32 m0, s60, 26624
    s_mov_b32 s62, 2162688
    buffer_load_dwordx4 v4, s[12:15], s62 offen  lds
    s_add_u32 m0, s60, 27648
    s_mov_b32 s62, 2195456
    buffer_load_dwordx4 v4, s[12:15], s62 offen  lds
    ds_read_b64_tr_b16 a[224:225], v16 offset:0
    ds_read_b64_tr_b16 a[226:227], v16 offset:1024
    ds_read_b64_tr_b16 a[228:229], v17 offset:0
    ds_read_b64_tr_b16 a[230:231], v17 offset:1024
    ds_read_b64_tr_b16 a[232:233], v16 offset:32
    ds_read_b64_tr_b16 a[234:235], v16 offset:1056
    ds_read_b64_tr_b16 a[236:237], v17 offset:32
    ds_read_b64_tr_b16 a[238:239], v17 offset:1056
    s_waitcnt vmcnt(20) lgkmcnt(0)
    s_barrier
    s_add_u32 m0, s60, 0
    s_mov_b32 s62, 2621440
    buffer_load_dwordx4 v4, s[12:15], s62 offen  lds
    s_add_u32 m0, s60, 1024
    s_mov_b32 s62, 2654208
    buffer_load_dwordx4 v4, s[12:15], s62 offen  lds
    s_add_u32 m0, s60, 2048
    s_mov_b32 s62, 2686976
    buffer_load_dwordx4 v4, s[12:15], s62 offen  lds
    s_add_u32 m0, s60, 3072
    s_mov_b32 s62, 2719744
    buffer_load_dwordx4 v4, s[12:15], s62 offen  lds
    s_add_u32 m0, s35, 0
    s_add_u32 s62, s34, 0
    buffer_load_dwordx4 v0, s[8:11], s62 offen lds
    s_add_u32 m0, s35, 1056
    s_add_u32 s62, s34, 1024
    buffer_load_dwordx4 v0, s[8:11], s62 offen lds
    s_add_u32 m0, s35, 2112
    s_add_u32 s62, s34, 2048
    buffer_load_dwordx4 v0, s[8:11], s62 offen lds
    s_add_u32 m0, s35, 3168
    s_add_u32 s62, s34, 3072
    buffer_load_dwordx4 v0, s[8:11], s62 offen lds
    s_add_u32 m0, s35, 4224
    s_add_u32 s62, s34, 4096
    buffer_load_dwordx4 v0, s[8:11], s62 offen lds
    s_add_u32 m0, s35, 5280
    s_add_u32 s62, s34, 5120
    buffer_load_dwordx4 v0, s[8:11], s62 offen lds
    s_add_u32 m0, s35, 6336
    s_add_u32 s62, s34, 6144
    buffer_load_dwordx4 v0, s[8:11], s62 offen lds
    s_add_u32 m0, s35, 7392
    s_add_u32 s62, s34, 7168
    buffer_load_dwordx4 v0, s[8:11], s62 offen lds
    global_load_ushort v5, v3, s[28:29] offset:192 sc1
    ds_read_b64_tr_b16 a[240:241], v16 offset:4096
    ds_read_b64_tr_b16 a[242:243], v16 offset:5120
    ds_read_b64_tr_b16 a[244:245], v17 offset:4096
    ds_read_b64_tr_b16 a[246:247], v17 offset:5120
    ds_read_b64_tr_b16 a[248:249], v16 offset:4128
    ds_read_b64_tr_b16 a[250:251], v16 offset:5152
    ds_read_b64_tr_b16 a[252:253], v17 offset:4128
    ds_read_b64_tr_b16 a[254:255], v17 offset:5152
    s_waitcnt vmcnt(29) lgkmcnt(0)
    s_barrier
    s_add_u32 m0, s60, 4096
    s_mov_b32 s62, 3145728
    buffer_load_dwordx4 v4, s[12:15], s62 offen  lds
    s_add_u32 m0, s60, 5120
    s_mov_b32 s62, 3178496
    buffer_load_dwordx4 v4, s[12:15], s62 offen  lds
    s_add_u32 m0, s60, 6144
    s_mov_b32 s62, 3211264
    buffer_load_dwordx4 v4, s[12:15], s62 offen  lds
    s_add_u32 m0, s60, 7168
    s_mov_b32 s62, 3244032
    buffer_load_dwordx4 v4, s[12:15], s62 offen  lds
    ds_read_b64_tr_b16 v[128:129], v16 offset:8192
    ds_read_b64_tr_b16 v[130:131], v16 offset:9216
    ds_read_b64_tr_b16 v[132:133], v17 offset:8192
    ds_read_b64_tr_b16 v[134:135], v17 offset:9216
    ds_read_b64_tr_b16 v[136:137], v16 offset:8224
    ds_read_b64_tr_b16 v[138:139], v16 offset:9248
    ds_read_b64_tr_b16 v[140:141], v17 offset:8224
    ds_read_b64_tr_b16 v[142:143], v17 offset:9248
    s_waitcnt vmcnt(29) lgkmcnt(0)
    s_barrier
    s_add_u32 m0, s60, 8192
    s_mov_b32 s62, 3670016
    buffer_load_dwordx4 v4, s[12:15], s62 offen  lds
    s_add_u32 m0, s60, 9216
    s_mov_b32 s62, 3702784
    buffer_load_dwordx4 v4, s[12:15], s62 offen  lds
    s_add_u32 m0, s60, 10240
    s_mov_b32 s62, 3735552
    buffer_load_dwordx4 v4, s[12:15], s62 offen  lds
    s_add_u32 m0, s60, 11264
    s_mov_b32 s62, 3768320
    buffer_load_dwordx4 v4, s[12:15], s62 offen  lds
    ds_read_b64_tr_b16 v[144:145], v16 offset:12288
    ds_read_b64_tr_b16 v[146:147], v16 offset:13312
    ds_read_b64_tr_b16 v[148:149], v17 offset:12288
    ds_read_b64_tr_b16 v[150:151], v17 offset:13312
    ds_read_b64_tr_b16 v[152:153], v16 offset:12320
    ds_read_b64_tr_b16 v[154:155], v16 offset:13344
    ds_read_b64_tr_b16 v[156:157], v17 offset:12320
    ds_read_b64_tr_b16 v[158:159], v17 offset:13344
    s_waitcnt vmcnt(29) lgkmcnt(0)
    s_barrier
    ds_read_b64_tr_b16 v[160:161], v16 offset:16384
    ds_read_b64_tr_b16 v[162:163], v16 offset:17408
    ds_read_b64_tr_b16 v[164:165], v17 offset:16384
    ds_read_b64_tr_b16 v[166:167], v17 offset:17408
    ds_read_b64_tr_b16 v[168:169], v16 offset:16416
    ds_read_b64_tr_b16 v[170:171], v16 offset:17440
    ds_read_b64_tr_b16 v[172:173], v17 offset:16416
    ds_read_b64_tr_b16 v[174:175], v17 offset:17440
    s_waitcnt vmcnt(25) lgkmcnt(0)
    s_barrier
    ds_read_b64_tr_b16 v[176:177], v16 offset:20480
    ds_read_b64_tr_b16 v[178:179], v16 offset:21504
    ds_read_b64_tr_b16 v[180:181], v17 offset:20480
    ds_read_b64_tr_b16 v[182:183], v17 offset:21504
    ds_read_b64_tr_b16 v[184:185], v16 offset:20512
    ds_read_b64_tr_b16 v[186:187], v16 offset:21536
    ds_read_b64_tr_b16 v[188:189], v17 offset:20512
    ds_read_b64_tr_b16 v[190:191], v17 offset:21536
    s_waitcnt vmcnt(21) lgkmcnt(0)
    s_barrier
    ds_read_b64_tr_b16 v[192:193], v16 offset:24576
    ds_read_b64_tr_b16 v[194:195], v16 offset:25600
    ds_read_b64_tr_b16 v[196:197], v17 offset:24576
    ds_read_b64_tr_b16 v[198:199], v17 offset:25600
    ds_read_b64_tr_b16 v[200:201], v16 offset:24608
    ds_read_b64_tr_b16 v[202:203], v16 offset:25632
    ds_read_b64_tr_b16 v[204:205], v17 offset:24608
    ds_read_b64_tr_b16 v[206:207], v17 offset:25632
    s_waitcnt vmcnt(17) lgkmcnt(0)
    s_barrier
    ds_read_b64_tr_b16 v[208:209], v16 offset:0
    ds_read_b64_tr_b16 v[210:211], v16 offset:1024
    ds_read_b64_tr_b16 v[212:213], v17 offset:0
    ds_read_b64_tr_b16 v[214:215], v17 offset:1024
    ds_read_b64_tr_b16 v[216:217], v16 offset:32
    ds_read_b64_tr_b16 v[218:219], v16 offset:1056
    ds_read_b64_tr_b16 v[220:221], v17 offset:32
    ds_read_b64_tr_b16 v[222:223], v17 offset:1056
    s_waitcnt vmcnt(4) lgkmcnt(0)
    s_barrier
    ds_read_b64_tr_b16 v[224:225], v16 offset:4096
    ds_read_b64_tr_b16 v[226:227], v16 offset:5120
    ds_read_b64_tr_b16 v[228:229], v17 offset:4096
    ds_read_b64_tr_b16 v[230:231], v17 offset:5120
    ds_read_b64_tr_b16 v[232:233], v16 offset:4128
    ds_read_b64_tr_b16 v[234:235], v16 offset:5152
    ds_read_b64_tr_b16 v[236:237], v17 offset:4128
    ds_read_b64_tr_b16 v[238:239], v17 offset:5152
    s_waitcnt vmcnt(0) lgkmcnt(0)
    s_barrier
    ds_read_b64_tr_b16 v[240:241], v16 offset:8192
    ds_read_b64_tr_b16 v[242:243], v16 offset:9216
    ds_read_b64_tr_b16 v[244:245], v17 offset:8192
    ds_read_b64_tr_b16 v[246:247], v17 offset:9216
    ds_read_b64_tr_b16 v[248:249], v16 offset:8224
    ds_read_b64_tr_b16 v[250:251], v16 offset:9248
    ds_read_b64_tr_b16 v[252:253], v17 offset:8224
    ds_read_b64_tr_b16 v[254:255], v17 offset:9248
    s_waitcnt lgkmcnt(0)
    s_barrier
    s_movk_i32 s62, 256
    v_cmp_gt_u32 vcc, s62, v5
    s_cbranch_vccz L_arrok_43
    s_movk_i32 s62, 256
L_spin_44:
    global_load_ushort v4, v3, s[28:29] offset:192 sc1
    s_sub_u32 s50, s50, 1
    s_cselect_b64 s[48:49], 0, s[48:49]
    s_waitcnt vmcnt(0)
    v_cmp_gt_u32 vcc, s62, v4
    s_and_b64 vcc, vcc, s[48:49]
    s_cbranch_scc0 L_spino_45
    s_sleep 8
    s_branch L_spin_44
L_spino_45:
L_arrok_43:
    s_cmp_eq_u32 s71, 0
    s_cselect_b32 s37, 32, 32
    s_mul_i32 s72, s70, 65
    s_add_u32 s72, s72, s71
    s_lshl_b32 s74, s33, 10
    s_lshl_b32 s73, s72, 13
    s_add_u32 s73, s73, s74
    s_add_u32 s73, s73, 51382272
    s_add_u32 s40, s4, s73
    s_addc_u32 s41, s5, 0
    s_lshl_b32 s73, s72, 14
    s_add_u32 s73, s73, s74
    s_add_u32 s73, s73, 16777216
    s_add_u32 s42, s4, s73
    s_addc_u32 s43, s5, 0
    s_lshl_b32 s73, s72, 14
    s_add_u32 s73, s73, s74
    s_add_u32 s73, s73, s74
    s_add_u32 s73, s73, 16785408
    s_add_u32 s44, s4, s73
    s_addc_u32 s45, s5, 0
    s_mul_i32 s73, s70, 65
    s_add_u32 s73, s73, s71
    s_lshl_b32 s73, s73, 12
    s_add_u32 s73, s73, s74
    s_add_u32 s73, s73, 69210112
    s_add_u32 s52, s4, s73
    s_addc_u32 s53, s5, 0
    v_mov_b64 v[104:105], -1
    v_mov_b64 v[106:107], -1
    s_lshl_b32 s73, s70, 8
    s_lshl_b32 s74, s71, 2
    s_add_u32 s73, s73, s74
    s_add_u32 s73, s73, 0
    s_add_u32 s46, s4, s73
    s_addc_u32 s47, s5, 0
    v_lshlrev_b32 v5, 11, v0
    s_mov_b32 s36, -33792
    s_mov_b32 s38, 0
L_proj_46:
    s_waitcnt vmcnt(7)
    s_barrier
    ds_read_b128 v[16:19], v1 offset:0
    ds_read_b128 v[20:23], v1 offset:16896
    s_add_u32 s34, s34, 65536
    s_add_u32 s35, s35, s36
    s_add_u32 m0, s35, 0
    s_add_u32 s62, s34, 0
    buffer_load_dwordx4 v0, s[8:11], s62 offen lds
    s_add_u32 m0, s35, 1056
    s_add_u32 s62, s34, 1024
    buffer_load_dwordx4 v0, s[8:11], s62 offen lds
    s_add_u32 m0, s35, 2112
    s_add_u32 s62, s34, 2048
    buffer_load_dwordx4 v0, s[8:11], s62 offen lds
    s_add_u32 m0, s35, 3168
    s_add_u32 s62, s34, 3072
    buffer_load_dwordx4 v0, s[8:11], s62 offen lds
    s_add_u32 m0, s35, 4224
    s_add_u32 s62, s34, 4096
    buffer_load_dwordx4 v0, s[8:11], s62 offen lds
    s_add_u32 m0, s35, 5280
    s_add_u32 s62, s34, 5120
    buffer_load_dwordx4 v0, s[8:11], s62 offen lds
    s_add_u32 m0, s35, 6336
    s_add_u32 s62, s34, 6144
    buffer_load_dwordx4 v0, s[8:11], s62 offen lds
    s_add_u32 m0, s35, 7392
    s_add_u32 s62, s34, 7168
    buffer_load_dwordx4 v0, s[8:11], s62 offen lds
    ds_read_b128 v[24:27], v1 offset:64
    ds_read_b128 v[28:31], v1 offset:16960
    s_waitcnt lgkmcnt(2)
    v_mfma_f32_16x16x32_bf16 v[48:51], a[0:3], v[16:19], 0
    v_mfma_f32_16x16x32_bf16 v[52:55], a[8:11], v[16:19], 0
    v_mfma_f32_16x16x32_bf16 v[56:59], a[0:3], v[20:23], 0
    v_mfma_f32_16x16x32_bf16 v[60:63], a[8:11], v[20:23], 0
    v_mfma_f32_16x16x32_bf16 v[64:67], v[16:19], a[128:131], 0
    v_mfma_f32_16x16x32_bf16 v[68:71], v[16:19], a[136:139], 0
    v_mfma_f32_16x16x32_bf16 v[72:75], v[20:23], a[128:131], 0
    v_mfma_f32_16x16x32_bf16 v[76:79], v[20:23], a[136:139], 0
    v_mfma_f32_16x16x32_bf16 v[32:35], v[128:131], v[16:19], 0
    v_mfma_f32_16x16x32_bf16 v[36:39], v[136:139], v[16:19], 0
    v_mfma_f32_16x16x32_bf16 v[40:43], v[128:131], v[20:23], 0
    v_mfma_f32_16x16x32_bf16 v[44:47], v[136:139], v[20:23], 0
    ds_read_b128 v[16:19], v1 offset:128
    ds_read_b128 v[20:23], v1 offset:17024
    s_waitcnt lgkmcnt(2)
    v_mfma_f32_16x16x32_bf16 v[48:51], a[4:7], v[24:27], v[48:51]
    v_mfma_f32_16x16x32_bf16 v[52:55], a[12:15], v[24:27], v[52:55]
    v_mfma_f32_16x16x32_bf16 v[56:59], a[4:7], v[28:31], v[56:59]
    v_mfma_f32_16x16x32_bf16 v[60:63], a[12:15], v[28:31], v[60:63]
    v_mfma_f32_16x16x32_bf16 v[64:67], v[24:27], a[132:135], v[64:67]
    v_mfma_f32_16x16x32_bf16 v[68:71], v[24:27], a[140:143], v[68:71]
    v_mfma_f32_16x16x32_bf16 v[72:75], v[28:31], a[132:135], v[72:75]
    v_mfma_f32_16x16x32_bf16 v[76:79], v[28:31], a[140:143], v[76:79]
    v_mfma_f32_16x16x32_bf16 v[32:35], v[132:135], v[24:27], v[32:35]
    v_mfma_f32_16x16x32_bf16 v[36:39], v[140:143], v[24:27], v[36:39]
    v_mfma_f32_16x16x32_bf16 v[40:43], v[132:135], v[28:31], v[40:43]
    v_mfma_f32_16x16x32_bf16 v[44:47], v[140:143], v[28:31], v[44:47]
    ds_read_b128 v[24:27], v1 offset:192
    ds_read_b128 v[28:31], v1 offset:17088
    s_waitcnt lgkmcnt(2)
    v_mfma_f32_16x16x32_bf16 v[48:51], a[16:19], v[16:19], v[48:51]
    v_mfma_f32_16x16x32_bf16 v[52:55], a[24:27], v[16:19], v[52:55]
    v_mfma_f32_16x16x32_bf16 v[56:59], a[16:19], v[20:23], v[56:59]
    v_mfma_f32_16x16x32_bf16 v[60:63], a[24:27], v[20:23], v[60:63]
    v_mfma_f32_16x16x32_bf16 v[64:67], v[16:19], a[144:147], v[64:67]
    v_mfma_f32_16x16x32_bf16 v[68:71], v[16:19], a[152:155], v[68:71]
    v_mfma_f32_16x16x32_bf16 v[72:75], v[20:23], a[144:147], v[72:75]
    v_mfma_f32_16x16x32_bf16 v[76:79], v[20:23], a[152:155], v[76:79]
    v_mfma_f32_16x16x32_bf16 v[32:35], v[144:147], v[16:19], v[32:35]
    v_mfma_f32_16x16x32_bf16 v[36:39], v[152:155], v[16:19], v[36:39]
    v_mfma_f32_16x16x32_bf16 v[40:43], v[144:147], v[20:23], v[40:43]
    v_mfma_f32_16x16x32_bf16 v[44:47], v[152:155], v[20:23], v[44:47]
    ds_read_b128 v[16:19], v1 offset:256
    ds_read_b128 v[20:23], v1 offset:17152
    s_waitcnt lgkmcnt(2)
    v_mfma_f32_16x16x32_bf16 v[48:51], a[20:23], v[24:27], v[48:51]
    v_mfma_f32_16x16x32_bf16 v[52:55], a[28:31], v[24:27], v[52:55]
    v_mfma_f32_16x16x32_bf16 v[56:59], a[20:23], v[28:31], v[56:59]
    v_mfma_f32_16x16x32_bf16 v[60:63], a[28:31], v[28:31], v[60:63]
    v_mfma_f32_16x16x32_bf16 v[64:67], v[24:27], a[148:151], v[64:67]
    v_mfma_f32_16x16x32_bf16 v[68:71], v[24:27], a[156:159], v[68:71]
    v_mfma_f32_16x16x32_bf16 v[72:75], v[28:31], a[148:151], v[72:75]
    v_mfma_f32_16x16x32_bf16 v[76:79], v[28:31], a[156:159], v[76:79]
    v_mfma_f32_16x16x32_bf16 v[32:35], v[148:151], v[24:27], v[32:35]
    v_mfma_f32_16x16x32_bf16 v[36:39], v[156:159], v[24:27], v[36:39]
    v_mfma_f32_16x16x32_bf16 v[40:43], v[148:151], v[28:31], v[40:43]
    v_mfma_f32_16x16x32_bf16 v[44:47], v[156:159], v[28:31], v[44:47]
    ds_read_b128 v[24:27], v1 offset:320
    ds_read_b128 v[28:31], v1 offset:17216
    s_waitcnt lgkmcnt(2)
    v_mfma_f32_16x16x32_bf16 v[48:51], a[32:35], v[16:19], v[48:51]
    v_mfma_f32_16x16x32_bf16 v[52:55], a[40:43], v[16:19], v[52:55]
    v_mfma_f32_16x16x32_bf16 v[56:59], a[32:35], v[20:23], v[56:59]
    v_mfma_f32_16x16x32_bf16 v[60:63], a[40:43], v[20:23], v[60:63]
    v_mfma_f32_16x16x32_bf16 v[64:67], v[16:19], a[160:163], v[64:67]
    v_mfma_f32_16x16x32_bf16 v[68:71], v[16:19], a[168:171], v[68:71]
    v_mfma_f32_16x16x32_bf16 v[72:75], v[20:23], a[160:163], v[72:75]
    v_mfma_f32_16x16x32_bf16 v[76:79], v[20:23], a[168:171], v[76:79]
    v_mfma_f32_16x16x32_bf16 v[32:35], v[160:163], v[16:19], v[32:35]
    v_mfma_f32_16x16x32_bf16 v[36:39], v[168:171], v[16:19], v[36:39]
    v_mfma_f32_16x16x32_bf16 v[40:43], v[160:163], v[20:23], v[40:43]
    v_mfma_f32_16x16x32_bf16 v[44:47], v[168:171], v[20:23], v[44:47]
    ds_read_b128 v[16:19], v1 offset:384
    ds_read_b128 v[20:23], v1 offset:17280
    s_waitcnt lgkmcnt(2)
    v_mfma_f32_16x16x32_bf16 v[48:51], a[36:39], v[24:27], v[48:51]
    v_mfma_f32_16x16x32_bf16 v[52:55], a[44:47], v[24:27], v[52:55]
    v_mfma_f32_16x16x32_bf16 v[56:59], a[36:39], v[28:31], v[56:59]
    v_mfma_f32_16x16x32_bf16 v[60:63], a[44:47], v[28:31], v[60:63]
    v_mfma_f32_16x16x32_bf16 v[64:67], v[24:27], a[164:167], v[64:67]
    v_mfma_f32_16x16x32_bf16 v[68:71], v[24:27], a[172:175], v[68:71]
    v_mfma_f32_16x16x32_bf16 v[72:75], v[28:31], a[164:167], v[72:75]
    v_mfma_f32_16x16x32_bf16 v[76:79], v[28:31], a[172:175], v[76:79]
    v_mfma_f32_16x16x32_bf16 v[32:35], v[164:167], v[24:27], v[32:35]
    v_mfma_f32_16x16x32_bf16 v[36:39], v[172:175], v[24:27], v[36:39]
    v_mfma_f32_16x16x32_bf16 v[40:43], v[164:167], v[28:31], v[40:43]
    v_mfma_f32_16x16x32_bf16 v[44:47], v[172:175], v[28:31], v[44:47]
    s_waitcnt vmcnt(8)
    s_barrier
    s_cmp_eq_u32 s33, 0
    s_cbranch_scc0 L_nofl_47
    v_mov_b32 v4, s38
    s_mov_b64 exec, 3
    global_store_dword v5, v4, s[46:47] sc1
    s_mov_b64 exec, -1
L_nofl_47:
    ds_read_b128 v[24:27], v1 offset:448
    ds_read_b128 v[28:31], v1 offset:17344
    s_waitcnt lgkmcnt(2)
    v_mfma_f32_16x16x32_bf16 v[48:51], a[48:51], v[16:19], v[48:51]
    v_mfma_f32_16x16x32_bf16 v[52:55], a[56:59], v[16:19], v[52:55]
    v_mfma_f32_16x16x32_bf16 v[56:59], a[48:51], v[20:23], v[56:59]
    v_mfma_f32_16x16x32_bf16 v[60:63], a[56:59], v[20:23], v[60:63]
    v_mfma_f32_16x16x32_bf16 v[64:67], v[16:19], a[176:179], v[64:67]
    v_mfma_f32_16x16x32_bf16 v[68:71], v[16:19], a[184:187], v[68:71]
    v_mfma_f32_16x16x32_bf16 v[72:75], v[20:23], a[176:179], v[72:75]
    v_mfma_f32_16x16x32_bf16 v[76:79], v[20:23], a[184:187], v[76:79]
    v_mfma_f32_16x16x32_bf16 v[32:35], v[176:179], v[16:19], v[32:35]
    v_mfma_f32_16x16x32_bf16 v[36:39], v[184:187], v[16:19], v[36:39]
    v_mfma_f32_16x16x32_bf16 v[40:43], v[176:179], v[20:23], v[40:43]
    v_mfma_f32_16x16x32_bf16 v[44:47], v[184:187], v[20:23], v[44:47]
    ds_read_b128 v[16:19], v1 offset:512
    ds_read_b128 v[20:23], v1 offset:17408
    s_waitcnt lgkmcnt(2)
    v_mfma_f32_16x16x32_bf16 v[48:51], a[52:55], v[24:27], v[48:51]
    v_mfma_f32_16x16x32_bf16 v[52:55], a[60:63], v[24:27], v[52:55]
    v_mfma_f32_16x16x32_bf16 v[56:59], a[52:55], v[28:31], v[56:59]
    v_mfma_f32_16x16x32_bf16 v[60:63], a[60:63], v[28:31], v[60:63]
    v_mfma_f32_16x16x32_bf16 v[64:67], v[24:27], a[180:183], v[64:67]
    v_mfma_f32_16x16x32_bf16 v[68:71], v[24:27], a[188:191], v[68:71]
    v_mfma_f32_16x16x32_bf16 v[72:75], v[28:31], a[180:183], v[72:75]
    v_mfma_f32_16x16x32_bf16 v[76:79], v[28:31], a[188:191], v[76:79]
    v_mfma_f32_16x16x32_bf16 v[32:35], v[180:183], v[24:27], v[32:35]
    v_mfma_f32_16x16x32_bf16 v[36:39], v[188:191], v[24:27], v[36:39]
    v_mfma_f32_16x16x32_bf16 v[40:43], v[180:183], v[28:31], v[40:43]
    v_mfma_f32_16x16x32_bf16 v[44:47], v[188:191], v[28:31], v[44:47]
    ds_read_b128 v[24:27], v1 offset:576
    ds_read_b128 v[28:31], v1 offset:17472
    s_waitcnt lgkmcnt(2)
    v_mfma_f32_16x16x32_bf16 v[48:51], a[64:67], v[16:19], v[48:51]
    v_mfma_f32_16x16x32_bf16 v[52:55], a[72:75], v[16:19], v[52:55]
    v_mfma_f32_16x16x32_bf16 v[56:59], a[64:67], v[20:23], v[56:59]
    v_mfma_f32_16x16x32_bf16 v[60:63], a[72:75], v[20:23], v[60:63]
    v_mfma_f32_16x16x32_bf16 v[64:67], v[16:19], a[192:195], v[64:67]
    v_mfma_f32_16x16x32_bf16 v[68:71], v[16:19], a[200:203], v[68:71]
    v_mfma_f32_16x16x32_bf16 v[72:75], v[20:23], a[192:195], v[72:75]
    v_mfma_f32_16x16x32_bf16 v[76:79], v[20:23], a[200:203], v[76:79]
    v_mfma_f32_16x16x32_bf16 v[32:35], v[192:195], v[16:19], v[32:35]
    v_mfma_f32_16x16x32_bf16 v[36:39], v[200:203], v[16:19], v[36:39]
    v_mfma_f32_16x16x32_bf16 v[40:43], v[192:195], v[20:23], v[40:43]
    v_mfma_f32_16x16x32_bf16 v[44:47], v[200:203], v[20:23], v[44:47]
    ds_read_b128 v[16:19], v1 offset:640
    ds_read_b128 v[20:23], v1 offset:17536
    s_waitcnt lgkmcnt(2)
    v_mfma_f32_16x16x32_bf16 v[48:51], a[68:71], v[24:27], v[48:51]
    v_mfma_f32_16x16x32_bf16 v[52:55], a[76:79], v[24:27], v[52:55]
    v_mfma_f32_16x16x32_bf16 v[56:59], a[68:71], v[28:31], v[56:59]
    v_mfma_f32_16x16x32_bf16 v[60:63], a[76:79], v[28:31], v[60:63]
    v_mfma_f32_16x16x32_bf16 v[64:67], v[24:27], a[196:199], v[64:67]
    v_mfma_f32_16x16x32_bf16 v[68:71], v[24:27], a[204:207], v[68:71]
    v_mfma_f32_16x16x32_bf16 v[72:75], v[28:31], a[196:199], v[72:75]
    v_mfma_f32_16x16x32_bf16 v[76:79], v[28:31], a[204:207], v[76:79]
    v_mfma_f32_16x16x32_bf16 v[32:35], v[196:199], v[24:27], v[32:35]
    v_mfma_f32_16x16x32_bf16 v[36:39], v[204:207], v[24:27], v[36:39]
    v_mfma_f32_16x16x32_bf16 v[40:43], v[196:199], v[28:31], v[40:43]
    v_mfma_f32_16x16x32_bf16 v[44:47], v[204:207], v[28:31], v[44:47]
    ds_read_b128 v[24:27], v1 offset:704
    ds_read_b128 v[28:31], v1 offset:17600
    s_waitcnt lgkmcnt(2)
    v_mfma_f32_16x16x32_bf16 v[48:51], a[80:83], v[16:19], v[48:51]
    v_mfma_f32_16x16x32_bf16 v[52:55], a[88:91], v[16:19], v[52:55]
    v_mfma_f32_16x16x32_bf16 v[56:59], a[80:83], v[20:23], v[56:59]
    v_mfma_f32_16x16x32_bf16 v[60:63], a[88:91], v[20:23], v[60:63]
    v_mfma_f32_16x16x32_bf16 v[64:67], v[16:19], a[208:211], v[64:67]
    v_mfma_f32_16x16x32_bf16 v[68:71], v[16:19], a[216:219], v[68:71]
    v_mfma_f32_16x16x32_bf16 v[72:75], v[20:23], a[208:211], v[72:75]
    v_mfma_f32_16x16x32_bf16 v[76:79], v[20:23], a[216:219], v[76:79]
    v_mfma_f32_16x16x32_bf16 v[32:35], v[208:211], v[16:19], v[32:35]
    v_mfma_f32_16x16x32_bf16 v[36:39], v[216:219], v[16:19], v[36:39]
    v_mfma_f32_16x16x32_bf16 v[40:43], v[208:211], v[20:23], v[40:43]
    v_mfma_f32_16x16x32_bf16 v[44:47], v[216:219], v[20:23], v[44:47]
    ds_read_b128 v[16:19], v1 offset:768
    ds_read_b128 v[20:23], v1 offset:17664
    s_waitcnt lgkmcnt(2)
    v_mfma_f32_16x16x32_bf16 v[48:51], a[84:87], v[24:27], v[48:51]
    v_mfma_f32_16x16x32_bf16 v[52:55], a[92:95], v[24:27], v[52:55]
    v_mfma_f32_16x16x32_bf16 v[56:59], a[84:87], v[28:31], v[56:59]
    v_mfma_f32_16x16x32_bf16 v[60:63], a[92:95], v[28:31], v[60:63]
    v_mfma_f32_16x16x32_bf16 v[64:67], v[24:27], a[212:215], v[64:67]
    v_mfma_f32_16x16x32_bf16 v[68:71], v[24:27], a[220:223], v[68:71]
    v_mfma_f32_16x16x32_bf16 v[72:75], v[28:31], a[212:215], v[72:75]
    v_mfma_f32_16x16x32_bf16 v[76:79], v[28:31], a[220:223], v[76:79]
    v_mfma_f32_16x16x32_bf16 v[32:35], v[212:215], v[24:27], v[32:35]
    v_mfma_f32_16x16x32_bf16 v[36:39], v[220:223], v[24:27], v[36:39]
    v_mfma_f32_16x16x32_bf16 v[40:43], v[212:215], v[28:31], v[40:43]
    v_mfma_f32_16x16x32_bf16 v[44:47], v[220:223], v[28:31], v[44:47]
    ds_read_b128 v[24:27], v1 offset:832
    ds_read_b128 v[28:31], v1 offset:17728
    s_waitcnt lgkmcnt(2)
    v_mfma_f32_16x16x32_bf16 v[48:51], a[96:99], v[16:19], v[48:51]
    v_mfma_f32_16x16x32_bf16 v[52:55], a[104:107], v[16:19], v[52:55]
    v_mfma_f32_16x16x32_bf16 v[56:59], a[96:99], v[20:23], v[56:59]
    v_mfma_f32_16x16x32_bf16 v[60:63], a[104:107], v[20:23], v[60:63]
    v_mfma_f32_16x16x32_bf16 v[64:67], v[16:19], a[224:227], v[64:67]
    v_mfma_f32_16x16x32_bf16 v[68:71], v[16:19], a[232:235], v[68:71]
    v_mfma_f32_16x16x32_bf16 v[72:75], v[20:23], a[224:227], v[72:75]
    v_mfma_f32_16x16x32_bf16 v[76:79], v[20:23], a[232:235], v[76:79]
    v_mfma_f32_16x16x32_bf16 v[32:35], v[224:227], v[16:19], v[32:35]
    v_mfma_f32_16x16x32_bf16 v[36:39], v[232:235], v[16:19], v[36:39]
    v_mfma_f32_16x16x32_bf16 v[40:43], v[224:227], v[20:23], v[40:43]
    v_mfma_f32_16x16x32_bf16 v[44:47], v[232:235], v[20:23], v[44:47]
    ds_read_b128 v[16:19], v1 offset:896
    ds_read_b128 v[20:23], v1 offset:17792
    s_waitcnt lgkmcnt(2)
    v_mfma_f32_16x16x32_bf16 v[48:51], a[100:103], v[24:27], v[48:51]
    v_mfma_f32_16x16x32_bf16 v[52:55], a[108:111], v[24:27], v[52:55]
    v_mfma_f32_16x16x32_bf16 v[56:59], a[100:103], v[28:31], v[56:59]
    v_mfma_f32_16x16x32_bf16 v[60:63], a[108:111], v[28:31], v[60:63]
    v_mfma_f32_16x16x32_bf16 v[64:67], v[24:27], a[228:231], v[64:67]
    v_mfma_f32_16x16x32_bf16 v[68:71], v[24:27], a[236:239], v[68:71]
    v_mfma_f32_16x16x32_bf16 v[72:75], v[28:31], a[228:231], v[72:75]
    v_mfma_f32_16x16x32_bf16 v[76:79], v[28:31], a[236:239], v[76:79]
    v_mfma_f32_16x16x32_bf16 v[32:35], v[228:231], v[24:27], v[32:35]
    v_mfma_f32_16x16x32_bf16 v[36:39], v[236:239], v[24:27], v[36:39]
    v_mfma_f32_16x16x32_bf16 v[40:43], v[228:231], v[28:31], v[40:43]
    v_mfma_f32_16x16x32_bf16 v[44:47], v[236:239], v[28:31], v[44:47]
    ds_read_b128 v[24:27], v1 offset:960
    ds_read_b128 v[28:31], v1 offset:17856
    s_waitcnt lgkmcnt(2)
    v_mfma_f32_16x16x32_bf16 v[48:51], a[112:115], v[16:19], v[48:51]
    v_mfma_f32_16x16x32_bf16 v[52:55], a[120:123], v[16:19], v[52:55]
    v_mfma_f32_16x16x32_bf16 v[56:59], a[112:115], v[20:23], v[56:59]
    v_mfma_f32_16x16x32_bf16 v[60:63], a[120:123], v[20:23], v[60:63]
    v_mfma_f32_16x16x32_bf16 v[64:67], v[16:19], a[240:243], v[64:67]
    v_mfma_f32_16x16x32_bf16 v[68:71], v[16:19], a[248:251], v[68:71]
    v_mfma_f32_16x16x32_bf16 v[72:75], v[20:23], a[240:243], v[72:75]
    v_mfma_f32_16x16x32_bf16 v[76:79], v[20:23], a[248:251], v[76:79]
    v_mfma_f32_16x16x32_bf16 v[32:35], v[240:243], v[16:19], v[32:35]
    v_mfma_f32_16x16x32_bf16 v[36:39], v[248:251], v[16:19], v[36:39]
    v_mfma_f32_16x16x32_bf16 v[40:43], v[240:243], v[20:23], v[40:43]
    v_mfma_f32_16x16x32_bf16 v[44:47], v[248:251], v[20:23], v[44:47]
    s_waitcnt lgkmcnt(0)
    v_mfma_f32_16x16x32_bf16 v[48:51], a[116:119], v[24:27], v[48:51]
    v_mfma_f32_16x16x32_bf16 v[52:55], a[124:127], v[24:27], v[52:55]
    v_mfma_f32_16x16x32_bf16 v[56:59], a[116:119], v[28:31], v[56:59]
    v_mfma_f32_16x16x32_bf16 v[60:63], a[124:127], v[28:31], v[60:63]
    v_mfma_f32_16x16x32_bf16 v[64:67], v[24:27], a[244:247], v[64:67]
    v_mfma_f32_16x16x32_bf16 v[68:71], v[24:27], a[252:255], v[68:71]
    v_mfma_f32_16x16x32_bf16 v[72:75], v[28:31], a[244:247], v[72:75]
    v_mfma_f32_16x16x32_bf16 v[76:79], v[28:31], a[252:255], v[76:79]
    v_mfma_f32_16x16x32_bf16 v[32:35], v[244:247], v[24:27], v[32:35]
    v_mfma_f32_16x16x32_bf16 v[36:39], v[252:255], v[24:27], v[36:39]
    v_mfma_f32_16x16x32_bf16 v[40:43], v[244:247], v[28:31], v[40:43]
    v_mfma_f32_16x16x32_bf16 v[44:47], v[252:255], v[28:31], v[44:47]
    v_add_u32 v1, s36, v1
    s_sub_u32 s36, 0, s36
    v_cvt_pk_bf16_f32 v80, v48, v52
    v_cvt_pk_bf16_f32 v81, v49, v53
    v_cvt_pk_bf16_f32 v82, v50, v54
    v_cvt_pk_bf16_f32 v83, v51, v55
    v_cvt_pk_bf16_f32 v84, v56, v60
    v_cvt_pk_bf16_f32 v85, v57, v61
    v_cvt_pk_bf16_f32 v86, v58, v62
    v_cvt_pk_bf16_f32 v87, v59, v63
    global_store_dwordx4 v2, v[80:83], s[42:43] offset:0 sc1
    global_store_dwordx4 v2, v[84:87], s[42:43] offset:128 sc1
    v_cvt_pk_bf16_f32 v88, v64, v65
    v_cvt_pk_bf16_f32 v89, v66, v67
    v_cvt_pk_bf16_f32 v90, v72, v73
    v_cvt_pk_bf16_f32 v91, v74, v75
    v_cvt_pk_bf16_f32 v92, v68, v69
    v_cvt_pk_bf16_f32 v93, v70, v71
    v_cvt_pk_bf16_f32 v94, v76, v77
    v_cvt_pk_bf16_f32 v95, v78, v79
    global_store_dwordx4 v0, v[88:91], s[44:45] offset:0 sc1
    global_store_dwordx4 v0, v[92:95], s[44:45] offset:1024 sc1
    v_cvt_pk_bf16_f32 v96, v32, v36
    v_cvt_pk_bf16_f32 v97, v33, v37
    v_cvt_pk_bf16_f32 v98, v34, v38
    v_cvt_pk_bf16_f32 v99, v35, v39
    v_cvt_pk_bf16_f32 v100, v40, v44
    v_cvt_pk_bf16_f32 v101, v41, v45
    v_cvt_pk_bf16_f32 v102, v42, v46
    v_cvt_pk_bf16_f32 v103, v43, v47
    global_store_dwordx4 v0, v[96:99], s[40:41] offset:-2048 sc1
    global_store_dwordx4 v0, v[100:103], s[40:41] offset:2048 sc1
    global_store_dwordx4 v0, v[104:107], s[52:53] sc1
    s_add_u32 s40, s40, 16384
    s_addc_u32 s41, s41, 0
    s_add_u32 s42, s42, 32768
    s_addc_u32 s43, s43, 0
    s_add_u32 s44, s44, 32768
    s_addc_u32 s45, s45, 0
    s_add_u32 s52, s52, 8192
    s_addc_u32 s53, s53, 0
    s_add_u32 s38, s38, 1
    s_cmp_lt_u32 s38, s37
    s_cbranch_scc1 L_proj_46
    s_waitcnt vmcnt(0)
    s_barrier
    s_cmp_eq_u32 s33, 0
    s_cbranch_scc0 L_nofl_48
    v_mov_b32 v4, 1000
    s_mov_b64 exec, 3
    global_store_dword v5, v4, s[46:47] sc1
    s_mov_b64 exec, -1
L_nofl_48:
    s_cmp_ge_u32 s32, 48
    s_cbranch_scc0 L_qe_49
    s_add_u32 s32, s32, 944
    s_branch L_role_att
L_qe_49:
    s_endpgm
L_role_chain:
    s_mov_b32 s8, s84
    s_and_b32 s9, s85, 0xffff
    s_mov_b32 s10, 0x400000
    s_mov_b32 s11, 0x20000
    s_mov_b32 s12, s86
    s_and_b32 s13, s87, 0xffff
    s_mov_b32 s14, 0x400000
    s_mov_b32 s15, 0x20000
    s_mov_b32 s16, s88
    s_and_b32 s17, s89, 0xffff
    s_mov_b32 s18, 0x400000
    s_mov_b32 s19, 0x20000
    s_mov_b32 s20, s90
    s_and_b32 s21, s91, 0xffff
    s_mov_b32 s22, 0x400000
    s_mov_b32 s23, 0x20000
    s_mov_b32 s24, s92
    s_and_b32 s25, s93, 0xffff
    s_mov_b32 s26, 0x2000
    s_mov_b32 s27, 0x20000
    v_bfe_u32 v114, v0, 4, 4
    v_lshlrev_b32 v114, 1, v114
    s_and_b32 s62, s32, 3
    s_lshl_b32 s62, s62, 11
    s_bfe_u32 s63, s32, 0x10002
    s_lshl_b32 s63, s63, 10
    s_add_u32 s62, s62, s63
    s_lshr_b32 s63, s32, 3
    s_lshl_b32 s63, s63, 6
    s_add_u32 s62, s62, s63
    s_lshl_b32 s63, s33, 8
    s_add_u32 s62, s62, s63
    buffer_load_ushort v115, v114, s[24:27], s62 offen
    buffer_load_ushort v112, v114, s[24:27], s62 offen offset:32
    v_lshrrev_b32 v96, 4, v0
    v_and_b32 v97, 15, v96
    v_lshrrev_b32 v98, 4, v96
    v_lshrrev_b32 v99, 2, v96
    v_and_b32 v100, 3, v96
    v_and_b32 v101, 3, v99
    s_lshl_b32 s62, s33, 4
    v_lshl_add_u32 v102, v98, 1, s62
    v_xor_b32 v103, v101, v98
    v_lshlrev_b32 v103, 6, v103
    v_lshl_add_u32 v103, v100, 4, v103
    v_lshl_add_u32 v120, v102, 13, v103
    s_lshl_b32 s62, s32, 8
    v_add_u32 v120, s62, v120
    s_and_b32 s62, s33, 1
    s_lshl_b32 s62, s62, 7
    v_xor_b32 v121, s62, v0
    s_lshl_b32 s62, s32, 17
    s_lshl_b32 s63, s33, 11
    s_add_u32 s62, s62, s63
    v_add_u32 v121, s62, v121
    s_lshl_b32 s60, s33, 15
    s_add_u32 s60, s60, 31360
    v_bfe_u32 v102, v98, 0, 1
    v_mul_u32_u24 v104, 1, v102
    v_bfe_u32 v102, v101, 1, 1
    v_mul_u32_u24 v102, 2, v102
    v_add_u32 v104, v104, v102
    v_xor_b32 v103, s33, v104
    v_bfe_u32 v102, v101, 0, 1
    v_mul_u32_u24 v122, 32768, v102
    v_bfe_u32 v102, v98, 1, 1
    v_mul_u32_u24 v102, 2048, v102
    v_add_u32 v122, v122, v102
    v_bfe_u32 v102, v104, 0, 2
    v_mul_u32_u24 v102, 256, v102
    v_add_u32 v122, v122, v102
    v_bfe_u32 v102, v103, 0, 2
    v_mul_u32_u24 v102, 64, v102
    v_add_u32 v122, v122, v102
    v_bfe_u32 v102, v100, 0, 2
    v_mul_u32_u24 v102, 8, v102
    v_add_u32 v122, v122, v102
    v_add_u32 v122, 31360, v122
    v_add_u32 v123, 65536, v122
    v_lshlrev_b32 v103, 1, v98
    v_xor_b32 v103, s33, v103
    v_bfe_u32 v102, v98, 0, 2
    v_mul_u32_u24 v124, 32768, v102
    v_bfe_u32 v102, v101, 0, 1
    v_mul_u32_u24 v102, 2048, v102
    v_add_u32 v124, v124, v102
    v_bfe_u32 v102, v103, 0, 2
    v_mul_u32_u24 v102, 64, v102
    v_add_u32 v124, v124, v102
    v_bfe_u32 v102, v101, 1, 1
    v_mul_u32_u24 v102, 32, v102
    v_add_u32 v124, v124, v102
    v_bfe_u32 v102, v100, 0, 2
    v_mul_u32_u24 v102, 8, v102
    v_add_u32 v124, v124, v102
    v_add_u32 v124, 31360, v124
    s_lshr_b32 s35, 0xa2222222, s32
    s_and_b32 s35, s35, 1
    s_add_u32 m0, s60, 0
    s_mov_b32 s62, 0
    buffer_load_dwordx4 v120, s[12:15], s62 offen  lds
    s_add_u32 m0, s60, 1024
    s_mov_b32 s62, 8192
    buffer_load_dwordx4 v120, s[12:15], s62 offen  lds
    s_add_u32 m0, s60, 2048
    s_mov_b32 s62, 65536
    buffer_load_dwordx4 v120, s[12:15], s62 offen  lds
    s_add_u32 m0, s60, 3072
    s_mov_b32 s62, 73728
    buffer_load_dwordx4 v120, s[12:15], s62 offen  lds
    s_cmp_eq_u32 s35, 0
    s_cbranch_scc0 L_thr_50
    s_waitcnt vmcnt(4)
L_thr_50:
    s_add_u32 m0, s60, 4096
    s_mov_b32 s62, 524288
    buffer_load_dwordx4 v120, s[12:15], s62 offen  lds
    s_add_u32 m0, s60, 5120
    s_mov_b32 s62, 532480
    buffer_load_dwordx4 v120, s[12:15], s62 offen  lds
    s_add_u32 m0, s60, 6144
    s_mov_b32 s62, 589824
    buffer_load_dwordx4 v120, s[12:15], s62 offen  lds
    s_add_u32 m0, s60, 7168
    s_mov_b32 s62, 598016
    buffer_load_dwordx4 v120, s[12:15], s62 offen  lds
    s_cmp_eq_u32 s35, 0
    s_cbranch_scc0 L_thr_51
    s_waitcnt vmcnt(4)
L_thr_51:
    s_add_u32 m0, s60, 8192
    s_mov_b32 s62, 1048576
    buffer_load_dwordx4 v120, s[12:15], s62 offen  lds
    s_add_u32 m0, s60, 9216
    s_mov_b32 s62, 1056768
    buffer_load_dwordx4 v120, s[12:15], s62 offen  lds
    s_add_u32 m0, s60, 10240
    s_mov_b32 s62, 1114112
    buffer_load_dwordx4 v120, s[12:15], s62 offen  lds
    s_add_u32 m0, s60, 11264
    s_mov_b32 s62, 1122304
    buffer_load_dwordx4 v120, s[12:15], s62 offen  lds
    s_cmp_eq_u32 s35, 0
    s_cbranch_scc0 L_thr_52
    s_waitcnt vmcnt(4)
L_thr_52:
    s_add_u32 m0, s60, 12288
    s_mov_b32 s62, 1572864
    buffer_load_dwordx4 v120, s[12:15], s62 offen  lds
    s_add_u32 m0, s60, 13312
    s_mov_b32 s62, 1581056
    buffer_load_dwordx4 v120, s[12:15], s62 offen  lds
    s_add_u32 m0, s60, 14336
    s_mov_b32 s62, 1638400
    buffer_load_dwordx4 v120, s[12:15], s62 offen  lds
    s_add_u32 m0, s60, 15360
    s_mov_b32 s62, 1646592
    buffer_load_dwordx4 v120, s[12:15], s62 offen  lds
    s_waitcnt vmcnt(12) lgkmcnt(0)
    s_barrier
    s_cmp_eq_u32 s35, 0
    s_cbranch_scc0 L_thr_53
    s_waitcnt vmcnt(4)
L_thr_53:
    s_add_u32 m0, s60, 16384
    s_mov_b32 s62, 2097152
    buffer_load_dwordx4 v120, s[12:15], s62 offen  lds
    s_add_u32 m0, s60, 17408
    s_mov_b32 s62, 2105344
    buffer_load_dwordx4 v120, s[12:15], s62 offen  lds
    s_add_u32 m0, s60, 18432
    s_mov_b32 s62, 2162688
    buffer_load_dwordx4 v120, s[12:15], s62 offen  lds
    s_add_u32 m0, s60, 19456
    s_mov_b32 s62, 2170880
    buffer_load_dwordx4 v120, s[12:15], s62 offen  lds
    s_cmp_eq_u32 s33, 1
    s_cbranch_scc0 L_nx_58
    s_branch L_cc1_55
L_nx_58:
    s_cmp_eq_u32 s33, 2
    s_cbranch_scc0 L_nx_59
    s_branch L_cc2_56
L_nx_59:
    s_cmp_eq_u32 s33, 3
    s_cbranch_scc0 L_nx_60
    s_branch L_cc3_57
L_nx_60:
L_cc0_54:
    v_lshrrev_b32 v96, 4, v0
    v_and_b32 v97, 15, v96
    v_lshrrev_b32 v98, 4, v96
    v_lshlrev_b32 v9, 2, v96
    v_add_u32 v8, 31360, v0
    s_mov_b32 s52, 0xcccccccc
    s_mov_b32 s53, 0xcccccccc
    v_mov_b32 v99, 0xe4844444
    v_mov_b32 v100, 0xee9eeeee
    v_cndmask_b32 v101, v99, v100, s[52:53]
    v_mov_b32 v99, 0x84e44444
    v_mov_b32 v100, 0x9eeeeeee
    v_cndmask_b32 v102, v99, v100, s[52:53]
    v_cmp_lt_u32 vcc, 31, v96
    s_nop 1
    v_cndmask_b32 v1, v101, v102, vcc
    s_lshl_b32 s62, s32, 6
    s_add_u32 s62, s62, 0
    v_mul_u32_u24 v2, 8320, v98
    v_lshl_add_u32 v2, v97, 2, v2
    v_add_u32 v2, s62, v2
    v_and_b32 v99, 1, v98
    v_mul_u32_u24 v3, 10240, v99
    v_lshrrev_b32 v99, 3, v97
    v_lshl_add_u32 v3, v99, 8, v3
    v_bfe_u32 v99, v97, 2, 1
    v_lshl_add_u32 v3, v99, 5, v3
    v_and_b32 v99, 3, v97
    v_lshl_add_u32 v3, v99, 2, v3
    s_add_u32 s64, s4, 3145727
    s_addc_u32 s65, s5, 0
    s_and_b32 s64, s64, 0xffe00000
    s_mul_i32 s36, s32, 8320
    s_add_u32 s36, s36, 0
    s_add_u32 s36, s36, s64
    s_add_u32 s40, s64, 1048576
    s_lshr_b32 s62, s32, 3
    s_lshl_b32 s62, s62, 9
    s_and_b32 s63, s32, 3
    s_lshl_b32 s63, s63, 6
    s_add_u32 s62, s62, s63
    s_and_b32 s63, s32, 4
    s_lshl_b32 s63, s63, 2
    s_add_u32 s62, s62, s63
    s_add_u32 s42, s40, s62
    s_xor_b32 s42, s42, 65536
    s_and_b32 s62, s32, 1
    s_mul_i32 s62, s62, 10240
    s_add_u32 s40, s40, s62
    s_add_i32 s40, s40, 2048
    s_mov_b32 s37, s65
    s_mov_b32 s41, s65
    s_mov_b32 s43, s65
    v_mul_u32_u24 v4, 1088, v98
    v_lshl_add_u32 v4, v97, 2, v4
    v_add_u32 v4, 24576, v4
    v_lshrrev_b32 v99, 2, v97
    v_and_b32 v100, 1, v97
    v_lshl_add_u32 v101, v99, 1, v100
    v_mul_u32_u24 v6, 544, v101
    v_lshl_add_u32 v6, v98, 4, v6
    v_add_u32 v6, 24576, v6
    v_mul_u32_u24 v7, 272, v98
    v_lshl_add_u32 v7, v97, 4, v7
    v_add_u32 v7, 28928, v7
    v_lshrrev_b32 v101, 3, v97
    v_mul_u32_u24 v5, 272, v101
    v_and_b32 v101, 1, v98
    v_lshl_add_u32 v5, v101, 7, v5
    v_lshrrev_b32 v101, 1, v98
    v_lshl_add_u32 v5, v101, 6, v5
    v_lshl_add_u32 v5, v100, 5, v5
    v_bfe_u32 v101, v97, 1, 2
    v_lshl_add_u32 v5, v101, 2, v5
    v_add_u32 v5, 28928, v5
    v_lshlrev_b32 v102, 4, v100
    v_mov_b32 v103, 0x3f80
    v_lshlrev_b32 v12, v102, v103
    v_lshlrev_b32 v13, v102, v103
    v_lshlrev_b32 v14, v102, v103
    v_lshlrev_b32 v15, v102, v103
    s_mov_b32 s54, 0x3f803f80
    s_mov_b32 s55, 0x3f803f80
    s_mov_b32 s56, 0x3f803f80
    s_mov_b32 s57, 0
    s_mov_b32 s58, 0x3e0293ee
    s_mov_b32 s59, 0x3e0293ee
    s_mov_b32 s61, 0xbe0293ee
    s_mov_b32 s70, 0
    s_mov_b32 s71, 0
    s_mov_b32 s34, 0
    s_mov_b32 s51, 0
    s_mov_b64 s[38:39], -1
    s_mov_b32 s2, 60000
    s_mul_i32 s62, s32, 1064960
    s_add_u32 s62, s62, 16777216
    s_add_u32 s44, s4, s62
    s_addc_u32 s45, s5, 0
    s_add_u32 s46, s44, 8192
    s_addc_u32 s47, s45, 0
    s_branch L_ccj_61
L_cc1_55:
    v_lshrrev_b32 v96, 4, v0
    v_and_b32 v97, 15, v96
    v_lshrrev_b32 v98, 4, v96
    v_lshlrev_b32 v9, 2, v96
    v_add_u32 v8, 64128, v0
    s_mov_b32 s52, 0xcccccccc
    s_mov_b32 s53, 0xcccccccc
    v_mov_b32 v99, 0xe4844444
    v_mov_b32 v100, 0xee9eeeee
    v_cndmask_b32 v101, v99, v100, s[52:53]
    v_mov_b32 v99, 0x84e44444
    v_mov_b32 v100, 0x9eeeeeee
    v_cndmask_b32 v102, v99, v100, s[52:53]
    v_cmp_lt_u32 vcc, 31, v96
    s_nop 1
    v_cndmask_b32 v1, v101, v102, vcc
    s_lshl_b32 s62, s32, 6
    s_add_u32 s62, s62, 66560
    v_mul_u32_u24 v2, 8320, v98
    v_lshl_add_u32 v2, v97, 2, v2
    v_add_u32 v2, s62, v2
    v_and_b32 v99, 1, v98
    v_mul_u32_u24 v3, 10240, v99
    v_lshrrev_b32 v99, 3, v97
    v_lshl_add_u32 v3, v99, 8, v3
    v_bfe_u32 v99, v97, 2, 1
    v_lshl_add_u32 v3, v99, 5, v3
    v_and_b32 v99, 3, v97
    v_lshl_add_u32 v3, v99, 2, v3
    s_add_u32 s64, s4, 3145727
    s_addc_u32 s65, s5, 0
    s_and_b32 s64, s64, 0xffe00000
    s_mul_i32 s36, s32, 8320
    s_add_u32 s36, s36, 2048
    s_add_u32 s36, s36, s64
    s_add_u32 s40, s64, 1050624
    s_lshr_b32 s62, s32, 3
    s_lshl_b32 s62, s62, 9
    s_and_b32 s63, s32, 3
    s_lshl_b32 s63, s63, 6
    s_add_u32 s62, s62, s63
    s_and_b32 s63, s32, 4
    s_lshl_b32 s63, s63, 2
    s_add_u32 s62, s62, s63
    s_add_u32 s42, s40, s62
    s_xor_b32 s42, s42, 65536
    s_and_b32 s62, s32, 1
    s_mul_i32 s62, s62, 10240
    s_add_u32 s40, s40, s62
    s_add_i32 s40, s40, 1024
    s_mov_b32 s37, s65
    s_mov_b32 s41, s65
    s_mov_b32 s43, s65
    v_mul_u32_u24 v4, 1088, v98
    v_lshl_add_u32 v4, v97, 2, v4
    v_add_u32 v4, 24640, v4
    v_lshrrev_b32 v99, 2, v97
    v_and_b32 v100, 1, v97
    v_lshl_add_u32 v101, v99, 1, v100
    v_mul_u32_u24 v6, 544, v101
    v_lshl_add_u32 v6, v98, 4, v6
    v_add_u32 v6, 24576, v6
    v_mul_u32_u24 v7, 272, v98
    v_lshl_add_u32 v7, v97, 4, v7
    v_add_u32 v7, 28928, v7
    v_lshrrev_b32 v101, 3, v97
    v_mul_u32_u24 v5, 272, v101
    v_and_b32 v101, 1, v98
    v_lshl_add_u32 v5, v101, 7, v5
    v_lshrrev_b32 v101, 1, v98
    v_lshl_add_u32 v5, v101, 6, v5
    v_lshl_add_u32 v5, v100, 5, v5
    v_bfe_u32 v101, v97, 1, 2
    v_lshl_add_u32 v5, v101, 2, v5
    v_add_u32 v5, 29472, v5
    v_lshlrev_b32 v102, 4, v100
    v_mov_b32 v103, 0x3f80
    v_lshlrev_b32 v12, v102, v103
    v_lshlrev_b32 v13, v102, v103
    v_lshlrev_b32 v14, v102, v103
    v_lshlrev_b32 v15, v102, v103
    s_mov_b32 s54, 0x3f803f80
    s_mov_b32 s55, 0x3f803f80
    s_mov_b32 s56, 0x3f803f80
    s_mov_b32 s57, 0
    s_mov_b32 s58, 0x3e0293ee
    s_mov_b32 s59, 0x3e0293ee
    s_mov_b32 s61, 0xbe0293ee
    s_mov_b32 s70, 0
    s_mov_b32 s71, 0
    s_mov_b32 s34, 0
    s_mov_b32 s51, 0
    s_mov_b64 s[38:39], -1
    s_mov_b32 s2, 60000
    s_mul_i32 s62, s32, 1064960
    s_add_u32 s62, s62, 16779264
    s_add_u32 s44, s4, s62
    s_addc_u32 s45, s5, 0
    s_add_u32 s46, s44, 8192
    s_addc_u32 s47, s45, 0
    s_branch L_ccj_61
L_cc2_56:
    v_lshrrev_b32 v96, 4, v0
    v_and_b32 v97, 15, v96
    v_lshrrev_b32 v98, 4, v96
    v_lshlrev_b32 v9, 2, v96
    v_add_u32 v8, 96896, v0
    s_mov_b32 s52, 0xcccccccc
    s_mov_b32 s53, 0xcccccccc
    v_mov_b32 v99, 0xe4844444
    v_mov_b32 v100, 0xee9eeeee
    v_cndmask_b32 v101, v99, v100, s[52:53]
    v_mov_b32 v99, 0x84e44444
    v_mov_b32 v100, 0x9eeeeeee
    v_cndmask_b32 v102, v99, v100, s[52:53]
    v_cmp_lt_u32 vcc, 31, v96
    s_nop 1
    v_cndmask_b32 v1, v101, v102, vcc
    s_lshl_b32 s62, s32, 6
    s_add_u32 s62, s62, 133120
    v_mul_u32_u24 v2, 8320, v98
    v_lshl_add_u32 v2, v97, 2, v2
    v_add_u32 v2, s62, v2
    v_and_b32 v99, 1, v98
    v_mul_u32_u24 v3, 10240, v99
    v_lshrrev_b32 v99, 3, v97
    v_lshl_add_u32 v3, v99, 8, v3
    v_bfe_u32 v99, v97, 2, 1
    v_lshl_add_u32 v3, v99, 5, v3
    v_and_b32 v99, 3, v97
    v_lshl_add_u32 v3, v99, 2, v3
    s_add_u32 s64, s4, 3145727
    s_addc_u32 s65, s5, 0
    s_and_b32 s64, s64, 0xffe00000
    s_mul_i32 s36, s32, 8320
    s_add_u32 s36, s36, 4096
    s_add_u32 s36, s36, s64
    s_add_u32 s40, s64, 1052672
    s_lshr_b32 s62, s32, 3
    s_lshl_b32 s62, s62, 9
    s_and_b32 s63, s32, 3
    s_lshl_b32 s63, s63, 6
    s_add_u32 s62, s62, s63
    s_and_b32 s63, s32, 4
    s_lshl_b32 s63, s63, 2
    s_add_u32 s62, s62, s63
    s_add_u32 s42, s40, s62
    s_xor_b32 s42, s42, 65536
    s_and_b32 s62, s32, 1
    s_mul_i32 s62, s62, 10240
    s_add_u32 s40, s40, s62
    s_add_i32 s40, s40, 0
    s_mov_b32 s37, s65
    s_mov_b32 s41, s65
    s_mov_b32 s43, s65
    v_mul_u32_u24 v4, 1088, v98
    v_lshl_add_u32 v4, v97, 2, v4
    v_add_u32 v4, 24704, v4
    v_lshrrev_b32 v99, 2, v97
    v_and_b32 v100, 1, v97
    v_lshl_add_u32 v101, v99, 1, v100
    v_mul_u32_u24 v6, 544, v101
    v_lshl_add_u32 v6, v98, 4, v6
    v_add_u32 v6, 24576, v6
    v_mul_u32_u24 v7, 272, v98
    v_lshl_add_u32 v7, v97, 4, v7
    v_add_u32 v7, 28928, v7
    v_lshrrev_b32 v101, 3, v97
    v_mul_u32_u24 v5, 272, v101
    v_and_b32 v101, 1, v98
    v_lshl_add_u32 v5, v101, 7, v5
    v_lshrrev_b32 v101, 1, v98
    v_lshl_add_u32 v5, v101, 6, v5
    v_lshl_add_u32 v5, v100, 5, v5
    v_bfe_u32 v101, v97, 1, 2
    v_lshl_add_u32 v5, v101, 2, v5
    v_add_u32 v5, 30016, v5
    v_lshlrev_b32 v102, 4, v100
    v_mov_b32 v103, 0x3f80
    v_lshlrev_b32 v12, v102, v103
    v_lshlrev_b32 v13, v102, v103
    v_lshlrev_b32 v14, v102, v103
    v_lshlrev_b32 v15, v102, v103
    s_mov_b32 s54, 0x3f803f80
    s_mov_b32 s55, 0x3f803f80
    s_mov_b32 s56, 0x3f803f80
    s_mov_b32 s57, 0
    s_mov_b32 s58, 0x3e0293ee
    s_mov_b32 s59, 0x3e0293ee
    s_mov_b32 s61, 0xbe0293ee
    s_mov_b32 s70, 0
    s_mov_b32 s71, 0
    s_mov_b32 s34, 0
    s_mov_b32 s51, 0
    s_mov_b64 s[38:39], -1
    s_mov_b32 s2, 60000
    s_mul_i32 s62, s32, 1064960
    s_add_u32 s62, s62, 16781312
    s_add_u32 s44, s4, s62
    s_addc_u32 s45, s5, 0
    s_add_u32 s46, s44, 8192
    s_addc_u32 s47, s45, 0
    s_branch L_ccj_61
L_cc3_57:
    v_lshrrev_b32 v96, 4, v0
    v_and_b32 v97, 15, v96
    v_lshrrev_b32 v98, 4, v96
    v_lshlrev_b32 v9, 2, v96
    v_add_u32 v8, 129664, v0
    s_mov_b32 s52, 0xcccccccc
    s_mov_b32 s53, 0xcccccccc
    v_mov_b32 v99, 0xe4844444
    v_mov_b32 v100, 0xee9eeeee
    v_cndmask_b32 v101, v99, v100, s[52:53]
    v_mov_b32 v99, 0x84e44444
    v_mov_b32 v100, 0x9eeeeeee
    v_cndmask_b32 v102, v99, v100, s[52:53]
    v_cmp_lt_u32 vcc, 31, v96
    s_nop 1
    v_cndmask_b32 v1, v101, v102, vcc
    s_lshl_b32 s62, s32, 6
    s_add_u32 s62, s62, 199680
    v_mul_u32_u24 v2, 8320, v98
    v_lshl_add_u32 v2, v97, 2, v2
    v_add_u32 v2, s62, v2
    v_and_b32 v99, 1, v98
    v_mul_u32_u24 v3, 10240, v99
    v_lshrrev_b32 v99, 3, v97
    v_lshl_add_u32 v3, v99, 8, v3
    v_bfe_u32 v99, v97, 2, 1
    v_lshl_add_u32 v3, v99, 5, v3
    v_and_b32 v99, 3, v97
    v_lshl_add_u32 v3, v99, 2, v3
    s_add_u32 s64, s4, 3145727
    s_addc_u32 s65, s5, 0
    s_and_b32 s64, s64, 0xffe00000
    s_mul_i32 s36, s32, 8320
    s_add_u32 s36, s36, 6144
    s_add_u32 s36, s36, s64
    s_add_u32 s40, s64, 1054720
    s_lshr_b32 s62, s32, 3
    s_lshl_b32 s62, s62, 9
    s_and_b32 s63, s32, 3
    s_lshl_b32 s63, s63, 6
    s_add_u32 s62, s62, s63
    s_and_b32 s63, s32, 4
    s_lshl_b32 s63, s63, 2
    s_add_u32 s62, s62, s63
    s_add_u32 s42, s40, s62
    s_xor_b32 s42, s42, 65536
    s_and_b32 s62, s32, 1
    s_mul_i32 s62, s62, 10240
    s_add_u32 s40, s40, s62
    s_add_i32 s40, s40, -1024
    s_mov_b32 s37, s65
    s_mov_b32 s41, s65
    s_mov_b32 s43, s65
    v_mul_u32_u24 v4, 1088, v98
    v_lshl_add_u32 v4, v97, 2, v4
    v_add_u32 v4, 24768, v4
    v_lshrrev_b32 v99, 2, v97
    v_and_b32 v100, 1, v97
    v_lshl_add_u32 v101, v99, 1, v100
    v_mul_u32_u24 v6, 544, v101
    v_lshl_add_u32 v6, v98, 4, v6
    v_add_u32 v6, 24576, v6
    v_mul_u32_u24 v7, 272, v98
    v_lshl_add_u32 v7, v97, 4, v7
    v_add_u32 v7, 28928, v7
    v_lshrrev_b32 v101, 3, v97
    v_mul_u32_u24 v5, 272, v101
    v_and_b32 v101, 1, v98
    v_lshl_add_u32 v5, v101, 7, v5
    v_lshrrev_b32 v101, 1, v98
    v_lshl_add_u32 v5, v101, 6, v5
    v_lshl_add_u32 v5, v100, 5, v5
    v_bfe_u32 v101, v97, 1, 2
    v_lshl_add_u32 v5, v101, 2, v5
    v_add_u32 v5, 30560, v5
    v_lshlrev_b32 v102, 4, v100
    v_mov_b32 v103, 0x3f80
    v_lshlrev_b32 v12, v102, v103
    v_lshlrev_b32 v13, v102, v103
    v_lshlrev_b32 v14, v102, v103
    v_lshlrev_b32 v15, v102, v103
    s_mov_b32 s54, 0x3f803f80
    s_mov_b32 s55, 0x3f803f80
    s_mov_b32 s56, 0x3f803f80
    s_mov_b32 s57, 0
    s_mov_b32 s58, 0x3e0293ee
    s_mov_b32 s59, 0x3e0293ee
    s_mov_b32 s61, 0xbe0293ee
    s_mov_b32 s70, 0
    s_mov_b32 s71, 0
    s_mov_b32 s34, 0
    s_mov_b32 s51, 0
    s_mov_b64 s[38:39], -1
    s_mov_b32 s2, 60000
    s_mul_i32 s62, s32, 1064960
    s_add_u32 s62, s62, 16783360
    s_add_u32 s44, s4, s62
    s_addc_u32 s45, s5, 0
    s_add_u32 s46, s44, 8192
    s_addc_u32 s47, s45, 0
L_ccj_61:
    v_mov_b64 v[80:81], 0
    v_mov_b64 v[82:83], 0
    v_mov_b64 v[84:85], 0
    v_mov_b64 v[86:87], 0
    v_mov_b64 v[88:89], 0
    v_mov_b64 v[90:91], 0
    v_mov_b64 v[92:93], 0
    v_mov_b64 v[94:95], 0
    v_mov_b64 v[116:117], -1
    v_mov_b64 v[118:119], -1
    v_lshl_or_b32 v10, v112, 16, v115
    global_store_dwordx4 v0, v[80:83], s[36:37] sc1
    global_store_dwordx4 v0, v[80:83], s[36:37] offset:1024 sc1
    global_store_dword v3, v116, s[42:43] offset:0 sc1
    s_xor_b32 s42, s42, 65536
    global_store_dword v3, v10, s[42:43] offset:0 sc1
    ds_read_b64_tr_b16 v[64:65], v122 offset:0
    ds_read_b64_tr_b16 v[66:67], v122 offset:1024
    ds_read_b64_tr_b16 v[68:69], v123 offset:0
    ds_read_b64_tr_b16 v[70:71], v123 offset:1024
    ds_read_b64_tr_b16 v[72:73], v122 offset:32
    ds_read_b64_tr_b16 v[74:75], v122 offset:1056
    ds_read_b64_tr_b16 v[76:77], v123 offset:32
    ds_read_b64_tr_b16 v[78:79], v123 offset:1056
    s_waitcnt vmcnt(16) lgkmcnt(0)
    s_barrier
    s_cmp_eq_u32 s35, 0
    s_cbranch_scc0 L_thr_62
    s_waitcnt vmcnt(4)
L_thr_62:
    s_add_u32 m0, s60, 20480
    s_mov_b32 s62, 2621440
    buffer_load_dwordx4 v120, s[12:15], s62 offen  lds
    s_add_u32 m0, s60, 21504
    s_mov_b32 s62, 2629632
    buffer_load_dwordx4 v120, s[12:15], s62 offen  lds
    s_add_u32 m0, s60, 22528
    s_mov_b32 s62, 2686976
    buffer_load_dwordx4 v120, s[12:15], s62 offen  lds
    s_add_u32 m0, s60, 23552
    s_mov_b32 s62, 2695168
    buffer_load_dwordx4 v120, s[12:15], s62 offen  lds
    ds_read_b64_tr_b16 v[144:145], v122 offset:4096
    ds_read_b64_tr_b16 v[146:147], v122 offset:5120
    ds_read_b64_tr_b16 v[148:149], v123 offset:4096
    ds_read_b64_tr_b16 v[150:151], v123 offset:5120
    ds_read_b64_tr_b16 v[152:153], v122 offset:4128
    ds_read_b64_tr_b16 v[154:155], v122 offset:5152
    ds_read_b64_tr_b16 v[156:157], v123 offset:4128
    ds_read_b64_tr_b16 v[158:159], v123 offset:5152
    s_waitcnt vmcnt(16) lgkmcnt(0)
    s_barrier
    s_cmp_eq_u32 s35, 0
    s_cbranch_scc0 L_thr_63
    s_waitcnt vmcnt(4)
L_thr_63:
    s_add_u32 m0, s60, 24576
    s_mov_b32 s62, 3145728
    buffer_load_dwordx4 v120, s[12:15], s62 offen  lds
    s_add_u32 m0, s60, 25600
    s_mov_b32 s62, 3153920
    buffer_load_dwordx4 v120, s[12:15], s62 offen  lds
    s_add_u32 m0, s60, 26624
    s_mov_b32 s62, 3211264
    buffer_load_dwordx4 v120, s[12:15], s62 offen  lds
    s_add_u32 m0, s60, 27648
    s_mov_b32 s62, 3219456
    buffer_load_dwordx4 v120, s[12:15], s62 offen  lds
    ds_read_b64_tr_b16 v[176:177], v122 offset:8192
    ds_read_b64_tr_b16 v[178:179], v122 offset:9216
    ds_read_b64_tr_b16 v[180:181], v123 offset:8192
    ds_read_b64_tr_b16 v[182:183], v123 offset:9216
    ds_read_b64_tr_b16 v[184:185], v122 offset:8224
    ds_read_b64_tr_b16 v[186:187], v122 offset:9248
    ds_read_b64_tr_b16 v[188:189], v123 offset:8224
    ds_read_b64_tr_b16 v[190:191], v123 offset:9248
    s_waitcnt vmcnt(16) lgkmcnt(0)
    s_barrier
    s_cmp_eq_u32 s35, 0
    s_cbranch_scc0 L_thr_64
    s_waitcnt vmcnt(4)
L_thr_64:
    s_add_u32 m0, s60, 28672
    s_mov_b32 s62, 3670016
    buffer_load_dwordx4 v120, s[12:15], s62 offen  lds
    s_add_u32 m0, s60, 29696
    s_mov_b32 s62, 3678208
    buffer_load_dwordx4 v120, s[12:15], s62 offen  lds
    s_add_u32 m0, s60, 30720
    s_mov_b32 s62, 3735552
    buffer_load_dwordx4 v120, s[12:15], s62 offen  lds
    s_add_u32 m0, s60, 31744
    s_mov_b32 s62, 3743744
    buffer_load_dwordx4 v120, s[12:15], s62 offen  lds
    ds_read_b64_tr_b16 v[208:209], v122 offset:12288
    ds_read_b64_tr_b16 v[210:211], v122 offset:13312
    ds_read_b64_tr_b16 v[212:213], v123 offset:12288
    ds_read_b64_tr_b16 v[214:215], v123 offset:13312
    ds_read_b64_tr_b16 v[216:217], v122 offset:12320
    ds_read_b64_tr_b16 v[218:219], v122 offset:13344
    ds_read_b64_tr_b16 v[220:221], v123 offset:12320
    ds_read_b64_tr_b16 v[222:223], v123 offset:13344
    s_waitcnt vmcnt(16) lgkmcnt(0)
    s_barrier
    s_cmp_eq_u32 s35, 0
    s_cbranch_scc0 L_thr_65
    s_waitcnt vmcnt(4)
L_thr_65:
    s_add_u32 m0, s60, 0
    s_mov_b32 s62, 0
    buffer_load_dwordx4 v120, s[16:19], s62 offen  lds
    s_add_u32 m0, s60, 1024
    s_mov_b32 s62, 8192
    buffer_load_dwordx4 v120, s[16:19], s62 offen  lds
    s_add_u32 m0, s60, 2048
    s_mov_b32 s62, 65536
    buffer_load_dwordx4 v120, s[16:19], s62 offen  lds
    s_add_u32 m0, s60, 3072
    s_mov_b32 s62, 73728
    buffer_load_dwordx4 v120, s[16:19], s62 offen  lds
    ds_read_b64_tr_b16 v[240:241], v122 offset:16384
    ds_read_b64_tr_b16 v[242:243], v122 offset:17408
    ds_read_b64_tr_b16 v[244:245], v123 offset:16384
    ds_read_b64_tr_b16 v[246:247], v123 offset:17408
    ds_read_b64_tr_b16 v[248:249], v122 offset:16416
    ds_read_b64_tr_b16 v[250:251], v122 offset:17440
    ds_read_b64_tr_b16 v[252:253], v123 offset:16416
    ds_read_b64_tr_b16 v[254:255], v123 offset:17440
    s_waitcnt vmcnt(12) lgkmcnt(0)
    s_barrier
    s_cmp_eq_u32 s35, 0
    s_cbranch_scc0 L_thr_66
    s_waitcnt vmcnt(4)
L_thr_66:
    s_add_u32 m0, s60, 4096
    s_mov_b32 s62, 524288
    buffer_load_dwordx4 v120, s[16:19], s62 offen  lds
    s_add_u32 m0, s60, 5120
    s_mov_b32 s62, 532480
    buffer_load_dwordx4 v120, s[16:19], s62 offen  lds
    s_add_u32 m0, s60, 6144
    s_mov_b32 s62, 589824
    buffer_load_dwordx4 v120, s[16:19], s62 offen  lds
    s_add_u32 m0, s60, 7168
    s_mov_b32 s62, 598016
    buffer_load_dwordx4 v120, s[16:19], s62 offen  lds
    s_cmp_eq_u32 s33, 0
    s_cbranch_scc0 L_arr_67
    v_mov_b32 v10, 0x10000
    s_mov_b64 exec, 1
    global_atomic_add v91, v10, s[28:29] offset:192
    s_mov_b64 exec, -1
L_arr_67:
    ds_read_b64_tr_b16 a[16:17], v122 offset:20480
    ds_read_b64_tr_b16 a[18:19], v122 offset:21504
    ds_read_b64_tr_b16 a[20:21], v123 offset:20480
    ds_read_b64_tr_b16 a[22:23], v123 offset:21504
    ds_read_b64_tr_b16 a[24:25], v122 offset:20512
    ds_read_b64_tr_b16 a[26:27], v122 offset:21536
    ds_read_b64_tr_b16 a[28:29], v123 offset:20512
    ds_read_b64_tr_b16 a[30:31], v123 offset:21536
    s_waitcnt vmcnt(12) lgkmcnt(0)
    s_barrier
    s_cmp_eq_u32 s35, 0
    s_cbranch_scc0 L_thr_68
    s_waitcnt vmcnt(4)
L_thr_68:
    s_add_u32 m0, s60, 8192
    s_mov_b32 s62, 1048576
    buffer_load_dwordx4 v120, s[16:19], s62 offen  lds
    s_add_u32 m0, s60, 9216
    s_mov_b32 s62, 1056768
    buffer_load_dwordx4 v120, s[16:19], s62 offen  lds
    s_add_u32 m0, s60, 10240
    s_mov_b32 s62, 1114112
    buffer_load_dwordx4 v120, s[16:19], s62 offen  lds
    s_add_u32 m0, s60, 11264
    s_mov_b32 s62, 1122304
    buffer_load_dwordx4 v120, s[16:19], s62 offen  lds
    ds_read_b64_tr_b16 a[48:49], v122 offset:24576
    ds_read_b64_tr_b16 a[50:51], v122 offset:25600
    ds_read_b64_tr_b16 a[52:53], v123 offset:24576
    ds_read_b64_tr_b16 a[54:55], v123 offset:25600
    ds_read_b64_tr_b16 a[56:57], v122 offset:24608
    ds_read_b64_tr_b16 a[58:59], v122 offset:25632
    ds_read_b64_tr_b16 a[60:61], v123 offset:24608
    ds_read_b64_tr_b16 a[62:63], v123 offset:25632
    s_waitcnt vmcnt(12) lgkmcnt(0)
    s_barrier
    s_cmp_eq_u32 s35, 0
    s_cbranch_scc0 L_thr_69
    s_waitcnt vmcnt(4)
L_thr_69:
    s_add_u32 m0, s60, 12288
    s_mov_b32 s62, 1572864
    buffer_load_dwordx4 v120, s[16:19], s62 offen  lds
    s_add_u32 m0, s60, 13312
    s_mov_b32 s62, 1581056
    buffer_load_dwordx4 v120, s[16:19], s62 offen  lds
    s_add_u32 m0, s60, 14336
    s_mov_b32 s62, 1638400
    buffer_load_dwordx4 v120, s[16:19], s62 offen  lds
    s_add_u32 m0, s60, 15360
    s_mov_b32 s62, 1646592
    buffer_load_dwordx4 v120, s[16:19], s62 offen  lds
    ds_read_b64_tr_b16 a[80:81], v122 offset:28672
    ds_read_b64_tr_b16 a[82:83], v122 offset:29696
    ds_read_b64_tr_b16 a[84:85], v123 offset:28672
    ds_read_b64_tr_b16 a[86:87], v123 offset:29696
    ds_read_b64_tr_b16 a[88:89], v122 offset:28704
    ds_read_b64_tr_b16 a[90:91], v122 offset:29728
    ds_read_b64_tr_b16 a[92:93], v123 offset:28704
    ds_read_b64_tr_b16 a[94:95], v123 offset:29728
    s_waitcnt vmcnt(12) lgkmcnt(0)
    s_barrier
    s_cmp_eq_u32 s35, 0
    s_cbranch_scc0 L_thr_70
    s_waitcnt vmcnt(4)
L_thr_70:
    s_add_u32 m0, s60, 16384
    s_mov_b32 s62, 2097152
    buffer_load_dwordx4 v120, s[16:19], s62 offen  lds
    s_add_u32 m0, s60, 17408
    s_mov_b32 s62, 2105344
    buffer_load_dwordx4 v120, s[16:19], s62 offen  lds
    s_add_u32 m0, s60, 18432
    s_mov_b32 s62, 2162688
    buffer_load_dwordx4 v120, s[16:19], s62 offen  lds
    s_add_u32 m0, s60, 19456
    s_mov_b32 s62, 2170880
    buffer_load_dwordx4 v120, s[16:19], s62 offen  lds
    ds_read_b64_tr_b16 a[96:97], v122 offset:0
    ds_read_b64_tr_b16 a[98:99], v122 offset:1024
    ds_read_b64_tr_b16 a[100:101], v123 offset:0
    ds_read_b64_tr_b16 a[102:103], v123 offset:1024
    ds_read_b64_tr_b16 a[104:105], v122 offset:32
    ds_read_b64_tr_b16 a[106:107], v122 offset:1056
    ds_read_b64_tr_b16 a[108:109], v123 offset:32
    ds_read_b64_tr_b16 a[110:111], v123 offset:1056
    s_waitcnt vmcnt(12) lgkmcnt(0)
    s_barrier
    s_cmp_eq_u32 s35, 0
    s_cbranch_scc0 L_thr_71
    s_waitcnt vmcnt(4)
L_thr_71:
    s_add_u32 m0, s60, 20480
    s_mov_b32 s62, 2621440
    buffer_load_dwordx4 v120, s[16:19], s62 offen  lds
    s_add_u32 m0, s60, 21504
    s_mov_b32 s62, 2629632
    buffer_load_dwordx4 v120, s[16:19], s62 offen  lds
    s_add_u32 m0, s60, 22528
    s_mov_b32 s62, 2686976
    buffer_load_dwordx4 v120, s[16:19], s62 offen  lds
    s_add_u32 m0, s60, 23552
    s_mov_b32 s62, 2695168
    buffer_load_dwordx4 v120, s[16:19], s62 offen  lds
    ds_read_b64_tr_b16 a[112:113], v122 offset:4096
    ds_read_b64_tr_b16 a[114:115], v122 offset:5120
    ds_read_b64_tr_b16 a[116:117], v123 offset:4096
    ds_read_b64_tr_b16 a[118:119], v123 offset:5120
    ds_read_b64_tr_b16 a[120:121], v122 offset:4128
    ds_read_b64_tr_b16 a[122:123], v122 offset:5152
    ds_read_b64_tr_b16 a[124:125], v123 offset:4128
    ds_read_b64_tr_b16 a[126:127], v123 offset:5152
    s_waitcnt vmcnt(12) lgkmcnt(0)
    s_barrier
    s_cmp_eq_u32 s35, 0
    s_cbranch_scc0 L_thr_72
    s_waitcnt vmcnt(4)
L_thr_72:
    s_add_u32 m0, s60, 24576
    s_mov_b32 s62, 3145728
    buffer_load_dwordx4 v120, s[16:19], s62 offen  lds
    s_add_u32 m0, s60, 25600
    s_mov_b32 s62, 3153920
    buffer_load_dwordx4 v120, s[16:19], s62 offen  lds
    s_add_u32 m0, s60, 26624
    s_mov_b32 s62, 3211264
    buffer_load_dwordx4 v120, s[16:19], s62 offen  lds
    s_add_u32 m0, s60, 27648
    s_mov_b32 s62, 3219456
    buffer_load_dwordx4 v120, s[16:19], s62 offen  lds
    ds_read_b64_tr_b16 a[128:129], v122 offset:8192
    ds_read_b64_tr_b16 a[130:131], v122 offset:9216
    ds_read_b64_tr_b16 a[132:133], v123 offset:8192
    ds_read_b64_tr_b16 a[134:135], v123 offset:9216
    ds_read_b64_tr_b16 a[136:137], v122 offset:8224
    ds_read_b64_tr_b16 a[138:139], v122 offset:9248
    ds_read_b64_tr_b16 a[140:141], v123 offset:8224
    ds_read_b64_tr_b16 a[142:143], v123 offset:9248
    s_waitcnt vmcnt(12) lgkmcnt(0)
    s_barrier
    s_cmp_eq_u32 s35, 0
    s_cbranch_scc0 L_thr_73
    s_waitcnt vmcnt(4)
L_thr_73:
    s_add_u32 m0, s60, 28672
    s_mov_b32 s62, 3670016
    buffer_load_dwordx4 v120, s[16:19], s62 offen  lds
    s_add_u32 m0, s60, 29696
    s_mov_b32 s62, 3678208
    buffer_load_dwordx4 v120, s[16:19], s62 offen  lds
    s_add_u32 m0, s60, 30720
    s_mov_b32 s62, 3735552
    buffer_load_dwordx4 v120, s[16:19], s62 offen  lds
    s_add_u32 m0, s60, 31744
    s_mov_b32 s62, 3743744
    buffer_load_dwordx4 v120, s[16:19], s62 offen  lds
    ds_read_b64_tr_b16 a[144:145], v122 offset:12288
    ds_read_b64_tr_b16 a[146:147], v122 offset:13312
    ds_read_b64_tr_b16 a[148:149], v123 offset:12288
    ds_read_b64_tr_b16 a[150:151], v123 offset:13312
    ds_read_b64_tr_b16 a[152:153], v122 offset:12320
    ds_read_b64_tr_b16 a[154:155], v122 offset:13344
    ds_read_b64_tr_b16 a[156:157], v123 offset:12320
    ds_read_b64_tr_b16 a[158:159], v123 offset:13344
    s_waitcnt vmcnt(12) lgkmcnt(0)
    s_barrier
    s_cmp_eq_u32 s35, 0
    s_cbranch_scc0 L_thr_74
    s_waitcnt vmcnt(4)
L_thr_74:
    s_add_u32 m0, s60, 0
    s_mov_b32 s62, 0
    buffer_load_dwordx4 v120, s[8:11], s62 offen  lds
    s_add_u32 m0, s60, 1024
    s_mov_b32 s62, 8192
    buffer_load_dwordx4 v120, s[8:11], s62 offen  lds
    s_add_u32 m0, s60, 2048
    s_mov_b32 s62, 65536
    buffer_load_dwordx4 v120, s[8:11], s62 offen  lds
    s_add_u32 m0, s60, 3072
    s_mov_b32 s62, 73728
    buffer_load_dwordx4 v120, s[8:11], s62 offen  lds
    ds_read_b64_tr_b16 a[160:161], v122 offset:16384
    ds_read_b64_tr_b16 a[162:163], v122 offset:17408
    ds_read_b64_tr_b16 a[164:165], v123 offset:16384
    ds_read_b64_tr_b16 a[166:167], v123 offset:17408
    ds_read_b64_tr_b16 a[168:169], v122 offset:16416
    ds_read_b64_tr_b16 a[170:171], v122 offset:17440
    ds_read_b64_tr_b16 a[172:173], v123 offset:16416
    ds_read_b64_tr_b16 a[174:175], v123 offset:17440
    s_waitcnt vmcnt(12) lgkmcnt(0)
    s_barrier
    s_cmp_eq_u32 s35, 0
    s_cbranch_scc0 L_thr_75
    s_waitcnt vmcnt(4)
L_thr_75:
    s_add_u32 m0, s60, 4096
    s_mov_b32 s62, 524288
    buffer_load_dwordx4 v120, s[8:11], s62 offen  lds
    s_add_u32 m0, s60, 5120
    s_mov_b32 s62, 532480
    buffer_load_dwordx4 v120, s[8:11], s62 offen  lds
    s_add_u32 m0, s60, 6144
    s_mov_b32 s62, 589824
    buffer_load_dwordx4 v120, s[8:11], s62 offen  lds
    s_add_u32 m0, s60, 7168
    s_mov_b32 s62, 598016
    buffer_load_dwordx4 v120, s[8:11], s62 offen  lds
    ds_read_b64_tr_b16 a[176:177], v122 offset:20480
    ds_read_b64_tr_b16 a[178:179], v122 offset:21504
    ds_read_b64_tr_b16 a[180:181], v123 offset:20480
    ds_read_b64_tr_b16 a[182:183], v123 offset:21504
    ds_read_b64_tr_b16 a[184:185], v122 offset:20512
    ds_read_b64_tr_b16 a[186:187], v122 offset:21536
    ds_read_b64_tr_b16 a[188:189], v123 offset:20512
    ds_read_b64_tr_b16 a[190:191], v123 offset:21536
    s_waitcnt vmcnt(12) lgkmcnt(0)
    s_barrier
    s_cmp_eq_u32 s35, 0
    s_cbranch_scc0 L_thr_76
    s_waitcnt vmcnt(4)
L_thr_76:
    s_add_u32 m0, s60, 8192
    s_mov_b32 s62, 1048576
    buffer_load_dwordx4 v120, s[8:11], s62 offen  lds
    s_add_u32 m0, s60, 9216
    s_mov_b32 s62, 1056768
    buffer_load_dwordx4 v120, s[8:11], s62 offen  lds
    s_add_u32 m0, s60, 10240
    s_mov_b32 s62, 1114112
    buffer_load_dwordx4 v120, s[8:11], s62 offen  lds
    s_add_u32 m0, s60, 11264
    s_mov_b32 s62, 1122304
    buffer_load_dwordx4 v120, s[8:11], s62 offen  lds
    global_load_dword v96, v91, s[28:29] offset:192 sc1
    ds_read_b64_tr_b16 a[192:193], v122 offset:24576
    ds_read_b64_tr_b16 a[194:195], v122 offset:25600
    ds_read_b64_tr_b16 a[196:197], v123 offset:24576
    ds_read_b64_tr_b16 a[198:199], v123 offset:25600
    ds_read_b64_tr_b16 a[200:201], v122 offset:24608
    ds_read_b64_tr_b16 a[202:203], v122 offset:25632
    ds_read_b64_tr_b16 a[204:205], v123 offset:24608
    ds_read_b64_tr_b16 a[206:207], v123 offset:25632
    s_waitcnt vmcnt(13) lgkmcnt(0)
    s_barrier
    s_cmp_eq_u32 s35, 0
    s_cbranch_scc0 L_thr_77
    s_waitcnt vmcnt(4)
L_thr_77:
    s_add_u32 m0, s60, 12288
    s_mov_b32 s62, 1572864
    buffer_load_dwordx4 v120, s[8:11], s62 offen  lds
    s_add_u32 m0, s60, 13312
    s_mov_b32 s62, 1581056
    buffer_load_dwordx4 v120, s[8:11], s62 offen  lds
    s_add_u32 m0, s60, 14336
    s_mov_b32 s62, 1638400
    buffer_load_dwordx4 v120, s[8:11], s62 offen  lds
    s_add_u32 m0, s60, 15360
    s_mov_b32 s62, 1646592
    buffer_load_dwordx4 v120, s[8:11], s62 offen  lds
    ds_read_b64_tr_b16 a[208:209], v122 offset:28672
    ds_read_b64_tr_b16 a[210:211], v122 offset:29696
    ds_read_b64_tr_b16 a[212:213], v123 offset:28672
    ds_read_b64_tr_b16 a[214:215], v123 offset:29696
    ds_read_b64_tr_b16 a[216:217], v122 offset:28704
    ds_read_b64_tr_b16 a[218:219], v122 offset:29728
    ds_read_b64_tr_b16 a[220:221], v123 offset:28704
    ds_read_b64_tr_b16 a[222:223], v123 offset:29728
    s_waitcnt vmcnt(13) lgkmcnt(0)
    s_barrier
    s_cmp_eq_u32 s35, 0
    s_cbranch_scc0 L_thr_78
    s_waitcnt vmcnt(4)
L_thr_78:
    s_add_u32 m0, s60, 16384
    s_mov_b32 s62, 2097152
    buffer_load_dwordx4 v120, s[8:11], s62 offen  lds
    s_add_u32 m0, s60, 17408
    s_mov_b32 s62, 2105344
    buffer_load_dwordx4 v120, s[8:11], s62 offen  lds
    s_add_u32 m0, s60, 18432
    s_mov_b32 s62, 2162688
    buffer_load_dwordx4 v120, s[8:11], s62 offen  lds
    s_add_u32 m0, s60, 19456
    s_mov_b32 s62, 2170880
    buffer_load_dwordx4 v120, s[8:11], s62 offen  lds
    ds_read_b64_tr_b16 v[48:49], v122 offset:0
    ds_read_b64_tr_b16 v[50:51], v122 offset:1024
    ds_read_b64_tr_b16 v[52:53], v123 offset:0
    ds_read_b64_tr_b16 v[54:55], v123 offset:1024
    ds_read_b64_tr_b16 v[56:57], v122 offset:32
    ds_read_b64_tr_b16 v[58:59], v122 offset:1056
    ds_read_b64_tr_b16 v[60:61], v123 offset:32
    ds_read_b64_tr_b16 v[62:63], v123 offset:1056
    s_waitcnt vmcnt(13) lgkmcnt(0)
    s_barrier
    s_cmp_eq_u32 s35, 0
    s_cbranch_scc0 L_thr_79
    s_waitcnt vmcnt(4)
L_thr_79:
    s_add_u32 m0, s60, 20480
    s_mov_b32 s62, 2621440
    buffer_load_dwordx4 v120, s[8:11], s62 offen  lds
    s_add_u32 m0, s60, 21504
    s_mov_b32 s62, 2629632
    buffer_load_dwordx4 v120, s[8:11], s62 offen  lds
    s_add_u32 m0, s60, 22528
    s_mov_b32 s62, 2686976
    buffer_load_dwordx4 v120, s[8:11], s62 offen  lds
    s_add_u32 m0, s60, 23552
    s_mov_b32 s62, 2695168
    buffer_load_dwordx4 v120, s[8:11], s62 offen  lds
    ds_read_b64_tr_b16 v[128:129], v122 offset:4096
    ds_read_b64_tr_b16 v[130:131], v122 offset:5120
    ds_read_b64_tr_b16 v[132:133], v123 offset:4096
    ds_read_b64_tr_b16 v[134:135], v123 offset:5120
    ds_read_b64_tr_b16 v[136:137], v122 offset:4128
    ds_read_b64_tr_b16 v[138:139], v122 offset:5152
    ds_read_b64_tr_b16 v[140:141], v123 offset:4128
    ds_read_b64_tr_b16 v[142:143], v123 offset:5152
    s_waitcnt vmcnt(13) lgkmcnt(0)
    s_barrier
    s_cmp_eq_u32 s35, 0
    s_cbranch_scc0 L_thr_80
    s_waitcnt vmcnt(4)
L_thr_80:
    s_add_u32 m0, s60, 24576
    s_mov_b32 s62, 3145728
    buffer_load_dwordx4 v120, s[8:11], s62 offen  lds
    s_add_u32 m0, s60, 25600
    s_mov_b32 s62, 3153920
    buffer_load_dwordx4 v120, s[8:11], s62 offen  lds
    s_add_u32 m0, s60, 26624
    s_mov_b32 s62, 3211264
    buffer_load_dwordx4 v120, s[8:11], s62 offen  lds
    s_add_u32 m0, s60, 27648
    s_mov_b32 s62, 3219456
    buffer_load_dwordx4 v120, s[8:11], s62 offen  lds
    ds_read_b64_tr_b16 v[160:161], v122 offset:8192
    ds_read_b64_tr_b16 v[162:163], v122 offset:9216
    ds_read_b64_tr_b16 v[164:165], v123 offset:8192
    ds_read_b64_tr_b16 v[166:167], v123 offset:9216
    ds_read_b64_tr_b16 v[168:169], v122 offset:8224
    ds_read_b64_tr_b16 v[170:171], v122 offset:9248
    ds_read_b64_tr_b16 v[172:173], v123 offset:8224
    ds_read_b64_tr_b16 v[174:175], v123 offset:9248
    s_waitcnt vmcnt(12) lgkmcnt(0)
    s_barrier
    s_cmp_eq_u32 s35, 0
    s_cbranch_scc0 L_thr_81
    s_waitcnt vmcnt(4)
L_thr_81:
    s_add_u32 m0, s60, 28672
    s_mov_b32 s62, 3670016
    buffer_load_dwordx4 v120, s[8:11], s62 offen  lds
    s_add_u32 m0, s60, 29696
    s_mov_b32 s62, 3678208
    buffer_load_dwordx4 v120, s[8:11], s62 offen  lds
    s_add_u32 m0, s60, 30720
    s_mov_b32 s62, 3735552
    buffer_load_dwordx4 v120, s[8:11], s62 offen  lds
    s_add_u32 m0, s60, 31744
    s_mov_b32 s62, 3743744
    buffer_load_dwordx4 v120, s[8:11], s62 offen  lds
    s_mov_b32 s63, 2097408
    v_cmp_ne_u32 vcc, s63, v96
    s_cbranch_vccz L_arrok_82
L_spin_83:
    global_load_dword v96, v91, s[28:29] offset:192 sc1
    s_sub_u32 s50, s50, 1
    s_cselect_b64 s[48:49], 0, s[48:49]
    s_waitcnt vmcnt(0)
    v_cmp_ne_u32 vcc, s63, v96
    s_and_b64 vcc, vcc, s[48:49]
    s_cbranch_scc0 L_spino_84
    s_branch L_spin_83
L_spino_84:
L_arrok_82:
    global_load_dwordx4 v[112:115], v0, s[36:37] offset:0 sc1
    global_load_dwordx4 v[112:115], v0, s[36:37] offset:1024 sc1
    s_xor_b32 s40, s40, 65536
    global_load_dwordx4 v[112:115], v0, s[40:41] offset:-2048 sc1
    global_load_dwordx4 v[112:115], v0, s[40:41] offset:2048 sc1
    s_xor_b32 s40, s40, 65536
    global_load_dwordx4 v[112:115], v0, s[40:41] offset:-2048 sc1
    global_load_dwordx4 v[112:115], v0, s[40:41] offset:2048 sc1
    ds_read_b64_tr_b16 v[192:193], v122 offset:12288
    ds_read_b64_tr_b16 v[194:195], v122 offset:13312
    ds_read_b64_tr_b16 v[196:197], v123 offset:12288
    ds_read_b64_tr_b16 v[198:199], v123 offset:13312
    ds_read_b64_tr_b16 v[200:201], v122 offset:12320
    ds_read_b64_tr_b16 v[202:203], v122 offset:13344
    ds_read_b64_tr_b16 v[204:205], v123 offset:12320
    ds_read_b64_tr_b16 v[206:207], v123 offset:13344
    s_waitcnt vmcnt(18) lgkmcnt(0)
    s_barrier
    s_cmp_eq_u32 s35, 0
    s_cbranch_scc0 L_thr_85
    s_waitcnt vmcnt(4)
L_thr_85:
    s_add_u32 m0, s60, 0
    s_mov_b32 s62, 0
    buffer_load_dwordx4 v121, s[20:23], s62 offen  lds
    s_add_u32 m0, s60, 1024
    s_mov_b32 s62, 1024
    buffer_load_dwordx4 v121, s[20:23], s62 offen  lds
    s_add_u32 m0, s60, 2048
    s_mov_b32 s62, 16384
    buffer_load_dwordx4 v121, s[20:23], s62 offen  lds
    s_add_u32 m0, s60, 3072
    s_mov_b32 s62, 17408
    buffer_load_dwordx4 v121, s[20:23], s62 offen  lds
    ds_read_b64_tr_b16 v[224:225], v122 offset:16384
    ds_read_b64_tr_b16 v[226:227], v122 offset:17408
    ds_read_b64_tr_b16 v[228:229], v123 offset:16384
    ds_read_b64_tr_b16 v[230:231], v123 offset:17408
    ds_read_b64_tr_b16 v[232:233], v122 offset:16416
    ds_read_b64_tr_b16 v[234:235], v122 offset:17440
    ds_read_b64_tr_b16 v[236:237], v123 offset:16416
    ds_read_b64_tr_b16 v[238:239], v123 offset:17440
    s_waitcnt vmcnt(18) lgkmcnt(0)
    s_barrier
    s_cmp_eq_u32 s35, 0
    s_cbranch_scc0 L_thr_86
    s_waitcnt vmcnt(4)
L_thr_86:
    s_add_u32 m0, s60, 4096
    s_mov_b32 s62, 8192
    buffer_load_dwordx4 v121, s[20:23], s62 offen  lds
    s_add_u32 m0, s60, 5120
    s_mov_b32 s62, 9216
    buffer_load_dwordx4 v121, s[20:23], s62 offen  lds
    s_add_u32 m0, s60, 6144
    s_mov_b32 s62, 24576
    buffer_load_dwordx4 v121, s[20:23], s62 offen  lds
    s_add_u32 m0, s60, 7168
    s_mov_b32 s62, 25600
    buffer_load_dwordx4 v121, s[20:23], s62 offen  lds
    ds_read_b64_tr_b16 a[0:1], v122 offset:20480
    ds_read_b64_tr_b16 a[2:3], v122 offset:21504
    ds_read_b64_tr_b16 a[4:5], v123 offset:20480
    ds_read_b64_tr_b16 a[6:7], v123 offset:21504
    ds_read_b64_tr_b16 a[8:9], v122 offset:20512
    ds_read_b64_tr_b16 a[10:11], v122 offset:21536
    ds_read_b64_tr_b16 a[12:13], v123 offset:20512
    ds_read_b64_tr_b16 a[14:15], v123 offset:21536
    s_waitcnt vmcnt(18) lgkmcnt(0)
    s_barrier
    s_cmp_eq_u32 s35, 0
    s_cbranch_scc0 L_thr_87
    s_waitcnt vmcnt(4)
L_thr_87:
    s_add_u32 m0, s60, 8192
    s_mov_b32 s62, 32768
    buffer_load_dwordx4 v121, s[20:23], s62 offen  lds
    s_add_u32 m0, s60, 9216
    s_mov_b32 s62, 33792
    buffer_load_dwordx4 v121, s[20:23], s62 offen  lds
    s_add_u32 m0, s60, 10240
    s_mov_b32 s62, 49152
    buffer_load_dwordx4 v121, s[20:23], s62 offen  lds
    s_add_u32 m0, s60, 11264
    s_mov_b32 s62, 50176
    buffer_load_dwordx4 v121, s[20:23], s62 offen  lds
    ds_read_b64_tr_b16 a[32:33], v122 offset:24576
    ds_read_b64_tr_b16 a[34:35], v122 offset:25600
    ds_read_b64_tr_b16 a[36:37], v123 offset:24576
    ds_read_b64_tr_b16 a[38:39], v123 offset:25600
    ds_read_b64_tr_b16 a[40:41], v122 offset:24608
    ds_read_b64_tr_b16 a[42:43], v122 offset:25632
    ds_read_b64_tr_b16 a[44:45], v123 offset:24608
    ds_read_b64_tr_b16 a[46:47], v123 offset:25632
    s_waitcnt vmcnt(18) lgkmcnt(0)
    s_barrier
    s_cmp_eq_u32 s35, 0
    s_cbranch_scc0 L_thr_88
    s_waitcnt vmcnt(4)
L_thr_88:
    s_add_u32 m0, s60, 12288
    s_mov_b32 s62, 40960
    buffer_load_dwordx4 v121, s[20:23], s62 offen  lds
    s_add_u32 m0, s60, 13312
    s_mov_b32 s62, 41984
    buffer_load_dwordx4 v121, s[20:23], s62 offen  lds
    s_add_u32 m0, s60, 14336
    s_mov_b32 s62, 57344
    buffer_load_dwordx4 v121, s[20:23], s62 offen  lds
    s_add_u32 m0, s60, 15360
    s_mov_b32 s62, 58368
    buffer_load_dwordx4 v121, s[20:23], s62 offen  lds
    ds_read_b64_tr_b16 a[64:65], v122 offset:28672
    ds_read_b64_tr_b16 a[66:67], v122 offset:29696
    ds_read_b64_tr_b16 a[68:69], v123 offset:28672
    ds_read_b64_tr_b16 a[70:71], v123 offset:29696
    ds_read_b64_tr_b16 a[72:73], v122 offset:28704
    ds_read_b64_tr_b16 a[74:75], v122 offset:29728
    ds_read_b64_tr_b16 a[76:77], v123 offset:28704
    ds_read_b64_tr_b16 a[78:79], v123 offset:29728
    s_waitcnt vmcnt(12) lgkmcnt(0)
    s_barrier
    s_cmp_eq_u32 s35, 0
    s_cbranch_scc0 L_thr_89
    s_waitcnt vmcnt(4)
L_thr_89:
    s_add_u32 m0, s60, 16384
    s_mov_b32 s62, 65536
    buffer_load_dwordx4 v121, s[20:23], s62 offen  lds
    s_add_u32 m0, s60, 17408
    s_mov_b32 s62, 66560
    buffer_load_dwordx4 v121, s[20:23], s62 offen  lds
    s_add_u32 m0, s60, 18432
    s_mov_b32 s62, 81920
    buffer_load_dwordx4 v121, s[20:23], s62 offen  lds
    s_add_u32 m0, s60, 19456
    s_mov_b32 s62, 82944
    buffer_load_dwordx4 v121, s[20:23], s62 offen  lds
    s_cmp_eq_u32 s33, 1
    s_cbranch_scc0 L_nx_94
    s_branch L_pk1_91
L_nx_94:
    s_cmp_eq_u32 s33, 2
    s_cbranch_scc0 L_nx_95
    s_branch L_pk2_92
L_nx_95:
    s_cmp_eq_u32 s33, 3
    s_cbranch_scc0 L_nx_96
    s_branch L_pk3_93
L_nx_96:
L_pk0_90:
    s_getpc_b64 s[64:65]
L_pc_98:
    s_add_u32 s64, s64, L_fast_0-L_pc_98
    s_addc_u32 s65, s65, 0
    v_lshlrev_b32 v98, 2, v0
    v_min_u32 v98, L_code_end-L_fast_0-4, v98
    global_load_dword v99, v98, s[64:65]
    v_add_u32 v98, 4096, v98
    v_min_u32 v98, L_code_end-L_fast_0-4, v98
    global_load_dword v99, v98, s[64:65]
    s_branch L_pkj_97
L_pk1_91:
    v_swap_b32 v128, v48
    v_swap_b32 v129, v49
    v_swap_b32 v130, v50
    v_swap_b32 v131, v51
    v_swap_b32 v132, v52
    v_swap_b32 v133, v53
    v_swap_b32 v134, v54
    v_swap_b32 v135, v55
    v_swap_b32 v136, v56
    v_swap_b32 v137, v57
    v_swap_b32 v138, v58
    v_swap_b32 v139, v59
    v_swap_b32 v140, v60
    v_swap_b32 v141, v61
    v_swap_b32 v142, v62
    v_swap_b32 v143, v63
    v_swap_b32 v144, v64
    v_swap_b32 v145, v65
    v_swap_b32 v146, v66
    v_swap_b32 v147, v67
    v_swap_b32 v148, v68
    v_swap_b32 v149, v69
    v_swap_b32 v150, v70
    v_swap_b32 v151, v71
    v_swap_b32 v152, v72
    v_swap_b32 v153, v73
    v_swap_b32 v154, v74
    v_swap_b32 v155, v75
    v_swap_b32 v156, v76
    v_swap_b32 v157, v77
    v_swap_b32 v158, v78
    v_swap_b32 v159, v79
    s_getpc_b64 s[64:65]
L_pc_99:
    s_add_u32 s64, s64, L_fast_1-L_pc_99
    s_addc_u32 s65, s65, 0
    v_lshlrev_b32 v98, 2, v0
    v_min_u32 v98, L_code_end-L_fast_1-4, v98
    global_load_dword v99, v98, s[64:65]
    v_add_u32 v98, 4096, v98
    v_min_u32 v98, L_code_end-L_fast_1-4, v98
    global_load_dword v99, v98, s[64:65]
    s_branch L_pkj_97
L_pk2_92:
    v_swap_b32 v160, v48
    v_swap_b32 v161, v49
    v_swap_b32 v162, v50
    v_swap_b32 v163, v51
    v_swap_b32 v164, v52
    v_swap_b32 v165, v53
    v_swap_b32 v166, v54
    v_swap_b32 v167, v55
    v_swap_b32 v168, v56
    v_swap_b32 v169, v57
    v_swap_b32 v170, v58
    v_swap_b32 v171, v59
    v_swap_b32 v172, v60
    v_swap_b32 v173, v61
    v_swap_b32 v174, v62
    v_swap_b32 v175, v63
    v_swap_b32 v176, v64
    v_swap_b32 v177, v65
    v_swap_b32 v178, v66
    v_swap_b32 v179, v67
    v_swap_b32 v180, v68
    v_swap_b32 v181, v69
    v_swap_b32 v182, v70
    v_swap_b32 v183, v71
    v_swap_b32 v184, v72
    v_swap_b32 v185, v73
    v_swap_b32 v186, v74
    v_swap_b32 v187, v75
    v_swap_b32 v188, v76
    v_swap_b32 v189, v77
    v_swap_b32 v190, v78
    v_swap_b32 v191, v79
    s_getpc_b64 s[64:65]
L_pc_100:
    s_add_u32 s64, s64, L_fast_2-L_pc_100
    s_addc_u32 s65, s65, 0
    v_lshlrev_b32 v98, 2, v0
    v_min_u32 v98, L_code_end-L_fast_2-4, v98
    global_load_dword v99, v98, s[64:65]
    v_add_u32 v98, 4096, v98
    v_min_u32 v98, L_code_end-L_fast_2-4, v98
    global_load_dword v99, v98, s[64:65]
    s_branch L_pkj_97
L_pk3_93:
    v_swap_b32 v192, v48
    v_swap_b32 v193, v49
    v_swap_b32 v194, v50
    v_swap_b32 v195, v51
    v_swap_b32 v196, v52
    v_swap_b32 v197, v53
    v_swap_b32 v198, v54
    v_swap_b32 v199, v55
    v_swap_b32 v200, v56
    v_swap_b32 v201, v57
    v_swap_b32 v202, v58
    v_swap_b32 v203, v59
    v_swap_b32 v204, v60
    v_swap_b32 v205, v61
    v_swap_b32 v206, v62
    v_swap_b32 v207, v63
    v_swap_b32 v208, v64
    v_swap_b32 v209, v65
    v_swap_b32 v210, v66
    v_swap_b32 v211, v67
    v_swap_b32 v212, v68
    v_swap_b32 v213, v69
    v_swap_b32 v214, v70
    v_swap_b32 v215, v71
    v_swap_b32 v216, v72
    v_swap_b32 v217, v73
    v_swap_b32 v218, v74
    v_swap_b32 v219, v75
    v_swap_b32 v220, v76
    v_swap_b32 v221, v77
    v_swap_b32 v222, v78
    v_swap_b32 v223, v79
    s_getpc_b64 s[64:65]
L_pc_101:
    s_add_u32 s64, s64, L_fast_3-L_pc_101
    s_addc_u32 s65, s65, 0
    v_lshlrev_b32 v98, 2, v0
    v_min_u32 v98, L_code_end-L_fast_3-4, v98
    global_load_dword v99, v98, s[64:65]
    v_add_u32 v98, 4096, v98
    v_min_u32 v98, L_code_end-L_fast_3-4, v98
    global_load_dword v99, v98, s[64:65]
L_pkj_97:
    ds_read_b64_tr_b16 v[16:17], v124 offset:0
    ds_read_b64_tr_b16 v[18:19], v124 offset:1024
    ds_read_b64_tr_b16 a[224:225], v124 offset:256
    ds_read_b64_tr_b16 a[226:227], v124 offset:1280
    ds_read_b64_tr_b16 v[24:25], v124 offset:512
    ds_read_b64_tr_b16 v[26:27], v124 offset:1536
    ds_read_b64_tr_b16 v[28:29], v124 offset:768
    ds_read_b64_tr_b16 v[30:31], v124 offset:1792
    s_waitcnt vmcnt(14) lgkmcnt(0)
    s_barrier
    s_cmp_eq_u32 s35, 0
    s_cbranch_scc0 L_thr_102
    s_waitcnt vmcnt(4)
L_thr_102:
    s_add_u32 m0, s60, 20480
    s_mov_b32 s62, 73728
    buffer_load_dwordx4 v121, s[20:23], s62 offen  lds
    s_add_u32 m0, s60, 21504
    s_mov_b32 s62, 74752
    buffer_load_dwordx4 v121, s[20:23], s62 offen  lds
    s_add_u32 m0, s60, 22528
    s_mov_b32 s62, 90112
    buffer_load_dwordx4 v121, s[20:23], s62 offen  lds
    s_add_u32 m0, s60, 23552
    s_mov_b32 s62, 91136
    buffer_load_dwordx4 v121, s[20:23], s62 offen  lds
    ds_write_b128 v8, v[16:19] offset:0
    ds_write_b128 v8, v[48:51] offset:1024
    ds_write_b128 v8, v[24:27] offset:2048
    ds_write_b128 v8, v[28:31] offset:3072
    ds_read_b64_tr_b16 v[32:33], v124 offset:4096
    ds_read_b64_tr_b16 v[34:35], v124 offset:5120
    ds_read_b64_tr_b16 a[228:229], v124 offset:4352
    ds_read_b64_tr_b16 a[230:231], v124 offset:5376
    ds_read_b64_tr_b16 v[40:41], v124 offset:4608
    ds_read_b64_tr_b16 v[42:43], v124 offset:5632
    ds_read_b64_tr_b16 v[44:45], v124 offset:4864
    ds_read_b64_tr_b16 v[46:47], v124 offset:5888
    s_waitcnt vmcnt(14) lgkmcnt(0)
    s_barrier
    s_cmp_eq_u32 s35, 0
    s_cbranch_scc0 L_thr_103
    s_waitcnt vmcnt(4)
L_thr_103:
    s_add_u32 m0, s60, 24576
    s_mov_b32 s62, 98304
    buffer_load_dwordx4 v121, s[20:23], s62 offen  lds
    s_add_u32 m0, s60, 25600
    s_mov_b32 s62, 99328
    buffer_load_dwordx4 v121, s[20:23], s62 offen  lds
    s_add_u32 m0, s60, 26624
    s_mov_b32 s62, 114688
    buffer_load_dwordx4 v121, s[20:23], s62 offen  lds
    s_add_u32 m0, s60, 27648
    s_mov_b32 s62, 115712
    buffer_load_dwordx4 v121, s[20:23], s62 offen  lds
    s_and_b32 s64, s42, 0xffe00000
    s_add_u32 s8, s64, 4096
    s_mov_b32 s9, s43
    s_add_u32 s10, s64, 37376
    s_mov_b32 s11, s43
    s_mov_b32 s16, 162432
    s_lshl_b32 s62, s32, 8
    s_add_u32 s62, s62, 32768
    s_add_u32 s14, s4, s62
    s_addc_u32 s15, s5, 0
    s_mov_b64 s[18:19], 3
    s_mov_b32 s26, -1
    s_mov_b32 s27, 0
    s_mul_i32 s62, s32, 266240
    s_add_u32 s62, s62, 69206016
    s_add_u32 s12, s4, s62
    s_addc_u32 s13, s5, 0
    global_load_dword v11, v91, s[28:29] offset:0 sc1
    global_load_dword v97, v91, s[14:15] sc1
    ds_write_b128 v8, v[32:35] offset:4096
    ds_write_b128 v8, v[52:55] offset:5120
    ds_write_b128 v8, v[40:43] offset:6144
    ds_write_b128 v8, v[44:47] offset:7168
    ds_read_b64_tr_b16 v[16:17], v124 offset:8192
    ds_read_b64_tr_b16 v[18:19], v124 offset:9216
    ds_read_b64_tr_b16 a[232:233], v124 offset:8448
    ds_read_b64_tr_b16 a[234:235], v124 offset:9472
    ds_read_b64_tr_b16 v[24:25], v124 offset:8704
    ds_read_b64_tr_b16 v[26:27], v124 offset:9728
    ds_read_b64_tr_b16 v[28:29], v124 offset:8960
    ds_read_b64_tr_b16 v[30:31], v124 offset:9984
    s_waitcnt vmcnt(16) lgkmcnt(0)
    s_barrier
    s_cmp_eq_u32 s35, 0
    s_cbranch_scc0 L_thr_104
    s_waitcnt vmcnt(4)
L_thr_104:
    s_add_u32 m0, s60, 28672
    s_mov_b32 s62, 106496
    buffer_load_dwordx4 v121, s[20:23], s62 offen  lds
    s_add_u32 m0, s60, 29696
    s_mov_b32 s62, 107520
    buffer_load_dwordx4 v121, s[20:23], s62 offen  lds
    s_add_u32 m0, s60, 30720
    s_mov_b32 s62, 122880
    buffer_load_dwordx4 v121, s[20:23], s62 offen  lds
    s_add_u32 m0, s60, 31744
    s_mov_b32 s62, 123904
    buffer_load_dwordx4 v121, s[20:23], s62 offen  lds
    ds_write_b128 v8, v[16:19] offset:8192
    ds_write_b128 v8, v[56:59] offset:9216
    ds_write_b128 v8, v[24:27] offset:10240
    ds_write_b128 v8, v[28:31] offset:11264
    ds_read_b64_tr_b16 v[32:33], v124 offset:12288
    ds_read_b64_tr_b16 v[34:35], v124 offset:13312
    ds_read_b64_tr_b16 a[236:237], v124 offset:12544
    ds_read_b64_tr_b16 a[238:239], v124 offset:13568
    ds_read_b64_tr_b16 v[40:41], v124 offset:12800
    ds_read_b64_tr_b16 v[42:43], v124 offset:13824
    ds_read_b64_tr_b16 v[44:45], v124 offset:13056
    ds_read_b64_tr_b16 v[46:47], v124 offset:14080
    s_waitcnt vmcnt(16) lgkmcnt(0)
    s_barrier
    ds_write_b128 v8, v[32:35] offset:12288
    ds_write_b128 v8, v[60:63] offset:13312
    ds_write_b128 v8, v[40:43] offset:14336
    ds_write_b128 v8, v[44:47] offset:15360
    ds_read_b64_tr_b16 v[16:17], v124 offset:16384
    ds_read_b64_tr_b16 v[18:19], v124 offset:17408
    ds_read_b64_tr_b16 a[240:241], v124 offset:16640
    ds_read_b64_tr_b16 a[242:243], v124 offset:17664
    ds_read_b64_tr_b16 v[24:25], v124 offset:16896
    ds_read_b64_tr_b16 v[26:27], v124 offset:17920
    ds_read_b64_tr_b16 v[28:29], v124 offset:17152
    ds_read_b64_tr_b16 v[30:31], v124 offset:18176
    s_waitcnt vmcnt(10) lgkmcnt(0)
    s_barrier
    ds_write_b128 v8, v[16:19] offset:16384
    ds_write_b128 v8, v[64:67] offset:17408
    ds_write_b128 v8, v[24:27] offset:18432
    ds_write_b128 v8, v[28:31] offset:19456
    ds_read_b64_tr_b16 v[32:33], v124 offset:20480
    ds_read_b64_tr_b16 v[34:35], v124 offset:21504
    ds_read_b64_tr_b16 a[244:245], v124 offset:20736
    ds_read_b64_tr_b16 a[246:247], v124 offset:21760
    ds_read_b64_tr_b16 v[40:41], v124 offset:20992
    ds_read_b64_tr_b16 v[42:43], v124 offset:22016
    ds_read_b64_tr_b16 v[44:45], v124 offset:21248
    ds_read_b64_tr_b16 v[46:47], v124 offset:22272
    s_waitcnt vmcnt(6) lgkmcnt(0)
    s_barrier
    ds_write_b128 v8, v[32:35] offset:20480
    ds_write_b128 v8, v[68:71] offset:21504
    ds_write_b128 v8, v[40:43] offset:22528
    ds_write_b128 v8, v[44:47] offset:23552
    ds_read_b64_tr_b16 v[16:17], v124 offset:24576
    ds_read_b64_tr_b16 v[18:19], v124 offset:25600
    ds_read_b64_tr_b16 a[248:249], v124 offset:24832
    ds_read_b64_tr_b16 a[250:251], v124 offset:25856
    ds_read_b64_tr_b16 v[24:25], v124 offset:25088
    ds_read_b64_tr_b16 v[26:27], v124 offset:26112
    ds_read_b64_tr_b16 v[28:29], v124 offset:25344
    ds_read_b64_tr_b16 v[30:31], v124 offset:26368
    s_waitcnt vmcnt(0) lgkmcnt(0)
    s_barrier
    s_lshl_b32 s63, s33, 11
    s_add_u32 m0, s63, 0
    s_nop 0
    global_load_lds_dwordx4 v0, s[44:45] sc1
    global_load_lds_dwordx4 v0, s[44:45] offset:1024 sc1
    s_add_u32 m0, s63, 8192
    s_nop 0
    global_load_lds_dwordx4 v0, s[46:47] sc1
    global_load_lds_dwordx4 v0, s[46:47] offset:1024 sc1
    s_mov_b32 m0, 31104
    s_nop 0
    global_load_lds_dword v9, s[14:15] sc1
    ds_write_b128 v8, v[16:19] offset:24576
    ds_write_b128 v8, v[72:75] offset:25600
    ds_write_b128 v8, v[24:27] offset:26624
    ds_write_b128 v8, v[28:31] offset:27648
    ds_read_b64_tr_b16 v[32:33], v124 offset:28672
    ds_read_b64_tr_b16 v[34:35], v124 offset:29696
    ds_read_b64_tr_b16 a[252:253], v124 offset:28928
    ds_read_b64_tr_b16 a[254:255], v124 offset:29952
    ds_read_b64_tr_b16 v[40:41], v124 offset:29184
    ds_read_b64_tr_b16 v[42:43], v124 offset:30208
    ds_read_b64_tr_b16 v[44:45], v124 offset:29440
    ds_read_b64_tr_b16 v[46:47], v124 offset:30464
    s_waitcnt lgkmcnt(0)
    s_barrier
    ds_write_b128 v8, v[32:35] offset:28672
    ds_write_b128 v8, v[76:79] offset:29696
    ds_write_b128 v8, v[40:43] offset:30720
    ds_write_b128 v8, v[44:47] offset:31744
    v_cmp_eq_u32 vcc, 0, v97
    s_cbranch_vccz L_fqok_105
L_spin_106:
    global_load_dword v97, v91, s[14:15] sc1
    s_sub_u32 s50, s50, 1
    s_cselect_b64 s[48:49], 0, s[48:49]
    s_waitcnt vmcnt(0)
    v_cmp_eq_u32 vcc, 0, v97
    s_and_b64 vcc, vcc, s[48:49]
    s_cbranch_scc0 L_spino_107
    s_branch L_spin_106
L_spino_107:
    s_lshl_b32 s63, s33, 11
    s_add_u32 m0, s63, 0
    s_nop 0
    global_load_lds_dwordx4 v0, s[44:45] sc1
    global_load_lds_dwordx4 v0, s[44:45] offset:1024 sc1
    s_add_u32 m0, s63, 8192
    s_nop 0
    global_load_lds_dwordx4 v0, s[46:47] sc1
    global_load_lds_dwordx4 v0, s[46:47] offset:1024 sc1
    s_mov_b32 m0, 31104
    s_nop 0
    global_load_lds_dword v9, s[14:15] sc1
L_fqok_105:
    v_readfirstlane_b32 s3, v11
    v_mov_b64 v[96:97], 0
    v_mov_b64 v[98:99], 0
    v_mov_b64 v[100:101], 0
    v_mov_b64 v[102:103], 0
    v_mov_b64 v[104:105], 0
    v_mov_b64 v[106:107], 0
    v_mov_b64 v[108:109], 0
    v_mov_b64 v[110:111], 0
    v_mov_b64 v[112:113], 0
    v_mov_b64 v[114:115], 0
    v_mov_b64 v[116:117], 0
    v_mov_b64 v[118:119], 0
    v_mov_b64 v[86:87], 0
    v_mov_b64 v[94:95], 0
    s_add_u32 s44, s44, 16384
    s_addc_u32 s45, s45, 0
    s_add_u32 s46, s46, 16384
    s_addc_u32 s47, s47, 0
    s_cmp_eq_u32 s33, 1
    s_cbranch_scc0 L_nx_112
    s_branch L_chain_w1_109
L_nx_112:
    s_cmp_eq_u32 s33, 2
    s_cbranch_scc0 L_nx_113
    s_branch L_chain_w2_110
L_nx_113:
    s_cmp_eq_u32 s33, 3
    s_cbranch_scc0 L_nx_114
    s_branch L_chain_w3_111
L_nx_114:
L_chain_w0_108:
    s_waitcnt vmcnt(0) lgkmcnt(0)
    s_cmp_lt_u32 s3, 32
    s_cbranch_scc1 L_slow_115
    s_branch L_fast_0
L_slow_115:
L_step_117:
    v_mov_b32 v10, 0
    s_xor_b32 s51, s51, 1
    s_xor_b32 s42, s42, 65536
    s_nop 0
    s_cmp_eq_u32 s34, 63
    s_barrier
    s_cbranch_scc1 L_exit_118
    v_mov_b32 v10, 0
    global_load_dwordx4 v[16:19], v0, s[40:41] offset:-2048 sc1
    ds_read_b64 v[80:81], v0 offset:8192
    ds_read_b64 v[84:85], v0 offset:8200
    ds_read_b64 v[88:89], v0 offset:9216
    ds_read_b64 v[92:93], v0 offset:9224
    v_mov_b32 v10, 0
    s_nop 4
    v_mov_b32 v10, 0
    s_nop 4
    global_load_dwordx4 v[20:23], v0, s[40:41] offset:2048 sc1
    v_mov_b32 v10, 0
    s_nop 4
    v_mov_b32 v10, 0
    s_nop 4
    v_mov_b32 v10, 0
    s_nop 4
    v_mov_b32 v10, 0
    s_nop 1
    global_load_dwordx4 v[16:19], v0, s[40:41] offset:-2048 sc1
    v_mov_b32 v10, 0
    s_nop 4
    v_mov_b32 v10, 0
    s_nop 4
    v_mov_b32 v10, 0
    s_nop 3
    global_load_dwordx4 v[20:23], v0, s[40:41] offset:2048 sc1
    s_waitcnt vmcnt(3) lgkmcnt(0)
L_h2ca_123:
    v_maximum3_f32 v11, v16, v17, v18
    v_cmp_u_f32 vcc, v11, v19
    v_smfmac_f32_16x16x64_bf16 v[96:99], v[16:19], v[48:55], v1
    ds_write_b128 v0, v[16:19] offset:16384
    v_smfmac_f32_16x16x64_bf16 v[100:103], v[16:19], v[56:63], v1
    s_cbranch_vccnz L_h2a_121
L_h2cc_125:
    v_smfmac_f32_16x16x64_bf16 v[104:107], v[16:19], v[64:71], v1
    s_waitcnt vmcnt(2)
    v_maximum3_f32 v11, v20, v21, v22
    v_cmp_u_f32 vcc, v11, v23
    v_smfmac_f32_16x16x64_bf16 v[108:111], v[16:19], v[72:79], v1
    ds_read_b128 v[48:51], v0 offset:0
    v_mov_b32 v122, -1
    v_smfmac_f32_16x16x64_bf16 v[112:115], v[16:19], a[96:103], v1
    ds_read_b128 v[52:55], v0 offset:1024
    s_mov_b32 m0, 18432
    v_smfmac_f32_16x16x64_bf16 v[116:119], v[16:19], a[104:111], v1
    s_cbranch_vccnz L_h2b_122
L_h2cb_124:
    global_load_lds_dwordx4 v0, s[40:41] offset:2048 sc1
    v_smfmac_f32_16x16x64_bf16 v[96:99], v[20:23], v[224:231], v1
    s_waitcnt lgkmcnt(2)
    s_barrier
    v_smfmac_f32_16x16x64_bf16 v[100:103], v[20:23], v[232:239], v1
    ds_read_b128 v[24:27], v0 offset:17408
    s_mov_b32 m0, 8192
    v_smfmac_f32_16x16x64_bf16 v[104:107], v[20:23], v[240:247], v1
    global_store_dword v3, v122, s[42:43] offset:0 sc1
    ds_read_b128 v[28:31], v0 offset:18432
    v_smfmac_f32_16x16x64_bf16 v[108:111], v[20:23], v[248:255], v1
    ds_read_b128 v[32:35], v0 offset:19456
    v_add_u32 v10, 28928, v9
    v_smfmac_f32_16x16x64_bf16 v[112:115], v[20:23], a[160:167], v1
    ds_read_b128 v[56:59], v0 offset:2048
    v_smfmac_f32_16x16x64_bf16 v[116:119], v[20:23], a[168:175], v1
    ds_read_b128 v[60:63], v0 offset:3072
    s_waitcnt lgkmcnt(4)
    v_smfmac_f32_16x16x64_bf16 v[96:99], v[24:27], v[128:135], v1
    global_load_lds_dwordx4 v0, s[46:47] sc1
    ds_read_b128 v[64:67], v0 offset:4096
    v_smfmac_f32_16x16x64_bf16 v[100:103], v[24:27], v[136:143], v1
    ds_read_b128 v[68:71], v0 offset:5120
    v_smfmac_f32_16x16x64_bf16 v[104:107], v[24:27], v[144:151], v1
    global_store_dword v9, v82, s[12:13] offset:2048 sc1
    ds_read_b128 v[72:75], v0 offset:6144
    v_smfmac_f32_16x16x64_bf16 v[108:111], v[24:27], v[152:159], v1
    ds_read_b128 v[76:79], v0 offset:7168
    s_waitcnt lgkmcnt(6)
    v_smfmac_f32_16x16x64_bf16 v[96:99], v[28:31], v[160:167], v1
    global_load_lds_dwordx4 v0, s[46:47] offset:1024 sc1
    s_mov_b32 m0, 0
    v_smfmac_f32_16x16x64_bf16 v[100:103], v[28:31], v[168:175], v1
    ds_read2_b32 v[124:125], v10 offset0:0 offset1:68
    v_smfmac_f32_16x16x64_bf16 v[104:107], v[28:31], v[176:183], v1
    global_store_dword v9, v90, s[12:13] offset:2304 sc1
    v_smfmac_f32_16x16x64_bf16 v[108:111], v[28:31], v[184:191], v1
    v_smfmac_f32_16x16x64_bf16 v[96:99], v[32:35], v[192:199], v1
    s_waitcnt vmcnt(5) lgkmcnt(0)
    s_barrier
    v_smfmac_f32_16x16x64_bf16 v[100:103], v[32:35], v[200:207], v1
    global_load_lds_dwordx4 v0, s[44:45] sc1
    ds_read_b128 v[36:39], v0 offset:21504
    v_smfmac_f32_16x16x64_bf16 v[104:107], v[32:35], v[208:215], v1
    global_store_dword v9, v124, s[12:13] offset:0 sc1
    ds_read_b128 v[40:43], v0 offset:22528
    v_smfmac_f32_16x16x64_bf16 v[108:111], v[32:35], v[216:223], v1
    ds_read_b128 v[44:47], v0 offset:23552
    s_waitcnt lgkmcnt(2)
    v_smfmac_f32_16x16x64_bf16 v[96:99], v[36:39], a[0:7], v1
    global_store_dword v9, v125, s[12:13] offset:256 sc1
    v_smfmac_f32_16x16x64_bf16 v[100:103], v[36:39], a[8:15], v1
    global_load_lds_dwordx4 v0, s[44:45] offset:1024 sc1
    s_waitcnt lgkmcnt(0)
    v_smfmac_f32_16x16x64_bf16 v[96:99], v[40:43], a[32:39], v1
    s_cmp_ge_u32 s34, 62
    v_smfmac_f32_16x16x64_bf16 v[96:99], v[44:47], a[64:71], v1
    v_smfmac_f32_16x16x64_bf16 v[100:103], v[40:43], a[40:47], v1
    v_smfmac_f32_16x16x64_bf16 v[100:103], v[44:47], a[72:79], v1
    v_add_f32 v96, v96, v98
    v_smfmac_f32_16x16x64_bf16 v[104:107], v[36:39], a[16:23], v1
    v_add_f32 v97, v97, v99
    v_smfmac_f32_16x16x64_bf16 v[104:107], v[40:43], a[48:55], v1
    v_add_f32 v100, v100, v102
    v_add_f32 v101, v101, v103
    v_smfmac_f32_16x16x64_bf16 v[104:107], v[44:47], a[80:87], v1
    v_cvt_pk_bf16_f32 v96, v96, v100
    v_smfmac_f32_16x16x64_bf16 v[108:111], v[36:39], a[24:31], v1
    v_cvt_pk_bf16_f32 v97, v97, v101
    v_smfmac_f32_16x16x64_bf16 v[108:111], v[40:43], a[56:63], v1
    ds_write2_b32 v4, v96, v97 offset0:0 offset1:136
    v_smfmac_f32_16x16x64_bf16 v[108:111], v[44:47], a[88:95], v1
    v_add_f32 v104, v104, v106
    v_smfmac_f32_16x16x64_bf16 v[112:115], v[24:27], a[112:119], v1
    v_add_f32 v105, v105, v107
    v_smfmac_f32_16x16x64_bf16 v[116:119], v[24:27], a[120:127], v1
    ds_read_b128 v[24:27], v8 offset:2048
    v_add_f32 v108, v108, v110
    v_smfmac_f32_16x16x64_bf16 v[112:115], v[28:31], a[128:135], v1
    v_add_f32 v109, v109, v111
    v_smfmac_f32_16x16x64_bf16 v[116:119], v[28:31], a[136:143], v1
    s_waitcnt vmcnt(9) lgkmcnt(1)
    s_barrier
    v_smfmac_f32_16x16x64_bf16 v[112:115], v[32:35], a[144:151], v1
    ds_read_b128 v[120:123], v6 offset:0
    v_cvt_pk_bf16_f32 v10, v104, v108
    v_smfmac_f32_16x16x64_bf16 v[116:119], v[32:35], a[152:159], v1
    ds_read_b128 v[124:127], v6 offset:64
    v_cvt_pk_bf16_f32 v11, v105, v109
    v_smfmac_f32_16x16x64_bf16 v[112:115], v[36:39], a[176:183], v1
    ds_write2_b32 v5, v10, v11 offset0:0 offset1:4
    v_smfmac_f32_16x16x64_bf16 v[116:119], v[36:39], a[184:191], v1
    ds_read_b128 v[16:19], v6 offset:128
    v_mov_b64 v[104:105], 0
    v_smfmac_f32_16x16x64_bf16 v[112:115], v[40:43], a[192:199], v1
    ds_read_b128 v[20:23], v6 offset:192
    v_mov_b64 v[106:107], 0
    v_smfmac_f32_16x16x64_bf16 v[116:119], v[40:43], a[200:207], v1
    ds_read_b128 v[28:31], v8 offset:6144
    v_mov_b64 v[108:109], 0
    v_smfmac_f32_16x16x64_bf16 v[112:115], v[44:47], a[208:215], v1
    ds_read_b128 v[32:35], v8 offset:10240
    v_mov_b64 v[110:111], 0
    v_smfmac_f32_16x16x64_bf16 v[116:119], v[44:47], a[216:223], v1
    ds_read_b128 v[36:39], v8 offset:14336
    s_waitcnt lgkmcnt(6)
    v_mfma_f32_16x16x32_bf16 v[96:99], v[48:51], v[120:123], 0
    s_waitcnt lgkmcnt(5)
    s_barrier
    v_mfma_f32_16x16x32_bf16 v[100:103], v[64:67], v[120:123], 0
    ds_read_b128 v[40:43], v7 offset:0
    v_add_f32 v112, v112, v114
    v_mfma_f32_16x16x32_bf16 v[96:99], v[52:55], v[124:127], v[96:99]
    ds_read_b128 v[44:47], v7 offset:1088
    v_add_f32 v113, v113, v115
    v_mfma_f32_16x16x32_bf16 v[100:103], v[68:71], v[124:127], v[100:103]
    s_waitcnt lgkmcnt(5)
    v_add_f32 v116, v116, v118
    v_add_f32 v117, v117, v119
    v_mfma_f32_16x16x32_bf16 v[96:99], v[56:59], v[16:19], v[96:99]
    ds_read_b128 v[48:51], v8 offset:0
    v_cvt_pk_bf16_f32 v82, v112, v113
    v_mfma_f32_16x16x32_bf16 v[96:99], v[60:63], v[20:23], v[96:99]
    ds_read_b128 v[64:67], v8 offset:16384
    v_cvt_pk_bf16_f32 v90, v116, v117
    v_mfma_f32_16x16x32_bf16 v[100:103], v[72:75], v[16:19], v[100:103]
    ds_read_b128 v[52:55], v8 offset:4096
    v_cvt_pk_bf16_f32 v94, v116, v117
    v_mfma_f32_16x16x32_bf16 v[100:103], v[76:79], v[20:23], v[100:103]
    s_waitcnt lgkmcnt(3)
    v_cvt_pk_bf16_f32 v86, v112, v113
    v_max3_f32 v10, v96, v97, v98
    v_smfmac_f32_16x16x64_bf16 v[104:107], v[40:43], v[120:127], v1
    ds_read_b128 v[68:71], v8 offset:20480
    v_cndmask_b32 v96, v96, v98, s[52:53]
    v_smfmac_f32_16x16x64_bf16 v[104:107], v[44:47], v[16:23], v1
    ds_read_b128 v[56:59], v8 offset:8192
    s_nop 0
    v_cndmask_b32 v97, v97, v99, s[52:53]
    v_max3_f32 v10, v10, v99, v100
    v_max3_f32 v10, v10, v101, v102
    v_cndmask_b32 v98, v100, v102, s[52:53]
    v_cndmask_b32 v99, v101, v103, s[52:53]
    v_max_f32 v10, v10, v103
    v_pk_add_f32 v[104:105], v[104:105], v[106:107]
    v_max3_f32 v11, v10, v104, v105
    v_max3_f32 v10, v10, v104, v105
    v_cndmask_b32 v104, v104, v105, s[52:53]
    v_mov_b64 v[120:121], s[54:55]
    v_permlane32_swap_b32 v10, v11
    v_max_f32 v106, v10, v11
    v_max_f32 v107, v10, v11
    v_mov_b64 v[122:123], s[56:57]
    v_mov_b64 v[116:117], 0
    v_permlane16_swap_b32 v106, v107
    v_max_f32 v10, v106, v107
    v_mul_f32 v10, s61, v10
    v_pk_fma_f32 v[96:97], v[96:97], s[58:59], v[10:11] op_sel_hi:[1,1,0]
    v_pk_fma_f32 v[98:99], v[98:99], s[58:59], v[10:11] op_sel_hi:[1,1,0]
    v_fma_f32 v104, v104, s58, v10
    v_exp_f32 v96, v96
    v_exp_f32 v97, v97
    v_exp_f32 v98, v98
    v_exp_f32 v99, v99
    v_exp_f32 v104, v104
    v_cvt_pk_bf16_f32 v100, v96, v97
    v_cvt_pk_bf16_f32 v102, v98, v99
    v_cvt_pk_bf16_f32 v101, v104, 0
    v_cvt_pk_bf16_f32 v103, v104, 0
    v_mov_b64 v[118:119], 0
    s_nop 0
    v_mfma_f32_16x16x32_bf16 v[112:115], v[100:103], v[120:123], 0
    ds_read_b128 v[60:63], v8 offset:12288
    ds_read_b128 v[72:75], v8 offset:24576
    v_smfmac_f32_16x16x64_bf16 v[108:111], v[100:103], v[80:87], v1 abid:1
    ds_read_b128 v[76:79], v8 offset:28672
    ds_read_b128 v[16:19], v8 offset:18432
    v_smfmac_f32_16x16x64_bf16 v[116:119], v[100:103], v[88:95], v1 abid:1
    ds_read_b128 v[20:23], v8 offset:22528
    s_nop 0
    v_add_f32 v112, v112, v114
    v_add_f32 v113, v113, v115
    v_rcp_f32 v112, v112
    v_rcp_f32 v113, v113
    v_pk_add_f32 v[108:109], v[108:109], v[110:111]
    v_pk_mul_f32 v[108:109], v[108:109], v[112:113]
    v_pk_add_f32 v[116:117], v[116:117], v[118:119]
    v_pk_mul_f32 v[116:117], v[116:117], v[112:113]
    v_cvt_pk_bf16_f32 v10, v108, v116
    v_cvt_pk_bf16_f32 v11, v109, v117
    ds_write2_b32 v4, v10, v11 offset0:64 offset1:200
    ds_read_b128 v[96:99], v6 offset:256
    v_mov_b64 v[112:113], 0
    v_mov_b64 v[114:115], 0
    v_mov_b64 v[116:117], 0
    v_mov_b64 v[118:119], 0
    s_cbranch_scc1 L_last_126
L_lastb_127:
    v_mov_b64 v[84:85], 0
    v_mov_b64 v[86:87], 0
    v_mov_b64 v[92:93], 0
    v_mov_b64 v[94:95], 0
    s_waitcnt vmcnt(8) lgkmcnt(1)
    s_barrier
    ds_read_b128 v[100:103], v6 offset:320
    ds_read_b128 v[104:107], v6 offset:384
    ds_read_b128 v[108:111], v6 offset:448
    s_waitcnt lgkmcnt(3)
    v_smfmac_f32_16x16x64_bf16 v[112:115], v[96:99], v[48:55], v1
    ds_read_b128 v[40:43], v8 offset:26624
    v_smfmac_f32_16x16x64_bf16 v[116:119], v[96:99], a[224:231], v1
    ds_read_b128 v[44:47], v8 offset:30720
    v_smfmac_f32_16x16x64_bf16 v[84:87], v[96:99], v[24:31], v1
    ds_read_b128 v[48:51], v8 offset:3072
    s_waitcnt lgkmcnt(5)
    v_smfmac_f32_16x16x64_bf16 v[112:115], v[100:103], v[56:63], v1
    ds_read_b128 v[52:55], v8 offset:7168
    s_waitcnt lgkmcnt(5)
    v_smfmac_f32_16x16x64_bf16 v[112:115], v[104:107], v[64:71], v1
    ds_read_b128 v[56:59], v8 offset:11264
    s_waitcnt lgkmcnt(5)
    v_smfmac_f32_16x16x64_bf16 v[112:115], v[108:111], v[72:79], v1
    ds_read_b128 v[60:63], v8 offset:15360
    v_smfmac_f32_16x16x64_bf16 v[116:119], v[100:103], a[232:239], v1
    ds_read_b128 v[64:67], v8 offset:19456
    v_smfmac_f32_16x16x64_bf16 v[116:119], v[104:107], a[240:247], v1
    ds_read_b128 v[68:71], v8 offset:23552
    v_cvt_pk_bf16_f32 v112, v112, v114
    v_and_or_b32 v112, v112, -2, s51
    v_smfmac_f32_16x16x64_bf16 v[116:119], v[108:111], a[248:255], v1
    global_store_dword v2, v112, s[8:9] offset:-4096 sc1
    v_cvt_pk_bf16_f32 v113, v113, v115
    v_and_or_b32 v113, v113, -2, s51
    v_smfmac_f32_16x16x64_bf16 v[84:87], v[100:103], v[32:39], v1
    global_store_dword v2, v113, s[10:11] offset:-4096 sc1
    ds_read_b128 v[72:75], v8 offset:27648
    v_smfmac_f32_16x16x64_bf16 v[84:87], v[104:107], v[16:23], v1
    ds_read_b128 v[76:79], v8 offset:31744
    s_waitcnt lgkmcnt(8)
    v_cvt_pk_bf16_f32 v116, v116, v118
    v_and_or_b32 v116, v116, -2, s51
    v_smfmac_f32_16x16x64_bf16 v[84:87], v[108:111], v[40:47], v1
    global_store_dword v2, v116, s[8:9] offset:-2048 sc1
    s_waitcnt lgkmcnt(6)
    v_cvt_pk_bf16_f32 v117, v117, v119
    v_and_or_b32 v117, v117, -2, s51
    v_smfmac_f32_16x16x64_bf16 v[92:95], v[96:99], v[48:55], v1
    global_store_dword v2, v117, s[10:11] offset:-2048 sc1
    s_waitcnt lgkmcnt(4)
    v_smfmac_f32_16x16x64_bf16 v[92:95], v[100:103], v[56:63], v1
    s_waitcnt lgkmcnt(2)
    v_cvt_pk_bf16_f32 v84, v84, v86
    v_and_or_b32 v84, v84, -2, s51
    v_smfmac_f32_16x16x64_bf16 v[92:95], v[104:107], v[64:71], v1
    global_store_dword v2, v84, s[8:9] offset:0 sc1
    s_waitcnt lgkmcnt(0)
    v_cvt_pk_bf16_f32 v85, v85, v87
    v_and_or_b32 v85, v85, -2, s51
    v_smfmac_f32_16x16x64_bf16 v[92:95], v[108:111], v[72:79], v1
    global_store_dword v2, v85, s[10:11] offset:0 sc1
    s_nop 0
    v_mov_b64 v[96:97], 0
    v_mov_b64 v[98:99], 0
    v_mov_b64 v[100:101], 0
    v_mov_b64 v[102:103], 0
    v_mov_b64 v[104:105], 0
    v_mov_b64 v[106:107], 0
    v_cvt_pk_bf16_f32 v92, v92, v94
    v_and_or_b32 v92, v92, -2, s51
    v_cvt_pk_bf16_f32 v93, v93, v95
    v_and_or_b32 v93, v93, -2, s51
    v_mov_b64 v[108:109], 0
    s_add_u32 s12, s12, 4096
    s_addc_u32 s13, s13, 0
    s_add_u32 s34, s34, 1
    global_store_dword v2, v92, s[8:9] offset:2048 sc1
    global_store_dword v2, v93, s[10:11] offset:2048 sc1
    v_mov_b64 v[110:111], 0
    s_add_u32 s44, s44, 16384
    s_addc_u32 s45, s45, 0
    s_add_u32 s46, s46, 16384
    s_addc_u32 s47, s47, 0
    s_xor_b32 s40, s40, 65536
    v_mov_b64 v[112:113], 0
    s_nop 4
    v_mov_b64 v[114:115], 0
    s_nop 4
    v_mov_b64 v[116:117], 0
    s_nop 4
    v_mov_b64 v[118:119], 0
    global_load_dword v120, v9, s[36:37] offset:0 sc1
    global_load_dword v121, v9, s[36:37] offset:256 sc1
    global_load_dword v122, v9, s[36:37] offset:512 sc1
    global_load_dword v123, v9, s[36:37] offset:768 sc1
    global_load_dword v124, v9, s[36:37] offset:1024 sc1
    global_load_dword v125, v9, s[36:37] offset:1280 sc1
    global_load_dword v126, v9, s[36:37] offset:1536 sc1
    global_load_dword v127, v9, s[36:37] offset:1792 sc1
    ds_read_b128 v[48:51], v8 offset:1024
    ds_read_b128 v[52:55], v8 offset:5120
    v_mov_b64 v[86:87], 0
    s_nop 1
    ds_read_b128 v[56:59], v8 offset:9216
    ds_read_b128 v[60:63], v8 offset:13312
    v_mov_b64 v[94:95], 0
    s_nop 1
    ds_read_b128 v[64:67], v8 offset:17408
    ds_read_b128 v[68:71], v8 offset:21504
    v_mov_b32 v10, 0
    s_nop 1
    ds_read_b128 v[72:75], v8 offset:25600
    ds_read_b128 v[76:79], v8 offset:29696
    v_mov_b32 v10, 0
    s_nop 1
    s_cmp_eq_u32 s51, 0
    s_cbranch_scc1 L_tag0_128
    s_waitcnt vmcnt(4)
    v_bitop3_b32 v10, v120, v121, v122 bitop3:0x80
    v_bitop3_b32 v10, v10, v123, 1 bitop3:0x80
    v_mfma_f32_16x16x32_bf16 v[32:35], v[12:15], v[120:123], 0
    s_waitcnt vmcnt(0)
    v_bitop3_b32 v10, v10, v124, v125 bitop3:0x80
    v_bitop3_b32 v10, v10, v126, v127 bitop3:0x80
    v_mfma_f32_16x16x32_bf16 v[32:35], v[12:15], v[124:127], v[32:35]
    s_nop 0
    v_cmp_ne_u32 vcc, 1, v10
    s_nop 0
    s_mov_b64 exec, s[26:27]
    s_nop 2
    s_cbranch_vccnz L_h1r_129
    v_cvt_pk_bf16_f32 v11, v32, v33
    global_store_dword v3, v11, s[42:43] offset:0 sc1
    s_mov_b64 exec, -1
    s_branch L_step_117
L_h1r_129:
    s_mov_b64 exec, -1
    global_load_dword v120, v9, s[36:37] offset:0 sc1
    global_load_dword v121, v9, s[36:37] offset:256 sc1
    global_load_dword v122, v9, s[36:37] offset:512 sc1
    global_load_dword v123, v9, s[36:37] offset:768 sc1
    global_load_dword v124, v9, s[36:37] offset:1024 sc1
    global_load_dword v125, v9, s[36:37] offset:1280 sc1
    global_load_dword v126, v9, s[36:37] offset:1536 sc1
    global_load_dword v127, v9, s[36:37] offset:1792 sc1
    s_sub_u32 s50, s50, 1
    s_cselect_b64 s[48:49], 0, s[48:49]
    s_waitcnt vmcnt(8)
    v_bitop3_b32 v10, v120, v121, v122 bitop3:0x80
    v_bitop3_b32 v10, v10, v123, 1 bitop3:0x80
    v_mfma_f32_16x16x32_bf16 v[32:35], v[12:15], v[120:123], 0
    s_nop 0
    v_bitop3_b32 v10, v10, v124, v125 bitop3:0x80
    v_bitop3_b32 v10, v10, v126, v127 bitop3:0x80
    v_mfma_f32_16x16x32_bf16 v[32:35], v[12:15], v[124:127], v[32:35]
    s_nop 0
    v_cmp_ne_u32 vcc, 1, v10
    s_nop 0
    s_mov_b64 exec, s[26:27]
    s_nop 1
    s_and_b64 vcc, vcc, s[48:49]
    s_cbranch_scc1 L_h1r_129
    v_cvt_pk_bf16_f32 v11, v32, v33
    global_store_dword v3, v11, s[42:43] offset:0 sc1
    s_mov_b64 exec, -1
    s_branch L_step_117
L_tag0_128:
    s_waitcnt vmcnt(4)
    v_bitop3_b32 v10, v120, v121, v122 bitop3:0x01
    v_bitop3_b32 v10, v10, v123, 1 bitop3:0x20
    v_mfma_f32_16x16x32_bf16 v[32:35], v[12:15], v[120:123], 0
    s_waitcnt vmcnt(0)
    v_bitop3_b32 v10, v10, v124, v125 bitop3:0x10
    v_bitop3_b32 v10, v10, v126, v127 bitop3:0x10
    v_mfma_f32_16x16x32_bf16 v[32:35], v[12:15], v[124:127], v[32:35]
    s_nop 0
    v_cmp_ne_u32 vcc, 1, v10
    s_nop 0
    s_mov_b64 exec, s[26:27]
    s_nop 2
    s_cbranch_vccnz L_h1r_130
    v_cvt_pk_bf16_f32 v11, v32, v33
    global_store_dword v3, v11, s[42:43] offset:0 sc1
    s_mov_b64 exec, -1
    s_branch L_step_117
L_h1r_130:
    s_mov_b64 exec, -1
    global_load_dword v120, v9, s[36:37] offset:0 sc1
    global_load_dword v121, v9, s[36:37] offset:256 sc1
    global_load_dword v122, v9, s[36:37] offset:512 sc1
    global_load_dword v123, v9, s[36:37] offset:768 sc1
    global_load_dword v124, v9, s[36:37] offset:1024 sc1
    global_load_dword v125, v9, s[36:37] offset:1280 sc1
    global_load_dword v126, v9, s[36:37] offset:1536 sc1
    global_load_dword v127, v9, s[36:37] offset:1792 sc1
    s_sub_u32 s50, s50, 1
    s_cselect_b64 s[48:49], 0, s[48:49]
    s_waitcnt vmcnt(8)
    v_bitop3_b32 v10, v120, v121, v122 bitop3:0x01
    v_bitop3_b32 v10, v10, v123, 1 bitop3:0x20
    v_mfma_f32_16x16x32_bf16 v[32:35], v[12:15], v[120:123], 0
    s_nop 0
    v_bitop3_b32 v10, v10, v124, v125 bitop3:0x10
    v_bitop3_b32 v10, v10, v126, v127 bitop3:0x10
    v_mfma_f32_16x16x32_bf16 v[32:35], v[12:15], v[124:127], v[32:35]
    s_nop 0
    v_cmp_ne_u32 vcc, 1, v10
    s_nop 0
    s_mov_b64 exec, s[26:27]
    s_nop 1
    s_and_b64 vcc, vcc, s[48:49]
    s_cbranch_scc1 L_h1r_130
    v_cvt_pk_bf16_f32 v11, v32, v33
    global_store_dword v3, v11, s[42:43] offset:0 sc1
    s_mov_b64 exec, -1
    s_branch L_step_117
L_last_126:
    v_add_u32 v10, 28928, v9
    ds_read2_b32 v[124:125], v10 offset0:0 offset1:68
    s_add_u32 s12, s12, 4096
    s_addc_u32 s13, s13, 0
    global_store_dword v9, v82, s[12:13] offset:2048 sc1
    global_store_dword v9, v90, s[12:13] offset:2304 sc1
    s_waitcnt lgkmcnt(0)
    global_store_dword v9, v124, s[12:13] offset:0 sc1
    global_store_dword v9, v125, s[12:13] offset:256 sc1
    s_cmp_eq_u32 s34, 63
    s_cbranch_scc1 L_exit_118
    s_sub_u32 s12, s12, 4096
    s_subb_u32 s13, s13, 0
    s_getpc_b64 s[64:65]
L_pc_131:
    s_add_u32 s64, s64, L_fin_0-L_pc_131
    s_addc_u32 s65, s65, 0
    v_lshlrev_b32 v126, 2, v0
    v_min_u32 v126, L_code_end-L_fin_0-4, v126
    global_load_dword v127, v126, s[64:65]
    s_branch L_lastb_127
L_h2a_121:
    global_load_dwordx4 v[16:19], v0, s[40:41] offset:-2048 sc1
    global_load_dwordx4 v[20:23], v0, s[40:41] offset:2048 sc1
    s_nop 4
    v_mov_b64 v[96:97], 0
    v_mov_b64 v[98:99], 0
    v_mov_b64 v[100:101], 0
    v_mov_b64 v[102:103], 0
    s_waitcnt vmcnt(3)
    v_maximum3_f32 v11, v16, v17, v18
    v_cmp_u_f32 vcc, v11, v19
    v_smfmac_f32_16x16x64_bf16 v[96:99], v[16:19], v[48:55], v1
    ds_write_b128 v0, v[16:19] offset:16384
    v_smfmac_f32_16x16x64_bf16 v[100:103], v[16:19], v[56:63], v1
    s_cbranch_vccz L_h2cc_125
L_h2l2_132:
    global_load_dwordx4 v[16:19], v0, s[40:41] offset:-2048 sc1
    global_load_dwordx4 v[20:23], v0, s[40:41] offset:2048 sc1
    s_sub_u32 s2, s2, 1
    s_cselect_b64 s[38:39], 0, s[38:39]
    s_nop 2
    v_mov_b64 v[96:97], 0
    v_mov_b64 v[98:99], 0
    v_mov_b64 v[100:101], 0
    v_mov_b64 v[102:103], 0
    s_waitcnt vmcnt(3)
    v_maximum3_f32 v11, v16, v17, v18
    v_cmp_u_f32 vcc, v11, v19
    v_smfmac_f32_16x16x64_bf16 v[96:99], v[16:19], v[48:55], v1
    ds_write_b128 v0, v[16:19] offset:16384
    v_smfmac_f32_16x16x64_bf16 v[100:103], v[16:19], v[56:63], v1
    s_and_b64 vcc, vcc, s[38:39]
    s_cbranch_scc0 L_h2cc_125
    s_branch L_h2l2_132
    global_load_dwordx4 v[16:19], v0, s[40:41] offset:-2048 sc1
    global_load_dwordx4 v[20:23], v0, s[40:41] offset:2048 sc1
    s_sub_u32 s2, s2, 1
    s_cselect_b64 s[38:39], 0, s[38:39]
    s_cmp_eq_u64 s[38:39], 0
    s_cbranch_scc1 L_h2cc_125
    s_nop 2
    v_mov_b64 v[96:97], 0
    v_mov_b64 v[98:99], 0
    v_mov_b64 v[100:101], 0
    v_mov_b64 v[102:103], 0
    s_waitcnt vmcnt(3)
    s_branch L_h2ca_123
L_h2b_122:
    global_load_dwordx4 v[20:23], v0, s[40:41] offset:2048 sc1
    s_sub_u32 s2, s2, 1
    s_cselect_b64 s[38:39], 0, s[38:39]
    s_waitcnt vmcnt(1)
    v_maximum3_f32 v11, v20, v21, v22
    v_cmp_u_f32 vcc, v11, v23
    s_and_b64 vcc, vcc, s[38:39]
    s_cbranch_scc0 L_h2cb_124
    s_branch L_h2b_122
L_exit_118:
    s_branch L_done_116
.p2align 6
L_fast_0:
L_step_133:
    v_mov_b32 v10, 0
    s_xor_b32 s51, s51, 1
    s_xor_b32 s42, s42, 65536
    s_nop 0
    s_cmp_eq_u32 s34, 63
    s_barrier
    s_cbranch_scc1 L_exit_134
    v_mov_b32 v10, 0
    global_load_dwordx4 v[16:19], v0, s[40:41] offset:-2048 sc1
    ds_read_b64 v[80:81], v0 offset:8192
    ds_read_b64 v[84:85], v0 offset:8200
    ds_read_b64 v[88:89], v0 offset:9216
    ds_read_b64 v[92:93], v0 offset:9224
    v_mov_b32 v10, 0
    s_nop 4
    v_mov_b32 v10, 0
    s_nop 4
    global_load_dwordx4 v[20:23], v0, s[40:41] offset:2048 sc1
    v_mov_b32 v10, 0
    s_nop 4
    v_mov_b32 v10, 0
    s_nop 4
    v_mov_b32 v10, 0
    s_nop 4
    v_mov_b32 v10, 0
    s_nop 1
    global_load_dwordx4 v[16:19], v0, s[40:41] offset:-2048 sc1
    v_mov_b32 v10, 0
    s_nop 4
    v_mov_b32 v10, 0
    s_nop 4
    v_mov_b32 v10, 0
    s_nop 3
    global_load_dwordx4 v[20:23], v0, s[40:41] offset:2048 sc1
    s_waitcnt vmcnt(3) lgkmcnt(0)
L_h2ca_139:
    v_maximum3_f32 v11, v16, v17, v18
    v_cmp_u_f32 vcc, v11, v19
    v_smfmac_f32_16x16x64_bf16 v[96:99], v[16:19], v[48:55], v1
    ds_write_b128 v0, v[16:19] offset:16384
    v_smfmac_f32_16x16x64_bf16 v[100:103], v[16:19], v[56:63], v1
    s_cbranch_vccnz L_h2a_137
L_h2cc_141:
    v_smfmac_f32_16x16x64_bf16 v[104:107], v[16:19], v[64:71], v1
    s_waitcnt vmcnt(2)
    v_maximum3_f32 v11, v20, v21, v22
    v_cmp_u_f32 vcc, v11, v23
    v_smfmac_f32_16x16x64_bf16 v[108:111], v[16:19], v[72:79], v1
    ds_read_b128 v[48:51], v0 offset:0
    v_mov_b32 v122, -1
    v_smfmac_f32_16x16x64_bf16 v[112:115], v[16:19], a[96:103], v1
    ds_read_b128 v[52:55], v0 offset:1024
    s_mov_b32 m0, 18432
    v_smfmac_f32_16x16x64_bf16 v[116:119], v[16:19], a[104:111], v1
    s_cbranch_vccnz L_h2b_138
L_h2cb_140:
    global_load_lds_dwordx4 v0, s[40:41] offset:2048 sc1
    v_smfmac_f32_16x16x64_bf16 v[96:99], v[20:23], v[224:231], v1
    s_waitcnt lgkmcnt(2)
    s_barrier
    v_smfmac_f32_16x16x64_bf16 v[100:103], v[20:23], v[232:239], v1
    ds_read_b128 v[24:27], v0 offset:17408
    s_mov_b32 m0, 8192
    v_smfmac_f32_16x16x64_bf16 v[104:107], v[20:23], v[240:247], v1
    global_store_dword v3, v122, s[42:43] offset:0
    ds_read_b128 v[28:31], v0 offset:18432
    v_smfmac_f32_16x16x64_bf16 v[108:111], v[20:23], v[248:255], v1
    ds_read_b128 v[32:35], v0 offset:19456
    v_add_u32 v10, 28928, v9
    v_smfmac_f32_16x16x64_bf16 v[112:115], v[20:23], a[160:167], v1
    ds_read_b128 v[56:59], v0 offset:2048
    v_smfmac_f32_16x16x64_bf16 v[116:119], v[20:23], a[168:175], v1
    ds_read_b128 v[60:63], v0 offset:3072
    s_waitcnt lgkmcnt(4)
    v_smfmac_f32_16x16x64_bf16 v[96:99], v[24:27], v[128:135], v1
    global_load_lds_dwordx4 v0, s[46:47] sc1
    ds_read_b128 v[64:67], v0 offset:4096
    v_smfmac_f32_16x16x64_bf16 v[100:103], v[24:27], v[136:143], v1
    ds_read_b128 v[68:71], v0 offset:5120
    v_smfmac_f32_16x16x64_bf16 v[104:107], v[24:27], v[144:151], v1
    global_store_dword v9, v82, s[12:13] offset:2048 sc1
    ds_read_b128 v[72:75], v0 offset:6144
    v_smfmac_f32_16x16x64_bf16 v[108:111], v[24:27], v[152:159], v1
    ds_read_b128 v[76:79], v0 offset:7168
    s_waitcnt lgkmcnt(6)
    v_smfmac_f32_16x16x64_bf16 v[96:99], v[28:31], v[160:167], v1
    global_load_lds_dwordx4 v0, s[46:47] offset:1024 sc1
    s_mov_b32 m0, 0
    v_smfmac_f32_16x16x64_bf16 v[100:103], v[28:31], v[168:175], v1
    ds_read2_b32 v[124:125], v10 offset0:0 offset1:68
    v_smfmac_f32_16x16x64_bf16 v[104:107], v[28:31], v[176:183], v1
    global_store_dword v9, v90, s[12:13] offset:2304 sc1
    v_smfmac_f32_16x16x64_bf16 v[108:111], v[28:31], v[184:191], v1
    v_smfmac_f32_16x16x64_bf16 v[96:99], v[32:35], v[192:199], v1
    s_waitcnt vmcnt(5) lgkmcnt(0)
    s_barrier
    v_smfmac_f32_16x16x64_bf16 v[100:103], v[32:35], v[200:207], v1
    global_load_lds_dwordx4 v0, s[44:45] sc1
    ds_read_b128 v[36:39], v0 offset:21504
    v_smfmac_f32_16x16x64_bf16 v[104:107], v[32:35], v[208:215], v1
    global_store_dword v9, v124, s[12:13] offset:0 sc1
    ds_read_b128 v[40:43], v0 offset:22528
    v_smfmac_f32_16x16x64_bf16 v[108:111], v[32:35], v[216:223], v1
    ds_read_b128 v[44:47], v0 offset:23552
    s_waitcnt lgkmcnt(2)
    v_smfmac_f32_16x16x64_bf16 v[96:99], v[36:39], a[0:7], v1
    global_store_dword v9, v125, s[12:13] offset:256 sc1
    v_smfmac_f32_16x16x64_bf16 v[100:103], v[36:39], a[8:15], v1
    global_load_lds_dwordx4 v0, s[44:45] offset:1024 sc1
    s_waitcnt lgkmcnt(0)
    v_smfmac_f32_16x16x64_bf16 v[96:99], v[40:43], a[32:39], v1
    s_cmp_ge_u32 s34, 62
    v_smfmac_f32_16x16x64_bf16 v[96:99], v[44:47], a[64:71], v1
    v_smfmac_f32_16x16x64_bf16 v[100:103], v[40:43], a[40:47], v1
    v_smfmac_f32_16x16x64_bf16 v[100:103], v[44:47], a[72:79], v1
    v_add_f32 v96, v96, v98
    v_smfmac_f32_16x16x64_bf16 v[104:107], v[36:39], a[16:23], v1
    v_add_f32 v97, v97, v99
    v_smfmac_f32_16x16x64_bf16 v[104:107], v[40:43], a[48:55], v1
    v_add_f32 v100, v100, v102
    v_add_f32 v101, v101, v103
    v_smfmac_f32_16x16x64_bf16 v[104:107], v[44:47], a[80:87], v1
    v_cvt_pk_bf16_f32 v96, v96, v100
    v_smfmac_f32_16x16x64_bf16 v[108:111], v[36:39], a[24:31], v1
    v_cvt_pk_bf16_f32 v97, v97, v101
    v_smfmac_f32_16x16x64_bf16 v[108:111], v[40:43], a[56:63], v1
    ds_write2_b32 v4, v96, v97 offset0:0 offset1:136
    v_smfmac_f32_16x16x64_bf16 v[108:111], v[44:47], a[88:95], v1
    v_add_f32 v104, v104, v106
    v_smfmac_f32_16x16x64_bf16 v[112:115], v[24:27], a[112:119], v1
    v_add_f32 v105, v105, v107
    v_smfmac_f32_16x16x64_bf16 v[116:119], v[24:27], a[120:127], v1
    ds_read_b128 v[24:27], v8 offset:2048
    v_add_f32 v108, v108, v110
    v_smfmac_f32_16x16x64_bf16 v[112:115], v[28:31], a[128:135], v1
    v_add_f32 v109, v109, v111
    v_smfmac_f32_16x16x64_bf16 v[116:119], v[28:31], a[136:143], v1
    s_waitcnt vmcnt(9) lgkmcnt(1)
    s_barrier
    v_smfmac_f32_16x16x64_bf16 v[112:115], v[32:35], a[144:151], v1
    ds_read_b128 v[120:123], v6 offset:0
    v_cvt_pk_bf16_f32 v10, v104, v108
    v_smfmac_f32_16x16x64_bf16 v[116:119], v[32:35], a[152:159], v1
    ds_read_b128 v[124:127], v6 offset:64
    v_cvt_pk_bf16_f32 v11, v105, v109
    v_smfmac_f32_16x16x64_bf16 v[112:115], v[36:39], a[176:183], v1
    ds_write2_b32 v5, v10, v11 offset0:0 offset1:4
    v_smfmac_f32_16x16x64_bf16 v[116:119], v[36:39], a[184:191], v1
    ds_read_b128 v[16:19], v6 offset:128
    v_mov_b64 v[104:105], 0
    v_smfmac_f32_16x16x64_bf16 v[112:115], v[40:43], a[192:199], v1
    ds_read_b128 v[20:23], v6 offset:192
    v_mov_b64 v[106:107], 0
    v_smfmac_f32_16x16x64_bf16 v[116:119], v[40:43], a[200:207], v1
    ds_read_b128 v[28:31], v8 offset:6144
    v_mov_b64 v[108:109], 0
    v_smfmac_f32_16x16x64_bf16 v[112:115], v[44:47], a[208:215], v1
    ds_read_b128 v[32:35], v8 offset:10240
    v_mov_b64 v[110:111], 0
    v_smfmac_f32_16x16x64_bf16 v[116:119], v[44:47], a[216:223], v1
    ds_read_b128 v[36:39], v8 offset:14336
    s_waitcnt lgkmcnt(6)
    v_mfma_f32_16x16x32_bf16 v[96:99], v[48:51], v[120:123], 0
    s_waitcnt lgkmcnt(5)
    s_barrier
    v_mfma_f32_16x16x32_bf16 v[100:103], v[64:67], v[120:123], 0
    ds_read_b128 v[40:43], v7 offset:0
    v_add_f32 v112, v112, v114
    v_mfma_f32_16x16x32_bf16 v[96:99], v[52:55], v[124:127], v[96:99]
    ds_read_b128 v[44:47], v7 offset:1088
    v_add_f32 v113, v113, v115
    v_mfma_f32_16x16x32_bf16 v[100:103], v[68:71], v[124:127], v[100:103]
    s_waitcnt lgkmcnt(5)
    v_add_f32 v116, v116, v118
    v_add_f32 v117, v117, v119
    v_mfma_f32_16x16x32_bf16 v[96:99], v[56:59], v[16:19], v[96:99]
    ds_read_b128 v[48:51], v8 offset:0
    v_cvt_pk_bf16_f32 v82, v112, v113
    v_mfma_f32_16x16x32_bf16 v[96:99], v[60:63], v[20:23], v[96:99]
    ds_read_b128 v[64:67], v8 offset:16384
    v_cvt_pk_bf16_f32 v90, v116, v117
    v_mfma_f32_16x16x32_bf16 v[100:103], v[72:75], v[16:19], v[100:103]
    ds_read_b128 v[52:55], v8 offset:4096
    v_cvt_pk_bf16_f32 v94, v116, v117
    v_mfma_f32_16x16x32_bf16 v[100:103], v[76:79], v[20:23], v[100:103]
    s_waitcnt lgkmcnt(3)
    v_cvt_pk_bf16_f32 v86, v112, v113
    v_max3_f32 v10, v96, v97, v98
    v_smfmac_f32_16x16x64_bf16 v[104:107], v[40:43], v[120:127], v1
    ds_read_b128 v[68:71], v8 offset:20480
    v_cndmask_b32 v96, v96, v98, s[52:53]
    v_smfmac_f32_16x16x64_bf16 v[104:107], v[44:47], v[16:23], v1
    ds_read_b128 v[56:59], v8 offset:8192
    s_nop 0
    v_cndmask_b32 v97, v97, v99, s[52:53]
    v_max3_f32 v10, v10, v99, v100
    v_max3_f32 v10, v10, v101, v102
    v_cndmask_b32 v98, v100, v102, s[52:53]
    v_cndmask_b32 v99, v101, v103, s[52:53]
    v_max_f32 v10, v10, v103
    v_pk_add_f32 v[104:105], v[104:105], v[106:107]
    v_max3_f32 v11, v10, v104, v105
    v_max3_f32 v10, v10, v104, v105
    v_cndmask_b32 v104, v104, v105, s[52:53]
    v_mov_b64 v[120:121], s[54:55]
    v_permlane32_swap_b32 v10, v11
    v_max_f32 v106, v10, v11
    v_max_f32 v107, v10, v11
    v_mov_b64 v[122:123], s[56:57]
    v_mov_b64 v[116:117], 0
    v_permlane16_swap_b32 v106, v107
    v_max_f32 v10, v106, v107
    v_mul_f32 v10, s61, v10
    v_pk_fma_f32 v[96:97], v[96:97], s[58:59], v[10:11] op_sel_hi:[1,1,0]
    v_pk_fma_f32 v[98:99], v[98:99], s[58:59], v[10:11] op_sel_hi:[1,1,0]
    v_fma_f32 v104, v104, s58, v10
    v_exp_f32 v96, v96
    v_exp_f32 v97, v97
    v_exp_f32 v98, v98
    v_exp_f32 v99, v99
    v_exp_f32 v104, v104
    v_cvt_pk_bf16_f32 v100, v96, v97
    v_cvt_pk_bf16_f32 v102, v98, v99
    v_cvt_pk_bf16_f32 v101, v104, 0
    v_cvt_pk_bf16_f32 v103, v104, 0
    v_mov_b64 v[118:119], 0
    s_nop 0
    v_mfma_f32_16x16x32_bf16 v[112:115], v[100:103], v[120:123], 0
    ds_read_b128 v[60:63], v8 offset:12288
    ds_read_b128 v[72:75], v8 offset:24576
    v_smfmac_f32_16x16x64_bf16 v[108:111], v[100:103], v[80:87], v1 abid:1
    ds_read_b128 v[76:79], v8 offset:28672
    ds_read_b128 v[16:19], v8 offset:18432
    v_smfmac_f32_16x16x64_bf16 v[116:119], v[100:103], v[88:95], v1 abid:1
    ds_read_b128 v[20:23], v8 offset:22528
    s_nop 0
    v_add_f32 v112, v112, v114
    v_add_f32 v113, v113, v115
    v_rcp_f32 v112, v112
    v_rcp_f32 v113, v113
    v_pk_add_f32 v[108:109], v[108:109], v[110:111]
    v_pk_mul_f32 v[108:109], v[108:109], v[112:113]
    v_pk_add_f32 v[116:117], v[116:117], v[118:119]
    v_pk_mul_f32 v[116:117], v[116:117], v[112:113]
    v_cvt_pk_bf16_f32 v10, v108, v116
    v_cvt_pk_bf16_f32 v11, v109, v117
    ds_write2_b32 v4, v10, v11 offset0:64 offset1:200
    ds_read_b128 v[96:99], v6 offset:256
    v_mov_b64 v[112:113], 0
    v_mov_b64 v[114:115], 0
    v_mov_b64 v[116:117], 0
    v_mov_b64 v[118:119], 0
    s_cbranch_scc1 L_last_142
L_lastb_143:
    v_mov_b64 v[84:85], 0
    v_mov_b64 v[86:87], 0
    v_mov_b64 v[92:93], 0
    v_mov_b64 v[94:95], 0
    s_waitcnt vmcnt(8) lgkmcnt(1)
    s_barrier
    ds_read_b128 v[100:103], v6 offset:320
    ds_read_b128 v[104:107], v6 offset:384
    ds_read_b128 v[108:111], v6 offset:448
    s_waitcnt lgkmcnt(3)
    v_smfmac_f32_16x16x64_bf16 v[112:115], v[96:99], v[48:55], v1
    ds_read_b128 v[40:43], v8 offset:26624
    v_smfmac_f32_16x16x64_bf16 v[116:119], v[96:99], a[224:231], v1
    ds_read_b128 v[44:47], v8 offset:30720
    v_smfmac_f32_16x16x64_bf16 v[84:87], v[96:99], v[24:31], v1
    ds_read_b128 v[48:51], v8 offset:3072
    s_waitcnt lgkmcnt(5)
    v_smfmac_f32_16x16x64_bf16 v[112:115], v[100:103], v[56:63], v1
    ds_read_b128 v[52:55], v8 offset:7168
    s_waitcnt lgkmcnt(5)
    v_smfmac_f32_16x16x64_bf16 v[112:115], v[104:107], v[64:71], v1
    ds_read_b128 v[56:59], v8 offset:11264
    s_waitcnt lgkmcnt(5)
    v_smfmac_f32_16x16x64_bf16 v[112:115], v[108:111], v[72:79], v1
    ds_read_b128 v[60:63], v8 offset:15360
    v_smfmac_f32_16x16x64_bf16 v[116:119], v[100:103], a[232:239], v1
    ds_read_b128 v[64:67], v8 offset:19456
    v_smfmac_f32_16x16x64_bf16 v[116:119], v[104:107], a[240:247], v1
    ds_read_b128 v[68:71], v8 offset:23552
    v_cvt_pk_bf16_f32 v112, v112, v114
    v_and_or_b32 v112, v112, -2, s51
    v_smfmac_f32_16x16x64_bf16 v[116:119], v[108:111], a[248:255], v1
    global_store_dword v2, v112, s[8:9] offset:-4096
    v_cvt_pk_bf16_f32 v113, v113, v115
    v_and_or_b32 v113, v113, -2, s51
    v_smfmac_f32_16x16x64_bf16 v[84:87], v[100:103], v[32:39], v1
    global_store_dword v2, v113, s[10:11] offset:-4096
    ds_read_b128 v[72:75], v8 offset:27648
    v_smfmac_f32_16x16x64_bf16 v[84:87], v[104:107], v[16:23], v1
    ds_read_b128 v[76:79], v8 offset:31744
    s_waitcnt lgkmcnt(8)
    v_cvt_pk_bf16_f32 v116, v116, v118
    v_and_or_b32 v116, v116, -2, s51
    v_smfmac_f32_16x16x64_bf16 v[84:87], v[108:111], v[40:47], v1
    global_store_dword v2, v116, s[8:9] offset:-2048
    s_waitcnt lgkmcnt(6)
    v_cvt_pk_bf16_f32 v117, v117, v119
    v_and_or_b32 v117, v117, -2, s51
    v_smfmac_f32_16x16x64_bf16 v[92:95], v[96:99], v[48:55], v1
    global_store_dword v2, v117, s[10:11] offset:-2048
    s_waitcnt lgkmcnt(4)
    v_smfmac_f32_16x16x64_bf16 v[92:95], v[100:103], v[56:63], v1
    s_waitcnt lgkmcnt(2)
    v_cvt_pk_bf16_f32 v84, v84, v86
    v_and_or_b32 v84, v84, -2, s51
    v_smfmac_f32_16x16x64_bf16 v[92:95], v[104:107], v[64:71], v1
    global_store_dword v2, v84, s[8:9] offset:0
    s_waitcnt lgkmcnt(0)
    v_cvt_pk_bf16_f32 v85, v85, v87
    v_and_or_b32 v85, v85, -2, s51
    v_smfmac_f32_16x16x64_bf16 v[92:95], v[108:111], v[72:79], v1
    global_store_dword v2, v85, s[10:11] offset:0
    s_nop 0
    v_mov_b64 v[96:97], 0
    v_mov_b64 v[98:99], 0
    v_mov_b64 v[100:101], 0
    v_mov_b64 v[102:103], 0
    v_mov_b64 v[104:105], 0
    v_mov_b64 v[106:107], 0
    v_cvt_pk_bf16_f32 v92, v92, v94
    v_and_or_b32 v92, v92, -2, s51
    v_cvt_pk_bf16_f32 v93, v93, v95
    v_and_or_b32 v93, v93, -2, s51
    v_mov_b64 v[108:109], 0
    s_add_u32 s12, s12, 4096
    s_addc_u32 s13, s13, 0
    s_add_u32 s34, s34, 1
    global_store_dword v2, v92, s[8:9] offset:2048
    global_store_dword v2, v93, s[10:11] offset:2048
    v_mov_b64 v[110:111], 0
    s_add_u32 s44, s44, 16384
    s_addc_u32 s45, s45, 0
    s_add_u32 s46, s46, 16384
    s_addc_u32 s47, s47, 0
    s_xor_b32 s40, s40, 65536
    v_mov_b64 v[112:113], 0
    s_nop 4
    v_mov_b64 v[114:115], 0
    s_nop 4
    v_mov_b64 v[116:117], 0
    s_nop 4
    v_mov_b64 v[118:119], 0
    global_load_dword v120, v9, s[36:37] offset:0 sc1
    global_load_dword v121, v9, s[36:37] offset:256 sc1
    global_load_dword v122, v9, s[36:37] offset:512 sc1
    global_load_dword v123, v9, s[36:37] offset:768 sc1
    global_load_dword v124, v9, s[36:37] offset:1024 sc1
    global_load_dword v125, v9, s[36:37] offset:1280 sc1
    global_load_dword v126, v9, s[36:37] offset:1536 sc1
    global_load_dword v127, v9, s[36:37] offset:1792 sc1
    ds_read_b128 v[48:51], v8 offset:1024
    ds_read_b128 v[52:55], v8 offset:5120
    v_mov_b64 v[86:87], 0
    s_nop 1
    ds_read_b128 v[56:59], v8 offset:9216
    ds_read_b128 v[60:63], v8 offset:13312
    v_mov_b64 v[94:95], 0
    s_nop 1
    ds_read_b128 v[64:67], v8 offset:17408
    ds_read_b128 v[68:71], v8 offset:21504
    v_mov_b32 v10, 0
    s_nop 1
    ds_read_b128 v[72:75], v8 offset:25600
    ds_read_b128 v[76:79], v8 offset:29696
    v_mov_b32 v10, 0
    s_nop 1
    s_cmp_eq_u32 s51, 0
    s_cbranch_scc1 L_tag0_144
    s_waitcnt vmcnt(4)
    v_bitop3_b32 v10, v120, v121, v122 bitop3:0x80
    v_bitop3_b32 v10, v10, v123, 1 bitop3:0x80
    v_mfma_f32_16x16x32_bf16 v[32:35], v[12:15], v[120:123], 0
    s_waitcnt vmcnt(0)
    v_bitop3_b32 v10, v10, v124, v125 bitop3:0x80
    v_bitop3_b32 v10, v10, v126, v127 bitop3:0x80
    v_mfma_f32_16x16x32_bf16 v[32:35], v[12:15], v[124:127], v[32:35]
    s_nop 0
    v_cmp_ne_u32 vcc, 1, v10
    s_nop 0
    s_mov_b64 exec, s[26:27]
    s_nop 2
    s_cbranch_vccnz L_h1r_145
    v_cvt_pk_bf16_f32 v11, v32, v33
    global_store_dword v3, v11, s[42:43] offset:0
    s_mov_b64 exec, -1
    s_branch L_step_133
L_h1r_145:
    s_mov_b64 exec, -1
    global_load_dword v120, v9, s[36:37] offset:0 sc1
    global_load_dword v121, v9, s[36:37] offset:256 sc1
    global_load_dword v122, v9, s[36:37] offset:512 sc1
    global_load_dword v123, v9, s[36:37] offset:768 sc1
    global_load_dword v124, v9, s[36:37] offset:1024 sc1
    global_load_dword v125, v9, s[36:37] offset:1280 sc1
    global_load_dword v126, v9, s[36:37] offset:1536 sc1
    global_load_dword v127, v9, s[36:37] offset:1792 sc1
    s_sub_u32 s50, s50, 1
    s_cselect_b64 s[48:49], 0, s[48:49]
    s_waitcnt vmcnt(8)
    v_bitop3_b32 v10, v120, v121, v122 bitop3:0x80
    v_bitop3_b32 v10, v10, v123, 1 bitop3:0x80
    v_mfma_f32_16x16x32_bf16 v[32:35], v[12:15], v[120:123], 0
    s_nop 0
    v_bitop3_b32 v10, v10, v124, v125 bitop3:0x80
    v_bitop3_b32 v10, v10, v126, v127 bitop3:0x80
    v_mfma_f32_16x16x32_bf16 v[32:35], v[12:15], v[124:127], v[32:35]
    s_nop 0
    v_cmp_ne_u32 vcc, 1, v10
    s_nop 0
    s_mov_b64 exec, s[26:27]
    s_nop 1
    s_and_b64 vcc, vcc, s[48:49]
    s_cbranch_scc1 L_h1r_145
    v_cvt_pk_bf16_f32 v11, v32, v33
    global_store_dword v3, v11, s[42:43] offset:0
    s_mov_b64 exec, -1
    s_branch L_step_133
L_tag0_144:
    s_waitcnt vmcnt(4)
    v_bitop3_b32 v10, v120, v121, v122 bitop3:0x01
    v_bitop3_b32 v10, v10, v123, 1 bitop3:0x20
    v_mfma_f32_16x16x32_bf16 v[32:35], v[12:15], v[120:123], 0
    s_waitcnt vmcnt(0)
    v_bitop3_b32 v10, v10, v124, v125 bitop3:0x10
    v_bitop3_b32 v10, v10, v126, v127 bitop3:0x10
    v_mfma_f32_16x16x32_bf16 v[32:35], v[12:15], v[124:127], v[32:35]
    s_nop 0
    v_cmp_ne_u32 vcc, 1, v10
    s_nop 0
    s_mov_b64 exec, s[26:27]
    s_nop 2
    s_cbranch_vccnz L_h1r_146
    v_cvt_pk_bf16_f32 v11, v32, v33
    global_store_dword v3, v11, s[42:43] offset:0
    s_mov_b64 exec, -1
    s_branch L_step_133
L_h1r_146:
    s_mov_b64 exec, -1
    global_load_dword v120, v9, s[36:37] offset:0 sc1
    global_load_dword v121, v9, s[36:37] offset:256 sc1
    global_load_dword v122, v9, s[36:37] offset:512 sc1
    global_load_dword v123, v9, s[36:37] offset:768 sc1
    global_load_dword v124, v9, s[36:37] offset:1024 sc1
    global_load_dword v125, v9, s[36:37] offset:1280 sc1
    global_load_dword v126, v9, s[36:37] offset:1536 sc1
    global_load_dword v127, v9, s[36:37] offset:1792 sc1
    s_sub_u32 s50, s50, 1
    s_cselect_b64 s[48:49], 0, s[48:49]
    s_waitcnt vmcnt(8)
    v_bitop3_b32 v10, v120, v121, v122 bitop3:0x01
    v_bitop3_b32 v10, v10, v123, 1 bitop3:0x20
    v_mfma_f32_16x16x32_bf16 v[32:35], v[12:15], v[120:123], 0
    s_nop 0
    v_bitop3_b32 v10, v10, v124, v125 bitop3:0x10
    v_bitop3_b32 v10, v10, v126, v127 bitop3:0x10
    v_mfma_f32_16x16x32_bf16 v[32:35], v[12:15], v[124:127], v[32:35]
    s_nop 0
    v_cmp_ne_u32 vcc, 1, v10
    s_nop 0
    s_mov_b64 exec, s[26:27]
    s_nop 1
    s_and_b64 vcc, vcc, s[48:49]
    s_cbranch_scc1 L_h1r_146
    v_cvt_pk_bf16_f32 v11, v32, v33
    global_store_dword v3, v11, s[42:43] offset:0
    s_mov_b64 exec, -1
    s_branch L_step_133
L_last_142:
    v_add_u32 v10, 28928, v9
    ds_read2_b32 v[124:125], v10 offset0:0 offset1:68
    s_add_u32 s12, s12, 4096
    s_addc_u32 s13, s13, 0
    global_store_dword v9, v82, s[12:13] offset:2048 sc1
    global_store_dword v9, v90, s[12:13] offset:2304 sc1
    s_waitcnt lgkmcnt(0)
    global_store_dword v9, v124, s[12:13] offset:0 sc1
    global_store_dword v9, v125, s[12:13] offset:256 sc1
    s_cmp_eq_u32 s34, 63
    s_cbranch_scc1 L_exit_134
    s_sub_u32 s12, s12, 4096
    s_subb_u32 s13, s13, 0
    s_getpc_b64 s[64:65]
L_pc_147:
    s_add_u32 s64, s64, L_fin_0-L_pc_147
    s_addc_u32 s65, s65, 0
    v_lshlrev_b32 v126, 2, v0
    v_min_u32 v126, L_code_end-L_fin_0-4, v126
    global_load_dword v127, v126, s[64:65]
    s_branch L_lastb_143
L_h2a_137:
    global_load_dwordx4 v[16:19], v0, s[40:41] offset:-2048 sc1
    global_load_dwordx4 v[20:23], v0, s[40:41] offset:2048 sc1
    s_nop 4
    v_mov_b64 v[96:97], 0
    v_mov_b64 v[98:99], 0
    v_mov_b64 v[100:101], 0
    v_mov_b64 v[102:103], 0
    s_waitcnt vmcnt(3)
    v_maximum3_f32 v11, v16, v17, v18
    v_cmp_u_f32 vcc, v11, v19
    v_smfmac_f32_16x16x64_bf16 v[96:99], v[16:19], v[48:55], v1
    ds_write_b128 v0, v[16:19] offset:16384
    v_smfmac_f32_16x16x64_bf16 v[100:103], v[16:19], v[56:63], v1
    s_cbranch_vccz L_h2cc_141
L_h2l2_148:
    global_load_dwordx4 v[16:19], v0, s[40:41] offset:-2048 sc1
    global_load_dwordx4 v[20:23], v0, s[40:41] offset:2048 sc1
    s_sub_u32 s2, s2, 1
    s_cselect_b64 s[38:39], 0, s[38:39]
    s_nop 2
    v_mov_b64 v[96:97], 0
    v_mov_b64 v[98:99], 0
    v_mov_b64 v[100:101], 0
    v_mov_b64 v[102:103], 0
    s_waitcnt vmcnt(3)
    v_maximum3_f32 v11, v16, v17, v18
    v_cmp_u_f32 vcc, v11, v19
    v_smfmac_f32_16x16x64_bf16 v[96:99], v[16:19], v[48:55], v1
    ds_write_b128 v0, v[16:19] offset:16384
    v_smfmac_f32_16x16x64_bf16 v[100:103], v[16:19], v[56:63], v1
    s_and_b64 vcc, vcc, s[38:39]
    s_cbranch_scc0 L_h2cc_141
    s_branch L_h2l2_148
    global_load_dwordx4 v[16:19], v0, s[40:41] offset:-2048 sc1
    global_load_dwordx4 v[20:23], v0, s[40:41] offset:2048 sc1
    s_sub_u32 s2, s2, 1
    s_cselect_b64 s[38:39], 0, s[38:39]
    s_cmp_eq_u64 s[38:39], 0
    s_cbranch_scc1 L_h2cc_141
    s_nop 2
    v_mov_b64 v[96:97], 0
    v_mov_b64 v[98:99], 0
    v_mov_b64 v[100:101], 0
    v_mov_b64 v[102:103], 0
    s_waitcnt vmcnt(3)
    s_branch L_h2ca_139
L_h2b_138:
    global_load_dwordx4 v[20:23], v0, s[40:41] offset:2048 sc1
    s_sub_u32 s2, s2, 1
    s_cselect_b64 s[38:39], 0, s[38:39]
    s_waitcnt vmcnt(1)
    v_maximum3_f32 v11, v20, v21, v22
    v_cmp_u_f32 vcc, v11, v23
    s_and_b64 vcc, vcc, s[38:39]
    s_cbranch_scc0 L_h2cb_140
    s_branch L_h2b_138
L_exit_134:
L_done_116:
L_fin_0:
    s_nop 9
    global_load_dwordx4 v[16:19], v0, s[40:41] offset:-2048 sc1
    global_load_dwordx4 v[20:23], v0, s[40:41] offset:2048 sc1
    v_lshrrev_b32 v80, 4, v0
    v_and_b32 v81, 15, v80
    v_lshrrev_b32 v82, 4, v80
    v_lshrrev_b32 v83, 2, v80
    v_and_b32 v84, 3, v80
    v_and_b32 v85, 3, v83
    v_add_u32 v86, 0, v81
    v_lshlrev_b32 v87, 2, v82
    v_sub_u32 v86, v86, v87
    v_cmp_le_i32 s[72:73], 0, v86
    v_cmp_le_i32 s[74:75], 1, v86
    v_cmp_le_i32 s[76:77], 2, v86
    v_cmp_le_i32 s[78:79], 3, v86
    v_cmp_le_i32 s[80:81], 16, v86
    v_cmp_le_i32 s[82:83], 17, v86
    v_cmp_le_i32 s[84:85], 18, v86
    v_cmp_le_i32 s[86:87], 19, v86
    s_mul_i32 s62, s32, 532480
    s_add_u32 s62, s62, 51896320
    s_add_u32 s88, s4, s62
    s_addc_u32 s89, s5, 0
    global_load_dwordx4 v[16:19], v0, s[40:41] offset:-2048 sc1
    global_load_dwordx4 v[20:23], v0, s[40:41] offset:2048 sc1
    s_lshl_b32 s62, s32, 11
    s_add_u32 s62, s62, 100401152
    s_add_u32 s90, s4, s62
    s_addc_u32 s91, s5, 0
    ds_read_b128 v[224:227], v0 offset:8192
    ds_read_b128 v[228:231], v0 offset:9216
    ds_read_b128 v[232:235], v0 offset:10240
    ds_read_b128 v[236:239], v0 offset:11264
    s_waitcnt vmcnt(2)
L_fp_149:
    v_maximum3_f32 v10, v16, v17, v18
    v_maximum3_f32 v10, v10, v19, v20
    v_maximum3_f32 v10, v10, v21, v22
    v_cmp_u_f32 vcc, v10, v23
    ds_write_b128 v0, v[16:19] offset:16384
    ds_write_b128 v0, v[20:23] offset:20480
    s_and_b64 vcc, vcc, s[38:39]
    s_cbranch_scc0 L_fo_150
    global_load_dwordx4 v[16:19], v0, s[40:41] offset:-2048 sc1
    global_load_dwordx4 v[20:23], v0, s[40:41] offset:2048 sc1
    s_sub_u32 s2, s2, 1
    s_cselect_b64 s[38:39], 0, s[38:39]
    s_waitcnt vmcnt(2)
    s_branch L_fp_149
L_fo_150:
    v_smfmac_f32_16x16x64_bf16 v[104:107], v[16:19], v[64:71], v1
    v_bfe_u32 v86, v81, 2, 1
    v_smfmac_f32_16x16x64_bf16 v[108:111], v[16:19], v[72:79], v1
    v_mul_u32_u24 v120, 4096, v86
    v_smfmac_f32_16x16x64_bf16 v[112:115], v[16:19], a[96:103], v1
    v_bfe_u32 v86, v82, 0, 2
    v_smfmac_f32_16x16x64_bf16 v[116:119], v[16:19], a[104:111], v1
    v_mul_u32_u24 v86, 256, v86
    v_smfmac_f32_16x16x64_bf16 v[104:107], v[20:23], v[240:247], v1
    v_add_u32 v120, v120, v86
    v_smfmac_f32_16x16x64_bf16 v[108:111], v[20:23], v[248:255], v1
    s_waitcnt lgkmcnt(0)
    s_barrier
    ds_read_b128 v[24:27], v0 offset:17408
    v_smfmac_f32_16x16x64_bf16 v[112:115], v[20:23], a[160:167], v1
    global_load_dwordx4 v[128:131], v0, s[88:89] offset:0 sc1
    ds_read_b128 v[28:31], v0 offset:18432
    v_smfmac_f32_16x16x64_bf16 v[116:119], v[20:23], a[168:175], v1
    global_load_dwordx4 v[132:135], v0, s[88:89] offset:1024 sc1
    ds_read_b128 v[32:35], v0 offset:19456
    s_waitcnt lgkmcnt(2)
    v_smfmac_f32_16x16x64_bf16 v[104:107], v[24:27], v[144:151], v1
    global_load_dwordx4 v[136:139], v0, s[88:89] offset:2048 sc1
    ds_read_b128 v[36:39], v0 offset:21504
    v_bfe_u32 v86, v81, 3, 1
    v_smfmac_f32_16x16x64_bf16 v[108:111], v[24:27], v[152:159], v1
    global_load_dwordx4 v[140:143], v0, s[88:89] offset:3072 sc1
    ds_read_b128 v[40:43], v0 offset:22528
    v_mul_u32_u24 v86, 64, v86
    v_smfmac_f32_16x16x64_bf16 v[112:115], v[24:27], a[112:119], v1
    ds_read_b128 v[44:47], v0 offset:23552
    v_add_u32 v120, v120, v86
    v_smfmac_f32_16x16x64_bf16 v[116:119], v[24:27], a[120:127], v1
    s_waitcnt lgkmcnt(4)
    v_bfe_u32 v86, v81, 0, 2
    v_smfmac_f32_16x16x64_bf16 v[104:107], v[28:31], v[176:183], v1
    v_mul_u32_u24 v86, 16, v86
    v_smfmac_f32_16x16x64_bf16 v[108:111], v[28:31], v[184:191], v1
    v_add_u32 v120, v120, v86
    v_smfmac_f32_16x16x64_bf16 v[112:115], v[28:31], a[128:135], v1
    v_bfe_u32 v86, v82, 0, 1
    v_smfmac_f32_16x16x64_bf16 v[116:119], v[28:31], a[136:143], v1
    s_waitcnt lgkmcnt(0)
    v_mul_u32_u24 v121, 128, v86
    v_smfmac_f32_16x16x64_bf16 v[104:107], v[32:35], v[208:215], v1
    ds_read_b128 v[160:163], v120 offset:0
    v_bfe_u32 v86, v82, 1, 1
    v_smfmac_f32_16x16x64_bf16 v[108:111], v[32:35], v[216:223], v1
    ds_read_b128 v[164:167], v120 offset:1024
    v_mul_u32_u24 v86, 64, v86
    v_smfmac_f32_16x16x64_bf16 v[112:115], v[32:35], a[144:151], v1
    ds_read_b128 v[168:171], v120 offset:2048
    v_add_u32 v121, v121, v86
    v_smfmac_f32_16x16x64_bf16 v[116:119], v[32:35], a[152:159], v1
    ds_read_b128 v[172:175], v120 offset:3072
    v_bfe_u32 v86, v81, 0, 4
    v_smfmac_f32_16x16x64_bf16 v[104:107], v[36:39], a[16:23], v1
    ds_read_b128 v[192:195], v120 offset:128
    v_mul_u32_u24 v86, 4, v86
    v_smfmac_f32_16x16x64_bf16 v[108:111], v[36:39], a[24:31], v1
    ds_read_b128 v[196:199], v120 offset:1152
    v_add_u32 v121, v121, v86
    v_smfmac_f32_16x16x64_bf16 v[112:115], v[36:39], a[176:183], v1
    ds_read_b128 v[200:203], v120 offset:2176
    v_bfe_u32 v86, v81, 3, 1
    v_smfmac_f32_16x16x64_bf16 v[116:119], v[36:39], a[184:191], v1
    ds_read_b128 v[204:207], v120 offset:3200
    v_mul_u32_u24 v122, 65536, v86
    v_smfmac_f32_16x16x64_bf16 v[104:107], v[40:43], a[48:55], v1
    v_bfe_u32 v86, v82, 0, 2
    v_smfmac_f32_16x16x64_bf16 v[108:111], v[40:43], a[56:63], v1
    v_mul_u32_u24 v86, 256, v86
    v_smfmac_f32_16x16x64_bf16 v[112:115], v[40:43], a[192:199], v1
    v_add_u32 v122, v122, v86
    v_smfmac_f32_16x16x64_bf16 v[116:119], v[40:43], a[200:207], v1
    v_bfe_u32 v86, v81, 0, 3
    v_smfmac_f32_16x16x64_bf16 v[104:107], v[44:47], a[80:87], v1
    v_mul_u32_u24 v86, 16, v86
    v_smfmac_f32_16x16x64_bf16 v[108:111], v[44:47], a[88:95], v1
    v_add_u32 v122, v122, v86
    v_smfmac_f32_16x16x64_bf16 v[112:115], v[44:47], a[208:215], v1
    v_mov_b32 v123, 0xd028965f
    v_smfmac_f32_16x16x64_bf16 v[116:119], v[44:47], a[216:223], v1
    s_nop 0
    v_add_f32 v104, v104, v106
    v_add_f32 v105, v105, v107
    v_add_f32 v108, v108, v110
    v_add_f32 v109, v109, v111
    v_cvt_pk_bf16_f32 v10, v104, v108
    v_cvt_pk_bf16_f32 v11, v105, v109
    ds_write2_b32 v5, v10, v11 offset0:0 offset1:4
    v_pk_add_f32 v[112:113], v[112:113], v[114:115]
    v_cvt_pk_bf16_f32 v112, v112, v113
    v_pk_add_f32 v[116:117], v[116:117], v[118:119]
    v_cvt_pk_bf16_f32 v116, v116, v117
    ds_write_b32 v9, v112 offset:24576
    ds_write_b32 v9, v116 offset:24832
    s_waitcnt vmcnt(0) lgkmcnt(3)
    v_mfma_f32_16x16x32_bf16 v[48:51], v[160:163], v[128:131], 0
    v_mov_b64 v[56:57], 0
    v_mov_b64 v[58:59], 0
    v_mfma_f32_16x16x32_bf16 v[48:51], v[164:167], v[132:135], v[48:51]
    v_mov_b64 v[72:73], s[54:55]
    v_mov_b64 v[74:75], s[54:55]
    v_mfma_f32_16x16x32_bf16 v[48:51], v[168:171], v[136:139], v[48:51]
    v_mov_b64 v[80:81], 0
    v_mov_b64 v[82:83], 0
    v_mfma_f32_16x16x32_bf16 v[48:51], v[172:175], v[140:143], v[48:51]
    v_mov_b64 v[84:85], 0
    v_mov_b64 v[86:87], 0
    v_mfma_f32_16x16x32_bf16 v[52:55], v[192:195], v[128:131], 0
    s_waitcnt lgkmcnt(0)
    s_barrier
    ds_read_b128 v[40:43], v7 offset:0
    ds_read_b128 v[44:47], v7 offset:1088
    v_mfma_f32_16x16x32_bf16 v[52:55], v[196:199], v[132:135], v[52:55]
    ds_read_b32 v80, v121 offset:24576
    ds_read_b32 v82, v121 offset:24832
    ds_read_b32 v84, v121 offset:25088
    ds_read_b32 v86, v121 offset:25344
    v_mfma_f32_16x16x32_bf16 v[52:55], v[200:203], v[136:139], v[52:55]
    v_mov_b64 v[64:65], 0
    v_mfma_f32_16x16x32_bf16 v[52:55], v[204:207], v[140:143], v[52:55]
    v_cndmask_b32 v48, v123, v48, s[72:73]
    v_cndmask_b32 v49, v123, v49, s[74:75]
    v_cndmask_b32 v50, v123, v50, s[76:77]
    v_cndmask_b32 v51, v123, v51, s[78:79]
    s_waitcnt lgkmcnt(4)
    v_smfmac_f32_16x16x64_bf16 v[56:59], v[40:43], v[128:135], v1
    v_smfmac_f32_16x16x64_bf16 v[56:59], v[44:47], v[136:143], v1
    v_cndmask_b32 v52, v123, v52, s[80:81]
    v_cndmask_b32 v53, v123, v53, s[82:83]
    v_cndmask_b32 v54, v123, v54, s[84:85]
    v_cndmask_b32 v55, v123, v55, s[86:87]
    v_max3_f32 v10, v48, v49, v50
    v_max3_f32 v10, v10, v51, v52
    v_max3_f32 v10, v10, v53, v54
    v_max_f32 v10, v10, v55
    v_pk_add_f32 v[56:57], v[56:57], v[58:59]
    v_max3_f32 v10, v10, v56, v57
    v_mov_b32 v11, v10
    s_nop 1
    v_permlane32_swap_b32 v10, v11
    v_max_f32 v10, v10, v11
    v_mov_b32 v11, v10
    s_nop 1
    v_permlane16_swap_b32 v10, v11
    v_max_f32 v10, v10, v11
    v_mul_f32 v10, s61, v10
    v_pk_fma_f32 v[48:49], v[48:49], s[58:59], v[10:11] op_sel_hi:[1,1,0]
    v_pk_fma_f32 v[50:51], v[50:51], s[58:59], v[10:11] op_sel_hi:[1,1,0]
    v_pk_fma_f32 v[52:53], v[52:53], s[58:59], v[10:11] op_sel_hi:[1,1,0]
    v_pk_fma_f32 v[54:55], v[54:55], s[58:59], v[10:11] op_sel_hi:[1,1,0]
    v_pk_fma_f32 v[56:57], v[56:57], s[58:59], v[10:11] op_sel_hi:[1,1,0]
    v_exp_f32 v48, v48
    v_exp_f32 v49, v49
    v_exp_f32 v50, v50
    v_exp_f32 v51, v51
    v_exp_f32 v52, v52
    v_exp_f32 v53, v53
    v_exp_f32 v54, v54
    v_exp_f32 v55, v55
    v_exp_f32 v56, v56
    v_exp_f32 v57, v57
    v_cvt_pk_bf16_f32 v60, v48, v49
    v_cvt_pk_bf16_f32 v61, v50, v51
    v_cvt_pk_bf16_f32 v62, v52, v53
    v_cvt_pk_bf16_f32 v63, v54, v55
    v_cvt_pk_bf16_f32 v64, v56, v57
    s_waitcnt lgkmcnt(0)
    s_nop 0
    v_mfma_f32_16x16x32_bf16 v[68:71], v[72:75], v[60:63], 0
    v_mfma_f32_16x16x32_bf16 v[24:27], v[224:227], v[60:63], 0
    v_mfma_f32_16x16x32_bf16 v[28:31], v[228:231], v[60:63], 0
    v_mfma_f32_16x16x32_bf16 v[32:35], v[232:235], v[60:63], 0
    v_mfma_f32_16x16x32_bf16 v[36:39], v[236:239], v[60:63], 0
    v_mfma_f32_16x16x16_bf16 v[68:71], v[72:73], v[64:65], v[68:71]
    v_mfma_f32_16x16x16_bf16 v[24:27], v[80:81], v[64:65], v[24:27]
    v_mfma_f32_16x16x16_bf16 v[28:31], v[82:83], v[64:65], v[28:31]
    v_mfma_f32_16x16x16_bf16 v[32:35], v[84:85], v[64:65], v[32:35]
    v_mfma_f32_16x16x16_bf16 v[36:39], v[86:87], v[64:65], v[36:39]
    v_rcp_f32 v68, v68
    s_nop 0
    v_mul_f32 v24, v24, v68
    v_mul_f32 v25, v25, v68
    v_cvt_pk_bf16_f32 v48, v24, v25
    v_mul_f32 v26, v26, v68
    v_mul_f32 v27, v27, v68
    v_cvt_pk_bf16_f32 v49, v26, v27
    v_mul_f32 v28, v28, v68
    v_mul_f32 v29, v29, v68
    v_cvt_pk_bf16_f32 v50, v28, v29
    v_mul_f32 v30, v30, v68
    v_mul_f32 v31, v31, v68
    v_cvt_pk_bf16_f32 v51, v30, v31
    global_store_dwordx4 v122, v[48:51], s[90:91] offset:0 sc1
    v_mul_f32 v32, v32, v68
    v_mul_f32 v33, v33, v68
    v_cvt_pk_bf16_f32 v52, v32, v33
    v_mul_f32 v34, v34, v68
    v_mul_f32 v35, v35, v68
    v_cvt_pk_bf16_f32 v53, v34, v35
    v_mul_f32 v36, v36, v68
    v_mul_f32 v37, v37, v68
    v_cvt_pk_bf16_f32 v54, v36, v37
    v_mul_f32 v38, v38, v68
    v_mul_f32 v39, v39, v68
    v_cvt_pk_bf16_f32 v55, v38, v39
    global_store_dwordx4 v122, v[52:55], s[90:91] offset:128 sc1
    s_lshr_b32 s63, s32, 3
    s_mul_i32 s63, s63, 96
    s_lshl_b32 s62, s32, 2
    s_add_u32 s62, s62, s63
    s_add_u32 s62, s62, 130048
    s_add_u32 s88, s4, s62
    s_addc_u32 s89, s5, 0
    v_lshlrev_b32 v10, 5, v0
    v_mov_b32 v11, 1
    s_waitcnt vmcnt(0)
    s_barrier
    s_mov_b64 exec, 3
    global_store_dword v10, v11, s[88:89] sc1
    s_mov_b64 exec, -1
    s_endpgm
L_chain_w1_109:
    s_waitcnt vmcnt(0) lgkmcnt(0)
    ds_read_b32 v40, v9 offset:31104
    s_cmp_lt_u32 s3, 32
    s_cbranch_scc1 L_slow_151
    s_branch L_fast_1
L_slow_151:
L_step_153:
    s_add_u32 s62, s34, 1
    s_lshl_b32 s62, s62, 2
    s_waitcnt lgkmcnt(0)
L_fqb_156:
    v_mad_u32_u24 v40, v40, 8, v9
    v_cmp_ge_u32 vcc, s62, v40
    s_add_u32 s63, s62, 8
    v_cmp_ge_u32 s[64:65], s63, v40
    s_and_b64 vcc, vcc, s[18:19]
    s_cbranch_scc1 L_fq_155
    v_mov_b32 v10, 0
    s_xor_b32 s51, s51, 1
    s_xor_b32 s42, s42, 65536
    s_nop 0
    s_cmp_eq_u32 s34, 63
    s_barrier
    s_cbranch_scc1 L_exit_154
    v_mov_b32 v10, 0
    s_and_b32 s64, s64, 3
    s_cselect_b64 s[20:21], s[14:15], s[36:37]
    s_cselect_b32 s22, 31104, s16
    s_nop 0
    global_load_dwordx4 v[16:19], v0, s[40:41] offset:-2048 sc1
    ds_read_b64 v[80:81], v0 offset:10240
    ds_read_b64 v[84:85], v0 offset:10248
    ds_read_b64 v[88:89], v0 offset:11264
    ds_read_b64 v[92:93], v0 offset:11272
    v_mov_b32 v10, 0
    s_nop 4
    v_mov_b32 v10, 0
    s_nop 4
    global_load_dwordx4 v[20:23], v0, s[40:41] offset:2048 sc1
    v_mov_b32 v10, 0
    s_nop 4
    v_mov_b32 v10, 0
    s_nop 4
    v_mov_b32 v10, 0
    s_nop 4
    v_mov_b32 v10, 0
    s_nop 1
    global_load_dwordx4 v[16:19], v0, s[40:41] offset:-2048 sc1
    v_mov_b32 v10, 0
    s_nop 4
    v_mov_b32 v10, 0
    s_nop 4
    v_mov_b32 v10, 0
    s_nop 3
    global_load_dwordx4 v[20:23], v0, s[40:41] offset:2048 sc1
    s_waitcnt vmcnt(3) lgkmcnt(0)
L_h2ca_159:
    v_maximum3_f32 v11, v16, v17, v18
    v_cmp_u_f32 vcc, v11, v19
    v_smfmac_f32_16x16x64_bf16 v[96:99], v[16:19], v[48:55], v1
    ds_write_b128 v0, v[16:19] offset:17408
    v_smfmac_f32_16x16x64_bf16 v[100:103], v[16:19], v[56:63], v1
    s_cbranch_vccnz L_h2a_157
L_h2cc_161:
    v_smfmac_f32_16x16x64_bf16 v[104:107], v[16:19], v[64:71], v1
    s_waitcnt vmcnt(2)
    v_maximum3_f32 v11, v20, v21, v22
    v_cmp_u_f32 vcc, v11, v23
    v_smfmac_f32_16x16x64_bf16 v[108:111], v[16:19], v[72:79], v1
    ds_read_b128 v[48:51], v0 offset:0
    v_mov_b32 v122, -1
    v_smfmac_f32_16x16x64_bf16 v[112:115], v[16:19], a[112:119], v1
    ds_read_b128 v[52:55], v0 offset:1024
    s_mov_b32 m0, 19456
    v_smfmac_f32_16x16x64_bf16 v[116:119], v[16:19], a[120:127], v1
    s_cbranch_vccnz L_h2b_158
L_h2cb_160:
    global_load_lds_dwordx4 v0, s[40:41] offset:2048 sc1
    v_smfmac_f32_16x16x64_bf16 v[96:99], v[20:23], a[0:7], v1
    s_waitcnt lgkmcnt(2)
    s_barrier
    v_smfmac_f32_16x16x64_bf16 v[100:103], v[20:23], a[8:15], v1
    global_store_dword v3, v122, s[42:43] offset:0 sc1
    ds_read_b128 v[24:27], v0 offset:18432
    v_smfmac_f32_16x16x64_bf16 v[104:107], v[20:23], a[16:23], v1
    ds_read_b128 v[28:31], v0 offset:19456
    s_mov_b32 m0, s22
    v_smfmac_f32_16x16x64_bf16 v[108:111], v[20:23], a[24:31], v1
    global_load_lds_dword v9, s[20:21] sc1
    ds_read_b128 v[32:35], v0 offset:16384
    v_smfmac_f32_16x16x64_bf16 v[112:115], v[20:23], a[176:183], v1
    ds_read_b128 v[56:59], v0 offset:2048
    s_mov_b32 m0, 10240
    v_smfmac_f32_16x16x64_bf16 v[116:119], v[20:23], a[184:191], v1
    ds_read_b128 v[60:63], v0 offset:3072
    s_waitcnt lgkmcnt(4)
    v_smfmac_f32_16x16x64_bf16 v[96:99], v[24:27], v[160:167], v1
    ds_read_b128 v[64:67], v0 offset:4096
    v_add_u32 v10, 29472, v9
    v_smfmac_f32_16x16x64_bf16 v[100:103], v[24:27], v[168:175], v1
    global_load_lds_dwordx4 v0, s[46:47] sc1
    ds_read_b128 v[68:71], v0 offset:5120
    v_smfmac_f32_16x16x64_bf16 v[104:107], v[24:27], v[176:183], v1
    ds_read_b128 v[72:75], v0 offset:6144
    v_smfmac_f32_16x16x64_bf16 v[108:111], v[24:27], v[184:191], v1
    ds_read_b128 v[76:79], v0 offset:7168
    s_waitcnt lgkmcnt(6)
    v_smfmac_f32_16x16x64_bf16 v[96:99], v[28:31], v[192:199], v1
    ds_read2_b32 v[124:125], v10 offset0:0 offset1:68
    v_smfmac_f32_16x16x64_bf16 v[100:103], v[28:31], v[200:207], v1
    global_load_lds_dwordx4 v0, s[46:47] offset:1024 sc1
    s_mov_b32 m0, 2048
    v_smfmac_f32_16x16x64_bf16 v[104:107], v[28:31], v[208:215], v1
    v_smfmac_f32_16x16x64_bf16 v[108:111], v[28:31], v[216:223], v1
    global_store_dword v9, v82, s[12:13] offset:2560 sc1
    v_smfmac_f32_16x16x64_bf16 v[96:99], v[32:35], v[128:135], v1
    s_waitcnt vmcnt(5) lgkmcnt(0)
    s_barrier
    v_smfmac_f32_16x16x64_bf16 v[100:103], v[32:35], v[136:143], v1
    global_store_dword v9, v90, s[12:13] offset:2816 sc1
    ds_read_b128 v[36:39], v0 offset:22528
    v_smfmac_f32_16x16x64_bf16 v[104:107], v[32:35], v[144:151], v1
    global_load_lds_dwordx4 v0, s[44:45] sc1
    ds_read_b128 v[40:43], v0 offset:23552
    v_smfmac_f32_16x16x64_bf16 v[108:111], v[32:35], v[152:159], v1
    ds_read_b128 v[44:47], v0 offset:20480
    s_waitcnt lgkmcnt(2)
    v_smfmac_f32_16x16x64_bf16 v[96:99], v[36:39], a[32:39], v1
    v_smfmac_f32_16x16x64_bf16 v[100:103], v[36:39], a[40:47], v1
    global_store_dword v9, v124, s[12:13] offset:512 sc1
    s_waitcnt lgkmcnt(0)
    v_smfmac_f32_16x16x64_bf16 v[96:99], v[40:43], a[64:71], v1
    global_load_lds_dwordx4 v0, s[44:45] offset:1024 sc1
    s_cmp_ge_u32 s34, 62
    v_smfmac_f32_16x16x64_bf16 v[96:99], v[44:47], v[224:231], v1
    global_store_dword v9, v125, s[12:13] offset:768 sc1
    v_smfmac_f32_16x16x64_bf16 v[100:103], v[40:43], a[72:79], v1
    v_smfmac_f32_16x16x64_bf16 v[100:103], v[44:47], v[232:239], v1
    v_add_f32 v96, v96, v98
    v_smfmac_f32_16x16x64_bf16 v[104:107], v[36:39], a[48:55], v1
    v_add_f32 v97, v97, v99
    v_smfmac_f32_16x16x64_bf16 v[104:107], v[40:43], a[80:87], v1
    v_add_f32 v100, v100, v102
    v_add_f32 v101, v101, v103
    v_smfmac_f32_16x16x64_bf16 v[104:107], v[44:47], v[240:247], v1
    v_cvt_pk_bf16_f32 v96, v96, v100
    v_smfmac_f32_16x16x64_bf16 v[108:111], v[36:39], a[56:63], v1
    v_cvt_pk_bf16_f32 v97, v97, v101
    v_smfmac_f32_16x16x64_bf16 v[108:111], v[40:43], a[88:95], v1
    ds_write2_b32 v4, v96, v97 offset0:0 offset1:136
    v_smfmac_f32_16x16x64_bf16 v[108:111], v[44:47], v[248:255], v1
    v_add_f32 v104, v104, v106
    v_smfmac_f32_16x16x64_bf16 v[112:115], v[24:27], a[128:135], v1
    v_add_f32 v105, v105, v107
    v_smfmac_f32_16x16x64_bf16 v[116:119], v[24:27], a[136:143], v1
    ds_read_b128 v[24:27], v8 offset:10240
    v_add_f32 v108, v108, v110
    v_smfmac_f32_16x16x64_bf16 v[112:115], v[28:31], a[144:151], v1
    v_add_f32 v109, v109, v111
    v_smfmac_f32_16x16x64_bf16 v[116:119], v[28:31], a[152:159], v1
    s_waitcnt vmcnt(10) lgkmcnt(1)
    s_barrier
    v_smfmac_f32_16x16x64_bf16 v[112:115], v[32:35], a[96:103], v1
    ds_read_b128 v[120:123], v6 offset:0
    v_cvt_pk_bf16_f32 v10, v104, v108
    v_smfmac_f32_16x16x64_bf16 v[116:119], v[32:35], a[104:111], v1
    ds_read_b128 v[124:127], v6 offset:64
    v_cvt_pk_bf16_f32 v11, v105, v109
    v_smfmac_f32_16x16x64_bf16 v[112:115], v[36:39], a[192:199], v1
    ds_write2_b32 v5, v10, v11 offset0:0 offset1:4
    v_smfmac_f32_16x16x64_bf16 v[116:119], v[36:39], a[200:207], v1
    ds_read_b128 v[16:19], v6 offset:128
    v_mov_b64 v[104:105], 0
    v_smfmac_f32_16x16x64_bf16 v[112:115], v[40:43], a[208:215], v1
    ds_read_b128 v[20:23], v6 offset:192
    v_mov_b64 v[106:107], 0
    v_smfmac_f32_16x16x64_bf16 v[116:119], v[40:43], a[216:223], v1
    ds_read_b128 v[28:31], v8 offset:14336
    v_mov_b64 v[108:109], 0
    v_smfmac_f32_16x16x64_bf16 v[112:115], v[44:47], a[160:167], v1
    ds_read_b128 v[32:35], v8 offset:18432
    v_mov_b64 v[110:111], 0
    v_smfmac_f32_16x16x64_bf16 v[116:119], v[44:47], a[168:175], v1
    ds_read_b128 v[36:39], v8 offset:22528
    s_waitcnt lgkmcnt(6)
    v_mfma_f32_16x16x32_bf16 v[96:99], v[48:51], v[120:123], 0
    s_waitcnt lgkmcnt(5)
    s_barrier
    v_mfma_f32_16x16x32_bf16 v[100:103], v[64:67], v[120:123], 0
    ds_read_b128 v[40:43], v7 offset:0
    v_add_f32 v112, v112, v114
    v_mfma_f32_16x16x32_bf16 v[96:99], v[52:55], v[124:127], v[96:99]
    ds_read_b128 v[44:47], v7 offset:1088
    v_add_f32 v113, v113, v115
    v_mfma_f32_16x16x32_bf16 v[100:103], v[68:71], v[124:127], v[100:103]
    s_waitcnt lgkmcnt(5)
    v_add_f32 v116, v116, v118
    v_add_f32 v117, v117, v119
    v_mfma_f32_16x16x32_bf16 v[96:99], v[56:59], v[16:19], v[96:99]
    ds_read_b128 v[48:51], v8 offset:0
    v_cvt_pk_bf16_f32 v82, v112, v113
    v_mfma_f32_16x16x32_bf16 v[96:99], v[60:63], v[20:23], v[96:99]
    ds_read_b128 v[64:67], v8 offset:16384
    v_cvt_pk_bf16_f32 v90, v116, v117
    v_mfma_f32_16x16x32_bf16 v[100:103], v[72:75], v[16:19], v[100:103]
    ds_read_b128 v[52:55], v8 offset:4096
    v_cvt_pk_bf16_f32 v94, v116, v117
    v_mfma_f32_16x16x32_bf16 v[100:103], v[76:79], v[20:23], v[100:103]
    s_waitcnt lgkmcnt(3)
    v_cvt_pk_bf16_f32 v86, v112, v113
    v_max3_f32 v10, v96, v97, v98
    v_smfmac_f32_16x16x64_bf16 v[104:107], v[40:43], v[120:127], v1
    ds_read_b128 v[68:71], v8 offset:20480
    v_cndmask_b32 v96, v96, v98, s[52:53]
    v_smfmac_f32_16x16x64_bf16 v[104:107], v[44:47], v[16:23], v1
    ds_read_b128 v[56:59], v8 offset:8192
    s_nop 0
    v_cndmask_b32 v97, v97, v99, s[52:53]
    v_max3_f32 v10, v10, v99, v100
    v_max3_f32 v10, v10, v101, v102
    v_cndmask_b32 v98, v100, v102, s[52:53]
    v_cndmask_b32 v99, v101, v103, s[52:53]
    v_max_f32 v10, v10, v103
    v_pk_add_f32 v[104:105], v[104:105], v[106:107]
    v_max3_f32 v11, v10, v104, v105
    v_max3_f32 v10, v10, v104, v105
    v_cndmask_b32 v104, v104, v105, s[52:53]
    v_mov_b64 v[120:121], s[54:55]
    v_permlane32_swap_b32 v10, v11
    v_max_f32 v106, v10, v11
    v_max_f32 v107, v10, v11
    v_mov_b64 v[122:123], s[56:57]
    v_mov_b64 v[116:117], 0
    v_permlane16_swap_b32 v106, v107
    v_max_f32 v10, v106, v107
    v_mul_f32 v10, s61, v10
    v_pk_fma_f32 v[96:97], v[96:97], s[58:59], v[10:11] op_sel_hi:[1,1,0]
    v_pk_fma_f32 v[98:99], v[98:99], s[58:59], v[10:11] op_sel_hi:[1,1,0]
    v_fma_f32 v104, v104, s58, v10
    v_exp_f32 v96, v96
    v_exp_f32 v97, v97
    v_exp_f32 v98, v98
    v_exp_f32 v99, v99
    v_exp_f32 v104, v104
    v_cvt_pk_bf16_f32 v100, v96, v97
    v_cvt_pk_bf16_f32 v102, v98, v99
    v_cvt_pk_bf16_f32 v101, v104, 0
    v_cvt_pk_bf16_f32 v103, v104, 0
    v_mov_b64 v[118:119], 0
    s_nop 0
    v_mfma_f32_16x16x32_bf16 v[112:115], v[100:103], v[120:123], 0
    ds_read_b128 v[60:63], v8 offset:12288
    ds_read_b128 v[72:75], v8 offset:24576
    v_smfmac_f32_16x16x64_bf16 v[108:111], v[100:103], v[80:87], v1 abid:1
    ds_read_b128 v[76:79], v8 offset:28672
    ds_read_b128 v[16:19], v8 offset:26624
    v_smfmac_f32_16x16x64_bf16 v[116:119], v[100:103], v[88:95], v1 abid:1
    ds_read_b128 v[20:23], v8 offset:30720
    s_nop 0
    v_add_f32 v112, v112, v114
    v_add_f32 v113, v113, v115
    v_rcp_f32 v112, v112
    v_rcp_f32 v113, v113
    v_pk_add_f32 v[108:109], v[108:109], v[110:111]
    v_pk_mul_f32 v[108:109], v[108:109], v[112:113]
    v_pk_add_f32 v[116:117], v[116:117], v[118:119]
    v_pk_mul_f32 v[116:117], v[116:117], v[112:113]
    v_cvt_pk_bf16_f32 v10, v108, v116
    v_cvt_pk_bf16_f32 v11, v109, v117
    ds_write2_b32 v4, v10, v11 offset0:64 offset1:200
    ds_read_b128 v[100:103], v6 offset:320
    v_mov_b64 v[112:113], 0
    v_mov_b64 v[114:115], 0
    v_mov_b64 v[116:117], 0
    v_mov_b64 v[118:119], 0
    s_cbranch_scc1 L_last_162
L_lastb_163:
    v_mov_b64 v[84:85], 0
    v_mov_b64 v[86:87], 0
    v_mov_b64 v[92:93], 0
    v_mov_b64 v[94:95], 0
    s_waitcnt vmcnt(9) lgkmcnt(1)
    s_barrier
    ds_read_b128 v[104:107], v6 offset:384
    ds_read_b128 v[108:111], v6 offset:448
    ds_read_b128 v[96:99], v6 offset:256
    s_waitcnt lgkmcnt(3)
    v_smfmac_f32_16x16x64_bf16 v[112:115], v[100:103], v[56:63], v1
    ds_read_b128 v[40:43], v8 offset:2048
    v_smfmac_f32_16x16x64_bf16 v[116:119], v[100:103], a[232:239], v1
    ds_read_b128 v[44:47], v8 offset:6144
    v_smfmac_f32_16x16x64_bf16 v[84:87], v[100:103], v[24:31], v1
    ds_read_b128 v[56:59], v8 offset:11264
    s_waitcnt lgkmcnt(5)
    v_smfmac_f32_16x16x64_bf16 v[112:115], v[104:107], v[64:71], v1
    ds_read_b128 v[60:63], v8 offset:15360
    s_waitcnt lgkmcnt(5)
    v_smfmac_f32_16x16x64_bf16 v[112:115], v[108:111], v[72:79], v1
    ds_read_b128 v[64:67], v8 offset:19456
    s_waitcnt lgkmcnt(5)
    v_smfmac_f32_16x16x64_bf16 v[112:115], v[96:99], v[48:55], v1
    ds_read_b128 v[68:71], v8 offset:23552
    v_smfmac_f32_16x16x64_bf16 v[116:119], v[104:107], a[240:247], v1
    ds_read_b128 v[72:75], v8 offset:27648
    v_smfmac_f32_16x16x64_bf16 v[116:119], v[108:111], a[248:255], v1
    ds_read_b128 v[76:79], v8 offset:31744
    v_cvt_pk_bf16_f32 v112, v112, v114
    v_and_or_b32 v112, v112, -2, s51
    v_smfmac_f32_16x16x64_bf16 v[116:119], v[96:99], a[224:231], v1
    global_store_dword v2, v112, s[8:9] offset:-4096 sc1
    v_cvt_pk_bf16_f32 v113, v113, v115
    v_and_or_b32 v113, v113, -2, s51
    v_smfmac_f32_16x16x64_bf16 v[84:87], v[104:107], v[32:39], v1
    global_store_dword v2, v113, s[10:11] offset:-4096 sc1
    ds_read_b128 v[48:51], v8 offset:3072
    v_smfmac_f32_16x16x64_bf16 v[84:87], v[108:111], v[16:23], v1
    ds_read_b128 v[52:55], v8 offset:7168
    s_waitcnt lgkmcnt(8)
    v_cvt_pk_bf16_f32 v116, v116, v118
    v_and_or_b32 v116, v116, -2, s51
    v_smfmac_f32_16x16x64_bf16 v[84:87], v[96:99], v[40:47], v1
    global_store_dword v2, v116, s[8:9] offset:-2048 sc1
    s_waitcnt lgkmcnt(6)
    v_cvt_pk_bf16_f32 v117, v117, v119
    v_and_or_b32 v117, v117, -2, s51
    v_smfmac_f32_16x16x64_bf16 v[92:95], v[100:103], v[56:63], v1
    global_store_dword v2, v117, s[10:11] offset:-2048 sc1
    s_waitcnt lgkmcnt(4)
    v_smfmac_f32_16x16x64_bf16 v[92:95], v[104:107], v[64:71], v1
    s_waitcnt lgkmcnt(2)
    v_cvt_pk_bf16_f32 v84, v84, v86
    v_and_or_b32 v84, v84, -2, s51
    v_smfmac_f32_16x16x64_bf16 v[92:95], v[108:111], v[72:79], v1
    global_store_dword v2, v84, s[8:9] offset:0 sc1
    s_waitcnt lgkmcnt(0)
    v_cvt_pk_bf16_f32 v85, v85, v87
    v_and_or_b32 v85, v85, -2, s51
    v_smfmac_f32_16x16x64_bf16 v[92:95], v[96:99], v[48:55], v1
    global_store_dword v2, v85, s[10:11] offset:0 sc1
    s_nop 0
    v_mov_b64 v[96:97], 0
    v_mov_b64 v[98:99], 0
    v_mov_b64 v[100:101], 0
    v_mov_b64 v[102:103], 0
    v_mov_b64 v[104:105], 0
    v_mov_b64 v[106:107], 0
    v_cvt_pk_bf16_f32 v92, v92, v94
    v_and_or_b32 v92, v92, -2, s51
    v_cvt_pk_bf16_f32 v93, v93, v95
    v_and_or_b32 v93, v93, -2, s51
    v_mov_b64 v[108:109], 0
    s_add_u32 s12, s12, 4096
    s_addc_u32 s13, s13, 0
    s_add_u32 s34, s34, 1
    global_store_dword v2, v92, s[8:9] offset:2048 sc1
    global_store_dword v2, v93, s[10:11] offset:2048 sc1
    v_mov_b64 v[110:111], 0
    s_add_u32 s44, s44, 16384
    s_addc_u32 s45, s45, 0
    s_add_u32 s46, s46, 16384
    s_addc_u32 s47, s47, 0
    s_xor_b32 s40, s40, 65536
    v_mov_b64 v[112:113], 0
    s_nop 4
    v_mov_b64 v[114:115], 0
    s_nop 4
    v_mov_b64 v[116:117], 0
    s_nop 4
    v_mov_b64 v[118:119], 0
    s_nop 4
    v_mov_b64 v[86:87], 0
    s_nop 4
    v_mov_b64 v[94:95], 0
    s_nop 3
    global_load_dword v120, v9, s[36:37] offset:0 sc1
    global_load_dword v121, v9, s[36:37] offset:256 sc1
    global_load_dword v122, v9, s[36:37] offset:512 sc1
    global_load_dword v123, v9, s[36:37] offset:768 sc1
    global_load_dword v124, v9, s[36:37] offset:1024 sc1
    global_load_dword v125, v9, s[36:37] offset:1280 sc1
    global_load_dword v126, v9, s[36:37] offset:1536 sc1
    global_load_dword v127, v9, s[36:37] offset:1792 sc1
    ds_read_b128 v[48:51], v8 offset:1024
    ds_read_b128 v[52:55], v8 offset:5120
    v_mov_b32 v10, 0
    s_nop 1
    ds_read_b128 v[56:59], v8 offset:9216
    ds_read_b128 v[60:63], v8 offset:13312
    v_mov_b32 v10, 0
    s_nop 1
    ds_read_b128 v[64:67], v8 offset:17408
    ds_read_b128 v[68:71], v8 offset:21504
    v_mov_b32 v10, 0
    s_nop 1
    ds_read_b128 v[72:75], v8 offset:25600
    ds_read_b128 v[76:79], v8 offset:29696
    v_mov_b32 v10, 0
    s_nop 1
    s_cmp_eq_u32 s51, 0
    s_cbranch_scc1 L_tag0_164
    s_waitcnt vmcnt(4)
    v_bitop3_b32 v10, v120, v121, v122 bitop3:0x80
    v_bitop3_b32 v10, v10, v123, 1 bitop3:0x80
    v_mfma_f32_16x16x32_bf16 v[32:35], v[12:15], v[120:123], 0
    s_waitcnt vmcnt(0)
    v_bitop3_b32 v10, v10, v124, v125 bitop3:0x80
    v_bitop3_b32 v10, v10, v126, v127 bitop3:0x80
    v_mfma_f32_16x16x32_bf16 v[32:35], v[12:15], v[124:127], v[32:35]
    s_nop 0
    v_cmp_ne_u32 vcc, 1, v10
    ds_read_b32 v40, v9 offset:31104
    s_mov_b64 exec, s[26:27]
    s_nop 2
    s_cbranch_vccnz L_h1r_165
    v_cvt_pk_bf16_f32 v11, v32, v33
    global_store_dword v3, v11, s[42:43] offset:0 sc1
    s_mov_b64 exec, -1
    s_branch L_step_153
L_h1r_165:
    s_mov_b64 exec, -1
    global_load_dword v120, v9, s[36:37] offset:0 sc1
    global_load_dword v121, v9, s[36:37] offset:256 sc1
    global_load_dword v122, v9, s[36:37] offset:512 sc1
    global_load_dword v123, v9, s[36:37] offset:768 sc1
    global_load_dword v124, v9, s[36:37] offset:1024 sc1
    global_load_dword v125, v9, s[36:37] offset:1280 sc1
    global_load_dword v126, v9, s[36:37] offset:1536 sc1
    global_load_dword v127, v9, s[36:37] offset:1792 sc1
    s_sub_u32 s50, s50, 1
    s_cselect_b64 s[48:49], 0, s[48:49]
    s_waitcnt vmcnt(8)
    v_bitop3_b32 v10, v120, v121, v122 bitop3:0x80
    v_bitop3_b32 v10, v10, v123, 1 bitop3:0x80
    v_mfma_f32_16x16x32_bf16 v[32:35], v[12:15], v[120:123], 0
    s_nop 0
    v_bitop3_b32 v10, v10, v124, v125 bitop3:0x80
    v_bitop3_b32 v10, v10, v126, v127 bitop3:0x80
    v_mfma_f32_16x16x32_bf16 v[32:35], v[12:15], v[124:127], v[32:35]
    s_nop 0
    v_cmp_ne_u32 vcc, 1, v10
    s_nop 0
    s_mov_b64 exec, s[26:27]
    s_nop 1
    s_and_b64 vcc, vcc, s[48:49]
    s_cbranch_scc1 L_h1r_165
    v_cvt_pk_bf16_f32 v11, v32, v33
    global_store_dword v3, v11, s[42:43] offset:0 sc1
    s_mov_b64 exec, -1
    s_branch L_step_153
L_tag0_164:
    s_waitcnt vmcnt(4)
    v_bitop3_b32 v10, v120, v121, v122 bitop3:0x01
    v_bitop3_b32 v10, v10, v123, 1 bitop3:0x20
    v_mfma_f32_16x16x32_bf16 v[32:35], v[12:15], v[120:123], 0
    s_waitcnt vmcnt(0)
    v_bitop3_b32 v10, v10, v124, v125 bitop3:0x10
    v_bitop3_b32 v10, v10, v126, v127 bitop3:0x10
    v_mfma_f32_16x16x32_bf16 v[32:35], v[12:15], v[124:127], v[32:35]
    s_nop 0
    v_cmp_ne_u32 vcc, 1, v10
    ds_read_b32 v40, v9 offset:31104
    s_mov_b64 exec, s[26:27]
    s_nop 2
    s_cbranch_vccnz L_h1r_166
    v_cvt_pk_bf16_f32 v11, v32, v33
    global_store_dword v3, v11, s[42:43] offset:0 sc1
    s_mov_b64 exec, -1
    s_branch L_step_153
L_h1r_166:
    s_mov_b64 exec, -1
    global_load_dword v120, v9, s[36:37] offset:0 sc1
    global_load_dword v121, v9, s[36:37] offset:256 sc1
    global_load_dword v122, v9, s[36:37] offset:512 sc1
    global_load_dword v123, v9, s[36:37] offset:768 sc1
    global_load_dword v124, v9, s[36:37] offset:1024 sc1
    global_load_dword v125, v9, s[36:37] offset:1280 sc1
    global_load_dword v126, v9, s[36:37] offset:1536 sc1
    global_load_dword v127, v9, s[36:37] offset:1792 sc1
    s_sub_u32 s50, s50, 1
    s_cselect_b64 s[48:49], 0, s[48:49]
    s_waitcnt vmcnt(8)
    v_bitop3_b32 v10, v120, v121, v122 bitop3:0x01
    v_bitop3_b32 v10, v10, v123, 1 bitop3:0x20
    v_mfma_f32_16x16x32_bf16 v[32:35], v[12:15], v[120:123], 0
    s_nop 0
    v_bitop3_b32 v10, v10, v124, v125 bitop3:0x10
    v_bitop3_b32 v10, v10, v126, v127 bitop3:0x10
    v_mfma_f32_16x16x32_bf16 v[32:35], v[12:15], v[124:127], v[32:35]
    s_nop 0
    v_cmp_ne_u32 vcc, 1, v10
    s_nop 0
    s_mov_b64 exec, s[26:27]
    s_nop 1
    s_and_b64 vcc, vcc, s[48:49]
    s_cbranch_scc1 L_h1r_166
    v_cvt_pk_bf16_f32 v11, v32, v33
    global_store_dword v3, v11, s[42:43] offset:0 sc1
    s_mov_b64 exec, -1
    s_branch L_step_153
L_fq_155:
    global_load_dword v40, v9, s[14:15] sc1
    s_sub_u32 s50, s50, 1
    s_cselect_b64 s[48:49], 0, s[48:49]
    s_and_b64 s[18:19], s[18:19], s[48:49]
    s_waitcnt vmcnt(0)
    ds_write_b32 v9, v40 offset:31104
    s_branch L_fqb_156
L_last_162:
    v_add_u32 v10, 29472, v9
    ds_read2_b32 v[124:125], v10 offset0:0 offset1:68
    s_add_u32 s12, s12, 4096
    s_addc_u32 s13, s13, 0
    global_store_dword v9, v82, s[12:13] offset:2560 sc1
    global_store_dword v9, v90, s[12:13] offset:2816 sc1
    s_waitcnt lgkmcnt(0)
    global_store_dword v9, v124, s[12:13] offset:512 sc1
    global_store_dword v9, v125, s[12:13] offset:768 sc1
    s_cmp_eq_u32 s34, 63
    s_cbranch_scc1 L_exit_154
    s_sub_u32 s12, s12, 4096
    s_subb_u32 s13, s13, 0
    s_getpc_b64 s[64:65]
L_pc_167:
    s_add_u32 s64, s64, L_fin_1-L_pc_167
    s_addc_u32 s65, s65, 0
    v_lshlrev_b32 v126, 2, v0
    v_min_u32 v126, L_code_end-L_fin_1-4, v126
    global_load_dword v127, v126, s[64:65]
    s_branch L_lastb_163
L_h2a_157:
    global_load_dwordx4 v[16:19], v0, s[40:41] offset:-2048 sc1
    global_load_dwordx4 v[20:23], v0, s[40:41] offset:2048 sc1
    s_nop 4
    v_mov_b64 v[96:97], 0
    v_mov_b64 v[98:99], 0
    v_mov_b64 v[100:101], 0
    v_mov_b64 v[102:103], 0
    s_waitcnt vmcnt(3)
    v_maximum3_f32 v11, v16, v17, v18
    v_cmp_u_f32 vcc, v11, v19
    v_smfmac_f32_16x16x64_bf16 v[96:99], v[16:19], v[48:55], v1
    ds_write_b128 v0, v[16:19] offset:17408
    v_smfmac_f32_16x16x64_bf16 v[100:103], v[16:19], v[56:63], v1
    s_cbranch_vccz L_h2cc_161
L_h2l2_168:
    global_load_dwordx4 v[16:19], v0, s[40:41] offset:-2048 sc1
    global_load_dwordx4 v[20:23], v0, s[40:41] offset:2048 sc1
    s_sub_u32 s2, s2, 1
    s_cselect_b64 s[38:39], 0, s[38:39]
    s_nop 2
    v_mov_b64 v[96:97], 0
    v_mov_b64 v[98:99], 0
    v_mov_b64 v[100:101], 0
    v_mov_b64 v[102:103], 0
    s_waitcnt vmcnt(3)
    v_maximum3_f32 v11, v16, v17, v18
    v_cmp_u_f32 vcc, v11, v19
    v_smfmac_f32_16x16x64_bf16 v[96:99], v[16:19], v[48:55], v1
    ds_write_b128 v0, v[16:19] offset:17408
    v_smfmac_f32_16x16x64_bf16 v[100:103], v[16:19], v[56:63], v1
    s_and_b64 vcc, vcc, s[38:39]
    s_cbranch_scc0 L_h2cc_161
    s_branch L_h2l2_168
    global_load_dwordx4 v[16:19], v0, s[40:41] offset:-2048 sc1
    global_load_dwordx4 v[20:23], v0, s[40:41] offset:2048 sc1
    s_sub_u32 s2, s2, 1
    s_cselect_b64 s[38:39], 0, s[38:39]
    s_cmp_eq_u64 s[38:39], 0
    s_cbranch_scc1 L_h2cc_161
    s_nop 2
    v_mov_b64 v[96:97], 0
    v_mov_b64 v[98:99], 0
    v_mov_b64 v[100:101], 0
    v_mov_b64 v[102:103], 0
    s_waitcnt vmcnt(3)
    s_branch L_h2ca_159
L_h2b_158:
    global_load_dwordx4 v[20:23], v0, s[40:41] offset:2048 sc1
    s_sub_u32 s2, s2, 1
    s_cselect_b64 s[38:39], 0, s[38:39]
    s_waitcnt vmcnt(1)
    v_maximum3_f32 v11, v20, v21, v22
    v_cmp_u_f32 vcc, v11, v23
    s_and_b64 vcc, vcc, s[38:39]
    s_cbranch_scc0 L_h2cb_160
    s_branch L_h2b_158
L_exit_154:
    s_branch L_done_152
.p2align 6
L_fast_1:
L_step_169:
    s_add_u32 s62, s34, 1
    s_lshl_b32 s62, s62, 2
    s_waitcnt lgkmcnt(0)
L_fqb_172:
    v_mad_u32_u24 v40, v40, 8, v9
    v_cmp_ge_u32 vcc, s62, v40
    s_add_u32 s63, s62, 8
    v_cmp_ge_u32 s[64:65], s63, v40
    s_and_b64 vcc, vcc, s[18:19]
    s_cbranch_scc1 L_fq_171
    v_mov_b32 v10, 0
    s_xor_b32 s51, s51, 1
    s_xor_b32 s42, s42, 65536
    s_nop 0
    s_cmp_eq_u32 s34, 63
    s_barrier
    s_cbranch_scc1 L_exit_170
    v_mov_b32 v10, 0
    s_and_b32 s64, s64, 3
    s_cselect_b64 s[20:21], s[14:15], s[36:37]
    s_cselect_b32 s22, 31104, s16
    s_nop 0
    global_load_dwordx4 v[16:19], v0, s[40:41] offset:-2048 sc1
    ds_read_b64 v[80:81], v0 offset:10240
    ds_read_b64 v[84:85], v0 offset:10248
    ds_read_b64 v[88:89], v0 offset:11264
    ds_read_b64 v[92:93], v0 offset:11272
    v_mov_b32 v10, 0
    s_nop 4
    v_mov_b32 v10, 0
    s_nop 4
    global_load_dwordx4 v[20:23], v0, s[40:41] offset:2048 sc1
    v_mov_b32 v10, 0
    s_nop 4
    v_mov_b32 v10, 0
    s_nop 4
    v_mov_b32 v10, 0
    s_nop 4
    v_mov_b32 v10, 0
    s_nop 1
    global_load_dwordx4 v[16:19], v0, s[40:41] offset:-2048 sc1
    v_mov_b32 v10, 0
    s_nop 4
    v_mov_b32 v10, 0
    s_nop 4
    v_mov_b32 v10, 0
    s_nop 3
    global_load_dwordx4 v[20:23], v0, s[40:41] offset:2048 sc1
    s_waitcnt vmcnt(3) lgkmcnt(0)
L_h2ca_175:
    v_maximum3_f32 v11, v16, v17, v18
    v_cmp_u_f32 vcc, v11, v19
    v_smfmac_f32_16x16x64_bf16 v[96:99], v[16:19], v[48:55], v1
    ds_write_b128 v0, v[16:19] offset:17408
    v_smfmac_f32_16x16x64_bf16 v[100:103], v[16:19], v[56:63], v1
    s_cbranch_vccnz L_h2a_173
L_h2cc_177:
    v_smfmac_f32_16x16x64_bf16 v[104:107], v[16:19], v[64:71], v1
    s_waitcnt vmcnt(2)
    v_maximum3_f32 v11, v20, v21, v22
    v_cmp_u_f32 vcc, v11, v23
    v_smfmac_f32_16x16x64_bf16 v[108:111], v[16:19], v[72:79], v1
    ds_read_b128 v[48:51], v0 offset:0
    v_mov_b32 v122, -1
    v_smfmac_f32_16x16x64_bf16 v[112:115], v[16:19], a[112:119], v1
    ds_read_b128 v[52:55], v0 offset:1024
    s_mov_b32 m0, 19456
    v_smfmac_f32_16x16x64_bf16 v[116:119], v[16:19], a[120:127], v1
    s_cbranch_vccnz L_h2b_174
L_h2cb_176:
    global_load_lds_dwordx4 v0, s[40:41] offset:2048 sc1
    v_smfmac_f32_16x16x64_bf16 v[96:99], v[20:23], a[0:7], v1
    s_waitcnt lgkmcnt(2)
    s_barrier
    v_smfmac_f32_16x16x64_bf16 v[100:103], v[20:23], a[8:15], v1
    global_store_dword v3, v122, s[42:43] offset:0
    ds_read_b128 v[24:27], v0 offset:18432
    v_smfmac_f32_16x16x64_bf16 v[104:107], v[20:23], a[16:23], v1
    ds_read_b128 v[28:31], v0 offset:19456
    s_mov_b32 m0, s22
    v_smfmac_f32_16x16x64_bf16 v[108:111], v[20:23], a[24:31], v1
    global_load_lds_dword v9, s[20:21] sc1
    ds_read_b128 v[32:35], v0 offset:16384
    v_smfmac_f32_16x16x64_bf16 v[112:115], v[20:23], a[176:183], v1
    ds_read_b128 v[56:59], v0 offset:2048
    s_mov_b32 m0, 10240
    v_smfmac_f32_16x16x64_bf16 v[116:119], v[20:23], a[184:191], v1
    ds_read_b128 v[60:63], v0 offset:3072
    s_waitcnt lgkmcnt(4)
    v_smfmac_f32_16x16x64_bf16 v[96:99], v[24:27], v[160:167], v1
    ds_read_b128 v[64:67], v0 offset:4096
    v_add_u32 v10, 29472, v9
    v_smfmac_f32_16x16x64_bf16 v[100:103], v[24:27], v[168:175], v1
    global_load_lds_dwordx4 v0, s[46:47] sc1
    ds_read_b128 v[68:71], v0 offset:5120
    v_smfmac_f32_16x16x64_bf16 v[104:107], v[24:27], v[176:183], v1
    ds_read_b128 v[72:75], v0 offset:6144
    v_smfmac_f32_16x16x64_bf16 v[108:111], v[24:27], v[184:191], v1
    ds_read_b128 v[76:79], v0 offset:7168
    s_waitcnt lgkmcnt(6)
    v_smfmac_f32_16x16x64_bf16 v[96:99], v[28:31], v[192:199], v1
    ds_read2_b32 v[124:125], v10 offset0:0 offset1:68
    v_smfmac_f32_16x16x64_bf16 v[100:103], v[28:31], v[200:207], v1
    global_load_lds_dwordx4 v0, s[46:47] offset:1024 sc1
    s_mov_b32 m0, 2048
    v_smfmac_f32_16x16x64_bf16 v[104:107], v[28:31], v[208:215], v1
    v_smfmac_f32_16x16x64_bf16 v[108:111], v[28:31], v[216:223], v1
    global_store_dword v9, v82, s[12:13] offset:2560 sc1
    v_smfmac_f32_16x16x64_bf16 v[96:99], v[32:35], v[128:135], v1
    s_waitcnt vmcnt(5) lgkmcnt(0)
    s_barrier
    v_smfmac_f32_16x16x64_bf16 v[100:103], v[32:35], v[136:143], v1
    global_store_dword v9, v90, s[12:13] offset:2816 sc1
    ds_read_b128 v[36:39], v0 offset:22528
    v_smfmac_f32_16x16x64_bf16 v[104:107], v[32:35], v[144:151], v1
    global_load_lds_dwordx4 v0, s[44:45] sc1
    ds_read_b128 v[40:43], v0 offset:23552
    v_smfmac_f32_16x16x64_bf16 v[108:111], v[32:35], v[152:159], v1
    ds_read_b128 v[44:47], v0 offset:20480
    s_waitcnt lgkmcnt(2)
    v_smfmac_f32_16x16x64_bf16 v[96:99], v[36:39], a[32:39], v1
    v_smfmac_f32_16x16x64_bf16 v[100:103], v[36:39], a[40:47], v1
    global_store_dword v9, v124, s[12:13] offset:512 sc1
    s_waitcnt lgkmcnt(0)
    v_smfmac_f32_16x16x64_bf16 v[96:99], v[40:43], a[64:71], v1
    global_load_lds_dwordx4 v0, s[44:45] offset:1024 sc1
    s_cmp_ge_u32 s34, 62
    v_smfmac_f32_16x16x64_bf16 v[96:99], v[44:47], v[224:231], v1
    global_store_dword v9, v125, s[12:13] offset:768 sc1
    v_smfmac_f32_16x16x64_bf16 v[100:103], v[40:43], a[72:79], v1
    v_smfmac_f32_16x16x64_bf16 v[100:103], v[44:47], v[232:239], v1
    v_add_f32 v96, v96, v98
    v_smfmac_f32_16x16x64_bf16 v[104:107], v[36:39], a[48:55], v1
    v_add_f32 v97, v97, v99
    v_smfmac_f32_16x16x64_bf16 v[104:107], v[40:43], a[80:87], v1
    v_add_f32 v100, v100, v102
    v_add_f32 v101, v101, v103
    v_smfmac_f32_16x16x64_bf16 v[104:107], v[44:47], v[240:247], v1
    v_cvt_pk_bf16_f32 v96, v96, v100
    v_smfmac_f32_16x16x64_bf16 v[108:111], v[36:39], a[56:63], v1
    v_cvt_pk_bf16_f32 v97, v97, v101
    v_smfmac_f32_16x16x64_bf16 v[108:111], v[40:43], a[88:95], v1
    ds_write2_b32 v4, v96, v97 offset0:0 offset1:136
    v_smfmac_f32_16x16x64_bf16 v[108:111], v[44:47], v[248:255], v1
    v_add_f32 v104, v104, v106
    v_smfmac_f32_16x16x64_bf16 v[112:115], v[24:27], a[128:135], v1
    v_add_f32 v105, v105, v107
    v_smfmac_f32_16x16x64_bf16 v[116:119], v[24:27], a[136:143], v1
    ds_read_b128 v[24:27], v8 offset:10240
    v_add_f32 v108, v108, v110
    v_smfmac_f32_16x16x64_bf16 v[112:115], v[28:31], a[144:151], v1
    v_add_f32 v109, v109, v111
    v_smfmac_f32_16x16x64_bf16 v[116:119], v[28:31], a[152:159], v1
    s_waitcnt vmcnt(10) lgkmcnt(1)
    s_barrier
    v_smfmac_f32_16x16x64_bf16 v[112:115], v[32:35], a[96:103], v1
    ds_read_b128 v[120:123], v6 offset:0
    v_cvt_pk_bf16_f32 v10, v104, v108
    v_smfmac_f32_16x16x64_bf16 v[116:119], v[32:35], a[104:111], v1
    ds_read_b128 v[124:127], v6 offset:64
    v_cvt_pk_bf16_f32 v11, v105, v109
    v_smfmac_f32_16x16x64_bf16 v[112:115], v[36:39], a[192:199], v1
    ds_write2_b32 v5, v10, v11 offset0:0 offset1:4
    v_smfmac_f32_16x16x64_bf16 v[116:119], v[36:39], a[200:207], v1
    ds_read_b128 v[16:19], v6 offset:128
    v_mov_b64 v[104:105], 0
    v_smfmac_f32_16x16x64_bf16 v[112:115], v[40:43], a[208:215], v1
    ds_read_b128 v[20:23], v6 offset:192
    v_mov_b64 v[106:107], 0
    v_smfmac_f32_16x16x64_bf16 v[116:119], v[40:43], a[216:223], v1
    ds_read_b128 v[28:31], v8 offset:14336
    v_mov_b64 v[108:109], 0
    v_smfmac_f32_16x16x64_bf16 v[112:115], v[44:47], a[160:167], v1
    ds_read_b128 v[32:35], v8 offset:18432
    v_mov_b64 v[110:111], 0
    v_smfmac_f32_16x16x64_bf16 v[116:119], v[44:47], a[168:175], v1
    ds_read_b128 v[36:39], v8 offset:22528
    s_waitcnt lgkmcnt(6)
    v_mfma_f32_16x16x32_bf16 v[96:99], v[48:51], v[120:123], 0
    s_waitcnt lgkmcnt(5)
    s_barrier
    v_mfma_f32_16x16x32_bf16 v[100:103], v[64:67], v[120:123], 0
    ds_read_b128 v[40:43], v7 offset:0
    v_add_f32 v112, v112, v114
    v_mfma_f32_16x16x32_bf16 v[96:99], v[52:55], v[124:127], v[96:99]
    ds_read_b128 v[44:47], v7 offset:1088
    v_add_f32 v113, v113, v115
    v_mfma_f32_16x16x32_bf16 v[100:103], v[68:71], v[124:127], v[100:103]
    s_waitcnt lgkmcnt(5)
    v_add_f32 v116, v116, v118
    v_add_f32 v117, v117, v119
    v_mfma_f32_16x16x32_bf16 v[96:99], v[56:59], v[16:19], v[96:99]
    ds_read_b128 v[48:51], v8 offset:0
    v_cvt_pk_bf16_f32 v82, v112, v113
    v_mfma_f32_16x16x32_bf16 v[96:99], v[60:63], v[20:23], v[96:99]
    ds_read_b128 v[64:67], v8 offset:16384
    v_cvt_pk_bf16_f32 v90, v116, v117
    v_mfma_f32_16x16x32_bf16 v[100:103], v[72:75], v[16:19], v[100:103]
    ds_read_b128 v[52:55], v8 offset:4096
    v_cvt_pk_bf16_f32 v94, v116, v117
    v_mfma_f32_16x16x32_bf16 v[100:103], v[76:79], v[20:23], v[100:103]
    s_waitcnt lgkmcnt(3)
    v_cvt_pk_bf16_f32 v86, v112, v113
    v_max3_f32 v10, v96, v97, v98
    v_smfmac_f32_16x16x64_bf16 v[104:107], v[40:43], v[120:127], v1
    ds_read_b128 v[68:71], v8 offset:20480
    v_cndmask_b32 v96, v96, v98, s[52:53]
    v_smfmac_f32_16x16x64_bf16 v[104:107], v[44:47], v[16:23], v1
    ds_read_b128 v[56:59], v8 offset:8192
    s_nop 0
    v_cndmask_b32 v97, v97, v99, s[52:53]
    v_max3_f32 v10, v10, v99, v100
    v_max3_f32 v10, v10, v101, v102
    v_cndmask_b32 v98, v100, v102, s[52:53]
    v_cndmask_b32 v99, v101, v103, s[52:53]
    v_max_f32 v10, v10, v103
    v_pk_add_f32 v[104:105], v[104:105], v[106:107]
    v_max3_f32 v11, v10, v104, v105
    v_max3_f32 v10, v10, v104, v105
    v_cndmask_b32 v104, v104, v105, s[52:53]
    v_mov_b64 v[120:121], s[54:55]
    v_permlane32_swap_b32 v10, v11
    v_max_f32 v106, v10, v11
    v_max_f32 v107, v10, v11
    v_mov_b64 v[122:123], s[56:57]
    v_mov_b64 v[116:117], 0
    v_permlane16_swap_b32 v106, v107
    v_max_f32 v10, v106, v107
    v_mul_f32 v10, s61, v10
    v_pk_fma_f32 v[96:97], v[96:97], s[58:59], v[10:11] op_sel_hi:[1,1,0]
    v_pk_fma_f32 v[98:99], v[98:99], s[58:59], v[10:11] op_sel_hi:[1,1,0]
    v_fma_f32 v104, v104, s58, v10
    v_exp_f32 v96, v96
    v_exp_f32 v97, v97
    v_exp_f32 v98, v98
    v_exp_f32 v99, v99
    v_exp_f32 v104, v104
    v_cvt_pk_bf16_f32 v100, v96, v97
    v_cvt_pk_bf16_f32 v102, v98, v99
    v_cvt_pk_bf16_f32 v101, v104, 0
    v_cvt_pk_bf16_f32 v103, v104, 0
    v_mov_b64 v[118:119], 0
    s_nop 0
    v_mfma_f32_16x16x32_bf16 v[112:115], v[100:103], v[120:123], 0
    ds_read_b128 v[60:63], v8 offset:12288
    ds_read_b128 v[72:75], v8 offset:24576
    v_smfmac_f32_16x16x64_bf16 v[108:111], v[100:103], v[80:87], v1 abid:1
    ds_read_b128 v[76:79], v8 offset:28672
    ds_read_b128 v[16:19], v8 offset:26624
    v_smfmac_f32_16x16x64_bf16 v[116:119], v[100:103], v[88:95], v1 abid:1
    ds_read_b128 v[20:23], v8 offset:30720
    s_nop 0
    v_add_f32 v112, v112, v114
    v_add_f32 v113, v113, v115
    v_rcp_f32 v112, v112
    v_rcp_f32 v113, v113
    v_pk_add_f32 v[108:109], v[108:109], v[110:111]
    v_pk_mul_f32 v[108:109], v[108:109], v[112:113]
    v_pk_add_f32 v[116:117], v[116:117], v[118:119]
    v_pk_mul_f32 v[116:117], v[116:117], v[112:113]
    v_cvt_pk_bf16_f32 v10, v108, v116
    v_cvt_pk_bf16_f32 v11, v109, v117
    ds_write2_b32 v4, v10, v11 offset0:64 offset1:200
    ds_read_b128 v[100:103], v6 offset:320
    v_mov_b64 v[112:113], 0
    v_mov_b64 v[114:115], 0
    v_mov_b64 v[116:117], 0
    v_mov_b64 v[118:119], 0
    s_cbranch_scc1 L_last_178
L_lastb_179:
    v_mov_b64 v[84:85], 0
    v_mov_b64 v[86:87], 0
    v_mov_b64 v[92:93], 0
    v_mov_b64 v[94:95], 0
    s_waitcnt vmcnt(9) lgkmcnt(1)
    s_barrier
    ds_read_b128 v[104:107], v6 offset:384
    ds_read_b128 v[108:111], v6 offset:448
    ds_read_b128 v[96:99], v6 offset:256
    s_waitcnt lgkmcnt(3)
    v_smfmac_f32_16x16x64_bf16 v[112:115], v[100:103], v[56:63], v1
    ds_read_b128 v[40:43], v8 offset:2048
    v_smfmac_f32_16x16x64_bf16 v[116:119], v[100:103], a[232:239], v1
    ds_read_b128 v[44:47], v8 offset:6144
    v_smfmac_f32_16x16x64_bf16 v[84:87], v[100:103], v[24:31], v1
    ds_read_b128 v[56:59], v8 offset:11264
    s_waitcnt lgkmcnt(5)
    v_smfmac_f32_16x16x64_bf16 v[112:115], v[104:107], v[64:71], v1
    ds_read_b128 v[60:63], v8 offset:15360
    s_waitcnt lgkmcnt(5)
    v_smfmac_f32_16x16x64_bf16 v[112:115], v[108:111], v[72:79], v1
    ds_read_b128 v[64:67], v8 offset:19456
    s_waitcnt lgkmcnt(5)
    v_smfmac_f32_16x16x64_bf16 v[112:115], v[96:99], v[48:55], v1
    ds_read_b128 v[68:71], v8 offset:23552
    v_smfmac_f32_16x16x64_bf16 v[116:119], v[104:107], a[240:247], v1
    ds_read_b128 v[72:75], v8 offset:27648
    v_smfmac_f32_16x16x64_bf16 v[116:119], v[108:111], a[248:255], v1
    ds_read_b128 v[76:79], v8 offset:31744
    v_cvt_pk_bf16_f32 v112, v112, v114
    v_and_or_b32 v112, v112, -2, s51
    v_smfmac_f32_16x16x64_bf16 v[116:119], v[96:99], a[224:231], v1
    global_store_dword v2, v112, s[8:9] offset:-4096
    v_cvt_pk_bf16_f32 v113, v113, v115
    v_and_or_b32 v113, v113, -2, s51
    v_smfmac_f32_16x16x64_bf16 v[84:87], v[104:107], v[32:39], v1
    global_store_dword v2, v113, s[10:11] offset:-4096
    ds_read_b128 v[48:51], v8 offset:3072
    v_smfmac_f32_16x16x64_bf16 v[84:87], v[108:111], v[16:23], v1
    ds_read_b128 v[52:55], v8 offset:7168
    s_waitcnt lgkmcnt(8)
    v_cvt_pk_bf16_f32 v116, v116, v118
    v_and_or_b32 v116, v116, -2, s51
    v_smfmac_f32_16x16x64_bf16 v[84:87], v[96:99], v[40:47], v1
    global_store_dword v2, v116, s[8:9] offset:-2048
    s_waitcnt lgkmcnt(6)
    v_cvt_pk_bf16_f32 v117, v117, v119
    v_and_or_b32 v117, v117, -2, s51
    v_smfmac_f32_16x16x64_bf16 v[92:95], v[100:103], v[56:63], v1
    global_store_dword v2, v117, s[10:11] offset:-2048
    s_waitcnt lgkmcnt(4)
    v_smfmac_f32_16x16x64_bf16 v[92:95], v[104:107], v[64:71], v1
    s_waitcnt lgkmcnt(2)
    v_cvt_pk_bf16_f32 v84, v84, v86
    v_and_or_b32 v84, v84, -2, s51
    v_smfmac_f32_16x16x64_bf16 v[92:95], v[108:111], v[72:79], v1
    global_store_dword v2, v84, s[8:9] offset:0
    s_waitcnt lgkmcnt(0)
    v_cvt_pk_bf16_f32 v85, v85, v87
    v_and_or_b32 v85, v85, -2, s51
    v_smfmac_f32_16x16x64_bf16 v[92:95], v[96:99], v[48:55], v1
    global_store_dword v2, v85, s[10:11] offset:0
    s_nop 0
    v_mov_b64 v[96:97], 0
    v_mov_b64 v[98:99], 0
    v_mov_b64 v[100:101], 0
    v_mov_b64 v[102:103], 0
    v_mov_b64 v[104:105], 0
    v_mov_b64 v[106:107], 0
    v_cvt_pk_bf16_f32 v92, v92, v94
    v_and_or_b32 v92, v92, -2, s51
    v_cvt_pk_bf16_f32 v93, v93, v95
    v_and_or_b32 v93, v93, -2, s51
    v_mov_b64 v[108:109], 0
    s_add_u32 s12, s12, 4096
    s_addc_u32 s13, s13, 0
    s_add_u32 s34, s34, 1
    global_store_dword v2, v92, s[8:9] offset:2048
    global_store_dword v2, v93, s[10:11] offset:2048
    v_mov_b64 v[110:111], 0
    s_add_u32 s44, s44, 16384
    s_addc_u32 s45, s45, 0
    s_add_u32 s46, s46, 16384
    s_addc_u32 s47, s47, 0
    s_xor_b32 s40, s40, 65536
    v_mov_b64 v[112:113], 0
    s_nop 4
    v_mov_b64 v[114:115], 0
    s_nop 4
    v_mov_b64 v[116:117], 0
    s_nop 4
    v_mov_b64 v[118:119], 0
    s_nop 4
    v_mov_b64 v[86:87], 0
    s_nop 4
    v_mov_b64 v[94:95], 0
    s_nop 3
    global_load_dword v120, v9, s[36:37] offset:0 sc1
    global_load_dword v121, v9, s[36:37] offset:256 sc1
    global_load_dword v122, v9, s[36:37] offset:512 sc1
    global_load_dword v123, v9, s[36:37] offset:768 sc1
    global_load_dword v124, v9, s[36:37] offset:1024 sc1
    global_load_dword v125, v9, s[36:37] offset:1280 sc1
    global_load_dword v126, v9, s[36:37] offset:1536 sc1
    global_load_dword v127, v9, s[36:37] offset:1792 sc1
    ds_read_b128 v[48:51], v8 offset:1024
    ds_read_b128 v[52:55], v8 offset:5120
    v_mov_b32 v10, 0
    s_nop 1
    ds_read_b128 v[56:59], v8 offset:9216
    ds_read_b128 v[60:63], v8 offset:13312
    v_mov_b32 v10, 0
    s_nop 1
    ds_read_b128 v[64:67], v8 offset:17408
    ds_read_b128 v[68:71], v8 offset:21504
    v_mov_b32 v10, 0
    s_nop 1
    ds_read_b128 v[72:75], v8 offset:25600
    ds_read_b128 v[76:79], v8 offset:29696
    v_mov_b32 v10, 0
    s_nop 1
    s_cmp_eq_u32 s51, 0
    s_cbranch_scc1 L_tag0_180
    s_waitcnt vmcnt(4)
    v_bitop3_b32 v10, v120, v121, v122 bitop3:0x80
    v_bitop3_b32 v10, v10, v123, 1 bitop3:0x80
    v_mfma_f32_16x16x32_bf16 v[32:35], v[12:15], v[120:123], 0
    s_waitcnt vmcnt(0)
    v_bitop3_b32 v10, v10, v124, v125 bitop3:0x80
    v_bitop3_b32 v10, v10, v126, v127 bitop3:0x80
    v_mfma_f32_16x16x32_bf16 v[32:35], v[12:15], v[124:127], v[32:35]
    s_nop 0
    v_cmp_ne_u32 vcc, 1, v10
    ds_read_b32 v40, v9 offset:31104
    s_mov_b64 exec, s[26:27]
    s_nop 2
    s_cbranch_vccnz L_h1r_181
    v_cvt_pk_bf16_f32 v11, v32, v33
    global_store_dword v3, v11, s[42:43] offset:0
    s_mov_b64 exec, -1
    s_branch L_step_169
L_h1r_181:
    s_mov_b64 exec, -1
    global_load_dword v120, v9, s[36:37] offset:0 sc1
    global_load_dword v121, v9, s[36:37] offset:256 sc1
    global_load_dword v122, v9, s[36:37] offset:512 sc1
    global_load_dword v123, v9, s[36:37] offset:768 sc1
    global_load_dword v124, v9, s[36:37] offset:1024 sc1
    global_load_dword v125, v9, s[36:37] offset:1280 sc1
    global_load_dword v126, v9, s[36:37] offset:1536 sc1
    global_load_dword v127, v9, s[36:37] offset:1792 sc1
    s_sub_u32 s50, s50, 1
    s_cselect_b64 s[48:49], 0, s[48:49]
    s_waitcnt vmcnt(8)
    v_bitop3_b32 v10, v120, v121, v122 bitop3:0x80
    v_bitop3_b32 v10, v10, v123, 1 bitop3:0x80
    v_mfma_f32_16x16x32_bf16 v[32:35], v[12:15], v[120:123], 0
    s_nop 0
    v_bitop3_b32 v10, v10, v124, v125 bitop3:0x80
    v_bitop3_b32 v10, v10, v126, v127 bitop3:0x80
    v_mfma_f32_16x16x32_bf16 v[32:35], v[12:15], v[124:127], v[32:35]
    s_nop 0
    v_cmp_ne_u32 vcc, 1, v10
    s_nop 0
    s_mov_b64 exec, s[26:27]
    s_nop 1
    s_and_b64 vcc, vcc, s[48:49]
    s_cbranch_scc1 L_h1r_181
    v_cvt_pk_bf16_f32 v11, v32, v33
    global_store_dword v3, v11, s[42:43] offset:0
    s_mov_b64 exec, -1
    s_branch L_step_169
L_tag0_180:
    s_waitcnt vmcnt(4)
    v_bitop3_b32 v10, v120, v121, v122 bitop3:0x01
    v_bitop3_b32 v10, v10, v123, 1 bitop3:0x20
    v_mfma_f32_16x16x32_bf16 v[32:35], v[12:15], v[120:123], 0
    s_waitcnt vmcnt(0)
    v_bitop3_b32 v10, v10, v124, v125 bitop3:0x10
    v_bitop3_b32 v10, v10, v126, v127 bitop3:0x10
    v_mfma_f32_16x16x32_bf16 v[32:35], v[12:15], v[124:127], v[32:35]
    s_nop 0
    v_cmp_ne_u32 vcc, 1, v10
    ds_read_b32 v40, v9 offset:31104
    s_mov_b64 exec, s[26:27]
    s_nop 2
    s_cbranch_vccnz L_h1r_182
    v_cvt_pk_bf16_f32 v11, v32, v33
    global_store_dword v3, v11, s[42:43] offset:0
    s_mov_b64 exec, -1
    s_branch L_step_169
L_h1r_182:
    s_mov_b64 exec, -1
    global_load_dword v120, v9, s[36:37] offset:0 sc1
    global_load_dword v121, v9, s[36:37] offset:256 sc1
    global_load_dword v122, v9, s[36:37] offset:512 sc1
    global_load_dword v123, v9, s[36:37] offset:768 sc1
    global_load_dword v124, v9, s[36:37] offset:1024 sc1
    global_load_dword v125, v9, s[36:37] offset:1280 sc1
    global_load_dword v126, v9, s[36:37] offset:1536 sc1
    global_load_dword v127, v9, s[36:37] offset:1792 sc1
    s_sub_u32 s50, s50, 1
    s_cselect_b64 s[48:49], 0, s[48:49]
    s_waitcnt vmcnt(8)
    v_bitop3_b32 v10, v120, v121, v122 bitop3:0x01
    v_bitop3_b32 v10, v10, v123, 1 bitop3:0x20
    v_mfma_f32_16x16x32_bf16 v[32:35], v[12:15], v[120:123], 0
    s_nop 0
    v_bitop3_b32 v10, v10, v124, v125 bitop3:0x10
    v_bitop3_b32 v10, v10, v126, v127 bitop3:0x10
    v_mfma_f32_16x16x32_bf16 v[32:35], v[12:15], v[124:127], v[32:35]
    s_nop 0
    v_cmp_ne_u32 vcc, 1, v10
    s_nop 0
    s_mov_b64 exec, s[26:27]
    s_nop 1
    s_and_b64 vcc, vcc, s[48:49]
    s_cbranch_scc1 L_h1r_182
    v_cvt_pk_bf16_f32 v11, v32, v33
    global_store_dword v3, v11, s[42:43] offset:0
    s_mov_b64 exec, -1
    s_branch L_step_169
L_fq_171:
    global_load_dword v40, v9, s[14:15] sc1
    s_sub_u32 s50, s50, 1
    s_cselect_b64 s[48:49], 0, s[48:49]
    s_and_b64 s[18:19], s[18:19], s[48:49]
    s_waitcnt vmcnt(0)
    ds_write_b32 v9, v40 offset:31104
    s_branch L_fqb_172
L_last_178:
    v_add_u32 v10, 29472, v9
    ds_read2_b32 v[124:125], v10 offset0:0 offset1:68
    s_add_u32 s12, s12, 4096
    s_addc_u32 s13, s13, 0
    global_store_dword v9, v82, s[12:13] offset:2560 sc1
    global_store_dword v9, v90, s[12:13] offset:2816 sc1
    s_waitcnt lgkmcnt(0)
    global_store_dword v9, v124, s[12:13] offset:512 sc1
    global_store_dword v9, v125, s[12:13] offset:768 sc1
    s_cmp_eq_u32 s34, 63
    s_cbranch_scc1 L_exit_170
    s_sub_u32 s12, s12, 4096
    s_subb_u32 s13, s13, 0
    s_getpc_b64 s[64:65]
L_pc_183:
    s_add_u32 s64, s64, L_fin_1-L_pc_183
    s_addc_u32 s65, s65, 0
    v_lshlrev_b32 v126, 2, v0
    v_min_u32 v126, L_code_end-L_fin_1-4, v126
    global_load_dword v127, v126, s[64:65]
    s_branch L_lastb_179
L_h2a_173:
    global_load_dwordx4 v[16:19], v0, s[40:41] offset:-2048 sc1
    global_load_dwordx4 v[20:23], v0, s[40:41] offset:2048 sc1
    s_nop 4
    v_mov_b64 v[96:97], 0
    v_mov_b64 v[98:99], 0
    v_mov_b64 v[100:101], 0
    v_mov_b64 v[102:103], 0
    s_waitcnt vmcnt(3)
    v_maximum3_f32 v11, v16, v17, v18
    v_cmp_u_f32 vcc, v11, v19
    v_smfmac_f32_16x16x64_bf16 v[96:99], v[16:19], v[48:55], v1
    ds_write_b128 v0, v[16:19] offset:17408
    v_smfmac_f32_16x16x64_bf16 v[100:103], v[16:19], v[56:63], v1
    s_cbranch_vccz L_h2cc_177
L_h2l2_184:
    global_load_dwordx4 v[16:19], v0, s[40:41] offset:-2048 sc1
    global_load_dwordx4 v[20:23], v0, s[40:41] offset:2048 sc1
    s_sub_u32 s2, s2, 1
    s_cselect_b64 s[38:39], 0, s[38:39]
    s_nop 2
    v_mov_b64 v[96:97], 0
    v_mov_b64 v[98:99], 0
    v_mov_b64 v[100:101], 0
    v_mov_b64 v[102:103], 0
    s_waitcnt vmcnt(3)
    v_maximum3_f32 v11, v16, v17, v18
    v_cmp_u_f32 vcc, v11, v19
    v_smfmac_f32_16x16x64_bf16 v[96:99], v[16:19], v[48:55], v1
    ds_write_b128 v0, v[16:19] offset:17408
    v_smfmac_f32_16x16x64_bf16 v[100:103], v[16:19], v[56:63], v1
    s_and_b64 vcc, vcc, s[38:39]
    s_cbranch_scc0 L_h2cc_177
    s_branch L_h2l2_184
    global_load_dwordx4 v[16:19], v0, s[40:41] offset:-2048 sc1
    global_load_dwordx4 v[20:23], v0, s[40:41] offset:2048 sc1
    s_sub_u32 s2, s2, 1
    s_cselect_b64 s[38:39], 0, s[38:39]
    s_cmp_eq_u64 s[38:39], 0
    s_cbranch_scc1 L_h2cc_177
    s_nop 2
    v_mov_b64 v[96:97], 0
    v_mov_b64 v[98:99], 0
    v_mov_b64 v[100:101], 0
    v_mov_b64 v[102:103], 0
    s_waitcnt vmcnt(3)
    s_branch L_h2ca_175
L_h2b_174:
    global_load_dwordx4 v[20:23], v0, s[40:41] offset:2048 sc1
    s_sub_u32 s2, s2, 1
    s_cselect_b64 s[38:39], 0, s[38:39]
    s_waitcnt vmcnt(1)
    v_maximum3_f32 v11, v20, v21, v22
    v_cmp_u_f32 vcc, v11, v23
    s_and_b64 vcc, vcc, s[38:39]
    s_cbranch_scc0 L_h2cb_176
    s_branch L_h2b_174
L_exit_170:
L_done_152:
L_fin_1:
    s_nop 9
    global_load_dwordx4 v[16:19], v0, s[40:41] offset:-2048 sc1
    global_load_dwordx4 v[20:23], v0, s[40:41] offset:2048 sc1
    v_lshrrev_b32 v80, 4, v0
    v_and_b32 v81, 15, v80
    v_lshrrev_b32 v82, 4, v80
    v_lshrrev_b32 v83, 2, v80
    v_and_b32 v84, 3, v80
    v_and_b32 v85, 3, v83
    v_add_u32 v86, 0, v81
    v_lshlrev_b32 v87, 2, v82
    v_sub_u32 v86, v86, v87
    v_cmp_le_i32 s[72:73], 0, v86
    v_cmp_le_i32 s[74:75], 1, v86
    v_cmp_le_i32 s[76:77], 2, v86
    v_cmp_le_i32 s[78:79], 3, v86
    v_cmp_le_i32 s[80:81], 16, v86
    v_cmp_le_i32 s[82:83], 17, v86
    v_cmp_le_i32 s[84:85], 18, v86
    v_cmp_le_i32 s[86:87], 19, v86
    s_mul_i32 s62, s32, 532480
    s_add_u32 s62, s62, 51896320
    s_add_u32 s88, s4, s62
    s_addc_u32 s89, s5, 0
    global_load_dwordx4 v[16:19], v0, s[40:41] offset:-2048 sc1
    global_load_dwordx4 v[20:23], v0, s[40:41] offset:2048 sc1
    s_lshl_b32 s62, s32, 11
    s_add_u32 s62, s62, 100402176
    s_add_u32 s90, s4, s62
    s_addc_u32 s91, s5, 0
    ds_read_b128 v[224:227], v0 offset:12288
    ds_read_b128 v[228:231], v0 offset:13312
    ds_read_b128 v[232:235], v0 offset:14336
    ds_read_b128 v[236:239], v0 offset:15360
    s_waitcnt vmcnt(2)
L_fp_185:
    v_maximum3_f32 v10, v16, v17, v18
    v_maximum3_f32 v10, v10, v19, v20
    v_maximum3_f32 v10, v10, v21, v22
    v_cmp_u_f32 vcc, v10, v23
    ds_write_b128 v0, v[16:19] offset:17408
    ds_write_b128 v0, v[20:23] offset:21504
    s_and_b64 vcc, vcc, s[38:39]
    s_cbranch_scc0 L_fo_186
    global_load_dwordx4 v[16:19], v0, s[40:41] offset:-2048 sc1
    global_load_dwordx4 v[20:23], v0, s[40:41] offset:2048 sc1
    s_sub_u32 s2, s2, 1
    s_cselect_b64 s[38:39], 0, s[38:39]
    s_waitcnt vmcnt(2)
    s_branch L_fp_185
L_fo_186:
    v_smfmac_f32_16x16x64_bf16 v[104:107], v[16:19], v[64:71], v1
    v_bfe_u32 v86, v81, 2, 1
    v_smfmac_f32_16x16x64_bf16 v[108:111], v[16:19], v[72:79], v1
    v_mul_u32_u24 v120, 4096, v86
    v_smfmac_f32_16x16x64_bf16 v[112:115], v[16:19], a[112:119], v1
    v_bfe_u32 v86, v82, 0, 2
    v_smfmac_f32_16x16x64_bf16 v[116:119], v[16:19], a[120:127], v1
    v_mul_u32_u24 v86, 256, v86
    v_smfmac_f32_16x16x64_bf16 v[104:107], v[20:23], a[16:23], v1
    v_add_u32 v120, v120, v86
    v_smfmac_f32_16x16x64_bf16 v[108:111], v[20:23], a[24:31], v1
    s_waitcnt lgkmcnt(0)
    s_barrier
    ds_read_b128 v[24:27], v0 offset:16384
    v_smfmac_f32_16x16x64_bf16 v[112:115], v[20:23], a[176:183], v1
    global_load_dwordx4 v[128:131], v0, s[88:89] offset:0 sc1
    ds_read_b128 v[28:31], v0 offset:18432
    v_smfmac_f32_16x16x64_bf16 v[116:119], v[20:23], a[184:191], v1
    global_load_dwordx4 v[132:135], v0, s[88:89] offset:1024 sc1
    ds_read_b128 v[32:35], v0 offset:19456
    s_waitcnt lgkmcnt(2)
    v_smfmac_f32_16x16x64_bf16 v[104:107], v[24:27], v[144:151], v1
    global_load_dwordx4 v[136:139], v0, s[88:89] offset:2048 sc1
    ds_read_b128 v[36:39], v0 offset:20480
    v_bfe_u32 v86, v81, 3, 1
    v_smfmac_f32_16x16x64_bf16 v[108:111], v[24:27], v[152:159], v1
    global_load_dwordx4 v[140:143], v0, s[88:89] offset:3072 sc1
    ds_read_b128 v[40:43], v0 offset:22528
    v_mul_u32_u24 v86, 64, v86
    v_smfmac_f32_16x16x64_bf16 v[112:115], v[24:27], a[96:103], v1
    ds_read_b128 v[44:47], v0 offset:23552
    v_add_u32 v120, v120, v86
    v_smfmac_f32_16x16x64_bf16 v[116:119], v[24:27], a[104:111], v1
    s_waitcnt lgkmcnt(4)
    v_bfe_u32 v86, v81, 0, 2
    v_smfmac_f32_16x16x64_bf16 v[104:107], v[28:31], v[176:183], v1
    v_mul_u32_u24 v86, 16, v86
    v_smfmac_f32_16x16x64_bf16 v[108:111], v[28:31], v[184:191], v1
    v_add_u32 v120, v120, v86
    v_smfmac_f32_16x16x64_bf16 v[112:115], v[28:31], a[128:135], v1
    v_bfe_u32 v86, v82, 0, 1
    v_smfmac_f32_16x16x64_bf16 v[116:119], v[28:31], a[136:143], v1
    s_waitcnt lgkmcnt(0)
    v_mul_u32_u24 v121, 128, v86
    v_smfmac_f32_16x16x64_bf16 v[104:107], v[32:35], v[208:215], v1
    ds_read_b128 v[160:163], v120 offset:0
    v_bfe_u32 v86, v82, 1, 1
    v_smfmac_f32_16x16x64_bf16 v[108:111], v[32:35], v[216:223], v1
    ds_read_b128 v[164:167], v120 offset:1024
    v_mul_u32_u24 v86, 64, v86
    v_smfmac_f32_16x16x64_bf16 v[112:115], v[32:35], a[144:151], v1
    ds_read_b128 v[168:171], v120 offset:2048
    v_add_u32 v121, v121, v86
    v_smfmac_f32_16x16x64_bf16 v[116:119], v[32:35], a[152:159], v1
    ds_read_b128 v[172:175], v120 offset:3072
    v_bfe_u32 v86, v81, 0, 4
    v_smfmac_f32_16x16x64_bf16 v[104:107], v[36:39], v[240:247], v1
    ds_read_b128 v[192:195], v120 offset:128
    v_mul_u32_u24 v86, 4, v86
    v_smfmac_f32_16x16x64_bf16 v[108:111], v[36:39], v[248:255], v1
    ds_read_b128 v[196:199], v120 offset:1152
    v_add_u32 v121, v121, v86
    v_smfmac_f32_16x16x64_bf16 v[112:115], v[36:39], a[160:167], v1
    ds_read_b128 v[200:203], v120 offset:2176
    v_bfe_u32 v86, v81, 3, 1
    v_smfmac_f32_16x16x64_bf16 v[116:119], v[36:39], a[168:175], v1
    ds_read_b128 v[204:207], v120 offset:3200
    v_mul_u32_u24 v122, 65536, v86
    v_smfmac_f32_16x16x64_bf16 v[104:107], v[40:43], a[48:55], v1
    v_bfe_u32 v86, v82, 0, 2
    v_smfmac_f32_16x16x64_bf16 v[108:111], v[40:43], a[56:63], v1
    v_mul_u32_u24 v86, 256, v86
    v_smfmac_f32_16x16x64_bf16 v[112:115], v[40:43], a[192:199], v1
    v_add_u32 v122, v122, v86
    v_smfmac_f32_16x16x64_bf16 v[116:119], v[40:43], a[200:207], v1
    v_bfe_u32 v86, v81, 0, 3
    v_smfmac_f32_16x16x64_bf16 v[104:107], v[44:47], a[80:87], v1
    v_mul_u32_u24 v86, 16, v86
    v_smfmac_f32_16x16x64_bf16 v[108:111], v[44:47], a[88:95], v1
    v_add_u32 v122, v122, v86
    v_smfmac_f32_16x16x64_bf16 v[112:115], v[44:47], a[208:215], v1
    v_mov_b32 v123, 0xd028965f
    v_smfmac_f32_16x16x64_bf16 v[116:119], v[44:47], a[216:223], v1
    s_nop 0
    v_add_f32 v104, v104, v106
    v_add_f32 v105, v105, v107
    v_add_f32 v108, v108, v110
    v_add_f32 v109, v109, v111
    v_cvt_pk_bf16_f32 v10, v104, v108
    v_cvt_pk_bf16_f32 v11, v105, v109
    ds_write2_b32 v5, v10, v11 offset0:0 offset1:4
    v_pk_add_f32 v[112:113], v[112:113], v[114:115]
    v_cvt_pk_bf16_f32 v112, v112, v113
    v_pk_add_f32 v[116:117], v[116:117], v[118:119]
    v_cvt_pk_bf16_f32 v116, v116, v117
    ds_write_b32 v9, v112 offset:25088
    ds_write_b32 v9, v116 offset:25344
    s_waitcnt vmcnt(0) lgkmcnt(3)
    v_mfma_f32_16x16x32_bf16 v[48:51], v[160:163], v[128:131], 0
    v_mov_b64 v[56:57], 0
    v_mov_b64 v[58:59], 0
    v_mfma_f32_16x16x32_bf16 v[48:51], v[164:167], v[132:135], v[48:51]
    v_mov_b64 v[72:73], s[54:55]
    v_mov_b64 v[74:75], s[54:55]
    v_mfma_f32_16x16x32_bf16 v[48:51], v[168:171], v[136:139], v[48:51]
    v_mov_b64 v[80:81], 0
    v_mov_b64 v[82:83], 0
    v_mfma_f32_16x16x32_bf16 v[48:51], v[172:175], v[140:143], v[48:51]
    v_mov_b64 v[84:85], 0
    v_mov_b64 v[86:87], 0
    v_mfma_f32_16x16x32_bf16 v[52:55], v[192:195], v[128:131], 0
    s_waitcnt lgkmcnt(0)
    s_barrier
    ds_read_b128 v[40:43], v7 offset:0
    ds_read_b128 v[44:47], v7 offset:1088
    v_mfma_f32_16x16x32_bf16 v[52:55], v[196:199], v[132:135], v[52:55]
    ds_read_b32 v80, v121 offset:25600
    ds_read_b32 v82, v121 offset:25856
    ds_read_b32 v84, v121 offset:26112
    ds_read_b32 v86, v121 offset:26368
    v_mfma_f32_16x16x32_bf16 v[52:55], v[200:203], v[136:139], v[52:55]
    v_mov_b64 v[64:65], 0
    v_mfma_f32_16x16x32_bf16 v[52:55], v[204:207], v[140:143], v[52:55]
    v_cndmask_b32 v48, v123, v48, s[72:73]
    v_cndmask_b32 v49, v123, v49, s[74:75]
    v_cndmask_b32 v50, v123, v50, s[76:77]
    v_cndmask_b32 v51, v123, v51, s[78:79]
    s_waitcnt lgkmcnt(4)
    v_smfmac_f32_16x16x64_bf16 v[56:59], v[40:43], v[128:135], v1
    v_smfmac_f32_16x16x64_bf16 v[56:59], v[44:47], v[136:143], v1
    v_cndmask_b32 v52, v123, v52, s[80:81]
    v_cndmask_b32 v53, v123, v53, s[82:83]
    v_cndmask_b32 v54, v123, v54, s[84:85]
    v_cndmask_b32 v55, v123, v55, s[86:87]
    v_max3_f32 v10, v48, v49, v50
    v_max3_f32 v10, v10, v51, v52
    v_max3_f32 v10, v10, v53, v54
    v_max_f32 v10, v10, v55
    v_pk_add_f32 v[56:57], v[56:57], v[58:59]
    v_max3_f32 v10, v10, v56, v57
    v_mov_b32 v11, v10
    s_nop 1
    v_permlane32_swap_b32 v10, v11
    v_max_f32 v10, v10, v11
    v_mov_b32 v11, v10
    s_nop 1
    v_permlane16_swap_b32 v10, v11
    v_max_f32 v10, v10, v11
    v_mul_f32 v10, s61, v10
    v_pk_fma_f32 v[48:49], v[48:49], s[58:59], v[10:11] op_sel_hi:[1,1,0]
    v_pk_fma_f32 v[50:51], v[50:51], s[58:59], v[10:11] op_sel_hi:[1,1,0]
    v_pk_fma_f32 v[52:53], v[52:53], s[58:59], v[10:11] op_sel_hi:[1,1,0]
    v_pk_fma_f32 v[54:55], v[54:55], s[58:59], v[10:11] op_sel_hi:[1,1,0]
    v_pk_fma_f32 v[56:57], v[56:57], s[58:59], v[10:11] op_sel_hi:[1,1,0]
    v_exp_f32 v48, v48
    v_exp_f32 v49, v49
    v_exp_f32 v50, v50
    v_exp_f32 v51, v51
    v_exp_f32 v52, v52
    v_exp_f32 v53, v53
    v_exp_f32 v54, v54
    v_exp_f32 v55, v55
    v_exp_f32 v56, v56
    v_exp_f32 v57, v57
    v_cvt_pk_bf16_f32 v60, v48, v49
    v_cvt_pk_bf16_f32 v61, v50, v51
    v_cvt_pk_bf16_f32 v62, v52, v53
    v_cvt_pk_bf16_f32 v63, v54, v55
    v_cvt_pk_bf16_f32 v64, v56, v57
    s_waitcnt lgkmcnt(0)
    s_nop 0
    v_mfma_f32_16x16x32_bf16 v[68:71], v[72:75], v[60:63], 0
    v_mfma_f32_16x16x32_bf16 v[24:27], v[224:227], v[60:63], 0
    v_mfma_f32_16x16x32_bf16 v[28:31], v[228:231], v[60:63], 0
    v_mfma_f32_16x16x32_bf16 v[32:35], v[232:235], v[60:63], 0
    v_mfma_f32_16x16x32_bf16 v[36:39], v[236:239], v[60:63], 0
    v_mfma_f32_16x16x16_bf16 v[68:71], v[72:73], v[64:65], v[68:71]
    v_mfma_f32_16x16x16_bf16 v[24:27], v[80:81], v[64:65], v[24:27]
    v_mfma_f32_16x16x16_bf16 v[28:31], v[82:83], v[64:65], v[28:31]
    v_mfma_f32_16x16x16_bf16 v[32:35], v[84:85], v[64:65], v[32:35]
    v_mfma_f32_16x16x16_bf16 v[36:39], v[86:87], v[64:65], v[36:39]
    v_rcp_f32 v68, v68
    s_nop 0
    v_mul_f32 v24, v24, v68
    v_mul_f32 v25, v25, v68
    v_cvt_pk_bf16_f32 v48, v24, v25
    v_mul_f32 v26, v26, v68
    v_mul_f32 v27, v27, v68
    v_cvt_pk_bf16_f32 v49, v26, v27
    v_mul_f32 v28, v28, v68
    v_mul_f32 v29, v29, v68
    v_cvt_pk_bf16_f32 v50, v28, v29
    v_mul_f32 v30, v30, v68
    v_mul_f32 v31, v31, v68
    v_cvt_pk_bf16_f32 v51, v30, v31
    global_store_dwordx4 v122, v[48:51], s[90:91] offset:0 sc1
    v_mul_f32 v32, v32, v68
    v_mul_f32 v33, v33, v68
    v_cvt_pk_bf16_f32 v52, v32, v33
    v_mul_f32 v34, v34, v68
    v_mul_f32 v35, v35, v68
    v_cvt_pk_bf16_f32 v53, v34, v35
    v_mul_f32 v36, v36, v68
    v_mul_f32 v37, v37, v68
    v_cvt_pk_bf16_f32 v54, v36, v37
    v_mul_f32 v38, v38, v68
    v_mul_f32 v39, v39, v68
    v_cvt_pk_bf16_f32 v55, v38, v39
    global_store_dwordx4 v122, v[52:55], s[90:91] offset:128 sc1
    s_lshr_b32 s63, s32, 3
    s_mul_i32 s63, s63, 96
    s_lshl_b32 s62, s32, 2
    s_add_u32 s62, s62, s63
    s_add_u32 s62, s62, 130048
    s_add_u32 s88, s4, s62
    s_addc_u32 s89, s5, 0
    v_lshlrev_b32 v10, 5, v0
    v_mov_b32 v11, 1
    s_waitcnt vmcnt(0)
    s_barrier
    s_endpgm
L_chain_w2_110:
    s_waitcnt vmcnt(0) lgkmcnt(0)
    s_cmp_lt_u32 s3, 32
    s_cbranch_scc1 L_slow_187
    s_branch L_fast_2
L_slow_187:
L_step_189:
    v_mov_b32 v10, 0
    s_xor_b32 s51, s51, 1
    s_xor_b32 s42, s42, 65536
    s_nop 0
    s_cmp_eq_u32 s34, 63
    s_barrier
    s_cbranch_scc1 L_exit_190
    v_mov_b32 v10, 0
    s_nop 1
    global_load_dwordx4 v[16:19], v0, s[40:41] offset:-2048 sc1
    ds_read_b64 v[80:81], v0 offset:12288
    ds_read_b64 v[84:85], v0 offset:12296
    ds_read_b64 v[88:89], v0 offset:13312
    ds_read_b64 v[92:93], v0 offset:13320
    v_mov_b32 v10, 0
    s_nop 4
    v_mov_b32 v10, 0
    s_nop 4
    global_load_dwordx4 v[20:23], v0, s[40:41] offset:2048 sc1
    v_mov_b32 v10, 0
    s_nop 4
    v_mov_b32 v10, 0
    s_nop 4
    v_mov_b32 v10, 0
    s_nop 4
    v_mov_b32 v10, 0
    s_nop 1
    global_load_dwordx4 v[16:19], v0, s[40:41] offset:-2048 sc1
    v_mov_b32 v10, 0
    s_nop 4
    v_mov_b32 v10, 0
    s_nop 4
    v_mov_b32 v10, 0
    s_nop 3
    global_load_dwordx4 v[20:23], v0, s[40:41] offset:2048 sc1
    s_waitcnt vmcnt(3) lgkmcnt(0)
L_h2ca_195:
    v_maximum3_f32 v11, v16, v17, v18
    v_cmp_u_f32 vcc, v11, v19
    v_smfmac_f32_16x16x64_bf16 v[96:99], v[16:19], v[48:55], v1
    ds_write_b128 v0, v[16:19] offset:18432
    v_smfmac_f32_16x16x64_bf16 v[100:103], v[16:19], v[56:63], v1
    s_cbranch_vccnz L_h2a_193
L_h2cc_197:
    v_smfmac_f32_16x16x64_bf16 v[104:107], v[16:19], v[64:71], v1
    s_waitcnt vmcnt(2)
    v_maximum3_f32 v11, v20, v21, v22
    v_cmp_u_f32 vcc, v11, v23
    v_smfmac_f32_16x16x64_bf16 v[108:111], v[16:19], v[72:79], v1
    ds_read_b128 v[48:51], v0 offset:0
    v_mov_b32 v122, -1
    v_smfmac_f32_16x16x64_bf16 v[112:115], v[16:19], a[128:135], v1
    ds_read_b128 v[52:55], v0 offset:1024
    s_mov_b32 m0, 20480
    v_smfmac_f32_16x16x64_bf16 v[116:119], v[16:19], a[136:143], v1
    s_cbranch_vccnz L_h2b_194
L_h2cb_196:
    global_load_lds_dwordx4 v0, s[40:41] offset:2048 sc1
    v_smfmac_f32_16x16x64_bf16 v[96:99], v[20:23], a[32:39], v1
    s_waitcnt lgkmcnt(2)
    s_barrier
    v_smfmac_f32_16x16x64_bf16 v[100:103], v[20:23], a[40:47], v1
    ds_read_b128 v[24:27], v0 offset:19456
    s_mov_b32 m0, 12288
    v_smfmac_f32_16x16x64_bf16 v[104:107], v[20:23], a[48:55], v1
    global_store_dword v3, v122, s[42:43] offset:0 sc1
    ds_read_b128 v[28:31], v0 offset:16384
    v_smfmac_f32_16x16x64_bf16 v[108:111], v[20:23], a[56:63], v1
    ds_read_b128 v[32:35], v0 offset:17408
    v_add_u32 v10, 30016, v9
    v_smfmac_f32_16x16x64_bf16 v[112:115], v[20:23], a[192:199], v1
    ds_read_b128 v[56:59], v0 offset:2048
    v_smfmac_f32_16x16x64_bf16 v[116:119], v[20:23], a[200:207], v1
    ds_read_b128 v[60:63], v0 offset:3072
    s_waitcnt lgkmcnt(4)
    v_smfmac_f32_16x16x64_bf16 v[96:99], v[24:27], v[192:199], v1
    global_store_dword v9, v82, s[12:13] offset:3072 sc1
    ds_read_b128 v[64:67], v0 offset:4096
    v_smfmac_f32_16x16x64_bf16 v[100:103], v[24:27], v[200:207], v1
    ds_read_b128 v[68:71], v0 offset:5120
    v_smfmac_f32_16x16x64_bf16 v[104:107], v[24:27], v[208:215], v1
    global_load_lds_dwordx4 v0, s[46:47] sc1
    ds_read_b128 v[72:75], v0 offset:6144
    v_smfmac_f32_16x16x64_bf16 v[108:111], v[24:27], v[216:223], v1
    ds_read_b128 v[76:79], v0 offset:7168
    s_waitcnt lgkmcnt(6)
    v_smfmac_f32_16x16x64_bf16 v[96:99], v[28:31], v[160:167], v1
    global_store_dword v9, v90, s[12:13] offset:3328 sc1
    ds_read2_b32 v[124:125], v10 offset0:0 offset1:68
    v_smfmac_f32_16x16x64_bf16 v[100:103], v[28:31], v[168:175], v1
    v_smfmac_f32_16x16x64_bf16 v[104:107], v[28:31], v[176:183], v1
    global_load_lds_dwordx4 v0, s[46:47] offset:1024 sc1
    s_mov_b32 m0, 4096
    v_smfmac_f32_16x16x64_bf16 v[108:111], v[28:31], v[184:191], v1
    v_smfmac_f32_16x16x64_bf16 v[96:99], v[32:35], v[128:135], v1
    s_waitcnt vmcnt(5) lgkmcnt(0)
    s_barrier
    v_smfmac_f32_16x16x64_bf16 v[100:103], v[32:35], v[136:143], v1
    ds_read_b128 v[36:39], v0 offset:23552
    v_smfmac_f32_16x16x64_bf16 v[104:107], v[32:35], v[144:151], v1
    global_store_dword v9, v124, s[12:13] offset:1024 sc1
    ds_read_b128 v[40:43], v0 offset:20480
    v_smfmac_f32_16x16x64_bf16 v[108:111], v[32:35], v[152:159], v1
    ds_read_b128 v[44:47], v0 offset:21504
    s_waitcnt lgkmcnt(2)
    v_smfmac_f32_16x16x64_bf16 v[96:99], v[36:39], a[64:71], v1
    global_load_lds_dwordx4 v0, s[44:45] sc1
    v_smfmac_f32_16x16x64_bf16 v[100:103], v[36:39], a[72:79], v1
    s_waitcnt lgkmcnt(0)
    v_smfmac_f32_16x16x64_bf16 v[96:99], v[40:43], v[224:231], v1
    global_store_dword v9, v125, s[12:13] offset:1280 sc1
    s_cmp_ge_u32 s34, 62
    v_smfmac_f32_16x16x64_bf16 v[96:99], v[44:47], a[0:7], v1
    v_smfmac_f32_16x16x64_bf16 v[100:103], v[40:43], v[232:239], v1
    global_load_lds_dwordx4 v0, s[44:45] offset:1024 sc1
    v_smfmac_f32_16x16x64_bf16 v[100:103], v[44:47], a[8:15], v1
    v_add_f32 v96, v96, v98
    v_smfmac_f32_16x16x64_bf16 v[104:107], v[36:39], a[80:87], v1
    v_add_f32 v97, v97, v99
    v_smfmac_f32_16x16x64_bf16 v[104:107], v[40:43], v[240:247], v1
    v_add_f32 v100, v100, v102
    v_add_f32 v101, v101, v103
    v_smfmac_f32_16x16x64_bf16 v[104:107], v[44:47], a[16:23], v1
    v_cvt_pk_bf16_f32 v96, v96, v100
    v_smfmac_f32_16x16x64_bf16 v[108:111], v[36:39], a[88:95], v1
    v_cvt_pk_bf16_f32 v97, v97, v101
    v_smfmac_f32_16x16x64_bf16 v[108:111], v[40:43], v[248:255], v1
    ds_write2_b32 v4, v96, v97 offset0:0 offset1:136
    v_smfmac_f32_16x16x64_bf16 v[108:111], v[44:47], a[24:31], v1
    v_add_f32 v104, v104, v106
    v_smfmac_f32_16x16x64_bf16 v[112:115], v[24:27], a[144:151], v1
    v_add_f32 v105, v105, v107
    v_smfmac_f32_16x16x64_bf16 v[116:119], v[24:27], a[152:159], v1
    ds_read_b128 v[24:27], v8 offset:18432
    v_add_f32 v108, v108, v110
    v_smfmac_f32_16x16x64_bf16 v[112:115], v[28:31], a[96:103], v1
    v_add_f32 v109, v109, v111
    v_smfmac_f32_16x16x64_bf16 v[116:119], v[28:31], a[104:111], v1
    s_waitcnt vmcnt(9) lgkmcnt(1)
    s_barrier
    v_smfmac_f32_16x16x64_bf16 v[112:115], v[32:35], a[112:119], v1
    ds_read_b128 v[120:123], v6 offset:0
    v_cvt_pk_bf16_f32 v10, v104, v108
    v_smfmac_f32_16x16x64_bf16 v[116:119], v[32:35], a[120:127], v1
    ds_read_b128 v[124:127], v6 offset:64
    v_cvt_pk_bf16_f32 v11, v105, v109
    v_smfmac_f32_16x16x64_bf16 v[112:115], v[36:39], a[208:215], v1
    ds_write2_b32 v5, v10, v11 offset0:0 offset1:4
    v_smfmac_f32_16x16x64_bf16 v[116:119], v[36:39], a[216:223], v1
    ds_read_b128 v[16:19], v6 offset:128
    v_mov_b64 v[104:105], 0
    v_smfmac_f32_16x16x64_bf16 v[112:115], v[40:43], a[160:167], v1
    ds_read_b128 v[20:23], v6 offset:192
    v_mov_b64 v[106:107], 0
    v_smfmac_f32_16x16x64_bf16 v[116:119], v[40:43], a[168:175], v1
    ds_read_b128 v[28:31], v8 offset:22528
    v_mov_b64 v[108:109], 0
    v_smfmac_f32_16x16x64_bf16 v[112:115], v[44:47], a[176:183], v1
    ds_read_b128 v[32:35], v8 offset:26624
    v_mov_b64 v[110:111], 0
    v_smfmac_f32_16x16x64_bf16 v[116:119], v[44:47], a[184:191], v1
    ds_read_b128 v[36:39], v8 offset:30720
    s_waitcnt lgkmcnt(6)
    v_mfma_f32_16x16x32_bf16 v[96:99], v[48:51], v[120:123], 0
    s_waitcnt lgkmcnt(5)
    s_barrier
    v_mfma_f32_16x16x32_bf16 v[100:103], v[64:67], v[120:123], 0
    ds_read_b128 v[40:43], v7 offset:0
    v_add_f32 v112, v112, v114
    v_mfma_f32_16x16x32_bf16 v[96:99], v[52:55], v[124:127], v[96:99]
    ds_read_b128 v[44:47], v7 offset:1088
    v_add_f32 v113, v113, v115
    v_mfma_f32_16x16x32_bf16 v[100:103], v[68:71], v[124:127], v[100:103]
    s_waitcnt lgkmcnt(5)
    v_add_f32 v116, v116, v118
    v_add_f32 v117, v117, v119
    v_mfma_f32_16x16x32_bf16 v[96:99], v[56:59], v[16:19], v[96:99]
    ds_read_b128 v[48:51], v8 offset:0
    v_cvt_pk_bf16_f32 v82, v112, v113
    v_mfma_f32_16x16x32_bf16 v[96:99], v[60:63], v[20:23], v[96:99]
    ds_read_b128 v[64:67], v8 offset:16384
    v_cvt_pk_bf16_f32 v90, v116, v117
    v_mfma_f32_16x16x32_bf16 v[100:103], v[72:75], v[16:19], v[100:103]
    ds_read_b128 v[52:55], v8 offset:4096
    v_cvt_pk_bf16_f32 v94, v116, v117
    v_mfma_f32_16x16x32_bf16 v[100:103], v[76:79], v[20:23], v[100:103]
    s_waitcnt lgkmcnt(3)
    v_cvt_pk_bf16_f32 v86, v112, v113
    v_max3_f32 v10, v96, v97, v98
    v_smfmac_f32_16x16x64_bf16 v[104:107], v[40:43], v[120:127], v1
    ds_read_b128 v[68:71], v8 offset:20480
    v_cndmask_b32 v96, v96, v98, s[52:53]
    v_smfmac_f32_16x16x64_bf16 v[104:107], v[44:47], v[16:23], v1
    ds_read_b128 v[56:59], v8 offset:8192
    s_nop 0
    v_cndmask_b32 v97, v97, v99, s[52:53]
    v_max3_f32 v10, v10, v99, v100
    v_max3_f32 v10, v10, v101, v102
    v_cndmask_b32 v98, v100, v102, s[52:53]
    v_cndmask_b32 v99, v101, v103, s[52:53]
    v_max_f32 v10, v10, v103
    v_pk_add_f32 v[104:105], v[104:105], v[106:107]
    v_max3_f32 v11, v10, v104, v105
    v_max3_f32 v10, v10, v104, v105
    v_cndmask_b32 v104, v104, v105, s[52:53]
    v_mov_b64 v[120:121], s[54:55]
    v_permlane32_swap_b32 v10, v11
    v_max_f32 v106, v10, v11
    v_max_f32 v107, v10, v11
    v_mov_b64 v[122:123], s[56:57]
    v_mov_b64 v[116:117], 0
    v_permlane16_swap_b32 v106, v107
    v_max_f32 v10, v106, v107
    v_mul_f32 v10, s61, v10
    v_pk_fma_f32 v[96:97], v[96:97], s[58:59], v[10:11] op_sel_hi:[1,1,0]
    v_pk_fma_f32 v[98:99], v[98:99], s[58:59], v[10:11] op_sel_hi:[1,1,0]
    v_fma_f32 v104, v104, s58, v10
    v_exp_f32 v96, v96
    v_exp_f32 v97, v97
    v_exp_f32 v98, v98
    v_exp_f32 v99, v99
    v_exp_f32 v104, v104
    v_cvt_pk_bf16_f32 v100, v96, v97
    v_cvt_pk_bf16_f32 v102, v98, v99
    v_cvt_pk_bf16_f32 v101, v104, 0
    v_cvt_pk_bf16_f32 v103, v104, 0
    v_mov_b64 v[118:119], 0
    s_nop 0
    v_mfma_f32_16x16x32_bf16 v[112:115], v[100:103], v[120:123], 0
    ds_read_b128 v[60:63], v8 offset:12288
    ds_read_b128 v[72:75], v8 offset:24576
    v_smfmac_f32_16x16x64_bf16 v[108:111], v[100:103], v[80:87], v1 abid:1
    ds_read_b128 v[76:79], v8 offset:28672
    ds_read_b128 v[16:19], v8 offset:2048
    v_smfmac_f32_16x16x64_bf16 v[116:119], v[100:103], v[88:95], v1 abid:1
    ds_read_b128 v[20:23], v8 offset:6144
    s_nop 0
    v_add_f32 v112, v112, v114
    v_add_f32 v113, v113, v115
    v_rcp_f32 v112, v112
    v_rcp_f32 v113, v113
    v_pk_add_f32 v[108:109], v[108:109], v[110:111]
    v_pk_mul_f32 v[108:109], v[108:109], v[112:113]
    v_pk_add_f32 v[116:117], v[116:117], v[118:119]
    v_pk_mul_f32 v[116:117], v[116:117], v[112:113]
    v_cvt_pk_bf16_f32 v10, v108, v116
    v_cvt_pk_bf16_f32 v11, v109, v117
    ds_write2_b32 v4, v10, v11 offset0:64 offset1:200
    ds_read_b128 v[104:107], v6 offset:384
    v_mov_b64 v[112:113], 0
    v_mov_b64 v[114:115], 0
    v_mov_b64 v[116:117], 0
    v_mov_b64 v[118:119], 0
    s_cbranch_scc1 L_last_198
L_lastb_199:
    v_mov_b64 v[84:85], 0
    v_mov_b64 v[86:87], 0
    v_mov_b64 v[92:93], 0
    v_mov_b64 v[94:95], 0
    s_waitcnt vmcnt(8) lgkmcnt(1)
    s_barrier
    ds_read_b128 v[108:111], v6 offset:448
    ds_read_b128 v[96:99], v6 offset:256
    ds_read_b128 v[100:103], v6 offset:320
    s_waitcnt lgkmcnt(3)
    v_smfmac_f32_16x16x64_bf16 v[112:115], v[104:107], v[64:71], v1
    ds_read_b128 v[40:43], v8 offset:10240
    v_smfmac_f32_16x16x64_bf16 v[116:119], v[104:107], a[240:247], v1
    ds_read_b128 v[44:47], v8 offset:14336
    v_smfmac_f32_16x16x64_bf16 v[84:87], v[104:107], v[24:31], v1
    ds_read_b128 v[64:67], v8 offset:19456
    s_waitcnt lgkmcnt(5)
    v_smfmac_f32_16x16x64_bf16 v[112:115], v[108:111], v[72:79], v1
    ds_read_b128 v[68:71], v8 offset:23552
    s_waitcnt lgkmcnt(5)
    v_smfmac_f32_16x16x64_bf16 v[112:115], v[96:99], v[48:55], v1
    ds_read_b128 v[72:75], v8 offset:27648
    s_waitcnt lgkmcnt(5)
    v_smfmac_f32_16x16x64_bf16 v[112:115], v[100:103], v[56:63], v1
    ds_read_b128 v[76:79], v8 offset:31744
    v_smfmac_f32_16x16x64_bf16 v[116:119], v[108:111], a[248:255], v1
    ds_read_b128 v[48:51], v8 offset:3072
    v_smfmac_f32_16x16x64_bf16 v[116:119], v[96:99], a[224:231], v1
    ds_read_b128 v[52:55], v8 offset:7168
    v_cvt_pk_bf16_f32 v112, v112, v114
    v_and_or_b32 v112, v112, -2, s51
    v_smfmac_f32_16x16x64_bf16 v[116:119], v[100:103], a[232:239], v1
    global_store_dword v2, v112, s[8:9] offset:-4096 sc1
    v_cvt_pk_bf16_f32 v113, v113, v115
    v_and_or_b32 v113, v113, -2, s51
    v_smfmac_f32_16x16x64_bf16 v[84:87], v[108:111], v[32:39], v1
    global_store_dword v2, v113, s[10:11] offset:-4096 sc1
    ds_read_b128 v[56:59], v8 offset:11264
    v_smfmac_f32_16x16x64_bf16 v[84:87], v[96:99], v[16:23], v1
    ds_read_b128 v[60:63], v8 offset:15360
    s_waitcnt lgkmcnt(8)
    v_cvt_pk_bf16_f32 v116, v116, v118
    v_and_or_b32 v116, v116, -2, s51
    v_smfmac_f32_16x16x64_bf16 v[84:87], v[100:103], v[40:47], v1
    global_store_dword v2, v116, s[8:9] offset:-2048 sc1
    s_waitcnt lgkmcnt(6)
    v_cvt_pk_bf16_f32 v117, v117, v119
    v_and_or_b32 v117, v117, -2, s51
    v_smfmac_f32_16x16x64_bf16 v[92:95], v[104:107], v[64:71], v1
    global_store_dword v2, v117, s[10:11] offset:-2048 sc1
    s_waitcnt lgkmcnt(4)
    v_smfmac_f32_16x16x64_bf16 v[92:95], v[108:111], v[72:79], v1
    s_waitcnt lgkmcnt(2)
    v_cvt_pk_bf16_f32 v84, v84, v86
    v_and_or_b32 v84, v84, -2, s51
    v_smfmac_f32_16x16x64_bf16 v[92:95], v[96:99], v[48:55], v1
    global_store_dword v2, v84, s[8:9] offset:0 sc1
    s_waitcnt lgkmcnt(0)
    v_cvt_pk_bf16_f32 v85, v85, v87
    v_and_or_b32 v85, v85, -2, s51
    v_smfmac_f32_16x16x64_bf16 v[92:95], v[100:103], v[56:63], v1
    global_store_dword v2, v85, s[10:11] offset:0 sc1
    s_nop 0
    v_mov_b64 v[96:97], 0
    v_mov_b64 v[98:99], 0
    v_mov_b64 v[100:101], 0
    v_mov_b64 v[102:103], 0
    v_mov_b64 v[104:105], 0
    v_mov_b64 v[106:107], 0
    v_cvt_pk_bf16_f32 v92, v92, v94
    v_and_or_b32 v92, v92, -2, s51
    v_cvt_pk_bf16_f32 v93, v93, v95
    v_and_or_b32 v93, v93, -2, s51
    v_mov_b64 v[108:109], 0
    s_add_u32 s12, s12, 4096
    s_addc_u32 s13, s13, 0
    s_add_u32 s34, s34, 1
    global_store_dword v2, v92, s[8:9] offset:2048 sc1
    global_store_dword v2, v93, s[10:11] offset:2048 sc1
    v_mov_b64 v[110:111], 0
    s_add_u32 s44, s44, 16384
    s_addc_u32 s45, s45, 0
    s_add_u32 s46, s46, 16384
    s_addc_u32 s47, s47, 0
    s_xor_b32 s40, s40, 65536
    v_mov_b64 v[112:113], 0
    s_nop 4
    v_mov_b64 v[114:115], 0
    s_nop 4
    v_mov_b64 v[116:117], 0
    s_nop 4
    v_mov_b64 v[118:119], 0
    s_nop 4
    v_mov_b64 v[86:87], 0
    s_nop 4
    v_mov_b64 v[94:95], 0
    s_nop 4
    v_mov_b32 v10, 0
    s_nop 4
    v_mov_b32 v10, 0
    s_nop 3
    global_load_dword v120, v9, s[36:37] offset:0 sc1
    global_load_dword v121, v9, s[36:37] offset:256 sc1
    global_load_dword v122, v9, s[36:37] offset:512 sc1
    global_load_dword v123, v9, s[36:37] offset:768 sc1
    global_load_dword v124, v9, s[36:37] offset:1024 sc1
    global_load_dword v125, v9, s[36:37] offset:1280 sc1
    global_load_dword v126, v9, s[36:37] offset:1536 sc1
    global_load_dword v127, v9, s[36:37] offset:1792 sc1
    ds_read_b128 v[48:51], v8 offset:1024
    ds_read_b128 v[52:55], v8 offset:5120
    v_mov_b32 v10, 0
    s_nop 1
    ds_read_b128 v[56:59], v8 offset:9216
    ds_read_b128 v[60:63], v8 offset:13312
    v_mov_b32 v10, 0
    s_nop 1
    ds_read_b128 v[64:67], v8 offset:17408
    ds_read_b128 v[68:71], v8 offset:21504
    v_mov_b32 v10, 0
    s_nop 1
    ds_read_b128 v[72:75], v8 offset:25600
    ds_read_b128 v[76:79], v8 offset:29696
    v_mov_b32 v10, 0
    s_nop 1
    s_cmp_eq_u32 s51, 0
    s_cbranch_scc1 L_tag0_200
    s_waitcnt vmcnt(4)
    v_bitop3_b32 v10, v120, v121, v122 bitop3:0x80
    v_bitop3_b32 v10, v10, v123, 1 bitop3:0x80
    v_mfma_f32_16x16x32_bf16 v[32:35], v[12:15], v[120:123], 0
    s_waitcnt vmcnt(0)
    v_bitop3_b32 v10, v10, v124, v125 bitop3:0x80
    v_bitop3_b32 v10, v10, v126, v127 bitop3:0x80
    v_mfma_f32_16x16x32_bf16 v[32:35], v[12:15], v[124:127], v[32:35]
    s_nop 0
    v_cmp_ne_u32 vcc, 1, v10
    s_nop 0
    s_mov_b64 exec, s[26:27]
    s_nop 2
    s_cbranch_vccnz L_h1r_201
    v_cvt_pk_bf16_f32 v11, v32, v33
    global_store_dword v3, v11, s[42:43] offset:0 sc1
    s_mov_b64 exec, -1
    s_branch L_step_189
L_h1r_201:
    s_mov_b64 exec, -1
    global_load_dword v120, v9, s[36:37] offset:0 sc1
    global_load_dword v121, v9, s[36:37] offset:256 sc1
    global_load_dword v122, v9, s[36:37] offset:512 sc1
    global_load_dword v123, v9, s[36:37] offset:768 sc1
    global_load_dword v124, v9, s[36:37] offset:1024 sc1
    global_load_dword v125, v9, s[36:37] offset:1280 sc1
    global_load_dword v126, v9, s[36:37] offset:1536 sc1
    global_load_dword v127, v9, s[36:37] offset:1792 sc1
    s_sub_u32 s50, s50, 1
    s_cselect_b64 s[48:49], 0, s[48:49]
    s_waitcnt vmcnt(8)
    v_bitop3_b32 v10, v120, v121, v122 bitop3:0x80
    v_bitop3_b32 v10, v10, v123, 1 bitop3:0x80
    v_mfma_f32_16x16x32_bf16 v[32:35], v[12:15], v[120:123], 0
    s_nop 0
    v_bitop3_b32 v10, v10, v124, v125 bitop3:0x80
    v_bitop3_b32 v10, v10, v126, v127 bitop3:0x80
    v_mfma_f32_16x16x32_bf16 v[32:35], v[12:15], v[124:127], v[32:35]
    s_nop 0
    v_cmp_ne_u32 vcc, 1, v10
    s_nop 0
    s_mov_b64 exec, s[26:27]
    s_nop 1
    s_and_b64 vcc, vcc, s[48:49]
    s_cbranch_scc1 L_h1r_201
    v_cvt_pk_bf16_f32 v11, v32, v33
    global_store_dword v3, v11, s[42:43] offset:0 sc1
    s_mov_b64 exec, -1
    s_branch L_step_189
L_tag0_200:
    s_waitcnt vmcnt(4)
    v_bitop3_b32 v10, v120, v121, v122 bitop3:0x01
    v_bitop3_b32 v10, v10, v123, 1 bitop3:0x20
    v_mfma_f32_16x16x32_bf16 v[32:35], v[12:15], v[120:123], 0
    s_waitcnt vmcnt(0)
    v_bitop3_b32 v10, v10, v124, v125 bitop3:0x10
    v_bitop3_b32 v10, v10, v126, v127 bitop3:0x10
    v_mfma_f32_16x16x32_bf16 v[32:35], v[12:15], v[124:127], v[32:35]
    s_nop 0
    v_cmp_ne_u32 vcc, 1, v10
    s_nop 0
    s_mov_b64 exec, s[26:27]
    s_nop 2
    s_cbranch_vccnz L_h1r_202
    v_cvt_pk_bf16_f32 v11, v32, v33
    global_store_dword v3, v11, s[42:43] offset:0 sc1
    s_mov_b64 exec, -1
    s_branch L_step_189
L_h1r_202:
    s_mov_b64 exec, -1
    global_load_dword v120, v9, s[36:37] offset:0 sc1
    global_load_dword v121, v9, s[36:37] offset:256 sc1
    global_load_dword v122, v9, s[36:37] offset:512 sc1
    global_load_dword v123, v9, s[36:37] offset:768 sc1
    global_load_dword v124, v9, s[36:37] offset:1024 sc1
    global_load_dword v125, v9, s[36:37] offset:1280 sc1
    global_load_dword v126, v9, s[36:37] offset:1536 sc1
    global_load_dword v127, v9, s[36:37] offset:1792 sc1
    s_sub_u32 s50, s50, 1
    s_cselect_b64 s[48:49], 0, s[48:49]
    s_waitcnt vmcnt(8)
    v_bitop3_b32 v10, v120, v121, v122 bitop3:0x01
    v_bitop3_b32 v10, v10, v123, 1 bitop3:0x20
    v_mfma_f32_16x16x32_bf16 v[32:35], v[12:15], v[120:123], 0
    s_nop 0
    v_bitop3_b32 v10, v10, v124, v125 bitop3:0x10
    v_bitop3_b32 v10, v10, v126, v127 bitop3:0x10
    v_mfma_f32_16x16x32_bf16 v[32:35], v[12:15], v[124:127], v[32:35]
    s_nop 0
    v_cmp_ne_u32 vcc, 1, v10
    s_nop 0
    s_mov_b64 exec, s[26:27]
    s_nop 1
    s_and_b64 vcc, vcc, s[48:49]
    s_cbranch_scc1 L_h1r_202
    v_cvt_pk_bf16_f32 v11, v32, v33
    global_store_dword v3, v11, s[42:43] offset:0 sc1
    s_mov_b64 exec, -1
    s_branch L_step_189
L_last_198:
    v_add_u32 v10, 30016, v9
    ds_read2_b32 v[124:125], v10 offset0:0 offset1:68
    s_add_u32 s12, s12, 4096
    s_addc_u32 s13, s13, 0
    global_store_dword v9, v82, s[12:13] offset:3072 sc1
    global_store_dword v9, v90, s[12:13] offset:3328 sc1
    s_waitcnt lgkmcnt(0)
    global_store_dword v9, v124, s[12:13] offset:1024 sc1
    global_store_dword v9, v125, s[12:13] offset:1280 sc1
    s_cmp_eq_u32 s34, 63
    s_cbranch_scc1 L_exit_190
    s_sub_u32 s12, s12, 4096
    s_subb_u32 s13, s13, 0
    s_getpc_b64 s[64:65]
L_pc_203:
    s_add_u32 s64, s64, L_fin_2-L_pc_203
    s_addc_u32 s65, s65, 0
    v_lshlrev_b32 v126, 2, v0
    v_min_u32 v126, L_code_end-L_fin_2-4, v126
    global_load_dword v127, v126, s[64:65]
    s_branch L_lastb_199
L_h2a_193:
    global_load_dwordx4 v[16:19], v0, s[40:41] offset:-2048 sc1
    global_load_dwordx4 v[20:23], v0, s[40:41] offset:2048 sc1
    s_nop 4
    v_mov_b64 v[96:97], 0
    v_mov_b64 v[98:99], 0
    v_mov_b64 v[100:101], 0
    v_mov_b64 v[102:103], 0
    s_waitcnt vmcnt(3)
    v_maximum3_f32 v11, v16, v17, v18
    v_cmp_u_f32 vcc, v11, v19
    v_smfmac_f32_16x16x64_bf16 v[96:99], v[16:19], v[48:55], v1
    ds_write_b128 v0, v[16:19] offset:18432
    v_smfmac_f32_16x16x64_bf16 v[100:103], v[16:19], v[56:63], v1
    s_cbranch_vccz L_h2cc_197
L_h2l2_204:
    global_load_dwordx4 v[16:19], v0, s[40:41] offset:-2048 sc1
    global_load_dwordx4 v[20:23], v0, s[40:41] offset:2048 sc1
    s_sub_u32 s2, s2, 1
    s_cselect_b64 s[38:39], 0, s[38:39]
    s_nop 2
    v_mov_b64 v[96:97], 0
    v_mov_b64 v[98:99], 0
    v_mov_b64 v[100:101], 0
    v_mov_b64 v[102:103], 0
    s_waitcnt vmcnt(3)
    v_maximum3_f32 v11, v16, v17, v18
    v_cmp_u_f32 vcc, v11, v19
    v_smfmac_f32_16x16x64_bf16 v[96:99], v[16:19], v[48:55], v1
    ds_write_b128 v0, v[16:19] offset:18432
    v_smfmac_f32_16x16x64_bf16 v[100:103], v[16:19], v[56:63], v1
    s_and_b64 vcc, vcc, s[38:39]
    s_cbranch_scc0 L_h2cc_197
    s_branch L_h2l2_204
    global_load_dwordx4 v[16:19], v0, s[40:41] offset:-2048 sc1
    global_load_dwordx4 v[20:23], v0, s[40:41] offset:2048 sc1
    s_sub_u32 s2, s2, 1
    s_cselect_b64 s[38:39], 0, s[38:39]
    s_cmp_eq_u64 s[38:39], 0
    s_cbranch_scc1 L_h2cc_197
    s_nop 2
    v_mov_b64 v[96:97], 0
    v_mov_b64 v[98:99], 0
    v_mov_b64 v[100:101], 0
    v_mov_b64 v[102:103], 0
    s_waitcnt vmcnt(3)
    s_branch L_h2ca_195
L_h2b_194:
    global_load_dwordx4 v[20:23], v0, s[40:41] offset:2048 sc1
    s_sub_u32 s2, s2, 1
    s_cselect_b64 s[38:39], 0, s[38:39]
    s_waitcnt vmcnt(1)
    v_maximum3_f32 v11, v20, v21, v22
    v_cmp_u_f32 vcc, v11, v23
    s_and_b64 vcc, vcc, s[38:39]
    s_cbranch_scc0 L_h2cb_196
    s_branch L_h2b_194
L_exit_190:
    s_branch L_done_188
.p2align 6
L_fast_2:
L_step_205:
    v_mov_b32 v10, 0
    s_xor_b32 s51, s51, 1
    s_xor_b32 s42, s42, 65536
    s_nop 0
    s_cmp_eq_u32 s34, 63
    s_barrier
    s_cbranch_scc1 L_exit_206
    v_mov_b32 v10, 0
    s_nop 1
    global_load_dwordx4 v[16:19], v0, s[40:41] offset:-2048 sc1
    ds_read_b64 v[80:81], v0 offset:12288
    ds_read_b64 v[84:85], v0 offset:12296
    ds_read_b64 v[88:89], v0 offset:13312
    ds_read_b64 v[92:93], v0 offset:13320
    v_mov_b32 v10, 0
    s_nop 4
    v_mov_b32 v10, 0
    s_nop 4
    global_load_dwordx4 v[20:23], v0, s[40:41] offset:2048 sc1
    v_mov_b32 v10, 0
    s_nop 4
    v_mov_b32 v10, 0
    s_nop 4
    v_mov_b32 v10, 0
    s_nop 4
    v_mov_b32 v10, 0
    s_nop 1
    global_load_dwordx4 v[16:19], v0, s[40:41] offset:-2048 sc1
    v_mov_b32 v10, 0
    s_nop 4
    v_mov_b32 v10, 0
    s_nop 4
    v_mov_b32 v10, 0
    s_nop 3
    global_load_dwordx4 v[20:23], v0, s[40:41] offset:2048 sc1
    s_waitcnt vmcnt(3) lgkmcnt(0)
L_h2ca_211:
    v_maximum3_f32 v11, v16, v17, v18
    v_cmp_u_f32 vcc, v11, v19
    v_smfmac_f32_16x16x64_bf16 v[96:99], v[16:19], v[48:55], v1
    ds_write_b128 v0, v[16:19] offset:18432
    v_smfmac_f32_16x16x64_bf16 v[100:103], v[16:19], v[56:63], v1
    s_cbranch_vccnz L_h2a_209
L_h2cc_213:
    v_smfmac_f32_16x16x64_bf16 v[104:107], v[16:19], v[64:71], v1
    s_waitcnt vmcnt(2)
    v_maximum3_f32 v11, v20, v21, v22
    v_cmp_u_f32 vcc, v11, v23
    v_smfmac_f32_16x16x64_bf16 v[108:111], v[16:19], v[72:79], v1
    ds_read_b128 v[48:51], v0 offset:0
    v_mov_b32 v122, -1
    v_smfmac_f32_16x16x64_bf16 v[112:115], v[16:19], a[128:135], v1
    ds_read_b128 v[52:55], v0 offset:1024
    s_mov_b32 m0, 20480
    v_smfmac_f32_16x16x64_bf16 v[116:119], v[16:19], a[136:143], v1
    s_cbranch_vccnz L_h2b_210
L_h2cb_212:
    global_load_lds_dwordx4 v0, s[40:41] offset:2048 sc1
    v_smfmac_f32_16x16x64_bf16 v[96:99], v[20:23], a[32:39], v1
    s_waitcnt lgkmcnt(2)
    s_barrier
    v_smfmac_f32_16x16x64_bf16 v[100:103], v[20:23], a[40:47], v1
    ds_read_b128 v[24:27], v0 offset:19456
    s_mov_b32 m0, 12288
    v_smfmac_f32_16x16x64_bf16 v[104:107], v[20:23], a[48:55], v1
    global_store_dword v3, v122, s[42:43] offset:0
    ds_read_b128 v[28:31], v0 offset:16384
    v_smfmac_f32_16x16x64_bf16 v[108:111], v[20:23], a[56:63], v1
    ds_read_b128 v[32:35], v0 offset:17408
    v_add_u32 v10, 30016, v9
    v_smfmac_f32_16x16x64_bf16 v[112:115], v[20:23], a[192:199], v1
    ds_read_b128 v[56:59], v0 offset:2048
    v_smfmac_f32_16x16x64_bf16 v[116:119], v[20:23], a[200:207], v1
    ds_read_b128 v[60:63], v0 offset:3072
    s_waitcnt lgkmcnt(4)
    v_smfmac_f32_16x16x64_bf16 v[96:99], v[24:27], v[192:199], v1
    global_store_dword v9, v82, s[12:13] offset:3072 sc1
    ds_read_b128 v[64:67], v0 offset:4096
    v_smfmac_f32_16x16x64_bf16 v[100:103], v[24:27], v[200:207], v1
    ds_read_b128 v[68:71], v0 offset:5120
    v_smfmac_f32_16x16x64_bf16 v[104:107], v[24:27], v[208:215], v1
    global_load_lds_dwordx4 v0, s[46:47] sc1
    ds_read_b128 v[72:75], v0 offset:6144
    v_smfmac_f32_16x16x64_bf16 v[108:111], v[24:27], v[216:223], v1
    ds_read_b128 v[76:79], v0 offset:7168
    s_waitcnt lgkmcnt(6)
    v_smfmac_f32_16x16x64_bf16 v[96:99], v[28:31], v[160:167], v1
    global_store_dword v9, v90, s[12:13] offset:3328 sc1
    ds_read2_b32 v[124:125], v10 offset0:0 offset1:68
    v_smfmac_f32_16x16x64_bf16 v[100:103], v[28:31], v[168:175], v1
    v_smfmac_f32_16x16x64_bf16 v[104:107], v[28:31], v[176:183], v1
    global_load_lds_dwordx4 v0, s[46:47] offset:1024 sc1
    s_mov_b32 m0, 4096
    v_smfmac_f32_16x16x64_bf16 v[108:111], v[28:31], v[184:191], v1
    v_smfmac_f32_16x16x64_bf16 v[96:99], v[32:35], v[128:135], v1
    s_waitcnt vmcnt(5) lgkmcnt(0)
    s_barrier
    v_smfmac_f32_16x16x64_bf16 v[100:103], v[32:35], v[136:143], v1
    ds_read_b128 v[36:39], v0 offset:23552
    v_smfmac_f32_16x16x64_bf16 v[104:107], v[32:35], v[144:151], v1
    global_store_dword v9, v124, s[12:13] offset:1024 sc1
    ds_read_b128 v[40:43], v0 offset:20480
    v_smfmac_f32_16x16x64_bf16 v[108:111], v[32:35], v[152:159], v1
    ds_read_b128 v[44:47], v0 offset:21504
    s_waitcnt lgkmcnt(2)
    v_smfmac_f32_16x16x64_bf16 v[96:99], v[36:39], a[64:71], v1
    global_load_lds_dwordx4 v0, s[44:45] sc1
    v_smfmac_f32_16x16x64_bf16 v[100:103], v[36:39], a[72:79], v1
    s_waitcnt lgkmcnt(0)
    v_smfmac_f32_16x16x64_bf16 v[96:99], v[40:43], v[224:231], v1
    global_store_dword v9, v125, s[12:13] offset:1280 sc1
    s_cmp_ge_u32 s34, 62
    v_smfmac_f32_16x16x64_bf16 v[96:99], v[44:47], a[0:7], v1
    v_smfmac_f32_16x16x64_bf16 v[100:103], v[40:43], v[232:239], v1
    global_load_lds_dwordx4 v0, s[44:45] offset:1024 sc1
    v_smfmac_f32_16x16x64_bf16 v[100:103], v[44:47], a[8:15], v1
    v_add_f32 v96, v96, v98
    v_smfmac_f32_16x16x64_bf16 v[104:107], v[36:39], a[80:87], v1
    v_add_f32 v97, v97, v99
    v_smfmac_f32_16x16x64_bf16 v[104:107], v[40:43], v[240:247], v1
    v_add_f32 v100, v100, v102
    v_add_f32 v101, v101, v103
    v_smfmac_f32_16x16x64_bf16 v[104:107], v[44:47], a[16:23], v1
    v_cvt_pk_bf16_f32 v96, v96, v100
    v_smfmac_f32_16x16x64_bf16 v[108:111], v[36:39], a[88:95], v1
    v_cvt_pk_bf16_f32 v97, v97, v101
    v_smfmac_f32_16x16x64_bf16 v[108:111], v[40:43], v[248:255], v1
    ds_write2_b32 v4, v96, v97 offset0:0 offset1:136
    v_smfmac_f32_16x16x64_bf16 v[108:111], v[44:47], a[24:31], v1
    v_add_f32 v104, v104, v106
    v_smfmac_f32_16x16x64_bf16 v[112:115], v[24:27], a[144:151], v1
    v_add_f32 v105, v105, v107
    v_smfmac_f32_16x16x64_bf16 v[116:119], v[24:27], a[152:159], v1
    ds_read_b128 v[24:27], v8 offset:18432
    v_add_f32 v108, v108, v110
    v_smfmac_f32_16x16x64_bf16 v[112:115], v[28:31], a[96:103], v1
    v_add_f32 v109, v109, v111
    v_smfmac_f32_16x16x64_bf16 v[116:119], v[28:31], a[104:111], v1
    s_waitcnt vmcnt(9) lgkmcnt(1)
    s_barrier
    v_smfmac_f32_16x16x64_bf16 v[112:115], v[32:35], a[112:119], v1
    ds_read_b128 v[120:123], v6 offset:0
    v_cvt_pk_bf16_f32 v10, v104, v108
    v_smfmac_f32_16x16x64_bf16 v[116:119], v[32:35], a[120:127], v1
    ds_read_b128 v[124:127], v6 offset:64
    v_cvt_pk_bf16_f32 v11, v105, v109
    v_smfmac_f32_16x16x64_bf16 v[112:115], v[36:39], a[208:215], v1
    ds_write2_b32 v5, v10, v11 offset0:0 offset1:4
    v_smfmac_f32_16x16x64_bf16 v[116:119], v[36:39], a[216:223], v1
    ds_read_b128 v[16:19], v6 offset:128
    v_mov_b64 v[104:105], 0
    v_smfmac_f32_16x16x64_bf16 v[112:115], v[40:43], a[160:167], v1
    ds_read_b128 v[20:23], v6 offset:192
    v_mov_b64 v[106:107], 0
    v_smfmac_f32_16x16x64_bf16 v[116:119], v[40:43], a[168:175], v1
    ds_read_b128 v[28:31], v8 offset:22528
    v_mov_b64 v[108:109], 0
    v_smfmac_f32_16x16x64_bf16 v[112:115], v[44:47], a[176:183], v1
    ds_read_b128 v[32:35], v8 offset:26624
    v_mov_b64 v[110:111], 0
    v_smfmac_f32_16x16x64_bf16 v[116:119], v[44:47], a[184:191], v1
    ds_read_b128 v[36:39], v8 offset:30720
    s_waitcnt lgkmcnt(6)
    v_mfma_f32_16x16x32_bf16 v[96:99], v[48:51], v[120:123], 0
    s_waitcnt lgkmcnt(5)
    s_barrier
    v_mfma_f32_16x16x32_bf16 v[100:103], v[64:67], v[120:123], 0
    ds_read_b128 v[40:43], v7 offset:0
    v_add_f32 v112, v112, v114
    v_mfma_f32_16x16x32_bf16 v[96:99], v[52:55], v[124:127], v[96:99]
    ds_read_b128 v[44:47], v7 offset:1088
    v_add_f32 v113, v113, v115
    v_mfma_f32_16x16x32_bf16 v[100:103], v[68:71], v[124:127], v[100:103]
    s_waitcnt lgkmcnt(5)
    v_add_f32 v116, v116, v118
    v_add_f32 v117, v117, v119
    v_mfma_f32_16x16x32_bf16 v[96:99], v[56:59], v[16:19], v[96:99]
    ds_read_b128 v[48:51], v8 offset:0
    v_cvt_pk_bf16_f32 v82, v112, v113
    v_mfma_f32_16x16x32_bf16 v[96:99], v[60:63], v[20:23], v[96:99]
    ds_read_b128 v[64:67], v8 offset:16384
    v_cvt_pk_bf16_f32 v90, v116, v117
    v_mfma_f32_16x16x32_bf16 v[100:103], v[72:75], v[16:19], v[100:103]
    ds_read_b128 v[52:55], v8 offset:4096
    v_cvt_pk_bf16_f32 v94, v116, v117
    v_mfma_f32_16x16x32_bf16 v[100:103], v[76:79], v[20:23], v[100:103]
    s_waitcnt lgkmcnt(3)
    v_cvt_pk_bf16_f32 v86, v112, v113
    v_max3_f32 v10, v96, v97, v98
    v_smfmac_f32_16x16x64_bf16 v[104:107], v[40:43], v[120:127], v1
    ds_read_b128 v[68:71], v8 offset:20480
    v_cndmask_b32 v96, v96, v98, s[52:53]
    v_smfmac_f32_16x16x64_bf16 v[104:107], v[44:47], v[16:23], v1
    ds_read_b128 v[56:59], v8 offset:8192
    s_nop 0
    v_cndmask_b32 v97, v97, v99, s[52:53]
    v_max3_f32 v10, v10, v99, v100
    v_max3_f32 v10, v10, v101, v102
    v_cndmask_b32 v98, v100, v102, s[52:53]
    v_cndmask_b32 v99, v101, v103, s[52:53]
    v_max_f32 v10, v10, v103
    v_pk_add_f32 v[104:105], v[104:105], v[106:107]
    v_max3_f32 v11, v10, v104, v105
    v_max3_f32 v10, v10, v104, v105
    v_cndmask_b32 v104, v104, v105, s[52:53]
    v_mov_b64 v[120:121], s[54:55]
    v_permlane32_swap_b32 v10, v11
    v_max_f32 v106, v10, v11
    v_max_f32 v107, v10, v11
    v_mov_b64 v[122:123], s[56:57]
    v_mov_b64 v[116:117], 0
    v_permlane16_swap_b32 v106, v107
    v_max_f32 v10, v106, v107
    v_mul_f32 v10, s61, v10
    v_pk_fma_f32 v[96:97], v[96:97], s[58:59], v[10:11] op_sel_hi:[1,1,0]
    v_pk_fma_f32 v[98:99], v[98:99], s[58:59], v[10:11] op_sel_hi:[1,1,0]
    v_fma_f32 v104, v104, s58, v10
    v_exp_f32 v96, v96
    v_exp_f32 v97, v97
    v_exp_f32 v98, v98
    v_exp_f32 v99, v99
    v_exp_f32 v104, v104
    v_cvt_pk_bf16_f32 v100, v96, v97
    v_cvt_pk_bf16_f32 v102, v98, v99
    v_cvt_pk_bf16_f32 v101, v104, 0
    v_cvt_pk_bf16_f32 v103, v104, 0
    v_mov_b64 v[118:119], 0
    s_nop 0
    v_mfma_f32_16x16x32_bf16 v[112:115], v[100:103], v[120:123], 0
    ds_read_b128 v[60:63], v8 offset:12288
    ds_read_b128 v[72:75], v8 offset:24576
    v_smfmac_f32_16x16x64_bf16 v[108:111], v[100:103], v[80:87], v1 abid:1
    ds_read_b128 v[76:79], v8 offset:28672
    ds_read_b128 v[16:19], v8 offset:2048
    v_smfmac_f32_16x16x64_bf16 v[116:119], v[100:103], v[88:95], v1 abid:1
    ds_read_b128 v[20:23], v8 offset:6144
    s_nop 0
    v_add_f32 v112, v112, v114
    v_add_f32 v113, v113, v115
    v_rcp_f32 v112, v112
    v_rcp_f32 v113, v113
    v_pk_add_f32 v[108:109], v[108:109], v[110:111]
    v_pk_mul_f32 v[108:109], v[108:109], v[112:113]
    v_pk_add_f32 v[116:117], v[116:117], v[118:119]
    v_pk_mul_f32 v[116:117], v[116:117], v[112:113]
    v_cvt_pk_bf16_f32 v10, v108, v116
    v_cvt_pk_bf16_f32 v11, v109, v117
    ds_write2_b32 v4, v10, v11 offset0:64 offset1:200
    ds_read_b128 v[104:107], v6 offset:384
    v_mov_b64 v[112:113], 0
    v_mov_b64 v[114:115], 0
    v_mov_b64 v[116:117], 0
    v_mov_b64 v[118:119], 0
    s_cbranch_scc1 L_last_214
L_lastb_215:
    v_mov_b64 v[84:85], 0
    v_mov_b64 v[86:87], 0
    v_mov_b64 v[92:93], 0
    v_mov_b64 v[94:95], 0
    s_waitcnt vmcnt(8) lgkmcnt(1)
    s_barrier
    ds_read_b128 v[108:111], v6 offset:448
    ds_read_b128 v[96:99], v6 offset:256
    ds_read_b128 v[100:103], v6 offset:320
    s_waitcnt lgkmcnt(3)
    v_smfmac_f32_16x16x64_bf16 v[112:115], v[104:107], v[64:71], v1
    ds_read_b128 v[40:43], v8 offset:10240
    v_smfmac_f32_16x16x64_bf16 v[116:119], v[104:107], a[240:247], v1
    ds_read_b128 v[44:47], v8 offset:14336
    v_smfmac_f32_16x16x64_bf16 v[84:87], v[104:107], v[24:31], v1
    ds_read_b128 v[64:67], v8 offset:19456
    s_waitcnt lgkmcnt(5)
    v_smfmac_f32_16x16x64_bf16 v[112:115], v[108:111], v[72:79], v1
    ds_read_b128 v[68:71], v8 offset:23552
    s_waitcnt lgkmcnt(5)
    v_smfmac_f32_16x16x64_bf16 v[112:115], v[96:99], v[48:55], v1
    ds_read_b128 v[72:75], v8 offset:27648
    s_waitcnt lgkmcnt(5)
    v_smfmac_f32_16x16x64_bf16 v[112:115], v[100:103], v[56:63], v1
    ds_read_b128 v[76:79], v8 offset:31744
    v_smfmac_f32_16x16x64_bf16 v[116:119], v[108:111], a[248:255], v1
    ds_read_b128 v[48:51], v8 offset:3072
    v_smfmac_f32_16x16x64_bf16 v[116:119], v[96:99], a[224:231], v1
    ds_read_b128 v[52:55], v8 offset:7168
    v_cvt_pk_bf16_f32 v112, v112, v114
    v_and_or_b32 v112, v112, -2, s51
    v_smfmac_f32_16x16x64_bf16 v[116:119], v[100:103], a[232:239], v1
    global_store_dword v2, v112, s[8:9] offset:-4096
    v_cvt_pk_bf16_f32 v113, v113, v115
    v_and_or_b32 v113, v113, -2, s51
    v_smfmac_f32_16x16x64_bf16 v[84:87], v[108:111], v[32:39], v1
    global_store_dword v2, v113, s[10:11] offset:-4096
    ds_read_b128 v[56:59], v8 offset:11264
    v_smfmac_f32_16x16x64_bf16 v[84:87], v[96:99], v[16:23], v1
    ds_read_b128 v[60:63], v8 offset:15360
    s_waitcnt lgkmcnt(8)
    v_cvt_pk_bf16_f32 v116, v116, v118
    v_and_or_b32 v116, v116, -2, s51
    v_smfmac_f32_16x16x64_bf16 v[84:87], v[100:103], v[40:47], v1
    global_store_dword v2, v116, s[8:9] offset:-2048
    s_waitcnt lgkmcnt(6)
    v_cvt_pk_bf16_f32 v117, v117, v119
    v_and_or_b32 v117, v117, -2, s51
    v_smfmac_f32_16x16x64_bf16 v[92:95], v[104:107], v[64:71], v1
    global_store_dword v2, v117, s[10:11] offset:-2048
    s_waitcnt lgkmcnt(4)
    v_smfmac_f32_16x16x64_bf16 v[92:95], v[108:111], v[72:79], v1
    s_waitcnt lgkmcnt(2)
    v_cvt_pk_bf16_f32 v84, v84, v86
    v_and_or_b32 v84, v84, -2, s51
    v_smfmac_f32_16x16x64_bf16 v[92:95], v[96:99], v[48:55], v1
    global_store_dword v2, v84, s[8:9] offset:0
    s_waitcnt lgkmcnt(0)
    v_cvt_pk_bf16_f32 v85, v85, v87
    v_and_or_b32 v85, v85, -2, s51
    v_smfmac_f32_16x16x64_bf16 v[92:95], v[100:103], v[56:63], v1
    global_store_dword v2, v85, s[10:11] offset:0
    s_nop 0
    v_mov_b64 v[96:97], 0
    v_mov_b64 v[98:99], 0
    v_mov_b64 v[100:101], 0
    v_mov_b64 v[102:103], 0
    v_mov_b64 v[104:105], 0
    v_mov_b64 v[106:107], 0
    v_cvt_pk_bf16_f32 v92, v92, v94
    v_and_or_b32 v92, v92, -2, s51
    v_cvt_pk_bf16_f32 v93, v93, v95
    v_and_or_b32 v93, v93, -2, s51
    v_mov_b64 v[108:109], 0
    s_add_u32 s12, s12, 4096
    s_addc_u32 s13, s13, 0
    s_add_u32 s34, s34, 1
    global_store_dword v2, v92, s[8:9] offset:2048
    global_store_dword v2, v93, s[10:11] offset:2048
    v_mov_b64 v[110:111], 0
    s_add_u32 s44, s44, 16384
    s_addc_u32 s45, s45, 0
    s_add_u32 s46, s46, 16384
    s_addc_u32 s47, s47, 0
    s_xor_b32 s40, s40, 65536
    v_mov_b64 v[112:113], 0
    s_nop 4
    v_mov_b64 v[114:115], 0
    s_nop 4
    v_mov_b64 v[116:117], 0
    s_nop 4
    v_mov_b64 v[118:119], 0
    s_nop 4
    v_mov_b64 v[86:87], 0
    s_nop 4
    v_mov_b64 v[94:95], 0
    s_nop 4
    v_mov_b32 v10, 0
    s_nop 4
    v_mov_b32 v10, 0
    s_nop 3
    global_load_dword v120, v9, s[36:37] offset:0 sc1
    global_load_dword v121, v9, s[36:37] offset:256 sc1
    global_load_dword v122, v9, s[36:37] offset:512 sc1
    global_load_dword v123, v9, s[36:37] offset:768 sc1
    global_load_dword v124, v9, s[36:37] offset:1024 sc1
    global_load_dword v125, v9, s[36:37] offset:1280 sc1
    global_load_dword v126, v9, s[36:37] offset:1536 sc1
    global_load_dword v127, v9, s[36:37] offset:1792 sc1
    ds_read_b128 v[48:51], v8 offset:1024
    ds_read_b128 v[52:55], v8 offset:5120
    v_mov_b32 v10, 0
    s_nop 1
    ds_read_b128 v[56:59], v8 offset:9216
    ds_read_b128 v[60:63], v8 offset:13312
    v_mov_b32 v10, 0
    s_nop 1
    ds_read_b128 v[64:67], v8 offset:17408
    ds_read_b128 v[68:71], v8 offset:21504
    v_mov_b32 v10, 0
    s_nop 1
    ds_read_b128 v[72:75], v8 offset:25600
    ds_read_b128 v[76:79], v8 offset:29696
    v_mov_b32 v10, 0
    s_nop 1
    s_cmp_eq_u32 s51, 0
    s_cbranch_scc1 L_tag0_216
    s_waitcnt vmcnt(4)
    v_bitop3_b32 v10, v120, v121, v122 bitop3:0x80
    v_bitop3_b32 v10, v10, v123, 1 bitop3:0x80
    v_mfma_f32_16x16x32_bf16 v[32:35], v[12:15], v[120:123], 0
    s_waitcnt vmcnt(0)
    v_bitop3_b32 v10, v10, v124, v125 bitop3:0x80
    v_bitop3_b32 v10, v10, v126, v127 bitop3:0x80
    v_mfma_f32_16x16x32_bf16 v[32:35], v[12:15], v[124:127], v[32:35]
    s_nop 0
    v_cmp_ne_u32 vcc, 1, v10
    s_nop 0
    s_mov_b64 exec, s[26:27]
    s_nop 2
    s_cbranch_vccnz L_h1r_217
    v_cvt_pk_bf16_f32 v11, v32, v33
    global_store_dword v3, v11, s[42:43] offset:0
    s_mov_b64 exec, -1
    s_branch L_step_205
L_h1r_217:
    s_mov_b64 exec, -1
    global_load_dword v120, v9, s[36:37] offset:0 sc1
    global_load_dword v121, v9, s[36:37] offset:256 sc1
    global_load_dword v122, v9, s[36:37] offset:512 sc1
    global_load_dword v123, v9, s[36:37] offset:768 sc1
    global_load_dword v124, v9, s[36:37] offset:1024 sc1
    global_load_dword v125, v9, s[36:37] offset:1280 sc1
    global_load_dword v126, v9, s[36:37] offset:1536 sc1
    global_load_dword v127, v9, s[36:37] offset:1792 sc1
    s_sub_u32 s50, s50, 1
    s_cselect_b64 s[48:49], 0, s[48:49]
    s_waitcnt vmcnt(8)
    v_bitop3_b32 v10, v120, v121, v122 bitop3:0x80
    v_bitop3_b32 v10, v10, v123, 1 bitop3:0x80
    v_mfma_f32_16x16x32_bf16 v[32:35], v[12:15], v[120:123], 0
    s_nop 0
    v_bitop3_b32 v10, v10, v124, v125 bitop3:0x80
    v_bitop3_b32 v10, v10, v126, v127 bitop3:0x80
    v_mfma_f32_16x16x32_bf16 v[32:35], v[12:15], v[124:127], v[32:35]
    s_nop 0
    v_cmp_ne_u32 vcc, 1, v10
    s_nop 0
    s_mov_b64 exec, s[26:27]
    s_nop 1
    s_and_b64 vcc, vcc, s[48:49]
    s_cbranch_scc1 L_h1r_217
    v_cvt_pk_bf16_f32 v11, v32, v33
    global_store_dword v3, v11, s[42:43] offset:0
    s_mov_b64 exec, -1
    s_branch L_step_205
L_tag0_216:
    s_waitcnt vmcnt(4)
    v_bitop3_b32 v10, v120, v121, v122 bitop3:0x01
    v_bitop3_b32 v10, v10, v123, 1 bitop3:0x20
    v_mfma_f32_16x16x32_bf16 v[32:35], v[12:15], v[120:123], 0
    s_waitcnt vmcnt(0)
    v_bitop3_b32 v10, v10, v124, v125 bitop3:0x10
    v_bitop3_b32 v10, v10, v126, v127 bitop3:0x10
    v_mfma_f32_16x16x32_bf16 v[32:35], v[12:15], v[124:127], v[32:35]
    s_nop 0
    v_cmp_ne_u32 vcc, 1, v10
    s_nop 0
    s_mov_b64 exec, s[26:27]
    s_nop 2
    s_cbranch_vccnz L_h1r_218
    v_cvt_pk_bf16_f32 v11, v32, v33
    global_store_dword v3, v11, s[42:43] offset:0
    s_mov_b64 exec, -1
    s_branch L_step_205
L_h1r_218:
    s_mov_b64 exec, -1
    global_load_dword v120, v9, s[36:37] offset:0 sc1
    global_load_dword v121, v9, s[36:37] offset:256 sc1
    global_load_dword v122, v9, s[36:37] offset:512 sc1
    global_load_dword v123, v9, s[36:37] offset:768 sc1
    global_load_dword v124, v9, s[36:37] offset:1024 sc1
    global_load_dword v125, v9, s[36:37] offset:1280 sc1
    global_load_dword v126, v9, s[36:37] offset:1536 sc1
    global_load_dword v127, v9, s[36:37] offset:1792 sc1
    s_sub_u32 s50, s50, 1
    s_cselect_b64 s[48:49], 0, s[48:49]
    s_waitcnt vmcnt(8)
    v_bitop3_b32 v10, v120, v121, v122 bitop3:0x01
    v_bitop3_b32 v10, v10, v123, 1 bitop3:0x20
    v_mfma_f32_16x16x32_bf16 v[32:35], v[12:15], v[120:123], 0
    s_nop 0
    v_bitop3_b32 v10, v10, v124, v125 bitop3:0x10
    v_bitop3_b32 v10, v10, v126, v127 bitop3:0x10
    v_mfma_f32_16x16x32_bf16 v[32:35], v[12:15], v[124:127], v[32:35]
    s_nop 0
    v_cmp_ne_u32 vcc, 1, v10
    s_nop 0
    s_mov_b64 exec, s[26:27]
    s_nop 1
    s_and_b64 vcc, vcc, s[48:49]
    s_cbranch_scc1 L_h1r_218
    v_cvt_pk_bf16_f32 v11, v32, v33
    global_store_dword v3, v11, s[42:43] offset:0
    s_mov_b64 exec, -1
    s_branch L_step_205
L_last_214:
    v_add_u32 v10, 30016, v9
    ds_read2_b32 v[124:125], v10 offset0:0 offset1:68
    s_add_u32 s12, s12, 4096
    s_addc_u32 s13, s13, 0
    global_store_dword v9, v82, s[12:13] offset:3072 sc1
    global_store_dword v9, v90, s[12:13] offset:3328 sc1
    s_waitcnt lgkmcnt(0)
    global_store_dword v9, v124, s[12:13] offset:1024 sc1
    global_store_dword v9, v125, s[12:13] offset:1280 sc1
    s_cmp_eq_u32 s34, 63
    s_cbranch_scc1 L_exit_206
    s_sub_u32 s12, s12, 4096
    s_subb_u32 s13, s13, 0
    s_getpc_b64 s[64:65]
L_pc_219:
    s_add_u32 s64, s64, L_fin_2-L_pc_219
    s_addc_u32 s65, s65, 0
    v_lshlrev_b32 v126, 2, v0
    v_min_u32 v126, L_code_end-L_fin_2-4, v126
    global_load_dword v127, v126, s[64:65]
    s_branch L_lastb_215
L_h2a_209:
    global_load_dwordx4 v[16:19], v0, s[40:41] offset:-2048 sc1
    global_load_dwordx4 v[20:23], v0, s[40:41] offset:2048 sc1
    s_nop 4
    v_mov_b64 v[96:97], 0
    v_mov_b64 v[98:99], 0
    v_mov_b64 v[100:101], 0
    v_mov_b64 v[102:103], 0
    s_waitcnt vmcnt(3)
    v_maximum3_f32 v11, v16, v17, v18
    v_cmp_u_f32 vcc, v11, v19
    v_smfmac_f32_16x16x64_bf16 v[96:99], v[16:19], v[48:55], v1
    ds_write_b128 v0, v[16:19] offset:18432
    v_smfmac_f32_16x16x64_bf16 v[100:103], v[16:19], v[56:63], v1
    s_cbranch_vccz L_h2cc_213
L_h2l2_220:
    global_load_dwordx4 v[16:19], v0, s[40:41] offset:-2048 sc1
    global_load_dwordx4 v[20:23], v0, s[40:41] offset:2048 sc1
    s_sub_u32 s2, s2, 1
    s_cselect_b64 s[38:39], 0, s[38:39]
    s_nop 2
    v_mov_b64 v[96:97], 0
    v_mov_b64 v[98:99], 0
    v_mov_b64 v[100:101], 0
    v_mov_b64 v[102:103], 0
    s_waitcnt vmcnt(3)
    v_maximum3_f32 v11, v16, v17, v18
    v_cmp_u_f32 vcc, v11, v19
    v_smfmac_f32_16x16x64_bf16 v[96:99], v[16:19], v[48:55], v1
    ds_write_b128 v0, v[16:19] offset:18432
    v_smfmac_f32_16x16x64_bf16 v[100:103], v[16:19], v[56:63], v1
    s_and_b64 vcc, vcc, s[38:39]
    s_cbranch_scc0 L_h2cc_213
    s_branch L_h2l2_220
    global_load_dwordx4 v[16:19], v0, s[40:41] offset:-2048 sc1
    global_load_dwordx4 v[20:23], v0, s[40:41] offset:2048 sc1
    s_sub_u32 s2, s2, 1
    s_cselect_b64 s[38:39], 0, s[38:39]
    s_cmp_eq_u64 s[38:39], 0
    s_cbranch_scc1 L_h2cc_213
    s_nop 2
    v_mov_b64 v[96:97], 0
    v_mov_b64 v[98:99], 0
    v_mov_b64 v[100:101], 0
    v_mov_b64 v[102:103], 0
    s_waitcnt vmcnt(3)
    s_branch L_h2ca_211
L_h2b_210:
    global_load_dwordx4 v[20:23], v0, s[40:41] offset:2048 sc1
    s_sub_u32 s2, s2, 1
    s_cselect_b64 s[38:39], 0, s[38:39]
    s_waitcnt vmcnt(1)
    v_maximum3_f32 v11, v20, v21, v22
    v_cmp_u_f32 vcc, v11, v23
    s_and_b64 vcc, vcc, s[38:39]
    s_cbranch_scc0 L_h2cb_212
    s_branch L_h2b_210
L_exit_206:
L_done_188:
L_fin_2:
    s_nop 9
    global_load_dwordx4 v[16:19], v0, s[40:41] offset:-2048 sc1
    global_load_dwordx4 v[20:23], v0, s[40:41] offset:2048 sc1
    v_lshrrev_b32 v80, 4, v0
    v_and_b32 v81, 15, v80
    v_lshrrev_b32 v82, 4, v80
    v_lshrrev_b32 v83, 2, v80
    v_and_b32 v84, 3, v80
    v_and_b32 v85, 3, v83
    v_add_u32 v86, 16, v81
    v_lshlrev_b32 v87, 2, v82
    v_sub_u32 v86, v86, v87
    v_cmp_le_i32 s[72:73], 0, v86
    v_cmp_le_i32 s[74:75], 1, v86
    v_cmp_le_i32 s[76:77], 2, v86
    v_cmp_le_i32 s[78:79], 3, v86
    v_cmp_le_i32 s[80:81], 16, v86
    v_cmp_le_i32 s[82:83], 17, v86
    v_cmp_le_i32 s[84:85], 18, v86
    v_cmp_le_i32 s[86:87], 19, v86
    s_mul_i32 s62, s32, 532480
    s_add_u32 s62, s62, 51900416
    s_add_u32 s88, s4, s62
    s_addc_u32 s89, s5, 0
    global_load_dwordx4 v[16:19], v0, s[40:41] offset:-2048 sc1
    global_load_dwordx4 v[20:23], v0, s[40:41] offset:2048 sc1
    s_lshl_b32 s62, s32, 11
    s_add_u32 s62, s62, 100532224
    s_add_u32 s90, s4, s62
    s_addc_u32 s91, s5, 0
    ds_read_b128 v[224:227], v0 offset:8192
    ds_read_b128 v[228:231], v0 offset:9216
    ds_read_b128 v[232:235], v0 offset:10240
    ds_read_b128 v[236:239], v0 offset:11264
    s_waitcnt vmcnt(2)
L_fp_221:
    v_maximum3_f32 v10, v16, v17, v18
    v_maximum3_f32 v10, v10, v19, v20
    v_maximum3_f32 v10, v10, v21, v22
    v_cmp_u_f32 vcc, v10, v23
    ds_write_b128 v0, v[16:19] offset:18432
    ds_write_b128 v0, v[20:23] offset:22528
    s_and_b64 vcc, vcc, s[38:39]
    s_cbranch_scc0 L_fo_222
    global_load_dwordx4 v[16:19], v0, s[40:41] offset:-2048 sc1
    global_load_dwordx4 v[20:23], v0, s[40:41] offset:2048 sc1
    s_sub_u32 s2, s2, 1
    s_cselect_b64 s[38:39], 0, s[38:39]
    s_waitcnt vmcnt(2)
    s_branch L_fp_221
L_fo_222:
    v_smfmac_f32_16x16x64_bf16 v[104:107], v[16:19], v[64:71], v1
    v_bfe_u32 v86, v81, 2, 1
    v_smfmac_f32_16x16x64_bf16 v[108:111], v[16:19], v[72:79], v1
    v_mul_u32_u24 v120, 4096, v86
    v_smfmac_f32_16x16x64_bf16 v[112:115], v[16:19], a[128:135], v1
    v_bfe_u32 v86, v82, 0, 2
    v_smfmac_f32_16x16x64_bf16 v[116:119], v[16:19], a[136:143], v1
    v_mul_u32_u24 v86, 256, v86
    v_smfmac_f32_16x16x64_bf16 v[104:107], v[20:23], a[48:55], v1
    v_add_u32 v120, v120, v86
    v_smfmac_f32_16x16x64_bf16 v[108:111], v[20:23], a[56:63], v1
    s_waitcnt lgkmcnt(0)
    s_barrier
    ds_read_b128 v[24:27], v0 offset:16384
    v_smfmac_f32_16x16x64_bf16 v[112:115], v[20:23], a[192:199], v1
    global_load_dwordx4 v[128:131], v0, s[88:89] offset:0 sc1
    ds_read_b128 v[28:31], v0 offset:17408
    v_smfmac_f32_16x16x64_bf16 v[116:119], v[20:23], a[200:207], v1
    global_load_dwordx4 v[132:135], v0, s[88:89] offset:1024 sc1
    ds_read_b128 v[32:35], v0 offset:19456
    s_waitcnt lgkmcnt(2)
    v_smfmac_f32_16x16x64_bf16 v[104:107], v[24:27], v[176:183], v1
    global_load_dwordx4 v[136:139], v0, s[88:89] offset:2048 sc1
    ds_read_b128 v[36:39], v0 offset:20480
    v_bfe_u32 v86, v81, 3, 1
    v_smfmac_f32_16x16x64_bf16 v[108:111], v[24:27], v[184:191], v1
    global_load_dwordx4 v[140:143], v0, s[88:89] offset:3072 sc1
    ds_read_b128 v[40:43], v0 offset:21504
    v_mul_u32_u24 v86, 64, v86
    v_smfmac_f32_16x16x64_bf16 v[112:115], v[24:27], a[96:103], v1
    ds_read_b128 v[44:47], v0 offset:23552
    v_add_u32 v120, v120, v86
    v_smfmac_f32_16x16x64_bf16 v[116:119], v[24:27], a[104:111], v1
    s_waitcnt lgkmcnt(4)
    v_bfe_u32 v86, v81, 0, 2
    v_smfmac_f32_16x16x64_bf16 v[104:107], v[28:31], v[144:151], v1
    v_mul_u32_u24 v86, 16, v86
    v_smfmac_f32_16x16x64_bf16 v[108:111], v[28:31], v[152:159], v1
    v_add_u32 v120, v120, v86
    v_smfmac_f32_16x16x64_bf16 v[112:115], v[28:31], a[112:119], v1
    v_bfe_u32 v86, v82, 0, 1
    v_smfmac_f32_16x16x64_bf16 v[116:119], v[28:31], a[120:127], v1
    s_waitcnt lgkmcnt(0)
    v_mul_u32_u24 v121, 128, v86
    v_smfmac_f32_16x16x64_bf16 v[104:107], v[32:35], v[208:215], v1
    ds_read_b128 v[160:163], v120 offset:0
    v_bfe_u32 v86, v82, 1, 1
    v_smfmac_f32_16x16x64_bf16 v[108:111], v[32:35], v[216:223], v1
    ds_read_b128 v[164:167], v120 offset:1024
    v_mul_u32_u24 v86, 64, v86
    v_smfmac_f32_16x16x64_bf16 v[112:115], v[32:35], a[144:151], v1
    ds_read_b128 v[168:171], v120 offset:2048
    v_add_u32 v121, v121, v86
    v_smfmac_f32_16x16x64_bf16 v[116:119], v[32:35], a[152:159], v1
    ds_read_b128 v[172:175], v120 offset:3072
    v_bfe_u32 v86, v81, 0, 4
    v_smfmac_f32_16x16x64_bf16 v[104:107], v[36:39], v[240:247], v1
    ds_read_b128 v[192:195], v120 offset:128
    v_mul_u32_u24 v86, 4, v86
    v_smfmac_f32_16x16x64_bf16 v[108:111], v[36:39], v[248:255], v1
    ds_read_b128 v[196:199], v120 offset:1152
    v_add_u32 v121, v121, v86
    v_smfmac_f32_16x16x64_bf16 v[112:115], v[36:39], a[160:167], v1
    ds_read_b128 v[200:203], v120 offset:2176
    v_bfe_u32 v86, v81, 3, 1
    v_smfmac_f32_16x16x64_bf16 v[116:119], v[36:39], a[168:175], v1
    ds_read_b128 v[204:207], v120 offset:3200
    v_mul_u32_u24 v122, 65536, v86
    v_smfmac_f32_16x16x64_bf16 v[104:107], v[40:43], a[16:23], v1
    v_bfe_u32 v86, v82, 0, 2
    v_smfmac_f32_16x16x64_bf16 v[108:111], v[40:43], a[24:31], v1
    v_mul_u32_u24 v86, 256, v86
    v_smfmac_f32_16x16x64_bf16 v[112:115], v[40:43], a[176:183], v1
    v_add_u32 v122, v122, v86
    v_smfmac_f32_16x16x64_bf16 v[116:119], v[40:43], a[184:191], v1
    v_bfe_u32 v86, v81, 0, 3
    v_smfmac_f32_16x16x64_bf16 v[104:107], v[44:47], a[80:87], v1
    v_mul_u32_u24 v86, 16, v86
    v_smfmac_f32_16x16x64_bf16 v[108:111], v[44:47], a[88:95], v1
    v_add_u32 v122, v122, v86
    v_smfmac_f32_16x16x64_bf16 v[112:115], v[44:47], a[208:215], v1
    v_mov_b32 v123, 0xd028965f
    v_smfmac_f32_16x16x64_bf16 v[116:119], v[44:47], a[216:223], v1
    s_nop 0
    v_add_f32 v104, v104, v106
    v_add_f32 v105, v105, v107
    v_add_f32 v108, v108, v110
    v_add_f32 v109, v109, v111
    v_cvt_pk_bf16_f32 v10, v104, v108
    v_cvt_pk_bf16_f32 v11, v105, v109
    ds_write2_b32 v5, v10, v11 offset0:0 offset1:4
    v_pk_add_f32 v[112:113], v[112:113], v[114:115]
    v_cvt_pk_bf16_f32 v112, v112, v113
    v_pk_add_f32 v[116:117], v[116:117], v[118:119]
    v_cvt_pk_bf16_f32 v116, v116, v117
    ds_write_b32 v9, v112 offset:25600
    ds_write_b32 v9, v116 offset:25856
    s_waitcnt vmcnt(0) lgkmcnt(3)
    v_mfma_f32_16x16x32_bf16 v[48:51], v[160:163], v[128:131], 0
    v_mov_b64 v[56:57], 0
    v_mov_b64 v[58:59], 0
    v_mfma_f32_16x16x32_bf16 v[48:51], v[164:167], v[132:135], v[48:51]
    v_mov_b64 v[72:73], s[54:55]
    v_mov_b64 v[74:75], s[54:55]
    v_mfma_f32_16x16x32_bf16 v[48:51], v[168:171], v[136:139], v[48:51]
    v_mov_b64 v[80:81], 0
    v_mov_b64 v[82:83], 0
    v_mfma_f32_16x16x32_bf16 v[48:51], v[172:175], v[140:143], v[48:51]
    v_mov_b64 v[84:85], 0
    v_mov_b64 v[86:87], 0
    v_mfma_f32_16x16x32_bf16 v[52:55], v[192:195], v[128:131], 0
    s_waitcnt lgkmcnt(0)
    s_barrier
    ds_read_b128 v[40:43], v7 offset:0
    ds_read_b128 v[44:47], v7 offset:1088
    v_mfma_f32_16x16x32_bf16 v[52:55], v[196:199], v[132:135], v[52:55]
    ds_read_b32 v80, v121 offset:24576
    ds_read_b32 v82, v121 offset:24832
    ds_read_b32 v84, v121 offset:25088
    ds_read_b32 v86, v121 offset:25344
    v_mfma_f32_16x16x32_bf16 v[52:55], v[200:203], v[136:139], v[52:55]
    v_mov_b64 v[64:65], 0
    v_mfma_f32_16x16x32_bf16 v[52:55], v[204:207], v[140:143], v[52:55]
    v_cndmask_b32 v48, v123, v48, s[72:73]
    v_cndmask_b32 v49, v123, v49, s[74:75]
    v_cndmask_b32 v50, v123, v50, s[76:77]
    v_cndmask_b32 v51, v123, v51, s[78:79]
    s_waitcnt lgkmcnt(4)
    v_smfmac_f32_16x16x64_bf16 v[56:59], v[40:43], v[128:135], v1
    v_smfmac_f32_16x16x64_bf16 v[56:59], v[44:47], v[136:143], v1
    v_cndmask_b32 v52, v123, v52, s[80:81]
    v_cndmask_b32 v53, v123, v53, s[82:83]
    v_cndmask_b32 v54, v123, v54, s[84:85]
    v_cndmask_b32 v55, v123, v55, s[86:87]
    v_max3_f32 v10, v48, v49, v50
    v_max3_f32 v10, v10, v51, v52
    v_max3_f32 v10, v10, v53, v54
    v_max_f32 v10, v10, v55
    v_pk_add_f32 v[56:57], v[56:57], v[58:59]
    v_max3_f32 v10, v10, v56, v57
    v_mov_b32 v11, v10
    s_nop 1
    v_permlane32_swap_b32 v10, v11
    v_max_f32 v10, v10, v11
    v_mov_b32 v11, v10
    s_nop 1
    v_permlane16_swap_b32 v10, v11
    v_max_f32 v10, v10, v11
    v_mul_f32 v10, s61, v10
    v_pk_fma_f32 v[48:49], v[48:49], s[58:59], v[10:11] op_sel_hi:[1,1,0]
    v_pk_fma_f32 v[50:51], v[50:51], s[58:59], v[10:11] op_sel_hi:[1,1,0]
    v_pk_fma_f32 v[52:53], v[52:53], s[58:59], v[10:11] op_sel_hi:[1,1,0]
    v_pk_fma_f32 v[54:55], v[54:55], s[58:59], v[10:11] op_sel_hi:[1,1,0]
    v_pk_fma_f32 v[56:57], v[56:57], s[58:59], v[10:11] op_sel_hi:[1,1,0]
    v_exp_f32 v48, v48
    v_exp_f32 v49, v49
    v_exp_f32 v50, v50
    v_exp_f32 v51, v51
    v_exp_f32 v52, v52
    v_exp_f32 v53, v53
    v_exp_f32 v54, v54
    v_exp_f32 v55, v55
    v_exp_f32 v56, v56
    v_exp_f32 v57, v57
    v_cvt_pk_bf16_f32 v60, v48, v49
    v_cvt_pk_bf16_f32 v61, v50, v51
    v_cvt_pk_bf16_f32 v62, v52, v53
    v_cvt_pk_bf16_f32 v63, v54, v55
    v_cvt_pk_bf16_f32 v64, v56, v57
    s_waitcnt lgkmcnt(0)
    s_nop 0
    v_mfma_f32_16x16x32_bf16 v[68:71], v[72:75], v[60:63], 0
    v_mfma_f32_16x16x32_bf16 v[24:27], v[224:227], v[60:63], 0
    v_mfma_f32_16x16x32_bf16 v[28:31], v[228:231], v[60:63], 0
    v_mfma_f32_16x16x32_bf16 v[32:35], v[232:235], v[60:63], 0
    v_mfma_f32_16x16x32_bf16 v[36:39], v[236:239], v[60:63], 0
    v_mfma_f32_16x16x16_bf16 v[68:71], v[72:73], v[64:65], v[68:71]
    v_mfma_f32_16x16x16_bf16 v[24:27], v[80:81], v[64:65], v[24:27]
    v_mfma_f32_16x16x16_bf16 v[28:31], v[82:83], v[64:65], v[28:31]
    v_mfma_f32_16x16x16_bf16 v[32:35], v[84:85], v[64:65], v[32:35]
    v_mfma_f32_16x16x16_bf16 v[36:39], v[86:87], v[64:65], v[36:39]
    v_rcp_f32 v68, v68
    s_nop 0
    v_mul_f32 v24, v24, v68
    v_mul_f32 v25, v25, v68
    v_cvt_pk_bf16_f32 v48, v24, v25
    v_mul_f32 v26, v26, v68
    v_mul_f32 v27, v27, v68
    v_cvt_pk_bf16_f32 v49, v26, v27
    v_mul_f32 v28, v28, v68
    v_mul_f32 v29, v29, v68
    v_cvt_pk_bf16_f32 v50, v28, v29
    v_mul_f32 v30, v30, v68
    v_mul_f32 v31, v31, v68
    v_cvt_pk_bf16_f32 v51, v30, v31
    global_store_dwordx4 v122, v[48:51], s[90:91] offset:0 sc1
    v_mul_f32 v32, v32, v68
    v_mul_f32 v33, v33, v68
    v_cvt_pk_bf16_f32 v52, v32, v33
    v_mul_f32 v34, v34, v68
    v_mul_f32 v35, v35, v68
    v_cvt_pk_bf16_f32 v53, v34, v35
    v_mul_f32 v36, v36, v68
    v_mul_f32 v37, v37, v68
    v_cvt_pk_bf16_f32 v54, v36, v37
    v_mul_f32 v38, v38, v68
    v_mul_f32 v39, v39, v68
    v_cvt_pk_bf16_f32 v55, v38, v39
    global_store_dwordx4 v122, v[52:55], s[90:91] offset:128 sc1
    s_lshr_b32 s63, s32, 3
    s_mul_i32 s63, s63, 96
    s_lshl_b32 s62, s32, 2
    s_add_u32 s62, s62, s63
    s_add_u32 s62, s62, 130048
    s_add_u32 s88, s4, s62
    s_addc_u32 s89, s5, 0
    v_lshlrev_b32 v10, 5, v0
    v_mov_b32 v11, 1
    s_waitcnt vmcnt(0)
    s_barrier
    s_endpgm
L_chain_w3_111:
    s_waitcnt vmcnt(0) lgkmcnt(0)
    s_cmp_lt_u32 s3, 32
    s_cbranch_scc1 L_slow_223
    s_branch L_fast_3
L_slow_223:
L_step_225:
    v_mov_b32 v10, 0
    s_xor_b32 s51, s51, 1
    s_xor_b32 s42, s42, 65536
    s_nop 0
    s_cmp_eq_u32 s34, 63
    s_barrier
    s_cbranch_scc1 L_exit_226
    v_mov_b32 v10, 0
    s_nop 2
    global_load_dwordx4 v[16:19], v0, s[40:41] offset:-2048 sc1
    ds_read_b64 v[80:81], v0 offset:14336
    ds_read_b64 v[84:85], v0 offset:14344
    ds_read_b64 v[88:89], v0 offset:15360
    ds_read_b64 v[92:93], v0 offset:15368
    v_mov_b32 v10, 0
    s_nop 4
    v_mov_b32 v10, 0
    s_nop 4
    global_load_dwordx4 v[20:23], v0, s[40:41] offset:2048 sc1
    v_mov_b32 v10, 0
    s_nop 4
    v_mov_b32 v10, 0
    s_nop 4
    v_mov_b32 v10, 0
    s_nop 4
    v_mov_b32 v10, 0
    s_nop 1
    global_load_dwordx4 v[16:19], v0, s[40:41] offset:-2048 sc1
    v_mov_b32 v10, 0
    s_nop 4
    v_mov_b32 v10, 0
    s_nop 4
    v_mov_b32 v10, 0
    s_nop 3
    global_load_dwordx4 v[20:23], v0, s[40:41] offset:2048 sc1
    s_waitcnt vmcnt(3) lgkmcnt(0)
L_h2ca_231:
    v_maximum3_f32 v11, v16, v17, v18
    v_cmp_u_f32 vcc, v11, v19
    v_smfmac_f32_16x16x64_bf16 v[96:99], v[16:19], v[48:55], v1
    ds_write_b128 v0, v[16:19] offset:19456
    v_smfmac_f32_16x16x64_bf16 v[100:103], v[16:19], v[56:63], v1
    s_cbranch_vccnz L_h2a_229
L_h2cc_233:
    v_smfmac_f32_16x16x64_bf16 v[104:107], v[16:19], v[64:71], v1
    s_waitcnt vmcnt(2)
    v_maximum3_f32 v11, v20, v21, v22
    v_cmp_u_f32 vcc, v11, v23
    v_smfmac_f32_16x16x64_bf16 v[108:111], v[16:19], v[72:79], v1
    ds_read_b128 v[48:51], v0 offset:0
    v_mov_b32 v122, -1
    v_smfmac_f32_16x16x64_bf16 v[112:115], v[16:19], a[144:151], v1
    ds_read_b128 v[52:55], v0 offset:1024
    s_mov_b32 m0, 21504
    v_smfmac_f32_16x16x64_bf16 v[116:119], v[16:19], a[152:159], v1
    s_cbranch_vccnz L_h2b_230
L_h2cb_232:
    global_load_lds_dwordx4 v0, s[40:41] offset:2048 sc1
    v_smfmac_f32_16x16x64_bf16 v[96:99], v[20:23], a[64:71], v1
    s_waitcnt lgkmcnt(2)
    s_barrier
    v_smfmac_f32_16x16x64_bf16 v[100:103], v[20:23], a[72:79], v1
    global_store_dword v3, v122, s[42:43] offset:0 sc1
    ds_read_b128 v[24:27], v0 offset:16384
    v_smfmac_f32_16x16x64_bf16 v[104:107], v[20:23], a[80:87], v1
    ds_read_b128 v[28:31], v0 offset:17408
    s_mov_b32 m0, 14336
    v_smfmac_f32_16x16x64_bf16 v[108:111], v[20:23], a[88:95], v1
    ds_read_b128 v[32:35], v0 offset:18432
    v_add_u32 v10, 30560, v9
    v_smfmac_f32_16x16x64_bf16 v[112:115], v[20:23], a[208:215], v1
    ds_read_b128 v[56:59], v0 offset:2048
    v_smfmac_f32_16x16x64_bf16 v[116:119], v[20:23], a[216:223], v1
    ds_read_b128 v[60:63], v0 offset:3072
    s_waitcnt lgkmcnt(4)
    v_smfmac_f32_16x16x64_bf16 v[96:99], v[24:27], v[192:199], v1
    ds_read_b128 v[64:67], v0 offset:4096
    v_smfmac_f32_16x16x64_bf16 v[100:103], v[24:27], v[200:207], v1
    global_store_dword v9, v82, s[12:13] offset:3584 sc1
    ds_read_b128 v[68:71], v0 offset:5120
    v_smfmac_f32_16x16x64_bf16 v[104:107], v[24:27], v[208:215], v1
    ds_read_b128 v[72:75], v0 offset:6144
    v_smfmac_f32_16x16x64_bf16 v[108:111], v[24:27], v[216:223], v1
    ds_read_b128 v[76:79], v0 offset:7168
    s_waitcnt lgkmcnt(6)
    v_smfmac_f32_16x16x64_bf16 v[96:99], v[28:31], v[128:135], v1
    global_load_lds_dwordx4 v0, s[46:47] sc1
    ds_read2_b32 v[124:125], v10 offset0:0 offset1:68
    v_smfmac_f32_16x16x64_bf16 v[100:103], v[28:31], v[136:143], v1
    global_store_dword v9, v90, s[12:13] offset:3840 sc1
    v_smfmac_f32_16x16x64_bf16 v[104:107], v[28:31], v[144:151], v1
    v_smfmac_f32_16x16x64_bf16 v[108:111], v[28:31], v[152:159], v1
    v_smfmac_f32_16x16x64_bf16 v[96:99], v[32:35], v[160:167], v1
    s_waitcnt vmcnt(4) lgkmcnt(0)
    s_barrier
    v_smfmac_f32_16x16x64_bf16 v[100:103], v[32:35], v[168:175], v1
    global_load_lds_dwordx4 v0, s[46:47] offset:1024 sc1
    ds_read_b128 v[36:39], v0 offset:20480
    v_smfmac_f32_16x16x64_bf16 v[104:107], v[32:35], v[176:183], v1
    ds_read_b128 v[40:43], v0 offset:21504
    s_mov_b32 m0, 6144
    v_smfmac_f32_16x16x64_bf16 v[108:111], v[32:35], v[184:191], v1
    ds_read_b128 v[44:47], v0 offset:22528
    s_waitcnt lgkmcnt(2)
    v_smfmac_f32_16x16x64_bf16 v[96:99], v[36:39], v[224:231], v1
    global_load_lds_dwordx4 v0, s[44:45] sc1
    v_smfmac_f32_16x16x64_bf16 v[100:103], v[36:39], v[232:239], v1
    global_store_dword v9, v124, s[12:13] offset:1536 sc1
    s_waitcnt lgkmcnt(0)
    v_smfmac_f32_16x16x64_bf16 v[96:99], v[40:43], a[0:7], v1
    s_cmp_ge_u32 s34, 62
    v_smfmac_f32_16x16x64_bf16 v[96:99], v[44:47], a[32:39], v1
    global_store_dword v9, v125, s[12:13] offset:1792 sc1
    v_smfmac_f32_16x16x64_bf16 v[100:103], v[40:43], a[8:15], v1
    global_load_lds_dwordx4 v0, s[44:45] offset:1024 sc1
    v_smfmac_f32_16x16x64_bf16 v[100:103], v[44:47], a[40:47], v1
    v_add_f32 v96, v96, v98
    v_smfmac_f32_16x16x64_bf16 v[104:107], v[36:39], v[240:247], v1
    v_add_f32 v97, v97, v99
    v_smfmac_f32_16x16x64_bf16 v[104:107], v[40:43], a[16:23], v1
    v_add_f32 v100, v100, v102
    v_add_f32 v101, v101, v103
    v_smfmac_f32_16x16x64_bf16 v[104:107], v[44:47], a[48:55], v1
    v_cvt_pk_bf16_f32 v96, v96, v100
    v_smfmac_f32_16x16x64_bf16 v[108:111], v[36:39], v[248:255], v1
    v_cvt_pk_bf16_f32 v97, v97, v101
    v_smfmac_f32_16x16x64_bf16 v[108:111], v[40:43], a[24:31], v1
    ds_write2_b32 v4, v96, v97 offset0:0 offset1:136
    v_smfmac_f32_16x16x64_bf16 v[108:111], v[44:47], a[56:63], v1
    v_add_f32 v104, v104, v106
    v_smfmac_f32_16x16x64_bf16 v[112:115], v[24:27], a[96:103], v1
    v_add_f32 v105, v105, v107
    v_smfmac_f32_16x16x64_bf16 v[116:119], v[24:27], a[104:111], v1
    ds_read_b128 v[24:27], v8 offset:26624
    v_add_f32 v108, v108, v110
    v_smfmac_f32_16x16x64_bf16 v[112:115], v[28:31], a[112:119], v1
    v_add_f32 v109, v109, v111
    v_smfmac_f32_16x16x64_bf16 v[116:119], v[28:31], a[120:127], v1
    s_waitcnt vmcnt(9) lgkmcnt(1)
    s_barrier
    v_smfmac_f32_16x16x64_bf16 v[112:115], v[32:35], a[128:135], v1
    ds_read_b128 v[120:123], v6 offset:0
    v_cvt_pk_bf16_f32 v10, v104, v108
    v_smfmac_f32_16x16x64_bf16 v[116:119], v[32:35], a[136:143], v1
    ds_read_b128 v[124:127], v6 offset:64
    v_cvt_pk_bf16_f32 v11, v105, v109
    v_smfmac_f32_16x16x64_bf16 v[112:115], v[36:39], a[160:167], v1
    ds_write2_b32 v5, v10, v11 offset0:0 offset1:4
    v_smfmac_f32_16x16x64_bf16 v[116:119], v[36:39], a[168:175], v1
    ds_read_b128 v[16:19], v6 offset:128
    v_mov_b64 v[104:105], 0
    v_smfmac_f32_16x16x64_bf16 v[112:115], v[40:43], a[176:183], v1
    ds_read_b128 v[20:23], v6 offset:192
    v_mov_b64 v[106:107], 0
    v_smfmac_f32_16x16x64_bf16 v[116:119], v[40:43], a[184:191], v1
    ds_read_b128 v[28:31], v8 offset:30720
    v_mov_b64 v[108:109], 0
    v_smfmac_f32_16x16x64_bf16 v[112:115], v[44:47], a[192:199], v1
    ds_read_b128 v[32:35], v8 offset:2048
    v_mov_b64 v[110:111], 0
    v_smfmac_f32_16x16x64_bf16 v[116:119], v[44:47], a[200:207], v1
    ds_read_b128 v[36:39], v8 offset:6144
    s_waitcnt lgkmcnt(6)
    v_mfma_f32_16x16x32_bf16 v[96:99], v[48:51], v[120:123], 0
    s_waitcnt lgkmcnt(5)
    s_barrier
    v_mfma_f32_16x16x32_bf16 v[100:103], v[64:67], v[120:123], 0
    ds_read_b128 v[40:43], v7 offset:0
    v_add_f32 v112, v112, v114
    v_mfma_f32_16x16x32_bf16 v[96:99], v[52:55], v[124:127], v[96:99]
    ds_read_b128 v[44:47], v7 offset:1088
    v_add_f32 v113, v113, v115
    v_mfma_f32_16x16x32_bf16 v[100:103], v[68:71], v[124:127], v[100:103]
    s_waitcnt lgkmcnt(5)
    v_add_f32 v116, v116, v118
    v_add_f32 v117, v117, v119
    v_mfma_f32_16x16x32_bf16 v[96:99], v[56:59], v[16:19], v[96:99]
    ds_read_b128 v[48:51], v8 offset:0
    v_cvt_pk_bf16_f32 v82, v112, v113
    v_mfma_f32_16x16x32_bf16 v[96:99], v[60:63], v[20:23], v[96:99]
    ds_read_b128 v[64:67], v8 offset:16384
    v_cvt_pk_bf16_f32 v90, v116, v117
    v_mfma_f32_16x16x32_bf16 v[100:103], v[72:75], v[16:19], v[100:103]
    ds_read_b128 v[52:55], v8 offset:4096
    v_cvt_pk_bf16_f32 v94, v116, v117
    v_mfma_f32_16x16x32_bf16 v[100:103], v[76:79], v[20:23], v[100:103]
    s_waitcnt lgkmcnt(3)
    v_cvt_pk_bf16_f32 v86, v112, v113
    v_max3_f32 v10, v96, v97, v98
    v_smfmac_f32_16x16x64_bf16 v[104:107], v[40:43], v[120:127], v1
    ds_read_b128 v[68:71], v8 offset:20480
    v_cndmask_b32 v96, v96, v98, s[52:53]
    v_smfmac_f32_16x16x64_bf16 v[104:107], v[44:47], v[16:23], v1
    ds_read_b128 v[56:59], v8 offset:8192
    s_nop 0
    v_cndmask_b32 v97, v97, v99, s[52:53]
    v_max3_f32 v10, v10, v99, v100
    v_max3_f32 v10, v10, v101, v102
    v_cndmask_b32 v98, v100, v102, s[52:53]
    v_cndmask_b32 v99, v101, v103, s[52:53]
    v_max_f32 v10, v10, v103
    v_pk_add_f32 v[104:105], v[104:105], v[106:107]
    v_max3_f32 v11, v10, v104, v105
    v_max3_f32 v10, v10, v104, v105
    v_cndmask_b32 v104, v104, v105, s[52:53]
    v_mov_b64 v[120:121], s[54:55]
    v_permlane32_swap_b32 v10, v11
    v_max_f32 v106, v10, v11
    v_max_f32 v107, v10, v11
    v_mov_b64 v[122:123], s[56:57]
    v_mov_b64 v[116:117], 0
    v_permlane16_swap_b32 v106, v107
    v_max_f32 v10, v106, v107
    v_mul_f32 v10, s61, v10
    v_pk_fma_f32 v[96:97], v[96:97], s[58:59], v[10:11] op_sel_hi:[1,1,0]
    v_pk_fma_f32 v[98:99], v[98:99], s[58:59], v[10:11] op_sel_hi:[1,1,0]
    v_fma_f32 v104, v104, s58, v10
    v_exp_f32 v96, v96
    v_exp_f32 v97, v97
    v_exp_f32 v98, v98
    v_exp_f32 v99, v99
    v_exp_f32 v104, v104
    v_cvt_pk_bf16_f32 v100, v96, v97
    v_cvt_pk_bf16_f32 v102, v98, v99
    v_cvt_pk_bf16_f32 v101, v104, 0
    v_cvt_pk_bf16_f32 v103, v104, 0
    v_mov_b64 v[118:119], 0
    s_nop 0
    v_mfma_f32_16x16x32_bf16 v[112:115], v[100:103], v[120:123], 0
    ds_read_b128 v[60:63], v8 offset:12288
    ds_read_b128 v[72:75], v8 offset:24576
    v_smfmac_f32_16x16x64_bf16 v[108:111], v[100:103], v[80:87], v1 abid:1
    ds_read_b128 v[76:79], v8 offset:28672
    ds_read_b128 v[16:19], v8 offset:10240
    v_smfmac_f32_16x16x64_bf16 v[116:119], v[100:103], v[88:95], v1 abid:1
    ds_read_b128 v[20:23], v8 offset:14336
    s_nop 0
    v_add_f32 v112, v112, v114
    v_add_f32 v113, v113, v115
    v_rcp_f32 v112, v112
    v_rcp_f32 v113, v113
    v_pk_add_f32 v[108:109], v[108:109], v[110:111]
    v_pk_mul_f32 v[108:109], v[108:109], v[112:113]
    v_pk_add_f32 v[116:117], v[116:117], v[118:119]
    v_pk_mul_f32 v[116:117], v[116:117], v[112:113]
    v_cvt_pk_bf16_f32 v10, v108, v116
    v_cvt_pk_bf16_f32 v11, v109, v117
    ds_write2_b32 v4, v10, v11 offset0:64 offset1:200
    ds_read_b128 v[108:111], v6 offset:448
    v_mov_b64 v[112:113], 0
    v_mov_b64 v[114:115], 0
    v_mov_b64 v[116:117], 0
    v_mov_b64 v[118:119], 0
    s_cbranch_scc1 L_last_234
L_lastb_235:
    v_mov_b64 v[84:85], 0
    v_mov_b64 v[86:87], 0
    v_mov_b64 v[92:93], 0
    v_mov_b64 v[94:95], 0
    s_waitcnt vmcnt(8) lgkmcnt(1)
    s_barrier
    ds_read_b128 v[96:99], v6 offset:256
    ds_read_b128 v[100:103], v6 offset:320
    ds_read_b128 v[104:107], v6 offset:384
    s_waitcnt lgkmcnt(3)
    v_smfmac_f32_16x16x64_bf16 v[112:115], v[108:111], v[72:79], v1
    ds_read_b128 v[40:43], v8 offset:18432
    v_smfmac_f32_16x16x64_bf16 v[116:119], v[108:111], a[248:255], v1
    ds_read_b128 v[44:47], v8 offset:22528
    v_smfmac_f32_16x16x64_bf16 v[84:87], v[108:111], v[24:31], v1
    ds_read_b128 v[72:75], v8 offset:27648
    s_waitcnt lgkmcnt(5)
    v_smfmac_f32_16x16x64_bf16 v[112:115], v[96:99], v[48:55], v1
    ds_read_b128 v[76:79], v8 offset:31744
    s_waitcnt lgkmcnt(5)
    v_smfmac_f32_16x16x64_bf16 v[112:115], v[100:103], v[56:63], v1
    ds_read_b128 v[48:51], v8 offset:3072
    s_waitcnt lgkmcnt(5)
    v_smfmac_f32_16x16x64_bf16 v[112:115], v[104:107], v[64:71], v1
    ds_read_b128 v[52:55], v8 offset:7168
    v_smfmac_f32_16x16x64_bf16 v[116:119], v[96:99], a[224:231], v1
    ds_read_b128 v[56:59], v8 offset:11264
    v_smfmac_f32_16x16x64_bf16 v[116:119], v[100:103], a[232:239], v1
    ds_read_b128 v[60:63], v8 offset:15360
    v_cvt_pk_bf16_f32 v112, v112, v114
    v_and_or_b32 v112, v112, -2, s51
    v_smfmac_f32_16x16x64_bf16 v[116:119], v[104:107], a[240:247], v1
    global_store_dword v2, v112, s[8:9] offset:-4096 sc1
    v_cvt_pk_bf16_f32 v113, v113, v115
    v_and_or_b32 v113, v113, -2, s51
    v_smfmac_f32_16x16x64_bf16 v[84:87], v[96:99], v[32:39], v1
    global_store_dword v2, v113, s[10:11] offset:-4096 sc1
    ds_read_b128 v[64:67], v8 offset:19456
    v_smfmac_f32_16x16x64_bf16 v[84:87], v[100:103], v[16:23], v1
    ds_read_b128 v[68:71], v8 offset:23552
    s_waitcnt lgkmcnt(8)
    v_cvt_pk_bf16_f32 v116, v116, v118
    v_and_or_b32 v116, v116, -2, s51
    v_smfmac_f32_16x16x64_bf16 v[84:87], v[104:107], v[40:47], v1
    global_store_dword v2, v116, s[8:9] offset:-2048 sc1
    s_waitcnt lgkmcnt(6)
    v_cvt_pk_bf16_f32 v117, v117, v119
    v_and_or_b32 v117, v117, -2, s51
    v_smfmac_f32_16x16x64_bf16 v[92:95], v[108:111], v[72:79], v1
    global_store_dword v2, v117, s[10:11] offset:-2048 sc1
    s_waitcnt lgkmcnt(4)
    v_smfmac_f32_16x16x64_bf16 v[92:95], v[96:99], v[48:55], v1
    s_waitcnt lgkmcnt(2)
    v_cvt_pk_bf16_f32 v84, v84, v86
    v_and_or_b32 v84, v84, -2, s51
    v_smfmac_f32_16x16x64_bf16 v[92:95], v[100:103], v[56:63], v1
    global_store_dword v2, v84, s[8:9] offset:0 sc1
    s_waitcnt lgkmcnt(0)
    v_cvt_pk_bf16_f32 v85, v85, v87
    v_and_or_b32 v85, v85, -2, s51
    v_smfmac_f32_16x16x64_bf16 v[92:95], v[104:107], v[64:71], v1
    global_store_dword v2, v85, s[10:11] offset:0 sc1
    s_nop 0
    v_mov_b64 v[96:97], 0
    v_mov_b64 v[98:99], 0
    v_mov_b64 v[100:101], 0
    v_mov_b64 v[102:103], 0
    v_mov_b64 v[104:105], 0
    v_mov_b64 v[106:107], 0
    v_cvt_pk_bf16_f32 v92, v92, v94
    v_and_or_b32 v92, v92, -2, s51
    v_cvt_pk_bf16_f32 v93, v93, v95
    v_and_or_b32 v93, v93, -2, s51
    v_mov_b64 v[108:109], 0
    s_add_u32 s12, s12, 4096
    s_addc_u32 s13, s13, 0
    s_add_u32 s34, s34, 1
    global_store_dword v2, v92, s[8:9] offset:2048 sc1
    global_store_dword v2, v93, s[10:11] offset:2048 sc1
    v_mov_b64 v[110:111], 0
    s_add_u32 s44, s44, 16384
    s_addc_u32 s45, s45, 0
    s_add_u32 s46, s46, 16384
    s_addc_u32 s47, s47, 0
    s_xor_b32 s40, s40, 65536
    v_mov_b64 v[112:113], 0
    s_nop 4
    v_mov_b64 v[114:115], 0
    s_nop 4
    v_mov_b64 v[116:117], 0
    s_nop 4
    v_mov_b64 v[118:119], 0
    s_nop 4
    v_mov_b64 v[86:87], 0
    s_nop 4
    v_mov_b64 v[94:95], 0
    s_nop 4
    v_mov_b32 v10, 0
    s_nop 4
    v_mov_b32 v10, 0
    s_nop 4
    v_mov_b32 v10, 0
    global_load_dword v120, v9, s[36:37] offset:0 sc1
    global_load_dword v121, v9, s[36:37] offset:256 sc1
    global_load_dword v122, v9, s[36:37] offset:512 sc1
    global_load_dword v123, v9, s[36:37] offset:768 sc1
    global_load_dword v124, v9, s[36:37] offset:1024 sc1
    global_load_dword v125, v9, s[36:37] offset:1280 sc1
    global_load_dword v126, v9, s[36:37] offset:1536 sc1
    global_load_dword v127, v9, s[36:37] offset:1792 sc1
    v_mov_b32 v10, 0
    s_nop 4
    v_mov_b32 v10, 0
    s_nop 0
    global_load_dword v120, v9, s[36:37] offset:0 sc1
    global_load_dword v121, v9, s[36:37] offset:256 sc1
    global_load_dword v122, v9, s[36:37] offset:512 sc1
    global_load_dword v123, v9, s[36:37] offset:768 sc1
    global_load_dword v124, v9, s[36:37] offset:1024 sc1
    global_load_dword v125, v9, s[36:37] offset:1280 sc1
    global_load_dword v126, v9, s[36:37] offset:1536 sc1
    global_load_dword v127, v9, s[36:37] offset:1792 sc1
    ds_read_b128 v[48:51], v8 offset:1024
    ds_read_b128 v[52:55], v8 offset:5120
    v_mov_b32 v10, 0
    s_nop 1
    ds_read_b128 v[56:59], v8 offset:9216
    ds_read_b128 v[60:63], v8 offset:13312
    v_mov_b32 v10, 0
    s_nop 1
    ds_read_b128 v[64:67], v8 offset:17408
    ds_read_b128 v[68:71], v8 offset:21504
    v_mov_b32 v10, 0
    s_nop 1
    ds_read_b128 v[72:75], v8 offset:25600
    ds_read_b128 v[76:79], v8 offset:29696
    v_mov_b32 v10, 0
    s_nop 1
    s_cmp_eq_u32 s51, 0
    s_cbranch_scc1 L_tag0_236
    s_waitcnt vmcnt(12)
    v_bitop3_b32 v10, v120, v121, v122 bitop3:0x80
    v_bitop3_b32 v10, v10, v123, 1 bitop3:0x80
    v_mfma_f32_16x16x32_bf16 v[32:35], v[12:15], v[120:123], 0
    s_waitcnt vmcnt(8)
    v_bitop3_b32 v10, v10, v124, v125 bitop3:0x80
    v_bitop3_b32 v10, v10, v126, v127 bitop3:0x80
    v_mfma_f32_16x16x32_bf16 v[32:35], v[12:15], v[124:127], v[32:35]
    s_nop 0
    v_cmp_ne_u32 vcc, 1, v10
    s_nop 0
    s_mov_b64 exec, s[26:27]
    s_nop 2
    s_cbranch_vccnz L_h1n_238
    v_cvt_pk_bf16_f32 v11, v32, v33
    global_store_dword v3, v11, s[42:43] offset:0 sc1
    s_mov_b64 exec, -1
    s_branch L_step_225
L_h1n_238:
    s_mov_b64 exec, -1
    global_load_dword v120, v9, s[36:37] offset:0 sc1
    global_load_dword v121, v9, s[36:37] offset:256 sc1
    global_load_dword v122, v9, s[36:37] offset:512 sc1
    global_load_dword v123, v9, s[36:37] offset:768 sc1
    global_load_dword v124, v9, s[36:37] offset:1024 sc1
    global_load_dword v125, v9, s[36:37] offset:1280 sc1
    global_load_dword v126, v9, s[36:37] offset:1536 sc1
    global_load_dword v127, v9, s[36:37] offset:1792 sc1
    s_waitcnt vmcnt(12)
    v_bitop3_b32 v10, v120, v121, v122 bitop3:0x80
    v_bitop3_b32 v10, v10, v123, 1 bitop3:0x80
    v_mfma_f32_16x16x32_bf16 v[32:35], v[12:15], v[120:123], 0
    s_waitcnt vmcnt(8)
    v_bitop3_b32 v10, v10, v124, v125 bitop3:0x80
    v_bitop3_b32 v10, v10, v126, v127 bitop3:0x80
    v_mfma_f32_16x16x32_bf16 v[32:35], v[12:15], v[124:127], v[32:35]
    s_nop 0
    v_cmp_ne_u32 vcc, 1, v10
    s_nop 0
    s_mov_b64 exec, s[26:27]
    s_nop 2
    s_cbranch_vccnz L_h1r_237
    v_cvt_pk_bf16_f32 v11, v32, v33
    global_store_dword v3, v11, s[42:43] offset:0 sc1
    s_mov_b64 exec, -1
    s_branch L_step_225
L_h1r_237:
    s_mov_b64 exec, -1
    global_load_dword v120, v9, s[36:37] offset:0 sc1
    global_load_dword v121, v9, s[36:37] offset:256 sc1
    global_load_dword v122, v9, s[36:37] offset:512 sc1
    global_load_dword v123, v9, s[36:37] offset:768 sc1
    global_load_dword v124, v9, s[36:37] offset:1024 sc1
    global_load_dword v125, v9, s[36:37] offset:1280 sc1
    global_load_dword v126, v9, s[36:37] offset:1536 sc1
    global_load_dword v127, v9, s[36:37] offset:1792 sc1
    s_sub_u32 s50, s50, 1
    s_cselect_b64 s[48:49], 0, s[48:49]
    s_waitcnt vmcnt(8)
    v_bitop3_b32 v10, v120, v121, v122 bitop3:0x80
    v_bitop3_b32 v10, v10, v123, 1 bitop3:0x80
    v_mfma_f32_16x16x32_bf16 v[32:35], v[12:15], v[120:123], 0
    s_nop 0
    v_bitop3_b32 v10, v10, v124, v125 bitop3:0x80
    v_bitop3_b32 v10, v10, v126, v127 bitop3:0x80
    v_mfma_f32_16x16x32_bf16 v[32:35], v[12:15], v[124:127], v[32:35]
    s_nop 0
    v_cmp_ne_u32 vcc, 1, v10
    s_nop 0
    s_mov_b64 exec, s[26:27]
    s_nop 1
    s_and_b64 vcc, vcc, s[48:49]
    s_cbranch_scc1 L_h1r_237
    v_cvt_pk_bf16_f32 v11, v32, v33
    global_store_dword v3, v11, s[42:43] offset:0 sc1
    s_mov_b64 exec, -1
    s_branch L_step_225
L_tag0_236:
    s_waitcnt vmcnt(12)
    v_bitop3_b32 v10, v120, v121, v122 bitop3:0x01
    v_bitop3_b32 v10, v10, v123, 1 bitop3:0x20
    v_mfma_f32_16x16x32_bf16 v[32:35], v[12:15], v[120:123], 0
    s_waitcnt vmcnt(8)
    v_bitop3_b32 v10, v10, v124, v125 bitop3:0x10
    v_bitop3_b32 v10, v10, v126, v127 bitop3:0x10
    v_mfma_f32_16x16x32_bf16 v[32:35], v[12:15], v[124:127], v[32:35]
    s_nop 0
    v_cmp_ne_u32 vcc, 1, v10
    s_nop 0
    s_mov_b64 exec, s[26:27]
    s_nop 2
    s_cbranch_vccnz L_h1n_240
    v_cvt_pk_bf16_f32 v11, v32, v33
    global_store_dword v3, v11, s[42:43] offset:0 sc1
    s_mov_b64 exec, -1
    s_branch L_step_225
L_h1n_240:
    s_mov_b64 exec, -1
    global_load_dword v120, v9, s[36:37] offset:0 sc1
    global_load_dword v121, v9, s[36:37] offset:256 sc1
    global_load_dword v122, v9, s[36:37] offset:512 sc1
    global_load_dword v123, v9, s[36:37] offset:768 sc1
    global_load_dword v124, v9, s[36:37] offset:1024 sc1
    global_load_dword v125, v9, s[36:37] offset:1280 sc1
    global_load_dword v126, v9, s[36:37] offset:1536 sc1
    global_load_dword v127, v9, s[36:37] offset:1792 sc1
    s_waitcnt vmcnt(12)
    v_bitop3_b32 v10, v120, v121, v122 bitop3:0x01
    v_bitop3_b32 v10, v10, v123, 1 bitop3:0x20
    v_mfma_f32_16x16x32_bf16 v[32:35], v[12:15], v[120:123], 0
    s_waitcnt vmcnt(8)
    v_bitop3_b32 v10, v10, v124, v125 bitop3:0x10
    v_bitop3_b32 v10, v10, v126, v127 bitop3:0x10
    v_mfma_f32_16x16x32_bf16 v[32:35], v[12:15], v[124:127], v[32:35]
    s_nop 0
    v_cmp_ne_u32 vcc, 1, v10
    s_nop 0
    s_mov_b64 exec, s[26:27]
    s_nop 2
    s_cbranch_vccnz L_h1r_239
    v_cvt_pk_bf16_f32 v11, v32, v33
    global_store_dword v3, v11, s[42:43] offset:0 sc1
    s_mov_b64 exec, -1
    s_branch L_step_225
L_h1r_239:
    s_mov_b64 exec, -1
    global_load_dword v120, v9, s[36:37] offset:0 sc1
    global_load_dword v121, v9, s[36:37] offset:256 sc1
    global_load_dword v122, v9, s[36:37] offset:512 sc1
    global_load_dword v123, v9, s[36:37] offset:768 sc1
    global_load_dword v124, v9, s[36:37] offset:1024 sc1
    global_load_dword v125, v9, s[36:37] offset:1280 sc1
    global_load_dword v126, v9, s[36:37] offset:1536 sc1
    global_load_dword v127, v9, s[36:37] offset:1792 sc1
    s_sub_u32 s50, s50, 1
    s_cselect_b64 s[48:49], 0, s[48:49]
    s_waitcnt vmcnt(8)
    v_bitop3_b32 v10, v120, v121, v122 bitop3:0x01
    v_bitop3_b32 v10, v10, v123, 1 bitop3:0x20
    v_mfma_f32_16x16x32_bf16 v[32:35], v[12:15], v[120:123], 0
    s_nop 0
    v_bitop3_b32 v10, v10, v124, v125 bitop3:0x10
    v_bitop3_b32 v10, v10, v126, v127 bitop3:0x10
    v_mfma_f32_16x16x32_bf16 v[32:35], v[12:15], v[124:127], v[32:35]
    s_nop 0
    v_cmp_ne_u32 vcc, 1, v10
    s_nop 0
    s_mov_b64 exec, s[26:27]
    s_nop 1
    s_and_b64 vcc, vcc, s[48:49]
    s_cbranch_scc1 L_h1r_239
    v_cvt_pk_bf16_f32 v11, v32, v33
    global_store_dword v3, v11, s[42:43] offset:0 sc1
    s_mov_b64 exec, -1
    s_branch L_step_225
L_last_234:
    v_add_u32 v10, 30560, v9
    ds_read2_b32 v[124:125], v10 offset0:0 offset1:68
    s_add_u32 s12, s12, 4096
    s_addc_u32 s13, s13, 0
    global_store_dword v9, v82, s[12:13] offset:3584 sc1
    global_store_dword v9, v90, s[12:13] offset:3840 sc1
    s_waitcnt lgkmcnt(0)
    global_store_dword v9, v124, s[12:13] offset:1536 sc1
    global_store_dword v9, v125, s[12:13] offset:1792 sc1
    s_cmp_eq_u32 s34, 63
    s_cbranch_scc1 L_exit_226
    s_sub_u32 s12, s12, 4096
    s_subb_u32 s13, s13, 0
    s_getpc_b64 s[64:65]
L_pc_241:
    s_add_u32 s64, s64, L_fin_3-L_pc_241
    s_addc_u32 s65, s65, 0
    v_lshlrev_b32 v126, 2, v0
    v_min_u32 v126, L_code_end-L_fin_3-4, v126
    global_load_dword v127, v126, s[64:65]
    s_branch L_lastb_235
L_h2a_229:
    global_load_dwordx4 v[16:19], v0, s[40:41] offset:-2048 sc1
    global_load_dwordx4 v[20:23], v0, s[40:41] offset:2048 sc1
    s_nop 4
    v_mov_b64 v[96:97], 0
    v_mov_b64 v[98:99], 0
    v_mov_b64 v[100:101], 0
    v_mov_b64 v[102:103], 0
    s_waitcnt vmcnt(3)
    v_maximum3_f32 v11, v16, v17, v18
    v_cmp_u_f32 vcc, v11, v19
    v_smfmac_f32_16x16x64_bf16 v[96:99], v[16:19], v[48:55], v1
    ds_write_b128 v0, v[16:19] offset:19456
    v_smfmac_f32_16x16x64_bf16 v[100:103], v[16:19], v[56:63], v1
    s_cbranch_vccz L_h2cc_233
L_h2l2_242:
    global_load_dwordx4 v[16:19], v0, s[40:41] offset:-2048 sc1
    global_load_dwordx4 v[20:23], v0, s[40:41] offset:2048 sc1
    s_sub_u32 s2, s2, 1
    s_cselect_b64 s[38:39], 0, s[38:39]
    s_nop 2
    v_mov_b64 v[96:97], 0
    v_mov_b64 v[98:99], 0
    v_mov_b64 v[100:101], 0
    v_mov_b64 v[102:103], 0
    s_waitcnt vmcnt(3)
    v_maximum3_f32 v11, v16, v17, v18
    v_cmp_u_f32 vcc, v11, v19
    v_smfmac_f32_16x16x64_bf16 v[96:99], v[16:19], v[48:55], v1
    ds_write_b128 v0, v[16:19] offset:19456
    v_smfmac_f32_16x16x64_bf16 v[100:103], v[16:19], v[56:63], v1
    s_and_b64 vcc, vcc, s[38:39]
    s_cbranch_scc0 L_h2cc_233
    s_branch L_h2l2_242
    global_load_dwordx4 v[16:19], v0, s[40:41] offset:-2048 sc1
    global_load_dwordx4 v[20:23], v0, s[40:41] offset:2048 sc1
    s_sub_u32 s2, s2, 1
    s_cselect_b64 s[38:39], 0, s[38:39]
    s_cmp_eq_u64 s[38:39], 0
    s_cbranch_scc1 L_h2cc_233
    s_nop 2
    v_mov_b64 v[96:97], 0
    v_mov_b64 v[98:99], 0
    v_mov_b64 v[100:101], 0
    v_mov_b64 v[102:103], 0
    s_waitcnt vmcnt(3)
    s_branch L_h2ca_231
L_h2b_230:
    global_load_dwordx4 v[20:23], v0, s[40:41] offset:2048 sc1
    s_sub_u32 s2, s2, 1
    s_cselect_b64 s[38:39], 0, s[38:39]
    s_waitcnt vmcnt(1)
    v_maximum3_f32 v11, v20, v21, v22
    v_cmp_u_f32 vcc, v11, v23
    s_and_b64 vcc, vcc, s[38:39]
    s_cbranch_scc0 L_h2cb_232
    s_branch L_h2b_230
L_exit_226:
    s_branch L_done_224
.p2align 6
L_fast_3:
L_step_243:
    v_mov_b32 v10, 0
    s_xor_b32 s51, s51, 1
    s_xor_b32 s42, s42, 65536
    s_nop 0
    s_cmp_eq_u32 s34, 63
    s_barrier
    s_cbranch_scc1 L_exit_244
    v_mov_b32 v10, 0
    s_nop 2
    global_load_dwordx4 v[16:19], v0, s[40:41] offset:-2048 sc1
    ds_read_b64 v[80:81], v0 offset:14336
    ds_read_b64 v[84:85], v0 offset:14344
    ds_read_b64 v[88:89], v0 offset:15360
    ds_read_b64 v[92:93], v0 offset:15368
    v_mov_b32 v10, 0
    s_nop 4
    v_mov_b32 v10, 0
    s_nop 4
    global_load_dwordx4 v[20:23], v0, s[40:41] offset:2048 sc1
    v_mov_b32 v10, 0
    s_nop 4
    v_mov_b32 v10, 0
    s_nop 4
    v_mov_b32 v10, 0
    s_nop 4
    v_mov_b32 v10, 0
    s_nop 1
    global_load_dwordx4 v[16:19], v0, s[40:41] offset:-2048 sc1
    v_mov_b32 v10, 0
    s_nop 4
    v_mov_b32 v10, 0
    s_nop 4
    v_mov_b32 v10, 0
    s_nop 3
    global_load_dwordx4 v[20:23], v0, s[40:41] offset:2048 sc1
    s_waitcnt vmcnt(3) lgkmcnt(0)
L_h2ca_249:
    v_maximum3_f32 v11, v16, v17, v18
    v_cmp_u_f32 vcc, v11, v19
    v_smfmac_f32_16x16x64_bf16 v[96:99], v[16:19], v[48:55], v1
    ds_write_b128 v0, v[16:19] offset:19456
    v_smfmac_f32_16x16x64_bf16 v[100:103], v[16:19], v[56:63], v1
    s_cbranch_vccnz L_h2a_247
L_h2cc_251:
    v_smfmac_f32_16x16x64_bf16 v[104:107], v[16:19], v[64:71], v1
    s_waitcnt vmcnt(2)
    v_maximum3_f32 v11, v20, v21, v22
    v_cmp_u_f32 vcc, v11, v23
    v_smfmac_f32_16x16x64_bf16 v[108:111], v[16:19], v[72:79], v1
    ds_read_b128 v[48:51], v0 offset:0
    v_mov_b32 v122, -1
    v_smfmac_f32_16x16x64_bf16 v[112:115], v[16:19], a[144:151], v1
    ds_read_b128 v[52:55], v0 offset:1024
    s_mov_b32 m0, 21504
    v_smfmac_f32_16x16x64_bf16 v[116:119], v[16:19], a[152:159], v1
    s_cbranch_vccnz L_h2b_248
L_h2cb_250:
    global_load_lds_dwordx4 v0, s[40:41] offset:2048 sc1
    v_smfmac_f32_16x16x64_bf16 v[96:99], v[20:23], a[64:71], v1
    s_waitcnt lgkmcnt(2)
    s_barrier
    v_smfmac_f32_16x16x64_bf16 v[100:103], v[20:23], a[72:79], v1
    global_store_dword v3, v122, s[42:43] offset:0
    ds_read_b128 v[24:27], v0 offset:16384
    v_smfmac_f32_16x16x64_bf16 v[104:107], v[20:23], a[80:87], v1
    ds_read_b128 v[28:31], v0 offset:17408
    s_mov_b32 m0, 14336
    v_smfmac_f32_16x16x64_bf16 v[108:111], v[20:23], a[88:95], v1
    ds_read_b128 v[32:35], v0 offset:18432
    v_add_u32 v10, 30560, v9
    v_smfmac_f32_16x16x64_bf16 v[112:115], v[20:23], a[208:215], v1
    ds_read_b128 v[56:59], v0 offset:2048
    v_smfmac_f32_16x16x64_bf16 v[116:119], v[20:23], a[216:223], v1
    ds_read_b128 v[60:63], v0 offset:3072
    s_waitcnt lgkmcnt(4)
    v_smfmac_f32_16x16x64_bf16 v[96:99], v[24:27], v[192:199], v1
    ds_read_b128 v[64:67], v0 offset:4096
    v_smfmac_f32_16x16x64_bf16 v[100:103], v[24:27], v[200:207], v1
    global_store_dword v9, v82, s[12:13] offset:3584 sc1
    ds_read_b128 v[68:71], v0 offset:5120
    v_smfmac_f32_16x16x64_bf16 v[104:107], v[24:27], v[208:215], v1
    ds_read_b128 v[72:75], v0 offset:6144
    v_smfmac_f32_16x16x64_bf16 v[108:111], v[24:27], v[216:223], v1
    ds_read_b128 v[76:79], v0 offset:7168
    s_waitcnt lgkmcnt(6)
    v_smfmac_f32_16x16x64_bf16 v[96:99], v[28:31], v[128:135], v1
    global_load_lds_dwordx4 v0, s[46:47] sc1
    ds_read2_b32 v[124:125], v10 offset0:0 offset1:68
    v_smfmac_f32_16x16x64_bf16 v[100:103], v[28:31], v[136:143], v1
    global_store_dword v9, v90, s[12:13] offset:3840 sc1
    v_smfmac_f32_16x16x64_bf16 v[104:107], v[28:31], v[144:151], v1
    v_smfmac_f32_16x16x64_bf16 v[108:111], v[28:31], v[152:159], v1
    v_smfmac_f32_16x16x64_bf16 v[96:99], v[32:35], v[160:167], v1
    s_waitcnt vmcnt(4) lgkmcnt(0)
    s_barrier
    v_smfmac_f32_16x16x64_bf16 v[100:103], v[32:35], v[168:175], v1
    global_load_lds_dwordx4 v0, s[46:47] offset:1024 sc1
    ds_read_b128 v[36:39], v0 offset:20480
    v_smfmac_f32_16x16x64_bf16 v[104:107], v[32:35], v[176:183], v1
    ds_read_b128 v[40:43], v0 offset:21504
    s_mov_b32 m0, 6144
    v_smfmac_f32_16x16x64_bf16 v[108:111], v[32:35], v[184:191], v1
    ds_read_b128 v[44:47], v0 offset:22528
    s_waitcnt lgkmcnt(2)
    v_smfmac_f32_16x16x64_bf16 v[96:99], v[36:39], v[224:231], v1
    global_load_lds_dwordx4 v0, s[44:45] sc1
    v_smfmac_f32_16x16x64_bf16 v[100:103], v[36:39], v[232:239], v1
    global_store_dword v9, v124, s[12:13] offset:1536 sc1
    s_waitcnt lgkmcnt(0)
    v_smfmac_f32_16x16x64_bf16 v[96:99], v[40:43], a[0:7], v1
    s_cmp_ge_u32 s34, 62
    v_smfmac_f32_16x16x64_bf16 v[96:99], v[44:47], a[32:39], v1
    global_store_dword v9, v125, s[12:13] offset:1792 sc1
    v_smfmac_f32_16x16x64_bf16 v[100:103], v[40:43], a[8:15], v1
    global_load_lds_dwordx4 v0, s[44:45] offset:1024 sc1
    v_smfmac_f32_16x16x64_bf16 v[100:103], v[44:47], a[40:47], v1
    v_add_f32 v96, v96, v98
    v_smfmac_f32_16x16x64_bf16 v[104:107], v[36:39], v[240:247], v1
    v_add_f32 v97, v97, v99
    v_smfmac_f32_16x16x64_bf16 v[104:107], v[40:43], a[16:23], v1
    v_add_f32 v100, v100, v102
    v_add_f32 v101, v101, v103
    v_smfmac_f32_16x16x64_bf16 v[104:107], v[44:47], a[48:55], v1
    v_cvt_pk_bf16_f32 v96, v96, v100
    v_smfmac_f32_16x16x64_bf16 v[108:111], v[36:39], v[248:255], v1
    v_cvt_pk_bf16_f32 v97, v97, v101
    v_smfmac_f32_16x16x64_bf16 v[108:111], v[40:43], a[24:31], v1
    ds_write2_b32 v4, v96, v97 offset0:0 offset1:136
    v_smfmac_f32_16x16x64_bf16 v[108:111], v[44:47], a[56:63], v1
    v_add_f32 v104, v104, v106
    v_smfmac_f32_16x16x64_bf16 v[112:115], v[24:27], a[96:103], v1
    v_add_f32 v105, v105, v107
    v_smfmac_f32_16x16x64_bf16 v[116:119], v[24:27], a[104:111], v1
    ds_read_b128 v[24:27], v8 offset:26624
    v_add_f32 v108, v108, v110
    v_smfmac_f32_16x16x64_bf16 v[112:115], v[28:31], a[112:119], v1
    v_add_f32 v109, v109, v111
    v_smfmac_f32_16x16x64_bf16 v[116:119], v[28:31], a[120:127], v1
    s_waitcnt vmcnt(9) lgkmcnt(1)
    s_barrier
    v_smfmac_f32_16x16x64_bf16 v[112:115], v[32:35], a[128:135], v1
    ds_read_b128 v[120:123], v6 offset:0
    v_cvt_pk_bf16_f32 v10, v104, v108
    v_smfmac_f32_16x16x64_bf16 v[116:119], v[32:35], a[136:143], v1
    ds_read_b128 v[124:127], v6 offset:64
    v_cvt_pk_bf16_f32 v11, v105, v109
    v_smfmac_f32_16x16x64_bf16 v[112:115], v[36:39], a[160:167], v1
    ds_write2_b32 v5, v10, v11 offset0:0 offset1:4
    v_smfmac_f32_16x16x64_bf16 v[116:119], v[36:39], a[168:175], v1
    ds_read_b128 v[16:19], v6 offset:128
    v_mov_b64 v[104:105], 0
    v_smfmac_f32_16x16x64_bf16 v[112:115], v[40:43], a[176:183], v1
    ds_read_b128 v[20:23], v6 offset:192
    v_mov_b64 v[106:107], 0
    v_smfmac_f32_16x16x64_bf16 v[116:119], v[40:43], a[184:191], v1
    ds_read_b128 v[28:31], v8 offset:30720
    v_mov_b64 v[108:109], 0
    v_smfmac_f32_16x16x64_bf16 v[112:115], v[44:47], a[192:199], v1
    ds_read_b128 v[32:35], v8 offset:2048
    v_mov_b64 v[110:111], 0
    v_smfmac_f32_16x16x64_bf16 v[116:119], v[44:47], a[200:207], v1
    ds_read_b128 v[36:39], v8 offset:6144
    s_waitcnt lgkmcnt(6)
    v_mfma_f32_16x16x32_bf16 v[96:99], v[48:51], v[120:123], 0
    s_waitcnt lgkmcnt(5)
    s_barrier
    v_mfma_f32_16x16x32_bf16 v[100:103], v[64:67], v[120:123], 0
    ds_read_b128 v[40:43], v7 offset:0
    v_add_f32 v112, v112, v114
    v_mfma_f32_16x16x32_bf16 v[96:99], v[52:55], v[124:127], v[96:99]
    ds_read_b128 v[44:47], v7 offset:1088
    v_add_f32 v113, v113, v115
    v_mfma_f32_16x16x32_bf16 v[100:103], v[68:71], v[124:127], v[100:103]
    s_waitcnt lgkmcnt(5)
    v_add_f32 v116, v116, v118
    v_add_f32 v117, v117, v119
    v_mfma_f32_16x16x32_bf16 v[96:99], v[56:59], v[16:19], v[96:99]
    ds_read_b128 v[48:51], v8 offset:0
    v_cvt_pk_bf16_f32 v82, v112, v113
    v_mfma_f32_16x16x32_bf16 v[96:99], v[60:63], v[20:23], v[96:99]
    ds_read_b128 v[64:67], v8 offset:16384
    v_cvt_pk_bf16_f32 v90, v116, v117
    v_mfma_f32_16x16x32_bf16 v[100:103], v[72:75], v[16:19], v[100:103]
    ds_read_b128 v[52:55], v8 offset:4096
    v_cvt_pk_bf16_f32 v94, v116, v117
    v_mfma_f32_16x16x32_bf16 v[100:103], v[76:79], v[20:23], v[100:103]
    s_waitcnt lgkmcnt(3)
    v_cvt_pk_bf16_f32 v86, v112, v113
    v_max3_f32 v10, v96, v97, v98
    v_smfmac_f32_16x16x64_bf16 v[104:107], v[40:43], v[120:127], v1
    ds_read_b128 v[68:71], v8 offset:20480
    v_cndmask_b32 v96, v96, v98, s[52:53]
    v_smfmac_f32_16x16x64_bf16 v[104:107], v[44:47], v[16:23], v1
    ds_read_b128 v[56:59], v8 offset:8192
    s_nop 0
    v_cndmask_b32 v97, v97, v99, s[52:53]
    v_max3_f32 v10, v10, v99, v100
    v_max3_f32 v10, v10, v101, v102
    v_cndmask_b32 v98, v100, v102, s[52:53]
    v_cndmask_b32 v99, v101, v103, s[52:53]
    v_max_f32 v10, v10, v103
    v_pk_add_f32 v[104:105], v[104:105], v[106:107]
    v_max3_f32 v11, v10, v104, v105
    v_max3_f32 v10, v10, v104, v105
    v_cndmask_b32 v104, v104, v105, s[52:53]
    v_mov_b64 v[120:121], s[54:55]
    v_permlane32_swap_b32 v10, v11
    v_max_f32 v106, v10, v11
    v_max_f32 v107, v10, v11
    v_mov_b64 v[122:123], s[56:57]
    v_mov_b64 v[116:117], 0
    v_permlane16_swap_b32 v106, v107
    v_max_f32 v10, v106, v107
    v_mul_f32 v10, s61, v10
    v_pk_fma_f32 v[96:97], v[96:97], s[58:59], v[10:11] op_sel_hi:[1,1,0]
    v_pk_fma_f32 v[98:99], v[98:99], s[58:59], v[10:11] op_sel_hi:[1,1,0]
    v_fma_f32 v104, v104, s58, v10
    v_exp_f32 v96, v96
    v_exp_f32 v97, v97
    v_exp_f32 v98, v98
    v_exp_f32 v99, v99
    v_exp_f32 v104, v104
    v_cvt_pk_bf16_f32 v100, v96, v97
    v_cvt_pk_bf16_f32 v102, v98, v99
    v_cvt_pk_bf16_f32 v101, v104, 0
    v_cvt_pk_bf16_f32 v103, v104, 0
    v_mov_b64 v[118:119], 0
    s_nop 0
    v_mfma_f32_16x16x32_bf16 v[112:115], v[100:103], v[120:123], 0
    ds_read_b128 v[60:63], v8 offset:12288
    ds_read_b128 v[72:75], v8 offset:24576
    v_smfmac_f32_16x16x64_bf16 v[108:111], v[100:103], v[80:87], v1 abid:1
    ds_read_b128 v[76:79], v8 offset:28672
    ds_read_b128 v[16:19], v8 offset:10240
    v_smfmac_f32_16x16x64_bf16 v[116:119], v[100:103], v[88:95], v1 abid:1
    ds_read_b128 v[20:23], v8 offset:14336
    s_nop 0
    v_add_f32 v112, v112, v114
    v_add_f32 v113, v113, v115
    v_rcp_f32 v112, v112
    v_rcp_f32 v113, v113
    v_pk_add_f32 v[108:109], v[108:109], v[110:111]
    v_pk_mul_f32 v[108:109], v[108:109], v[112:113]
    v_pk_add_f32 v[116:117], v[116:117], v[118:119]
    v_pk_mul_f32 v[116:117], v[116:117], v[112:113]
    v_cvt_pk_bf16_f32 v10, v108, v116
    v_cvt_pk_bf16_f32 v11, v109, v117
    ds_write2_b32 v4, v10, v11 offset0:64 offset1:200
    ds_read_b128 v[108:111], v6 offset:448
    v_mov_b64 v[112:113], 0
    v_mov_b64 v[114:115], 0
    v_mov_b64 v[116:117], 0
    v_mov_b64 v[118:119], 0
    s_cbranch_scc1 L_last_252
L_lastb_253:
    v_mov_b64 v[84:85], 0
    v_mov_b64 v[86:87], 0
    v_mov_b64 v[92:93], 0
    v_mov_b64 v[94:95], 0
    s_waitcnt vmcnt(8) lgkmcnt(1)
    s_barrier
    ds_read_b128 v[96:99], v6 offset:256
    ds_read_b128 v[100:103], v6 offset:320
    ds_read_b128 v[104:107], v6 offset:384
    s_waitcnt lgkmcnt(3)
    v_smfmac_f32_16x16x64_bf16 v[112:115], v[108:111], v[72:79], v1
    ds_read_b128 v[40:43], v8 offset:18432
    v_smfmac_f32_16x16x64_bf16 v[116:119], v[108:111], a[248:255], v1
    ds_read_b128 v[44:47], v8 offset:22528
    v_smfmac_f32_16x16x64_bf16 v[84:87], v[108:111], v[24:31], v1
    ds_read_b128 v[72:75], v8 offset:27648
    s_waitcnt lgkmcnt(5)
    v_smfmac_f32_16x16x64_bf16 v[112:115], v[96:99], v[48:55], v1
    ds_read_b128 v[76:79], v8 offset:31744
    s_waitcnt lgkmcnt(5)
    v_smfmac_f32_16x16x64_bf16 v[112:115], v[100:103], v[56:63], v1
    ds_read_b128 v[48:51], v8 offset:3072
    s_waitcnt lgkmcnt(5)
    v_smfmac_f32_16x16x64_bf16 v[112:115], v[104:107], v[64:71], v1
    ds_read_b128 v[52:55], v8 offset:7168
    v_smfmac_f32_16x16x64_bf16 v[116:119], v[96:99], a[224:231], v1
    ds_read_b128 v[56:59], v8 offset:11264
    v_smfmac_f32_16x16x64_bf16 v[116:119], v[100:103], a[232:239], v1
    ds_read_b128 v[60:63], v8 offset:15360
    v_cvt_pk_bf16_f32 v112, v112, v114
    v_and_or_b32 v112, v112, -2, s51
    v_smfmac_f32_16x16x64_bf16 v[116:119], v[104:107], a[240:247], v1
    global_store_dword v2, v112, s[8:9] offset:-4096
    v_cvt_pk_bf16_f32 v113, v113, v115
    v_and_or_b32 v113, v113, -2, s51
    v_smfmac_f32_16x16x64_bf16 v[84:87], v[96:99], v[32:39], v1
    global_store_dword v2, v113, s[10:11] offset:-4096
    ds_read_b128 v[64:67], v8 offset:19456
    v_smfmac_f32_16x16x64_bf16 v[84:87], v[100:103], v[16:23], v1
    ds_read_b128 v[68:71], v8 offset:23552
    s_waitcnt lgkmcnt(8)
    v_cvt_pk_bf16_f32 v116, v116, v118
    v_and_or_b32 v116, v116, -2, s51
    v_smfmac_f32_16x16x64_bf16 v[84:87], v[104:107], v[40:47], v1
    global_store_dword v2, v116, s[8:9] offset:-2048
    s_waitcnt lgkmcnt(6)
    v_cvt_pk_bf16_f32 v117, v117, v119
    v_and_or_b32 v117, v117, -2, s51
    v_smfmac_f32_16x16x64_bf16 v[92:95], v[108:111], v[72:79], v1
    global_store_dword v2, v117, s[10:11] offset:-2048
    s_waitcnt lgkmcnt(4)
    v_smfmac_f32_16x16x64_bf16 v[92:95], v[96:99], v[48:55], v1
    s_waitcnt lgkmcnt(2)
    v_cvt_pk_bf16_f32 v84, v84, v86
    v_and_or_b32 v84, v84, -2, s51
    v_smfmac_f32_16x16x64_bf16 v[92:95], v[100:103], v[56:63], v1
    global_store_dword v2, v84, s[8:9] offset:0
    s_waitcnt lgkmcnt(0)
    v_cvt_pk_bf16_f32 v85, v85, v87
    v_and_or_b32 v85, v85, -2, s51
    v_smfmac_f32_16x16x64_bf16 v[92:95], v[104:107], v[64:71], v1
    global_store_dword v2, v85, s[10:11] offset:0
    s_nop 0
    v_mov_b64 v[96:97], 0
    v_mov_b64 v[98:99], 0
    v_mov_b64 v[100:101], 0
    v_mov_b64 v[102:103], 0
    v_mov_b64 v[104:105], 0
    v_mov_b64 v[106:107], 0
    v_cvt_pk_bf16_f32 v92, v92, v94
    v_and_or_b32 v92, v92, -2, s51
    v_cvt_pk_bf16_f32 v93, v93, v95
    v_and_or_b32 v93, v93, -2, s51
    v_mov_b64 v[108:109], 0
    s_add_u32 s12, s12, 4096
    s_addc_u32 s13, s13, 0
    s_add_u32 s34, s34, 1
    global_store_dword v2, v92, s[8:9] offset:2048
    global_store_dword v2, v93, s[10:11] offset:2048
    v_mov_b64 v[110:111], 0
    s_add_u32 s44, s44, 16384
    s_addc_u32 s45, s45, 0
    s_add_u32 s46, s46, 16384
    s_addc_u32 s47, s47, 0
    s_xor_b32 s40, s40, 65536
    v_mov_b64 v[112:113], 0
    s_nop 4
    v_mov_b64 v[114:115], 0
    s_nop 4
    v_mov_b64 v[116:117], 0
    s_nop 4
    v_mov_b64 v[118:119], 0
    s_nop 4
    v_mov_b64 v[86:87], 0
    s_nop 4
    v_mov_b64 v[94:95], 0
    s_nop 4
    v_mov_b32 v10, 0
    s_nop 4
    v_mov_b32 v10, 0
    s_nop 4
    v_mov_b32 v10, 0
    global_load_dword v120, v9, s[36:37] offset:0 sc1
    global_load_dword v121, v9, s[36:37] offset:256 sc1
    global_load_dword v122, v9, s[36:37] offset:512 sc1
    global_load_dword v123, v9, s[36:37] offset:768 sc1
    global_load_dword v124, v9, s[36:37] offset:1024 sc1
    global_load_dword v125, v9, s[36:37] offset:1280 sc1
    global_load_dword v126, v9, s[36:37] offset:1536 sc1
    global_load_dword v127, v9, s[36:37] offset:1792 sc1
    v_mov_b32 v10, 0
    s_nop 4
    v_mov_b32 v10, 0
    s_nop 0
    global_load_dword v120, v9, s[36:37] offset:0 sc1
    global_load_dword v121, v9, s[36:37] offset:256 sc1
    global_load_dword v122, v9, s[36:37] offset:512 sc1
    global_load_dword v123, v9, s[36:37] offset:768 sc1
    global_load_dword v124, v9, s[36:37] offset:1024 sc1
    global_load_dword v125, v9, s[36:37] offset:1280 sc1
    global_load_dword v126, v9, s[36:37] offset:1536 sc1
    global_load_dword v127, v9, s[36:37] offset:1792 sc1
    ds_read_b128 v[48:51], v8 offset:1024
    ds_read_b128 v[52:55], v8 offset:5120
    v_mov_b32 v10, 0
    s_nop 1
    ds_read_b128 v[56:59], v8 offset:9216
    ds_read_b128 v[60:63], v8 offset:13312
    v_mov_b32 v10, 0
    s_nop 1
    ds_read_b128 v[64:67], v8 offset:17408
    ds_read_b128 v[68:71], v8 offset:21504
    v_mov_b32 v10, 0
    s_nop 1
    ds_read_b128 v[72:75], v8 offset:25600
    ds_read_b128 v[76:79], v8 offset:29696
    v_mov_b32 v10, 0
    s_nop 1
    s_cmp_eq_u32 s51, 0
    s_cbranch_scc1 L_tag0_254
    s_waitcnt vmcnt(12)
    v_bitop3_b32 v10, v120, v121, v122 bitop3:0x80
    v_bitop3_b32 v10, v10, v123, 1 bitop3:0x80
    v_mfma_f32_16x16x32_bf16 v[32:35], v[12:15], v[120:123], 0
    s_waitcnt vmcnt(8)
    v_bitop3_b32 v10, v10, v124, v125 bitop3:0x80
    v_bitop3_b32 v10, v10, v126, v127 bitop3:0x80
    v_mfma_f32_16x16x32_bf16 v[32:35], v[12:15], v[124:127], v[32:35]
    s_nop 0
    v_cmp_ne_u32 vcc, 1, v10
    s_nop 0
    s_mov_b64 exec, s[26:27]
    s_nop 2
    s_cbranch_vccnz L_h1n_256
    v_cvt_pk_bf16_f32 v11, v32, v33
    global_store_dword v3, v11, s[42:43] offset:0
    s_mov_b64 exec, -1
    s_branch L_step_243
L_h1n_256:
    s_mov_b64 exec, -1
    global_load_dword v120, v9, s[36:37] offset:0 sc1
    global_load_dword v121, v9, s[36:37] offset:256 sc1
    global_load_dword v122, v9, s[36:37] offset:512 sc1
    global_load_dword v123, v9, s[36:37] offset:768 sc1
    global_load_dword v124, v9, s[36:37] offset:1024 sc1
    global_load_dword v125, v9, s[36:37] offset:1280 sc1
    global_load_dword v126, v9, s[36:37] offset:1536 sc1
    global_load_dword v127, v9, s[36:37] offset:1792 sc1
    s_waitcnt vmcnt(12)
    v_bitop3_b32 v10, v120, v121, v122 bitop3:0x80
    v_bitop3_b32 v10, v10, v123, 1 bitop3:0x80
    v_mfma_f32_16x16x32_bf16 v[32:35], v[12:15], v[120:123], 0
    s_waitcnt vmcnt(8)
    v_bitop3_b32 v10, v10, v124, v125 bitop3:0x80
    v_bitop3_b32 v10, v10, v126, v127 bitop3:0x80
    v_mfma_f32_16x16x32_bf16 v[32:35], v[12:15], v[124:127], v[32:35]
    s_nop 0
    v_cmp_ne_u32 vcc, 1, v10
    s_nop 0
    s_mov_b64 exec, s[26:27]
    s_nop 2
    s_cbranch_vccnz L_h1r_255
    v_cvt_pk_bf16_f32 v11, v32, v33
    global_store_dword v3, v11, s[42:43] offset:0
    s_mov_b64 exec, -1
    s_branch L_step_243
L_h1r_255:
    s_mov_b64 exec, -1
    global_load_dword v120, v9, s[36:37] offset:0 sc1
    global_load_dword v121, v9, s[36:37] offset:256 sc1
    global_load_dword v122, v9, s[36:37] offset:512 sc1
    global_load_dword v123, v9, s[36:37] offset:768 sc1
    global_load_dword v124, v9, s[36:37] offset:1024 sc1
    global_load_dword v125, v9, s[36:37] offset:1280 sc1
    global_load_dword v126, v9, s[36:37] offset:1536 sc1
    global_load_dword v127, v9, s[36:37] offset:1792 sc1
    s_sub_u32 s50, s50, 1
    s_cselect_b64 s[48:49], 0, s[48:49]
    s_waitcnt vmcnt(8)
    v_bitop3_b32 v10, v120, v121, v122 bitop3:0x80
    v_bitop3_b32 v10, v10, v123, 1 bitop3:0x80
    v_mfma_f32_16x16x32_bf16 v[32:35], v[12:15], v[120:123], 0
    s_nop 0
    v_bitop3_b32 v10, v10, v124, v125 bitop3:0x80
    v_bitop3_b32 v10, v10, v126, v127 bitop3:0x80
    v_mfma_f32_16x16x32_bf16 v[32:35], v[12:15], v[124:127], v[32:35]
    s_nop 0
    v_cmp_ne_u32 vcc, 1, v10
    s_nop 0
    s_mov_b64 exec, s[26:27]
    s_nop 1
    s_and_b64 vcc, vcc, s[48:49]
    s_cbranch_scc1 L_h1r_255
    v_cvt_pk_bf16_f32 v11, v32, v33
    global_store_dword v3, v11, s[42:43] offset:0
    s_mov_b64 exec, -1
    s_branch L_step_243
L_tag0_254:
    s_waitcnt vmcnt(12)
    v_bitop3_b32 v10, v120, v121, v122 bitop3:0x01
    v_bitop3_b32 v10, v10, v123, 1 bitop3:0x20
    v_mfma_f32_16x16x32_bf16 v[32:35], v[12:15], v[120:123], 0
    s_waitcnt vmcnt(8)
    v_bitop3_b32 v10, v10, v124, v125 bitop3:0x10
    v_bitop3_b32 v10, v10, v126, v127 bitop3:0x10
    v_mfma_f32_16x16x32_bf16 v[32:35], v[12:15], v[124:127], v[32:35]
    s_nop 0
    v_cmp_ne_u32 vcc, 1, v10
    s_nop 0
    s_mov_b64 exec, s[26:27]
    s_nop 2
    s_cbranch_vccnz L_h1n_258
    v_cvt_pk_bf16_f32 v11, v32, v33
    global_store_dword v3, v11, s[42:43] offset:0
    s_mov_b64 exec, -1
    s_branch L_step_243
L_h1n_258:
    s_mov_b64 exec, -1
    global_load_dword v120, v9, s[36:37] offset:0 sc1
    global_load_dword v121, v9, s[36:37] offset:256 sc1
    global_load_dword v122, v9, s[36:37] offset:512 sc1
    global_load_dword v123, v9, s[36:37] offset:768 sc1
    global_load_dword v124, v9, s[36:37] offset:1024 sc1
    global_load_dword v125, v9, s[36:37] offset:1280 sc1
    global_load_dword v126, v9, s[36:37] offset:1536 sc1
    global_load_dword v127, v9, s[36:37] offset:1792 sc1
    s_waitcnt vmcnt(12)
    v_bitop3_b32 v10, v120, v121, v122 bitop3:0x01
    v_bitop3_b32 v10, v10, v123, 1 bitop3:0x20
    v_mfma_f32_16x16x32_bf16 v[32:35], v[12:15], v[120:123], 0
    s_waitcnt vmcnt(8)
    v_bitop3_b32 v10, v10, v124, v125 bitop3:0x10
    v_bitop3_b32 v10, v10, v126, v127 bitop3:0x10
    v_mfma_f32_16x16x32_bf16 v[32:35], v[12:15], v[124:127], v[32:35]
    s_nop 0
    v_cmp_ne_u32 vcc, 1, v10
    s_nop 0
    s_mov_b64 exec, s[26:27]
    s_nop 2
    s_cbranch_vccnz L_h1r_257
    v_cvt_pk_bf16_f32 v11, v32, v33
    global_store_dword v3, v11, s[42:43] offset:0
    s_mov_b64 exec, -1
    s_branch L_step_243
L_h1r_257:
    s_mov_b64 exec, -1
    global_load_dword v120, v9, s[36:37] offset:0 sc1
    global_load_dword v121, v9, s[36:37] offset:256 sc1
    global_load_dword v122, v9, s[36:37] offset:512 sc1
    global_load_dword v123, v9, s[36:37] offset:768 sc1
    global_load_dword v124, v9, s[36:37] offset:1024 sc1
    global_load_dword v125, v9, s[36:37] offset:1280 sc1
    global_load_dword v126, v9, s[36:37] offset:1536 sc1
    global_load_dword v127, v9, s[36:37] offset:1792 sc1
    s_sub_u32 s50, s50, 1
    s_cselect_b64 s[48:49], 0, s[48:49]
    s_waitcnt vmcnt(8)
    v_bitop3_b32 v10, v120, v121, v122 bitop3:0x01
    v_bitop3_b32 v10, v10, v123, 1 bitop3:0x20
    v_mfma_f32_16x16x32_bf16 v[32:35], v[12:15], v[120:123], 0
    s_nop 0
    v_bitop3_b32 v10, v10, v124, v125 bitop3:0x10
    v_bitop3_b32 v10, v10, v126, v127 bitop3:0x10
    v_mfma_f32_16x16x32_bf16 v[32:35], v[12:15], v[124:127], v[32:35]
    s_nop 0
    v_cmp_ne_u32 vcc, 1, v10
    s_nop 0
    s_mov_b64 exec, s[26:27]
    s_nop 1
    s_and_b64 vcc, vcc, s[48:49]
    s_cbranch_scc1 L_h1r_257
    v_cvt_pk_bf16_f32 v11, v32, v33
    global_store_dword v3, v11, s[42:43] offset:0
    s_mov_b64 exec, -1
    s_branch L_step_243
L_last_252:
    v_add_u32 v10, 30560, v9
    ds_read2_b32 v[124:125], v10 offset0:0 offset1:68
    s_add_u32 s12, s12, 4096
    s_addc_u32 s13, s13, 0
    global_store_dword v9, v82, s[12:13] offset:3584 sc1
    global_store_dword v9, v90, s[12:13] offset:3840 sc1
    s_waitcnt lgkmcnt(0)
    global_store_dword v9, v124, s[12:13] offset:1536 sc1
    global_store_dword v9, v125, s[12:13] offset:1792 sc1
    s_cmp_eq_u32 s34, 63
    s_cbranch_scc1 L_exit_244
    s_sub_u32 s12, s12, 4096
    s_subb_u32 s13, s13, 0
    s_getpc_b64 s[64:65]
L_pc_259:
    s_add_u32 s64, s64, L_fin_3-L_pc_259
    s_addc_u32 s65, s65, 0
    v_lshlrev_b32 v126, 2, v0
    v_min_u32 v126, L_code_end-L_fin_3-4, v126
    global_load_dword v127, v126, s[64:65]
    s_branch L_lastb_253
L_h2a_247:
    global_load_dwordx4 v[16:19], v0, s[40:41] offset:-2048 sc1
    global_load_dwordx4 v[20:23], v0, s[40:41] offset:2048 sc1
    s_nop 4
    v_mov_b64 v[96:97], 0
    v_mov_b64 v[98:99], 0
    v_mov_b64 v[100:101], 0
    v_mov_b64 v[102:103], 0
    s_waitcnt vmcnt(3)
    v_maximum3_f32 v11, v16, v17, v18
    v_cmp_u_f32 vcc, v11, v19
    v_smfmac_f32_16x16x64_bf16 v[96:99], v[16:19], v[48:55], v1
    ds_write_b128 v0, v[16:19] offset:19456
    v_smfmac_f32_16x16x64_bf16 v[100:103], v[16:19], v[56:63], v1
    s_cbranch_vccz L_h2cc_251
L_h2l2_260:
    global_load_dwordx4 v[16:19], v0, s[40:41] offset:-2048 sc1
    global_load_dwordx4 v[20:23], v0, s[40:41] offset:2048 sc1
    s_sub_u32 s2, s2, 1
    s_cselect_b64 s[38:39], 0, s[38:39]
    s_nop 2
    v_mov_b64 v[96:97], 0
    v_mov_b64 v[98:99], 0
    v_mov_b64 v[100:101], 0
    v_mov_b64 v[102:103], 0
    s_waitcnt vmcnt(3)
    v_maximum3_f32 v11, v16, v17, v18
    v_cmp_u_f32 vcc, v11, v19
    v_smfmac_f32_16x16x64_bf16 v[96:99], v[16:19], v[48:55], v1
    ds_write_b128 v0, v[16:19] offset:19456
    v_smfmac_f32_16x16x64_bf16 v[100:103], v[16:19], v[56:63], v1
    s_and_b64 vcc, vcc, s[38:39]
    s_cbranch_scc0 L_h2cc_251
    s_branch L_h2l2_260
    global_load_dwordx4 v[16:19], v0, s[40:41] offset:-2048 sc1
    global_load_dwordx4 v[20:23], v0, s[40:41] offset:2048 sc1
    s_sub_u32 s2, s2, 1
    s_cselect_b64 s[38:39], 0, s[38:39]
    s_cmp_eq_u64 s[38:39], 0
    s_cbranch_scc1 L_h2cc_251
    s_nop 2
    v_mov_b64 v[96:97], 0
    v_mov_b64 v[98:99], 0
    v_mov_b64 v[100:101], 0
    v_mov_b64 v[102:103], 0
    s_waitcnt vmcnt(3)
    s_branch L_h2ca_249
L_h2b_248:
    global_load_dwordx4 v[20:23], v0, s[40:41] offset:2048 sc1
    s_sub_u32 s2, s2, 1
    s_cselect_b64 s[38:39], 0, s[38:39]
    s_waitcnt vmcnt(1)
    v_maximum3_f32 v11, v20, v21, v22
    v_cmp_u_f32 vcc, v11, v23
    s_and_b64 vcc, vcc, s[38:39]
    s_cbranch_scc0 L_h2cb_250
    s_branch L_h2b_248
L_exit_244:
L_done_224:
L_fin_3:
    s_nop 9
    global_load_dwordx4 v[16:19], v0, s[40:41] offset:-2048 sc1
    global_load_dwordx4 v[20:23], v0, s[40:41] offset:2048 sc1
    v_lshrrev_b32 v80, 4, v0
    v_and_b32 v81, 15, v80
    v_lshrrev_b32 v82, 4, v80
    v_lshrrev_b32 v83, 2, v80
    v_and_b32 v84, 3, v80
    v_and_b32 v85, 3, v83
    v_add_u32 v86, 16, v81
    v_lshlrev_b32 v87, 2, v82
    v_sub_u32 v86, v86, v87
    v_cmp_le_i32 s[72:73], 0, v86
    v_cmp_le_i32 s[74:75], 1, v86
    v_cmp_le_i32 s[76:77], 2, v86
    v_cmp_le_i32 s[78:79], 3, v86
    v_cmp_le_i32 s[80:81], 16, v86
    v_cmp_le_i32 s[82:83], 17, v86
    v_cmp_le_i32 s[84:85], 18, v86
    v_cmp_le_i32 s[86:87], 19, v86
    s_mul_i32 s62, s32, 532480
    s_add_u32 s62, s62, 51900416
    s_add_u32 s88, s4, s62
    s_addc_u32 s89, s5, 0
    global_load_dwordx4 v[16:19], v0, s[40:41] offset:-2048 sc1
    global_load_dwordx4 v[20:23], v0, s[40:41] offset:2048 sc1
    s_lshl_b32 s62, s32, 11
    s_add_u32 s62, s62, 100533248
    s_add_u32 s90, s4, s62
    s_addc_u32 s91, s5, 0
    ds_read_b128 v[224:227], v0 offset:12288
    ds_read_b128 v[228:231], v0 offset:13312
    ds_read_b128 v[232:235], v0 offset:14336
    ds_read_b128 v[236:239], v0 offset:15360
    s_waitcnt vmcnt(2)
L_fp_261:
    v_maximum3_f32 v10, v16, v17, v18
    v_maximum3_f32 v10, v10, v19, v20
    v_maximum3_f32 v10, v10, v21, v22
    v_cmp_u_f32 vcc, v10, v23
    ds_write_b128 v0, v[16:19] offset:19456
    ds_write_b128 v0, v[20:23] offset:23552
    s_and_b64 vcc, vcc, s[38:39]
    s_cbranch_scc0 L_fo_262
    global_load_dwordx4 v[16:19], v0, s[40:41] offset:-2048 sc1
    global_load_dwordx4 v[20:23], v0, s[40:41] offset:2048 sc1
    s_sub_u32 s2, s2, 1
    s_cselect_b64 s[38:39], 0, s[38:39]
    s_waitcnt vmcnt(2)
    s_branch L_fp_261
L_fo_262:
    v_smfmac_f32_16x16x64_bf16 v[104:107], v[16:19], v[64:71], v1
    v_bfe_u32 v86, v81, 2, 1
    v_smfmac_f32_16x16x64_bf16 v[108:111], v[16:19], v[72:79], v1
    v_mul_u32_u24 v120, 4096, v86
    v_smfmac_f32_16x16x64_bf16 v[112:115], v[16:19], a[144:151], v1
    v_bfe_u32 v86, v82, 0, 2
    v_smfmac_f32_16x16x64_bf16 v[116:119], v[16:19], a[152:159], v1
    v_mul_u32_u24 v86, 256, v86
    v_smfmac_f32_16x16x64_bf16 v[104:107], v[20:23], a[80:87], v1
    v_add_u32 v120, v120, v86
    v_smfmac_f32_16x16x64_bf16 v[108:111], v[20:23], a[88:95], v1
    s_waitcnt lgkmcnt(0)
    s_barrier
    ds_read_b128 v[24:27], v0 offset:16384
    v_smfmac_f32_16x16x64_bf16 v[112:115], v[20:23], a[208:215], v1
    global_load_dwordx4 v[128:131], v0, s[88:89] offset:0 sc1
    ds_read_b128 v[28:31], v0 offset:17408
    v_smfmac_f32_16x16x64_bf16 v[116:119], v[20:23], a[216:223], v1
    global_load_dwordx4 v[132:135], v0, s[88:89] offset:1024 sc1
    ds_read_b128 v[32:35], v0 offset:18432
    s_waitcnt lgkmcnt(2)
    v_smfmac_f32_16x16x64_bf16 v[104:107], v[24:27], v[208:215], v1
    global_load_dwordx4 v[136:139], v0, s[88:89] offset:2048 sc1
    ds_read_b128 v[36:39], v0 offset:20480
    v_bfe_u32 v86, v81, 3, 1
    v_smfmac_f32_16x16x64_bf16 v[108:111], v[24:27], v[216:223], v1
    global_load_dwordx4 v[140:143], v0, s[88:89] offset:3072 sc1
    ds_read_b128 v[40:43], v0 offset:21504
    v_mul_u32_u24 v86, 64, v86
    v_smfmac_f32_16x16x64_bf16 v[112:115], v[24:27], a[96:103], v1
    ds_read_b128 v[44:47], v0 offset:22528
    v_add_u32 v120, v120, v86
    v_smfmac_f32_16x16x64_bf16 v[116:119], v[24:27], a[104:111], v1
    s_waitcnt lgkmcnt(4)
    v_bfe_u32 v86, v81, 0, 2
    v_smfmac_f32_16x16x64_bf16 v[104:107], v[28:31], v[144:151], v1
    v_mul_u32_u24 v86, 16, v86
    v_smfmac_f32_16x16x64_bf16 v[108:111], v[28:31], v[152:159], v1
    v_add_u32 v120, v120, v86
    v_smfmac_f32_16x16x64_bf16 v[112:115], v[28:31], a[112:119], v1
    v_bfe_u32 v86, v82, 0, 1
    v_smfmac_f32_16x16x64_bf16 v[116:119], v[28:31], a[120:127], v1
    s_waitcnt lgkmcnt(0)
    v_mul_u32_u24 v121, 128, v86
    v_smfmac_f32_16x16x64_bf16 v[104:107], v[32:35], v[176:183], v1
    ds_read_b128 v[160:163], v120 offset:0
    v_bfe_u32 v86, v82, 1, 1
    v_smfmac_f32_16x16x64_bf16 v[108:111], v[32:35], v[184:191], v1
    ds_read_b128 v[164:167], v120 offset:1024
    v_mul_u32_u24 v86, 64, v86
    v_smfmac_f32_16x16x64_bf16 v[112:115], v[32:35], a[128:135], v1
    ds_read_b128 v[168:171], v120 offset:2048
    v_add_u32 v121, v121, v86
    v_smfmac_f32_16x16x64_bf16 v[116:119], v[32:35], a[136:143], v1
    ds_read_b128 v[172:175], v120 offset:3072
    v_bfe_u32 v86, v81, 0, 4
    v_smfmac_f32_16x16x64_bf16 v[104:107], v[36:39], v[240:247], v1
    ds_read_b128 v[192:195], v120 offset:128
    v_mul_u32_u24 v86, 4, v86
    v_smfmac_f32_16x16x64_bf16 v[108:111], v[36:39], v[248:255], v1
    ds_read_b128 v[196:199], v120 offset:1152
    v_add_u32 v121, v121, v86
    v_smfmac_f32_16x16x64_bf16 v[112:115], v[36:39], a[160:167], v1
    ds_read_b128 v[200:203], v120 offset:2176
    v_bfe_u32 v86, v81, 3, 1
    v_smfmac_f32_16x16x64_bf16 v[116:119], v[36:39], a[168:175], v1
    ds_read_b128 v[204:207], v120 offset:3200
    v_mul_u32_u24 v122, 65536, v86
    v_smfmac_f32_16x16x64_bf16 v[104:107], v[40:43], a[16:23], v1
    v_bfe_u32 v86, v82, 0, 2
    v_smfmac_f32_16x16x64_bf16 v[108:111], v[40:43], a[24:31], v1
    v_mul_u32_u24 v86, 256, v86
    v_smfmac_f32_16x16x64_bf16 v[112:115], v[40:43], a[176:183], v1
    v_add_u32 v122, v122, v86
    v_smfmac_f32_16x16x64_bf16 v[116:119], v[40:43], a[184:191], v1
    v_bfe_u32 v86, v81, 0, 3
    v_smfmac_f32_16x16x64_bf16 v[104:107], v[44:47], a[48:55], v1
    v_mul_u32_u24 v86, 16, v86
    v_smfmac_f32_16x16x64_bf16 v[108:111], v[44:47], a[56:63], v1
    v_add_u32 v122, v122, v86
    v_smfmac_f32_16x16x64_bf16 v[112:115], v[44:47], a[192:199], v1
    v_mov_b32 v123, 0xd028965f
    v_smfmac_f32_16x16x64_bf16 v[116:119], v[44:47], a[200:207], v1
    s_nop 0
    v_add_f32 v104, v104, v106
    v_add_f32 v105, v105, v107
    v_add_f32 v108, v108, v110
    v_add_f32 v109, v109, v111
    v_cvt_pk_bf16_f32 v10, v104, v108
    v_cvt_pk_bf16_f32 v11, v105, v109
    ds_write2_b32 v5, v10, v11 offset0:0 offset1:4
    v_pk_add_f32 v[112:113], v[112:113], v[114:115]
    v_cvt_pk_bf16_f32 v112, v112, v113
    v_pk_add_f32 v[116:117], v[116:117], v[118:119]
    v_cvt_pk_bf16_f32 v116, v116, v117
    ds_write_b32 v9, v112 offset:26112
    ds_write_b32 v9, v116 offset:26368
    s_waitcnt vmcnt(0) lgkmcnt(3)
    v_mfma_f32_16x16x32_bf16 v[48:51], v[160:163], v[128:131], 0
    v_mov_b64 v[56:57], 0
    v_mov_b64 v[58:59], 0
    v_mfma_f32_16x16x32_bf16 v[48:51], v[164:167], v[132:135], v[48:51]
    v_mov_b64 v[72:73], s[54:55]
    v_mov_b64 v[74:75], s[54:55]
    v_mfma_f32_16x16x32_bf16 v[48:51], v[168:171], v[136:139], v[48:51]
    v_mov_b64 v[80:81], 0
    v_mov_b64 v[82:83], 0
    v_mfma_f32_16x16x32_bf16 v[48:51], v[172:175], v[140:143], v[48:51]
    v_mov_b64 v[84:85], 0
    v_mov_b64 v[86:87], 0
    v_mfma_f32_16x16x32_bf16 v[52:55], v[192:195], v[128:131], 0
    s_waitcnt lgkmcnt(0)
    s_barrier
    ds_read_b128 v[40:43], v7 offset:0
    ds_read_b128 v[44:47], v7 offset:1088
    v_mfma_f32_16x16x32_bf16 v[52:55], v[196:199], v[132:135], v[52:55]
    ds_read_b32 v80, v121 offset:25600
    ds_read_b32 v82, v121 offset:25856
    ds_read_b32 v84, v121 offset:26112
    ds_read_b32 v86, v121 offset:26368
    v_mfma_f32_16x16x32_bf16 v[52:55], v[200:203], v[136:139], v[52:55]
    v_mov_b64 v[64:65], 0
    v_mfma_f32_16x16x32_bf16 v[52:55], v[204:207], v[140:143], v[52:55]
    v_cndmask_b32 v48, v123, v48, s[72:73]
    v_cndmask_b32 v49, v123, v49, s[74:75]
    v_cndmask_b32 v50, v123, v50, s[76:77]
    v_cndmask_b32 v51, v123, v51, s[78:79]
    s_waitcnt lgkmcnt(4)
    v_smfmac_f32_16x16x64_bf16 v[56:59], v[40:43], v[128:135], v1
    v_smfmac_f32_16x16x64_bf16 v[56:59], v[44:47], v[136:143], v1
    v_cndmask_b32 v52, v123, v52, s[80:81]
    v_cndmask_b32 v53, v123, v53, s[82:83]
    v_cndmask_b32 v54, v123, v54, s[84:85]
    v_cndmask_b32 v55, v123, v55, s[86:87]
    v_max3_f32 v10, v48, v49, v50
    v_max3_f32 v10, v10, v51, v52
    v_max3_f32 v10, v10, v53, v54
    v_max_f32 v10, v10, v55
    v_pk_add_f32 v[56:57], v[56:57], v[58:59]
    v_max3_f32 v10, v10, v56, v57
    v_mov_b32 v11, v10
    s_nop 1
    v_permlane32_swap_b32 v10, v11
    v_max_f32 v10, v10, v11
    v_mov_b32 v11, v10
    s_nop 1
    v_permlane16_swap_b32 v10, v11
    v_max_f32 v10, v10, v11
    v_mul_f32 v10, s61, v10
    v_pk_fma_f32 v[48:49], v[48:49], s[58:59], v[10:11] op_sel_hi:[1,1,0]
    v_pk_fma_f32 v[50:51], v[50:51], s[58:59], v[10:11] op_sel_hi:[1,1,0]
    v_pk_fma_f32 v[52:53], v[52:53], s[58:59], v[10:11] op_sel_hi:[1,1,0]
    v_pk_fma_f32 v[54:55], v[54:55], s[58:59], v[10:11] op_sel_hi:[1,1,0]
    v_pk_fma_f32 v[56:57], v[56:57], s[58:59], v[10:11] op_sel_hi:[1,1,0]
    v_exp_f32 v48, v48
    v_exp_f32 v49, v49
    v_exp_f32 v50, v50
    v_exp_f32 v51, v51
    v_exp_f32 v52, v52
    v_exp_f32 v53, v53
    v_exp_f32 v54, v54
    v_exp_f32 v55, v55
    v_exp_f32 v56, v56
    v_exp_f32 v57, v57
    v_cvt_pk_bf16_f32 v60, v48, v49
    v_cvt_pk_bf16_f32 v61, v50, v51
    v_cvt_pk_bf16_f32 v62, v52, v53
    v_cvt_pk_bf16_f32 v63, v54, v55
    v_cvt_pk_bf16_f32 v64, v56, v57
    s_waitcnt lgkmcnt(0)
    s_nop 0
    v_mfma_f32_16x16x32_bf16 v[68:71], v[72:75], v[60:63], 0
    v_mfma_f32_16x16x32_bf16 v[24:27], v[224:227], v[60:63], 0
    v_mfma_f32_16x16x32_bf16 v[28:31], v[228:231], v[60:63], 0
    v_mfma_f32_16x16x32_bf16 v[32:35], v[232:235], v[60:63], 0
    v_mfma_f32_16x16x32_bf16 v[36:39], v[236:239], v[60:63], 0
    v_mfma_f32_16x16x16_bf16 v[68:71], v[72:73], v[64:65], v[68:71]
    v_mfma_f32_16x16x16_bf16 v[24:27], v[80:81], v[64:65], v[24:27]
    v_mfma_f32_16x16x16_bf16 v[28:31], v[82:83], v[64:65], v[28:31]
    v_mfma_f32_16x16x16_bf16 v[32:35], v[84:85], v[64:65], v[32:35]
    v_mfma_f32_16x16x16_bf16 v[36:39], v[86:87], v[64:65], v[36:39]
    v_rcp_f32 v68, v68
    s_nop 0
    v_mul_f32 v24, v24, v68
    v_mul_f32 v25, v25, v68
    v_cvt_pk_bf16_f32 v48, v24, v25
    v_mul_f32 v26, v26, v68
    v_mul_f32 v27, v27, v68
    v_cvt_pk_bf16_f32 v49, v26, v27
    v_mul_f32 v28, v28, v68
    v_mul_f32 v29, v29, v68
    v_cvt_pk_bf16_f32 v50, v28, v29
    v_mul_f32 v30, v30, v68
    v_mul_f32 v31, v31, v68
    v_cvt_pk_bf16_f32 v51, v30, v31
    global_store_dwordx4 v122, v[48:51], s[90:91] offset:0 sc1
    v_mul_f32 v32, v32, v68
    v_mul_f32 v33, v33, v68
    v_cvt_pk_bf16_f32 v52, v32, v33
    v_mul_f32 v34, v34, v68
    v_mul_f32 v35, v35, v68
    v_cvt_pk_bf16_f32 v53, v34, v35
    v_mul_f32 v36, v36, v68
    v_mul_f32 v37, v37, v68
    v_cvt_pk_bf16_f32 v54, v36, v37
    v_mul_f32 v38, v38, v68
    v_mul_f32 v39, v39, v68
    v_cvt_pk_bf16_f32 v55, v38, v39
    global_store_dwordx4 v122, v[52:55], s[90:91] offset:128 sc1
    s_lshr_b32 s63, s32, 3
    s_mul_i32 s63, s63, 96
    s_lshl_b32 s62, s32, 2
    s_add_u32 s62, s62, s63
    s_add_u32 s62, s62, 130048
    s_add_u32 s88, s4, s62
    s_addc_u32 s89, s5, 0
    v_lshlrev_b32 v10, 5, v0
    v_mov_b32 v11, 1
    s_waitcnt vmcnt(0)
    s_barrier
    s_endpgm
L_code_end:
.section .rodata,"a"
.p2align 6
.amdhsa_kernel concat_heads__linear_kernel_hedgehog__memory_aug_recurrent_mem_tr__prompt_kernel
  .amdhsa_next_free_vgpr 512
  .amdhsa_next_free_sgpr 102
  .amdhsa_accum_offset 256
  .amdhsa_group_segment_fixed_size 0
  .amdhsa_kernarg_size 112
  .amdhsa_user_sgpr_count 2
  .amdhsa_user_sgpr_kernarg_segment_ptr 1
  .amdhsa_system_sgpr_workgroup_id_x 1
.end_amdhsa_kernel
```
